```python
import torch

def _softmax(x, axis=-1):
    return torch.softmax(x, dim=axis)

def _gelu(x):
    return torch.nn.functional.gelu(x, approximate='tanh')

def _silu(x):
    return torch.nn.functional.silu(x)

def _sigmoid(x):
    return torch.sigmoid(x)

def _layernorm(x, axis=-1, eps=1e-05):
    m = x.mean(dim=axis, keepdim=True)
    v = x.var(dim=axis, keepdim=True, unbiased=False)
    return (x - m) / torch.sqrt(v + eps)

def _scatter_add(tgt, idx, src, axis=0):
    return tgt.clone().index_add_(axis, idx, src)

def _segment_sum(src, seg, n):
    out = torch.zeros((n,) + src.shape[1:], dtype=src.dtype)
    return out.index_add_(0, seg, src)

def _pad(x, pw):
    flat = tuple((v for pair in reversed(pw) for v in pair))
    return torch.nn.functional.pad(x, flat)
kernel_name = 'adaLN_cond__mha_block_cached__mixer_s_mlp__prompt'

def setup_inputs():

    _w = lambda a: (lambda t: t.to(torch.bfloat16) if t.is_floating_point() else t)(torch.as_tensor(a))

    def _A_setup():
        B, Sq, D = (1, 2048, 512)
        H, Sk, Dh = (32, 2048, 128)
        return {'x': _w((lambda *s: torch.randn(*s, dtype=torch.bfloat16) * 0.1)(B, Sq, D)), 'k_cache': _w((lambda *s: torch.randn(*s, dtype=torch.bfloat16) * 0.8)(B, H, Sk, Dh)), 'v_cache': _w((lambda *s: torch.randn(*s, dtype=torch.bfloat16) * 0.8)(B, H, Sk, Dh)), 'wq': _w((lambda *s: torch.randn(*s, dtype=torch.bfloat16) * 0.8)(D, H * Dh) * D ** (-0.5)), 'wo': _w((lambda *s: torch.randn(*s, dtype=torch.bfloat16) * 0.8)(H * Dh, D) * (H * Dh) ** (-0.5))}
    _A_in = _A_setup()

    def _B_setup():
        B, S, D, F = (1, 2048, 512, 1792)
        return {'x': _w((lambda *s: torch.randn(*s, dtype=torch.bfloat16) * 0.1)(B, S, D)), 'w1': _w((lambda *s: torch.randn(*s, dtype=torch.bfloat16) * 3.2)(D, D) * D ** (-0.5)), 'w2': _w((lambda *s: torch.randn(*s, dtype=torch.bfloat16) * 3.2)(D, D) * D ** (-0.5)), 'w3': _w((lambda *s: torch.randn(*s, dtype=torch.bfloat16) * 3.2)(D, F) * D ** (-0.5)), 'w4': _w((lambda *s: torch.randn(*s, dtype=torch.bfloat16) * 3.2)(F, D) * F ** (-0.5))}
    _B_in = _B_setup()
    return {'A_x': _A_in['x'], 'A_k_cache': _A_in['k_cache'], 'A_v_cache': _A_in['v_cache'], 'A_wq': _A_in['wq'], 'A_wo': _A_in['wo'], 'B_x': _B_in['x'], 'B_w1': _B_in['w1'], 'B_w2': _B_in['w2'], 'B_w3': _B_in['w3'], 'B_w4': _B_in['w4'], 'c': _w((lambda *s: torch.randn(*s, dtype=torch.bfloat16) * 0.2)(1, 512) * 8.0), 'w_mod': _w((lambda *s: torch.randn(*s, dtype=torch.bfloat16) * 0.2)(512, 6 * 512) * 512 ** (-0.5) * 8.0)}

def reference(A_x, A_k_cache, A_v_cache, A_wq, A_wo, B_x, B_w1, B_w2, B_w3, B_w4, c, w_mod):

    def _A_ref(x, k_cache, v_cache, wq, wo):
        B, Sq, D = x.shape
        H, Dh = (32, 128)
        q = (lambda x, *d: x.permute(*d))((x @ wq).reshape(B, Sq, H, Dh), 0, 2, 1, 3)
        scores = torch.einsum('bhqd,bhkd->bhqk', q, k_cache) * Dh ** (-0.5)
        p = _softmax(scores, axis=-1)
        o = torch.einsum('bhqk,bhkd->bhqd', p, v_cache)
        return (lambda x, *d: x.permute(*d))(o, 0, 2, 1, 3).reshape(B, Sq, H * Dh) @ wo

    def _B_ref(x, w1, w2, w3, w4):
        B, S, D = x.shape
        h = _gelu(_layernorm(x, axis=-1) @ w1)
        c = D // 4
        g0 = _pad(h[:, :, 0 * c:1 * c], ((0, 0), (1, 0), (0, 0)))[:, :S, :]
        g1 = _pad(h[:, :, 1 * c:2 * c], ((0, 0), (0, 1), (0, 0)))[:, 1:, :]
        g2 = _pad(h[:, :, 2 * c:3 * c], ((0, 0), (2, 0), (0, 0)))[:, :S, :]
        g3 = _pad(h[:, :, 3 * c:], ((0, 0), (0, 2), (0, 0)))[:, 2:, :]
        hs = torch.concatenate([g0, g1, g2, g3], axis=-1) @ w2
        x1 = x + hs
        h2 = _gelu(_layernorm(x1, axis=-1) @ w3) @ w4
        return x1 + h2
    x = A_x
    mod = (_silu(c) @ w_mod).reshape(c.shape[0], 6, 1, -1)
    sa, ca, ga, sb, cb, gb = (mod[:, 0].clone(), mod[:, 1].clone(), mod[:, 2].clone(), mod[:, 3].clone(), mod[:, 4].clone(), mod[:, 5].clone())
    h = _layernorm(x, axis=-1) * (1 + ca) + sa
    x = x + ga * _A_ref(h, A_k_cache, A_v_cache, A_wq, A_wo)
    h = _layernorm(x, axis=-1) * (1 + cb) + sb
    x = x + gb * _B_ref(h, B_w1, B_w2, B_w3, B_w4)
    return x
```

```asm
; @launch kernel=k0_kernel grid=(308,1,1) block=(512,1,1) lds=20480
; @launch kernel=mega_kernel grid=(256,1,1) block=(256,1,1) lds=152576
.amdgcn_target "amdgcn-amd-amdhsa--gfx950"
.text
.globl k0_kernel
.p2align 8
.type k0_kernel,@function
k0_kernel:
    s_cmp_ge_u32 s2, 308
    s_cbranch_scc1 k0_kernel_end
    s_getpc_b64 s[56:57]
k0_kernel_self:
    s_add_u32 s56, s56, k0_kernel-k0_kernel_self
    s_addc_u32 s57, s57, -1
    s_and_b32 s57, s57, 0xffff
    s_mov_b32 s58, k0_kernel_end-k0_kernel
    s_mov_b32 s59, 0x20000
    v_lshlrev_b32 v1, 4, v0
    buffer_load_dwordx4 v[72:75], v1, s[56:59], 0 offen
    s_load_dwordx2 s[4:5], s[0:1], 112
    s_load_dwordx4 s[8:11], s[0:1], 80
    s_load_dwordx2 s[6:7], s[0:1], 64
    s_load_dwordx2 s[12:13], s[0:1], 0
    s_load_dwordx2 s[14:15], s[0:1], 24
    s_waitcnt lgkmcnt(0)
    s_cmp_ge_u32 s2, 204
    s_cbranch_scc1 k0_kernel_pf
    s_cmp_ge_u32 s2, 76
    s_cbranch_scc1 k0_kernel_xn
    s_mov_b32 s24, 3145728
    s_mov_b32 s25, 1835008
    s_mov_b32 s26, 6144
    s_mov_b32 s27, 3584
    s_sub_u32 s28, s2, 48
    s_cmp_lt_u32 s2, 48
    s_cselect_b32 s16, s10, s6
    s_cselect_b32 s17, s11, s7
    s_cselect_b32 s18, s24, s25
    s_cselect_b32 s29, s26, s27
    s_cselect_b32 s30, s2, s28
    s_cselect_b32 s31, 1, 0
    s_and_b32 s17, s17, 0xffff
    s_mov_b32 s19, 0x20000
    s_mov_b32 s20, s8
    s_and_b32 s21, s9, 0xffff
    s_mov_b32 s22, 1024
    s_mov_b32 s23, 0x20000
    v_and_b32 v1, 7, v0
    v_lshrrev_b32 v2, 3, v0
    s_lshl_b32 s33, s29, 3
    v_mul_lo_u32 v3, v2, s33
    v_lshl_add_u32 v3, v1, 4, v3
    s_lshl_b32 s34, s30, 7
    v_add_u32 v3, s34, v3
    v_lshlrev_b32 v4, 1, v0
    buffer_load_ushort v5, v4, s[20:23], 0 offen
    s_mov_b32 s35, 0
    buffer_load_dwordx4 v[16:19], v3, s[16:19], s35 offen
    s_add_u32 s35, s35, s29
    buffer_load_dwordx4 v[20:23], v3, s[16:19], s35 offen
    s_add_u32 s35, s35, s29
    buffer_load_dwordx4 v[24:27], v3, s[16:19], s35 offen
    s_add_u32 s35, s35, s29
    buffer_load_dwordx4 v[28:31], v3, s[16:19], s35 offen
    s_add_u32 s35, s35, s29
    buffer_load_dwordx4 v[32:35], v3, s[16:19], s35 offen
    s_add_u32 s35, s35, s29
    buffer_load_dwordx4 v[36:39], v3, s[16:19], s35 offen
    s_add_u32 s35, s35, s29
    buffer_load_dwordx4 v[40:43], v3, s[16:19], s35 offen
    s_add_u32 s35, s35, s29
    buffer_load_dwordx4 v[44:47], v3, s[16:19], s35 offen
    s_waitcnt vmcnt(8)
    v_lshlrev_b32 v6, 16, v5
    v_mul_f32 v8, 0xbfb8aa3b, v6
    v_exp_f32 v8, v8
    s_nop 0
    v_add_f32 v8, 1.0, v8
    v_rcp_f32 v8, v8
    s_nop 0
    v_mul_f32 v6, v6, v8
    v_cvt_pk_bf16_f32 v8, v6, v6
    v_lshlrev_b32 v6, 16, v8
    s_cmp_eq_u32 s31, 1
    s_cbranch_scc1 k0_kernel_havea
    v_mov_b32 v6, 1.0
k0_kernel_havea:
    v_lshlrev_b32 v4, 2, v0
    ds_write_b32 v4, v6
    s_waitcnt lgkmcnt(0)
    s_barrier
    v_lshlrev_b32 v4, 5, v2
    ds_read_b128 v[80:83], v4 offset:0
    ds_read_b128 v[84:87], v4 offset:16
    v_pk_mov_b32 v[96:97], 0, 0
    v_pk_mov_b32 v[98:99], 0, 0
    v_pk_mov_b32 v[100:101], 0, 0
    v_pk_mov_b32 v[102:103], 0, 0
    s_waitcnt lgkmcnt(0)
    s_waitcnt vmcnt(7)
    v_lshlrev_b32 v8, 16, v16
    v_and_b32 v9, 0xffff0000, v16
    v_pk_fma_f32 v[96:97], v[8:9], v[80:81], v[96:97] op_sel:[0,0,0] op_sel_hi:[1,0,1]
    v_lshlrev_b32 v10, 16, v17
    v_and_b32 v11, 0xffff0000, v17
    v_pk_fma_f32 v[98:99], v[10:11], v[80:81], v[98:99] op_sel:[0,0,0] op_sel_hi:[1,0,1]
    v_lshlrev_b32 v8, 16, v18
    v_and_b32 v9, 0xffff0000, v18
    v_pk_fma_f32 v[100:101], v[8:9], v[80:81], v[100:101] op_sel:[0,0,0] op_sel_hi:[1,0,1]
    v_lshlrev_b32 v10, 16, v19
    v_and_b32 v11, 0xffff0000, v19
    v_pk_fma_f32 v[102:103], v[10:11], v[80:81], v[102:103] op_sel:[0,0,0] op_sel_hi:[1,0,1]
    s_waitcnt vmcnt(6)
    v_lshlrev_b32 v8, 16, v20
    v_and_b32 v9, 0xffff0000, v20
    v_pk_fma_f32 v[96:97], v[8:9], v[80:81], v[96:97] op_sel:[0,1,0] op_sel_hi:[1,1,1]
    v_lshlrev_b32 v10, 16, v21
    v_and_b32 v11, 0xffff0000, v21
    v_pk_fma_f32 v[98:99], v[10:11], v[80:81], v[98:99] op_sel:[0,1,0] op_sel_hi:[1,1,1]
    v_lshlrev_b32 v8, 16, v22
    v_and_b32 v9, 0xffff0000, v22
    v_pk_fma_f32 v[100:101], v[8:9], v[80:81], v[100:101] op_sel:[0,1,0] op_sel_hi:[1,1,1]
    v_lshlrev_b32 v10, 16, v23
    v_and_b32 v11, 0xffff0000, v23
    v_pk_fma_f32 v[102:103], v[10:11], v[80:81], v[102:103] op_sel:[0,1,0] op_sel_hi:[1,1,1]
    s_waitcnt vmcnt(5)
    v_lshlrev_b32 v8, 16, v24
    v_and_b32 v9, 0xffff0000, v24
    v_pk_fma_f32 v[96:97], v[8:9], v[82:83], v[96:97] op_sel:[0,0,0] op_sel_hi:[1,0,1]
    v_lshlrev_b32 v10, 16, v25
    v_and_b32 v11, 0xffff0000, v25
    v_pk_fma_f32 v[98:99], v[10:11], v[82:83], v[98:99] op_sel:[0,0,0] op_sel_hi:[1,0,1]
    v_lshlrev_b32 v8, 16, v26
    v_and_b32 v9, 0xffff0000, v26
    v_pk_fma_f32 v[100:101], v[8:9], v[82:83], v[100:101] op_sel:[0,0,0] op_sel_hi:[1,0,1]
    v_lshlrev_b32 v10, 16, v27
    v_and_b32 v11, 0xffff0000, v27
    v_pk_fma_f32 v[102:103], v[10:11], v[82:83], v[102:103] op_sel:[0,0,0] op_sel_hi:[1,0,1]
    s_waitcnt vmcnt(4)
    v_lshlrev_b32 v8, 16, v28
    v_and_b32 v9, 0xffff0000, v28
    v_pk_fma_f32 v[96:97], v[8:9], v[82:83], v[96:97] op_sel:[0,1,0] op_sel_hi:[1,1,1]
    v_lshlrev_b32 v10, 16, v29
    v_and_b32 v11, 0xffff0000, v29
    v_pk_fma_f32 v[98:99], v[10:11], v[82:83], v[98:99] op_sel:[0,1,0] op_sel_hi:[1,1,1]
    v_lshlrev_b32 v8, 16, v30
    v_and_b32 v9, 0xffff0000, v30
    v_pk_fma_f32 v[100:101], v[8:9], v[82:83], v[100:101] op_sel:[0,1,0] op_sel_hi:[1,1,1]
    v_lshlrev_b32 v10, 16, v31
    v_and_b32 v11, 0xffff0000, v31
    v_pk_fma_f32 v[102:103], v[10:11], v[82:83], v[102:103] op_sel:[0,1,0] op_sel_hi:[1,1,1]
    s_waitcnt vmcnt(3)
    v_lshlrev_b32 v8, 16, v32
    v_and_b32 v9, 0xffff0000, v32
    v_pk_fma_f32 v[96:97], v[8:9], v[84:85], v[96:97] op_sel:[0,0,0] op_sel_hi:[1,0,1]
    v_lshlrev_b32 v10, 16, v33
    v_and_b32 v11, 0xffff0000, v33
    v_pk_fma_f32 v[98:99], v[10:11], v[84:85], v[98:99] op_sel:[0,0,0] op_sel_hi:[1,0,1]
    v_lshlrev_b32 v8, 16, v34
    v_and_b32 v9, 0xffff0000, v34
    v_pk_fma_f32 v[100:101], v[8:9], v[84:85], v[100:101] op_sel:[0,0,0] op_sel_hi:[1,0,1]
    v_lshlrev_b32 v10, 16, v35
    v_and_b32 v11, 0xffff0000, v35
    v_pk_fma_f32 v[102:103], v[10:11], v[84:85], v[102:103] op_sel:[0,0,0] op_sel_hi:[1,0,1]
    s_waitcnt vmcnt(2)
    v_lshlrev_b32 v8, 16, v36
    v_and_b32 v9, 0xffff0000, v36
    v_pk_fma_f32 v[96:97], v[8:9], v[84:85], v[96:97] op_sel:[0,1,0] op_sel_hi:[1,1,1]
    v_lshlrev_b32 v10, 16, v37
    v_and_b32 v11, 0xffff0000, v37
    v_pk_fma_f32 v[98:99], v[10:11], v[84:85], v[98:99] op_sel:[0,1,0] op_sel_hi:[1,1,1]
    v_lshlrev_b32 v8, 16, v38
    v_and_b32 v9, 0xffff0000, v38
    v_pk_fma_f32 v[100:101], v[8:9], v[84:85], v[100:101] op_sel:[0,1,0] op_sel_hi:[1,1,1]
    v_lshlrev_b32 v10, 16, v39
    v_and_b32 v11, 0xffff0000, v39
    v_pk_fma_f32 v[102:103], v[10:11], v[84:85], v[102:103] op_sel:[0,1,0] op_sel_hi:[1,1,1]
    s_waitcnt vmcnt(1)
    v_lshlrev_b32 v8, 16, v40
    v_and_b32 v9, 0xffff0000, v40
    v_pk_fma_f32 v[96:97], v[8:9], v[86:87], v[96:97] op_sel:[0,0,0] op_sel_hi:[1,0,1]
    v_lshlrev_b32 v10, 16, v41
    v_and_b32 v11, 0xffff0000, v41
    v_pk_fma_f32 v[98:99], v[10:11], v[86:87], v[98:99] op_sel:[0,0,0] op_sel_hi:[1,0,1]
    v_lshlrev_b32 v8, 16, v42
    v_and_b32 v9, 0xffff0000, v42
    v_pk_fma_f32 v[100:101], v[8:9], v[86:87], v[100:101] op_sel:[0,0,0] op_sel_hi:[1,0,1]
    v_lshlrev_b32 v10, 16, v43
    v_and_b32 v11, 0xffff0000, v43
    v_pk_fma_f32 v[102:103], v[10:11], v[86:87], v[102:103] op_sel:[0,0,0] op_sel_hi:[1,0,1]
    s_waitcnt vmcnt(0)
    v_lshlrev_b32 v8, 16, v44
    v_and_b32 v9, 0xffff0000, v44
    v_pk_fma_f32 v[96:97], v[8:9], v[86:87], v[96:97] op_sel:[0,1,0] op_sel_hi:[1,1,1]
    v_lshlrev_b32 v10, 16, v45
    v_and_b32 v11, 0xffff0000, v45
    v_pk_fma_f32 v[98:99], v[10:11], v[86:87], v[98:99] op_sel:[0,1,0] op_sel_hi:[1,1,1]
    v_lshlrev_b32 v8, 16, v46
    v_and_b32 v9, 0xffff0000, v46
    v_pk_fma_f32 v[100:101], v[8:9], v[86:87], v[100:101] op_sel:[0,1,0] op_sel_hi:[1,1,1]
    v_lshlrev_b32 v10, 16, v47
    v_and_b32 v11, 0xffff0000, v47
    v_pk_fma_f32 v[102:103], v[10:11], v[86:87], v[102:103] op_sel:[0,1,0] op_sel_hi:[1,1,1]
    v_lshlrev_b32 v4, 8, v2
    v_lshl_add_u32 v4, v1, 5, v4
    ds_write_b128 v4, v[96:99] offset:2048
    ds_write_b128 v4, v[100:103] offset:2064
    s_waitcnt lgkmcnt(0)
    s_barrier
    v_and_b32 v5, 63, v0
    v_lshrrev_b32 v6, 6, v0
    v_lshlrev_b32 v4, 2, v5
    v_lshl_add_u32 v7, v6, 11, v4
    ds_read_b32 v16, v7 offset:2048
    ds_read_b32 v17, v7 offset:2304
    ds_read_b32 v18, v7 offset:2560
    ds_read_b32 v19, v7 offset:2816
    ds_read_b32 v20, v7 offset:3072
    ds_read_b32 v21, v7 offset:3328
    ds_read_b32 v22, v7 offset:3584
    ds_read_b32 v23, v7 offset:3840
    v_lshl_add_u32 v7, v6, 8, v4
    s_waitcnt lgkmcnt(0)
    v_add_f32 v16, v16, v20
    v_add_f32 v17, v17, v21
    v_add_f32 v18, v18, v22
    v_add_f32 v19, v19, v23
    v_add_f32 v16, v16, v18
    v_add_f32 v17, v17, v19
    v_add_f32 v16, v16, v17
    ds_write_b32 v7, v16 offset:18432
    s_waitcnt lgkmcnt(0)
    s_barrier
    v_cmp_gt_u32 vcc, 64, v0
    s_and_saveexec_b64 s[36:37], vcc
    s_cbranch_execz k0_kernel_fin
    ds_read_b32 v16, v4 offset:18432
    ds_read_b32 v17, v4 offset:18688
    ds_read_b32 v18, v4 offset:18944
    ds_read_b32 v19, v4 offset:19200
    ds_read_b32 v20, v4 offset:19456
    ds_read_b32 v21, v4 offset:19712
    ds_read_b32 v22, v4 offset:19968
    ds_read_b32 v23, v4 offset:20224
    s_waitcnt lgkmcnt(0)
    v_add_f32 v16, v16, v20
    v_add_f32 v17, v17, v21
    v_add_f32 v18, v18, v22
    v_add_f32 v19, v19, v23
    v_add_f32 v16, v16, v18
    v_add_f32 v17, v17, v19
    v_add_f32 v16, v16, v17
    s_lshl_b32 s34, s30, 8
    v_add_u32 v4, s34, v4
    s_cmp_eq_u32 s31, 1
    s_cbranch_scc1 k0_kernel_ismod
    s_add_u32 s40, s4, 24576
    s_addc_u32 s41, s5, 0
    s_and_b32 s41, s41, 0xffff
    s_mov_b32 s42, 7168
    s_mov_b32 s43, 0x20000
    buffer_store_dword v16, v4, s[40:43], 0 offen sc1
    s_branch k0_kernel_fin
k0_kernel_ismod:
    v_cvt_pk_bf16_f32 v16, v16, v16
    v_lshlrev_b32 v16, 16, v16
    s_lshr_b32 s38, s30, 3
    s_cmp_eq_u32 s38, 1
    s_cselect_b32 s39, 1, 0
    s_cmp_eq_u32 s38, 4
    s_cselect_b32 s39, 1, s39
    s_cmp_eq_u32 s39, 0
    s_cbranch_scc1 k0_kernel_nog
    v_add_f32 v16, 1.0, v16
    v_cvt_pk_bf16_f32 v16, v16, v16
    v_lshlrev_b32 v16, 16, v16
k0_kernel_nog:
    s_mov_b32 s40, s4
    s_and_b32 s41, s5, 0xffff
    s_mov_b32 s42, 12288
    s_mov_b32 s43, 0x20000
    buffer_store_dword v16, v4, s[40:43], 0 offen sc1
    s_cmp_ge_u32 s30, 16
    s_cbranch_scc1 k0_kernel_fin
    s_add_u32 s44, s4, 16384
    s_addc_u32 s45, s5, 0
    s_and_b32 s45, s45, 0xffff
    s_mov_b32 s46, 4096
    s_mov_b32 s47, 0x20000
    v_mul_f32 v17, 0x3e0293ee, v16
    buffer_store_dword v17, v4, s[44:47], 0 offen sc1
    s_branch k0_kernel_fin
k0_kernel_xn:
    s_sub_u32 s28, s2, 76
    s_mov_b32 s16, s12
    s_and_b32 s17, s13, 0xffff
    s_mov_b32 s18, 2097152
    s_mov_b32 s19, 0x20000
    s_add_u32 s20, s4, 1048576
    s_addc_u32 s21, s5, 0
    s_and_b32 s21, s21, 0xffff
    s_mov_b32 s22, 2097152
    s_mov_b32 s23, 0x20000
    v_lshrrev_b32 v1, 6, v0
    v_and_b32 v2, 63, v0
    s_lshl_b32 s29, s28, 14
    v_lshlrev_b32 v3, 11, v1
    v_lshl_add_u32 v3, v2, 4, v3
    buffer_load_dwordx4 v[16:19], v3, s[16:19], s29 offen offset:0
    buffer_load_dwordx4 v[20:23], v3, s[16:19], s29 offen offset:1024
    v_lshrrev_b32 v4, 2, v2
    v_lshlrev_b32 v4, 10, v4
    v_and_b32 v5, 3, v2
    v_lshl_add_u32 v4, v5, 8, v4
    v_lshl_add_u32 v4, v1, 5, v4
    s_waitcnt vmcnt(0)
    v_lshlrev_b32 v32, 16, v16
    v_and_b32 v33, 0xffff0000, v16
    v_lshlrev_b32 v34, 16, v17
    v_and_b32 v35, 0xffff0000, v17
    v_lshlrev_b32 v36, 16, v18
    v_and_b32 v37, 0xffff0000, v18
    v_lshlrev_b32 v38, 16, v19
    v_and_b32 v39, 0xffff0000, v19
    v_lshlrev_b32 v40, 16, v20
    v_and_b32 v41, 0xffff0000, v20
    v_lshlrev_b32 v42, 16, v21
    v_and_b32 v43, 0xffff0000, v21
    v_lshlrev_b32 v44, 16, v22
    v_and_b32 v45, 0xffff0000, v22
    v_lshlrev_b32 v46, 16, v23
    v_and_b32 v47, 0xffff0000, v23
    v_add_f32 v64, v32, v33
    v_add_f32 v64, v64, v34
    v_add_f32 v64, v64, v35
    v_add_f32 v64, v64, v36
    v_add_f32 v64, v64, v37
    v_add_f32 v64, v64, v38
    v_add_f32 v64, v64, v39
    v_add_f32 v65, v40, v41
    v_add_f32 v65, v65, v42
    v_add_f32 v65, v65, v43
    v_add_f32 v65, v65, v44
    v_add_f32 v65, v65, v45
    v_add_f32 v65, v65, v46
    v_add_f32 v65, v65, v47
    s_nop 1
    v_add_f32_dpp v64, v64, v64 quad_perm:[1,0,3,2] row_mask:0xf bank_mask:0xf
    v_add_f32_dpp v65, v65, v65 quad_perm:[1,0,3,2] row_mask:0xf bank_mask:0xf
    s_nop 1
    v_add_f32_dpp v64, v64, v64 quad_perm:[2,3,0,1] row_mask:0xf bank_mask:0xf
    v_add_f32_dpp v65, v65, v65 quad_perm:[2,3,0,1] row_mask:0xf bank_mask:0xf
    s_nop 1
    v_add_f32_dpp v64, v64, v64 row_half_mirror row_mask:0xf bank_mask:0xf
    v_add_f32_dpp v65, v65, v65 row_half_mirror row_mask:0xf bank_mask:0xf
    s_nop 1
    v_add_f32_dpp v64, v64, v64 row_mirror row_mask:0xf bank_mask:0xf
    v_add_f32_dpp v65, v65, v65 row_mirror row_mask:0xf bank_mask:0xf
    s_nop 1
    v_mov_b32 v68, v64
    v_mov_b32 v69, v65
    s_nop 1
    v_permlane16_swap_b32 v64, v68
    v_permlane16_swap_b32 v65, v69
    s_nop 1
    v_add_f32 v64, v64, v68
    v_add_f32 v65, v65, v69
    s_nop 0
    v_mov_b32 v68, v64
    v_mov_b32 v69, v65
    s_nop 1
    v_permlane32_swap_b32 v64, v68
    v_permlane32_swap_b32 v65, v69
    s_nop 1
    v_add_f32 v64, v64, v68
    v_add_f32 v65, v65, v69
    s_nop 0
    v_mul_f32 v64, 0x3b000000, v64
    v_mul_f32 v65, 0x3b000000, v65
    v_sub_f32 v32, v32, v64
    v_sub_f32 v33, v33, v64
    v_sub_f32 v34, v34, v64
    v_sub_f32 v35, v35, v64
    v_sub_f32 v36, v36, v64
    v_sub_f32 v37, v37, v64
    v_sub_f32 v38, v38, v64
    v_sub_f32 v39, v39, v64
    v_sub_f32 v40, v40, v65
    v_sub_f32 v41, v41, v65
    v_sub_f32 v42, v42, v65
    v_sub_f32 v43, v43, v65
    v_sub_f32 v44, v44, v65
    v_sub_f32 v45, v45, v65
    v_sub_f32 v46, v46, v65
    v_sub_f32 v47, v47, v65
    v_mul_f32 v64, v32, v32
    v_fmac_f32 v64, v33, v33
    v_fmac_f32 v64, v34, v34
    v_fmac_f32 v64, v35, v35
    v_fmac_f32 v64, v36, v36
    v_fmac_f32 v64, v37, v37
    v_fmac_f32 v64, v38, v38
    v_fmac_f32 v64, v39, v39
    v_mul_f32 v65, v40, v40
    v_fmac_f32 v65, v41, v41
    v_fmac_f32 v65, v42, v42
    v_fmac_f32 v65, v43, v43
    v_fmac_f32 v65, v44, v44
    v_fmac_f32 v65, v45, v45
    v_fmac_f32 v65, v46, v46
    v_fmac_f32 v65, v47, v47
    s_nop 1
    v_add_f32_dpp v64, v64, v64 quad_perm:[1,0,3,2] row_mask:0xf bank_mask:0xf
    v_add_f32_dpp v65, v65, v65 quad_perm:[1,0,3,2] row_mask:0xf bank_mask:0xf
    s_nop 1
    v_add_f32_dpp v64, v64, v64 quad_perm:[2,3,0,1] row_mask:0xf bank_mask:0xf
    v_add_f32_dpp v65, v65, v65 quad_perm:[2,3,0,1] row_mask:0xf bank_mask:0xf
    s_nop 1
    v_add_f32_dpp v64, v64, v64 row_half_mirror row_mask:0xf bank_mask:0xf
    v_add_f32_dpp v65, v65, v65 row_half_mirror row_mask:0xf bank_mask:0xf
    s_nop 1
    v_add_f32_dpp v64, v64, v64 row_mirror row_mask:0xf bank_mask:0xf
    v_add_f32_dpp v65, v65, v65 row_mirror row_mask:0xf bank_mask:0xf
    s_nop 1
    v_mov_b32 v68, v64
    v_mov_b32 v69, v65
    s_nop 1
    v_permlane16_swap_b32 v64, v68
    v_permlane16_swap_b32 v65, v69
    s_nop 1
    v_add_f32 v64, v64, v68
    v_add_f32 v65, v65, v69
    s_nop 0
    v_mov_b32 v68, v64
    v_mov_b32 v69, v65
    s_nop 1
    v_permlane32_swap_b32 v64, v68
    v_permlane32_swap_b32 v65, v69
    s_nop 1
    v_add_f32 v64, v64, v68
    v_add_f32 v65, v65, v69
    s_nop 0
    s_mov_b32 s30, 0x3727c5ac
    v_mov_b32 v68, s30
    v_mov_b32 v69, s30
    v_fmac_f32 v68, 0x3b000000, v64
    v_fmac_f32 v69, 0x3b000000, v65
    v_rsq_f32 v68, v68
    v_rsq_f32 v69, v69
    s_nop 0
    v_mul_f32 v32, v32, v68
    v_mul_f32 v33, v33, v68
    v_mul_f32 v34, v34, v68
    v_mul_f32 v35, v35, v68
    v_mul_f32 v36, v36, v68
    v_mul_f32 v37, v37, v68
    v_mul_f32 v38, v38, v68
    v_mul_f32 v39, v39, v68
    v_mul_f32 v40, v40, v69
    v_mul_f32 v41, v41, v69
    v_mul_f32 v42, v42, v69
    v_mul_f32 v43, v43, v69
    v_mul_f32 v44, v44, v69
    v_mul_f32 v45, v45, v69
    v_mul_f32 v46, v46, v69
    v_mul_f32 v47, v47, v69
    v_cvt_pk_f16_f32 v16, v32, v33
    v_cvt_pk_f16_f32 v17, v34, v35
    v_cvt_pk_f16_f32 v18, v36, v37
    v_cvt_pk_f16_f32 v19, v38, v39
    v_cvt_pk_f16_f32 v20, v40, v41
    v_cvt_pk_f16_f32 v21, v42, v43
    v_cvt_pk_f16_f32 v22, v44, v45
    v_cvt_pk_f16_f32 v23, v46, v47
    ds_write_b128 v4, v[16:19] offset:0
    ds_write_b128 v4, v[20:23] offset:16
    s_waitcnt lgkmcnt(0)
    s_barrier
    v_lshlrev_b32 v5, 4, v0
    ds_read_b128 v[16:19], v5 offset:0
    ds_read_b128 v[20:23], v5 offset:8192
    s_waitcnt lgkmcnt(0)
    buffer_store_dwordx4 v[16:19], v5, s[20:23], s29 offen sc1
    v_add_u32 v5, 8192, v5
    buffer_store_dwordx4 v[20:23], v5, s[20:23], s29 offen sc1
    s_branch k0_kernel_fin
k0_kernel_pf:
    s_cmp_eq_u32 s2, 204
    s_cbranch_scc0 k0_kernel_pf2
    s_add_u32 s20, s4, 131072
    s_addc_u32 s21, s5, 0
    s_and_b32 s21, s21, 0xffff
    s_mov_b32 s22, 32768
    s_mov_b32 s23, 0x20000
    v_lshlrev_b32 v2, 4, v0
    v_mov_b32 v100, 0
    v_mov_b32 v101, 0
    v_mov_b32 v102, 0
    v_mov_b32 v103, 0
    buffer_store_dwordx4 v[100:103], v2, s[20:23], 0 offen sc1
    v_add_u32 v2, 8192, v2
    buffer_store_dwordx4 v[100:103], v2, s[20:23], 0 offen sc1
    v_add_u32 v2, 8192, v2
    buffer_store_dwordx4 v[100:103], v2, s[20:23], 0 offen sc1
    v_add_u32 v2, 8192, v2
    buffer_store_dwordx4 v[100:103], v2, s[20:23], 0 offen sc1
    v_add_u32 v2, 8192, v2
k0_kernel_pf2:
    s_getpc_b64 s[24:25]
k0_kernel_pc:
    s_add_u32 s24, s24, mega_kernel-k0_kernel_pc
    s_addc_u32 s25, s25, 0
    s_and_b32 s25, s25, 0xffff
    s_mov_b32 s26, mega_kernel_finish-mega_kernel
    s_mov_b32 s27, 0x20000
    s_sub_u32 s28, s2, 204
    s_lshl_b32 s28, s28, 10
    v_lshlrev_b32 v2, 1, v0
    v_add_u32 v2, s28, v2
    buffer_load_ushort v96, v2, s[24:27], 0 offen
    s_mov_b32 s16, s14
    s_and_b32 s17, s15, 0xffff
    s_mov_b32 s18, 4194304
    s_mov_b32 s19, 0x20000
    s_sub_u32 s28, s2, 204
    s_and_b32 s29, s2, 7
    s_lshl_b32 s29, s29, 10
    s_lshr_b32 s28, s28, 3
    s_mul_i32 s28, s28, 327680
    s_add_u32 s28, s28, s29
    v_lshrrev_b32 v1, 6, v0
    v_lshlrev_b32 v1, 13, v1
    v_and_b32 v2, 63, v0
    v_lshl_add_u32 v1, v2, 4, v1
    v_add_u32 v1, s28, v1
    buffer_load_dwordx4 v[4:7], v1, s[16:19], 0 offen
    v_add_u32 v1, 65536, v1
    buffer_load_dwordx4 v[8:11], v1, s[16:19], 0 offen
    v_add_u32 v1, 65536, v1
    buffer_load_dwordx4 v[12:15], v1, s[16:19], 0 offen
    v_add_u32 v1, 65536, v1
    buffer_load_dwordx4 v[16:19], v1, s[16:19], 0 offen
    v_add_u32 v1, 65536, v1
    buffer_load_dwordx4 v[20:23], v1, s[16:19], 0 offen
    s_waitcnt vmcnt(0)
k0_kernel_fin:
k0_kernel_end:
    s_endpgm
.globl mega_kernel
.p2align 8
.type mega_kernel,@function
mega_kernel:
    s_cmp_lt_u32 s2, 256
    s_cbranch_scc1 mega_kernel_go
    s_endpgm
mega_kernel_go:
    s_load_dwordx2 s[4:5], s[0:1], 112
    s_load_dwordx4 s[48:51], s[0:1], 8
    s_load_dwordx4 s[52:55], s[0:1], 24
    s_load_dwordx4 s[56:59], s[0:1], 48
    s_load_dwordx4 s[60:63], s[0:1], 64
    s_load_dwordx2 s[100:101], s[0:1], 96
    s_load_dwordx2 s[6:7], s[0:1], 0
    v_lshrrev_b32 v2, 6, v0
    v_and_b32 v1, 63, v0
    s_nop 0
    v_readfirstlane_b32 s32, v2
    s_getpc_b64 s[82:83]
mega_kernel_pc0:
    s_add_u32 s80, s82, mega_kernel-mega_kernel_pc0
    s_addc_u32 s81, s83, -1
    s_and_b32 s81, s81, 0xffff
    s_mov_b32 s82, mega_kernel_finish-mega_kernel
    s_mov_b32 s83, 0x20000
    s_lshr_b32 s3, s2, 3
    s_lshl_b32 s3, s3, 2
    s_add_u32 s3, s3, s32
    s_lshl_b32 s3, s3, 10
    v_lshlrev_b32 v2, 4, v1
    v_add_u32 v2, s3, v2
    buffer_load_dwordx4 v[40:43], v2, s[80:83], 0 offen
    s_waitcnt lgkmcnt(0)
    s_mov_b64 s[96:97], s[58:59]
    s_mov_b64 s[98:99], s[60:61]
    s_add_u32 s72, s4, 131072
    s_addc_u32 s73, s5, 0
    s_and_b32 s73, s73, 0xffff
    s_mov_b32 s74, 32768
    s_mov_b32 s75, 0x20000
    s_and_b32 s33, s2, 7
    s_lshl_b32 s33, s33, 2
    s_lshr_b32 s37, s2, 3
    s_and_b32 s37, s37, 3
    s_add_u32 s33, s33, s37
    s_lshr_b32 s34, s2, 5
    s_lshl_b32 s37, s33, 8
    s_add_u32 s16, s52, s37
    s_addc_u32 s17, s53, 0
    s_and_b32 s17, s17, 0xffff
    s_sub_u32 s18, 4194304, s37
    s_mov_b32 s19, 0x20000
    v_and_b32 v92, 15, v1
    v_lshrrev_b32 v93, 4, v1
    s_lshl_b32 s37, s32, 5
    v_add_u32 v94, s37, v93
    v_lshlrev_b32 v94, 13, v94
    v_or_b32 v95, 0, v93
    v_lshlrev_b32 v95, 1, v95
    v_xor_b32 v95, v95, v92
    v_lshl_add_u32 v32, v95, 4, v94
    v_or_b32 v95, 4, v93
    v_lshlrev_b32 v95, 1, v95
    v_xor_b32 v95, v95, v92
    v_lshl_add_u32 v33, v95, 4, v94
    s_lshl_b32 s36, s32, 13
    s_add_u32 m0, s36, 0
    s_mov_b32 s38, 0
    buffer_load_dwordx4 v32, s[16:19], s38 offen lds
    s_add_u32 m0, s36, 1024
    s_mov_b32 s38, 32768
    buffer_load_dwordx4 v32, s[16:19], s38 offen lds
    s_add_u32 m0, s36, 2048
    s_mov_b32 s38, 65536
    buffer_load_dwordx4 v33, s[16:19], s38 offen lds
    s_add_u32 m0, s36, 3072
    s_mov_b32 s38, 98304
    buffer_load_dwordx4 v33, s[16:19], s38 offen lds
    s_add_u32 m0, s36, 4096
    s_mov_b32 s38, 131072
    buffer_load_dwordx4 v32, s[16:19], s38 offen lds
    s_add_u32 m0, s36, 5120
    s_mov_b32 s38, 163840
    buffer_load_dwordx4 v32, s[16:19], s38 offen lds
    s_add_u32 m0, s36, 6144
    s_mov_b32 s38, 196608
    buffer_load_dwordx4 v33, s[16:19], s38 offen lds
    s_add_u32 m0, s36, 7168
    s_mov_b32 s38, 229376
    buffer_load_dwordx4 v33, s[16:19], s38 offen lds
    s_add_u32 s20, s4, 1048576
    s_addc_u32 s21, s5, 0
    s_and_b32 s21, s21, 0xffff
    s_mov_b32 s22, 2097152
    s_mov_b32 s23, 0x20000
    s_mov_b32 s40, 0
    s_mov_b32 s41, 4096
    s_mov_b32 s42, 8192
    s_mov_b32 s43, 12288
    s_lshl_b32 s44, s34, 4
    s_lshl_b32 s37, s32, 2
    s_add_u32 s44, s44, s37
    s_lshl_b32 s37, s44, 14
    v_lshlrev_b32 v94, 4, v1
    v_add_u32 v4, s37, v94
    v_add_u32 v5, 16384, v4
    v_add_u32 v6, 32768, v4
    v_add_u32 v7, 49152, v4
    buffer_load_dwordx4 v[128:131], v4, s[20:23], s40 offen offset:0
    buffer_load_dwordx4 v[132:135], v5, s[20:23], s40 offen offset:0
    buffer_load_dwordx4 v[136:139], v6, s[20:23], s40 offen offset:0
    buffer_load_dwordx4 v[140:143], v7, s[20:23], s40 offen offset:0
    buffer_load_dwordx4 v[144:147], v4, s[20:23], s40 offen offset:1024
    buffer_load_dwordx4 v[148:151], v5, s[20:23], s40 offen offset:1024
    buffer_load_dwordx4 v[152:155], v6, s[20:23], s40 offen offset:1024
    buffer_load_dwordx4 v[156:159], v7, s[20:23], s40 offen offset:1024
    s_add_u32 s24, s4, 16384
    s_addc_u32 s25, s5, 0
    s_and_b32 s25, s25, 0xffff
    s_mov_b32 s26, 4096
    s_mov_b32 s27, 0x20000
    s_lshl_b32 s37, s32, 10
    s_add_u32 m0, s37, 131072
    s_nop 0
    buffer_load_dwordx4 v94, s[24:27], s37 offen lds
    s_lshl_b32 s37, s33, 19
    s_add_u32 s8, s48, s37
    s_addc_u32 s9, s49, 0
    s_and_b32 s9, s9, 0xffff
    s_mov_b32 s10, 524288
    s_mov_b32 s11, 0x20000
    s_add_u32 s12, s50, s37
    s_addc_u32 s13, s51, 0
    s_and_b32 s13, s13, 0xffff
    s_mov_b32 s14, 524288
    s_mov_b32 s15, 0x20000
    s_add_u32 s28, s4, 4194304
    s_addc_u32 s29, s5, 0
    s_and_b32 s29, s29, 0xffff
    s_mov_b32 s30, 16777216
    s_mov_b32 s31, 0x20000
    s_mov_b32 s76, s4
    s_and_b32 s77, s5, 0xffff
    s_mov_b32 s78, 12288
    s_mov_b32 s79, 0x20000
    s_cmp_lt_u32 s2, 17
    s_cselect_b32 s45, 1, 0
    s_cmp_eq_u32 s32, 0
    s_cselect_b32 s45, s45, 0
    s_cmp_eq_u32 s45, 0
    s_cbranch_scc1 mega_kernel_sj0
    s_cmp_eq_u32 s2, 16
    s_cbranch_scc1 mega_kernel_sjc
    s_lshl_b32 s37, s2, 7
    v_lshl_add_u32 v112, v93, 4, s37
    v_add_u32 v113, 64, v112
    s_branch mega_kernel_sjl
mega_kernel_sjc:
    v_lshlrev_b32 v112, 5, v1
    v_add_u32 v113, 16, v112
mega_kernel_sjl:
    s_mov_b32 s37, 6144
    s_mov_b32 s38, 8192
    buffer_load_dwordx4 v[96:99], v112, s[76:79], s37 offen
    buffer_load_dwordx4 v[100:103], v113, s[76:79], s37 offen
    buffer_load_dwordx4 v[104:107], v112, s[76:79], s38 offen
    buffer_load_dwordx4 v[108:111], v113, s[76:79], s38 offen
mega_kernel_sj0:
    buffer_load_dwordx4 v[160:163], v4, s[20:23], s40 offen offset:2048
    buffer_load_dwordx4 v[164:167], v5, s[20:23], s40 offen offset:2048
    buffer_load_dwordx4 v[168:171], v6, s[20:23], s40 offen offset:2048
    buffer_load_dwordx4 v[172:175], v7, s[20:23], s40 offen offset:2048
    buffer_load_dwordx4 v[176:179], v4, s[20:23], s40 offen offset:3072
    buffer_load_dwordx4 v[180:183], v5, s[20:23], s40 offen offset:3072
    buffer_load_dwordx4 v[184:187], v6, s[20:23], s40 offen offset:3072
    buffer_load_dwordx4 v[188:191], v7, s[20:23], s40 offen offset:3072
    s_lshl_b32 s37, s32, 4
    v_add_u32 v94, s37, v93
    v_lshlrev_b32 v94, 8, v94
    v_or_b32 v95, 0, v93
    v_xor_b32 v95, v95, v92
    v_lshl_add_u32 v124, v95, 4, v94
    v_or_b32 v95, 4, v93
    v_xor_b32 v95, v95, v92
    v_lshl_add_u32 v125, v95, 4, v94
    v_or_b32 v95, 8, v93
    v_xor_b32 v95, v95, v92
    v_lshl_add_u32 v126, v95, 4, v94
    v_or_b32 v95, 12, v93
    v_xor_b32 v95, v95, v92
    v_lshl_add_u32 v127, v95, 4, v94
    v_or_b32 v95, 0, v93
    v_lshlrev_b32 v95, 1, v95
    v_xor_b32 v95, v95, v92
    v_lshl_add_u32 v2, v95, 4, v94
    v_or_b32 v95, 4, v93
    v_lshlrev_b32 v95, 1, v95
    v_xor_b32 v95, v95, v92
    v_lshl_add_u32 v3, v95, 4, v94
    v_lshrrev_b32 v84, 2, v92
    v_and_b32 v85, 3, v92
    v_and_b32 v86, 1, v93
    v_lshl_or_b32 v86, v86, 2, v84
    v_lshlrev_b32 v87, 3, v85
    v_lshl_add_u32 v90, v93, 3, v84
    v_lshl_add_u32 v90, v90, 8, v87
    v_xor_b32 v91, 0, v86
    v_lshl_add_u32 v44, v91, 5, v90
    v_xor_b32 v91, 1, v86
    v_lshl_add_u32 v45, v91, 5, v90
    v_xor_b32 v91, 2, v86
    v_lshl_add_u32 v46, v91, 5, v90
    v_xor_b32 v91, 3, v86
    v_lshl_add_u32 v47, v91, 5, v90
    v_xor_b32 v91, 4, v86
    v_lshl_add_u32 v48, v91, 5, v90
    v_xor_b32 v91, 5, v86
    v_lshl_add_u32 v49, v91, 5, v90
    v_xor_b32 v91, 6, v86
    v_lshl_add_u32 v50, v91, 5, v90
    v_xor_b32 v91, 7, v86
    v_lshl_add_u32 v51, v91, 5, v90
    v_lshlrev_b32 v34, 5, v93
    v_add_u32 v34, 131072, v34
    v_lshl_add_u32 v90, v93, 2, v84
    v_lshl_add_u32 v90, v90, 8, v87
    v_xor_b32 v91, 0, v86
    v_lshl_add_u32 v16, v91, 5, v90
    v_add_u32 v17, 0x10000, v16
    v_xor_b32 v91, 1, v86
    v_lshl_add_u32 v18, v91, 5, v90
    v_add_u32 v19, 0x10000, v18
    v_xor_b32 v91, 2, v86
    v_lshl_add_u32 v20, v91, 5, v90
    v_add_u32 v21, 0x10000, v20
    v_xor_b32 v91, 3, v86
    v_lshl_add_u32 v22, v91, 5, v90
    v_add_u32 v23, 0x10000, v22
    v_xor_b32 v91, 4, v86
    v_lshl_add_u32 v24, v91, 5, v90
    v_add_u32 v25, 0x10000, v24
    v_xor_b32 v91, 5, v86
    v_lshl_add_u32 v26, v91, 5, v90
    v_add_u32 v27, 0x10000, v26
    v_xor_b32 v91, 6, v86
    v_lshl_add_u32 v28, v91, 5, v90
    v_add_u32 v29, 0x10000, v28
    v_xor_b32 v91, 7, v86
    v_lshl_add_u32 v30, v91, 5, v90
    v_add_u32 v31, 0x10000, v30
    v_and_b32 v90, 1, v93
    v_lshlrev_b32 v90, 1, v90
    v_lshrrev_b32 v91, 1, v93
    v_or_b32 v90, v90, v91
    v_lshlrev_b32 v87, 8, v92
    v_or_b32 v91, 0, v90
    v_xor_b32 v91, v91, v92
    v_lshl_add_u32 v8, v91, 4, v87
    v_add_u32 v9, 0x10000, v8
    v_or_b32 v91, 4, v90
    v_xor_b32 v91, v91, v92
    v_lshl_add_u32 v10, v91, 4, v87
    v_add_u32 v11, 0x10000, v10
    v_or_b32 v91, 8, v90
    v_xor_b32 v91, v91, v92
    v_lshl_add_u32 v12, v91, 4, v87
    v_add_u32 v13, 0x10000, v12
    v_or_b32 v91, 12, v90
    v_xor_b32 v91, v91, v92
    v_lshl_add_u32 v14, v91, 4, v87
    v_add_u32 v15, 0x10000, v14
    v_cmp_eq_u32 vcc, 0, v92
    v_mov_b32 v91, 0x3f803f80
    s_nop 0
    v_cndmask_b32 v88, 0, v91, vcc
    v_cndmask_b32 v89, 0, v91, vcc
    v_cndmask_b32 v90, 0, v91, vcc
    v_cndmask_b32 v91, 0, v91, vcc
    s_cmp_eq_u32 s45, 0
    s_cbranch_scc1 mega_kernel_sj1
    s_waitcnt vmcnt(8)
    s_cmp_eq_u32 s2, 16
    s_cbranch_scc1 mega_kernel_sjc2
    v_cmp_eq_u32 vcc, 1, v92
    v_cmp_eq_u32 s[78:79], 2, v92
    v_cmp_eq_u32 s[80:81], 0, v92
    s_nop 1
    v_cndmask_b32 v114, 0, 1.0, vcc
    v_cndmask_b32 v115, 0, 1.0, vcc
    v_cndmask_b32 v116, 0, 1.0, vcc
    v_cndmask_b32 v117, 0, 1.0, vcc
    v_cndmask_b32 v118, 0, 1.0, vcc
    v_cndmask_b32 v119, 0, 1.0, vcc
    v_cndmask_b32 v120, 0, 1.0, vcc
    v_cndmask_b32 v121, 0, 1.0, vcc
    v_cndmask_b32 v114, v114, v104, s[78:79]
    v_cndmask_b32 v115, v115, v105, s[78:79]
    v_cndmask_b32 v116, v116, v106, s[78:79]
    v_cndmask_b32 v117, v117, v107, s[78:79]
    v_cndmask_b32 v118, v118, v108, s[78:79]
    v_cndmask_b32 v119, v119, v109, s[78:79]
    v_cndmask_b32 v120, v120, v110, s[78:79]
    v_cndmask_b32 v121, v121, v111, s[78:79]
    v_cndmask_b32 v114, v114, v96, s[80:81]
    v_cndmask_b32 v115, v115, v97, s[80:81]
    v_cndmask_b32 v116, v116, v98, s[80:81]
    v_cndmask_b32 v117, v117, v99, s[80:81]
    v_cndmask_b32 v118, v118, v100, s[80:81]
    v_cndmask_b32 v119, v119, v101, s[80:81]
    v_cndmask_b32 v120, v120, v102, s[80:81]
    v_cndmask_b32 v121, v121, v103, s[80:81]
    v_cvt_pk_bf16_f32 v96, v114, v115
    v_cvt_pk_bf16_f32 v97, v116, v117
    v_cvt_pk_bf16_f32 v98, v118, v119
    v_cvt_pk_bf16_f32 v99, v120, v121
    s_add_u32 s84, s4, 32768
    s_addc_u32 s85, s5, 0
    s_and_b32 s85, s85, 0xffff
    s_mov_b32 s86, 16384
    s_mov_b32 s87, 0x20000
    s_lshl_b32 s37, s2, 10
    v_lshlrev_b32 v112, 4, v1
    buffer_store_dwordx4 v[96:99], v112, s[84:87], s37 offen sc1
    s_branch mega_kernel_sj1
mega_kernel_sjc2:
    v_mov_b32 v114, 0
    v_mov_b32 v115, 0
    v_mov_b32 v116, 0
    v_mov_b32 v117, 0
    v_mov_b32 v118, 0
    v_add_f32 v114, v114, v104
    v_add_f32 v115, v115, v96
    v_fmac_f32 v116, v104, v104
    v_fmac_f32 v117, v104, v96
    v_fmac_f32 v118, v96, v96
    v_add_f32 v114, v114, v105
    v_add_f32 v115, v115, v97
    v_fmac_f32 v116, v105, v105
    v_fmac_f32 v117, v105, v97
    v_fmac_f32 v118, v97, v97
    v_add_f32 v114, v114, v106
    v_add_f32 v115, v115, v98
    v_fmac_f32 v116, v106, v106
    v_fmac_f32 v117, v106, v98
    v_fmac_f32 v118, v98, v98
    v_add_f32 v114, v114, v107
    v_add_f32 v115, v115, v99
    v_fmac_f32 v116, v107, v107
    v_fmac_f32 v117, v107, v99
    v_fmac_f32 v118, v99, v99
    v_add_f32 v114, v114, v108
    v_add_f32 v115, v115, v100
    v_fmac_f32 v116, v108, v108
    v_fmac_f32 v117, v108, v100
    v_fmac_f32 v118, v100, v100
    v_add_f32 v114, v114, v109
    v_add_f32 v115, v115, v101
    v_fmac_f32 v116, v109, v109
    v_fmac_f32 v117, v109, v101
    v_fmac_f32 v118, v101, v101
    v_add_f32 v114, v114, v110
    v_add_f32 v115, v115, v102
    v_fmac_f32 v116, v110, v110
    v_fmac_f32 v117, v110, v102
    v_fmac_f32 v118, v102, v102
    v_add_f32 v114, v114, v111
    v_add_f32 v115, v115, v103
    v_fmac_f32 v116, v111, v111
    v_fmac_f32 v117, v111, v103
    v_fmac_f32 v118, v103, v103
    v_add_f32_dpp v114, v114, v114 quad_perm:[1,0,3,2] row_mask:0xf bank_mask:0xf
    v_add_f32_dpp v115, v115, v115 quad_perm:[1,0,3,2] row_mask:0xf bank_mask:0xf
    v_add_f32_dpp v116, v116, v116 quad_perm:[1,0,3,2] row_mask:0xf bank_mask:0xf
    v_add_f32_dpp v117, v117, v117 quad_perm:[1,0,3,2] row_mask:0xf bank_mask:0xf
    v_add_f32_dpp v118, v118, v118 quad_perm:[1,0,3,2] row_mask:0xf bank_mask:0xf
    v_add_f32_dpp v114, v114, v114 quad_perm:[2,3,0,1] row_mask:0xf bank_mask:0xf
    v_add_f32_dpp v115, v115, v115 quad_perm:[2,3,0,1] row_mask:0xf bank_mask:0xf
    v_add_f32_dpp v116, v116, v116 quad_perm:[2,3,0,1] row_mask:0xf bank_mask:0xf
    v_add_f32_dpp v117, v117, v117 quad_perm:[2,3,0,1] row_mask:0xf bank_mask:0xf
    v_add_f32_dpp v118, v118, v118 quad_perm:[2,3,0,1] row_mask:0xf bank_mask:0xf
    v_add_f32_dpp v114, v114, v114 row_half_mirror row_mask:0xf bank_mask:0xf
    v_add_f32_dpp v115, v115, v115 row_half_mirror row_mask:0xf bank_mask:0xf
    v_add_f32_dpp v116, v116, v116 row_half_mirror row_mask:0xf bank_mask:0xf
    v_add_f32_dpp v117, v117, v117 row_half_mirror row_mask:0xf bank_mask:0xf
    v_add_f32_dpp v118, v118, v118 row_half_mirror row_mask:0xf bank_mask:0xf
    v_add_f32_dpp v114, v114, v114 row_mirror row_mask:0xf bank_mask:0xf
    v_add_f32_dpp v115, v115, v115 row_mirror row_mask:0xf bank_mask:0xf
    v_add_f32_dpp v116, v116, v116 row_mirror row_mask:0xf bank_mask:0xf
    v_add_f32_dpp v117, v117, v117 row_mirror row_mask:0xf bank_mask:0xf
    v_add_f32_dpp v118, v118, v118 row_mirror row_mask:0xf bank_mask:0xf
    s_nop 1
    v_mov_b32 v96, v114
    v_mov_b32 v97, v115
    v_mov_b32 v98, v116
    v_mov_b32 v99, v117
    v_mov_b32 v100, v118
    s_nop 1
    v_permlane16_swap_b32 v114, v96
    v_permlane16_swap_b32 v115, v97
    v_permlane16_swap_b32 v116, v98
    v_permlane16_swap_b32 v117, v99
    v_permlane16_swap_b32 v118, v100
    s_nop 1
    v_add_f32 v114, v114, v96
    v_add_f32 v115, v115, v97
    v_add_f32 v116, v116, v98
    v_add_f32 v117, v117, v99
    v_add_f32 v118, v118, v100
    s_nop 0
    v_mov_b32 v96, v114
    v_mov_b32 v97, v115
    v_mov_b32 v98, v116
    v_mov_b32 v99, v117
    v_mov_b32 v100, v118
    s_nop 1
    v_permlane32_swap_b32 v114, v96
    v_permlane32_swap_b32 v115, v97
    v_permlane32_swap_b32 v116, v98
    v_permlane32_swap_b32 v117, v99
    v_permlane32_swap_b32 v118, v100
    s_nop 1
    v_add_f32 v114, v114, v96
    v_add_f32 v115, v115, v97
    v_add_f32 v116, v116, v98
    v_add_f32 v117, v117, v99
    v_add_f32 v118, v118, v100
    s_nop 0
    s_add_u32 s84, s4, 49152
    s_addc_u32 s85, s5, 0
    s_and_b32 s85, s85, 0xffff
    s_mov_b32 s86, 64
    s_mov_b32 s87, 0x20000
    v_lshlrev_b32 v112, 6, v1
    buffer_store_dwordx4 v[114:117], v112, s[84:87], 0 offen sc1
    buffer_store_dword v118, v112, s[84:87], 0 offen offset:16 sc1
mega_kernel_sj1:
    s_waitcnt vmcnt(8)
    s_add_u32 m0, s36, 32768
    s_mov_b32 s38, 1048576
    buffer_load_dwordx4 v32, s[16:19], s38 offen lds
    s_add_u32 m0, s36, 33792
    s_mov_b32 s38, 1081344
    buffer_load_dwordx4 v32, s[16:19], s38 offen lds
    s_add_u32 m0, s36, 34816
    s_mov_b32 s38, 1114112
    buffer_load_dwordx4 v33, s[16:19], s38 offen lds
    s_add_u32 m0, s36, 35840
    s_mov_b32 s38, 1146880
    buffer_load_dwordx4 v33, s[16:19], s38 offen lds
    s_add_u32 m0, s36, 36864
    s_mov_b32 s38, 1179648
    buffer_load_dwordx4 v32, s[16:19], s38 offen lds
    s_add_u32 m0, s36, 37888
    s_mov_b32 s38, 1212416
    buffer_load_dwordx4 v32, s[16:19], s38 offen lds
    s_add_u32 m0, s36, 38912
    s_mov_b32 s38, 1245184
    buffer_load_dwordx4 v33, s[16:19], s38 offen lds
    s_add_u32 m0, s36, 39936
    s_mov_b32 s38, 1277952
    buffer_load_dwordx4 v33, s[16:19], s38 offen lds
    buffer_load_dwordx4 v[192:195], v4, s[20:23], s41 offen offset:0
    buffer_load_dwordx4 v[196:199], v5, s[20:23], s41 offen offset:0
    buffer_load_dwordx4 v[200:203], v6, s[20:23], s41 offen offset:0
    buffer_load_dwordx4 v[204:207], v7, s[20:23], s41 offen offset:0
    buffer_load_dwordx4 v[208:211], v4, s[20:23], s41 offen offset:1024
    buffer_load_dwordx4 v[212:215], v5, s[20:23], s41 offen offset:1024
    buffer_load_dwordx4 v[216:219], v6, s[20:23], s41 offen offset:1024
    buffer_load_dwordx4 v[220:223], v7, s[20:23], s41 offen offset:1024
    s_add_u32 m0, s36, 65536
    s_mov_b32 s38, 2097152
    buffer_load_dwordx4 v32, s[16:19], s38 offen lds
    s_add_u32 m0, s36, 66560
    s_mov_b32 s38, 2129920
    buffer_load_dwordx4 v32, s[16:19], s38 offen lds
    s_add_u32 m0, s36, 67584
    s_mov_b32 s38, 2162688
    buffer_load_dwordx4 v33, s[16:19], s38 offen lds
    s_add_u32 m0, s36, 68608
    s_mov_b32 s38, 2195456
    buffer_load_dwordx4 v33, s[16:19], s38 offen lds
    s_add_u32 m0, s36, 69632
    s_mov_b32 s38, 2228224
    buffer_load_dwordx4 v32, s[16:19], s38 offen lds
    s_add_u32 m0, s36, 70656
    s_mov_b32 s38, 2260992
    buffer_load_dwordx4 v32, s[16:19], s38 offen lds
    s_add_u32 m0, s36, 71680
    s_mov_b32 s38, 2293760
    buffer_load_dwordx4 v33, s[16:19], s38 offen lds
    s_add_u32 m0, s36, 72704
    s_mov_b32 s38, 2326528
    buffer_load_dwordx4 v33, s[16:19], s38 offen lds
    s_barrier
    ds_read_b128 v[52:55], v34 offset:0
    ds_read_b128 v[56:59], v34 offset:16
    ds_read_b128 v[60:63], v34 offset:2048
    ds_read_b128 v[64:67], v34 offset:2064
    ds_read_b128 v[68:71], v34 offset:128
    ds_read_b128 v[72:75], v34 offset:144
    ds_read_b128 v[76:79], v34 offset:2176
    ds_read_b128 v[80:83], v34 offset:2192
    ds_read_b64_tr_b16 a[64:65], v44 offset:0
    ds_read_b64_tr_b16 a[66:67], v44 offset:1024
    ds_read_b64_tr_b16 a[68:69], v45 offset:0
    ds_read_b64_tr_b16 a[70:71], v45 offset:1024
    ds_read_b64_tr_b16 a[72:73], v46 offset:0
    ds_read_b64_tr_b16 a[74:75], v46 offset:1024
    ds_read_b64_tr_b16 a[76:77], v47 offset:0
    ds_read_b64_tr_b16 a[78:79], v47 offset:1024
    ds_read_b64_tr_b16 a[80:81], v48 offset:0
    ds_read_b64_tr_b16 a[82:83], v48 offset:1024
    ds_read_b64_tr_b16 a[84:85], v49 offset:0
    ds_read_b64_tr_b16 a[86:87], v49 offset:1024
    ds_read_b64_tr_b16 a[88:89], v50 offset:0
    ds_read_b64_tr_b16 a[90:91], v50 offset:1024
    ds_read_b64_tr_b16 a[92:93], v51 offset:0
    ds_read_b64_tr_b16 a[94:95], v51 offset:1024
    s_waitcnt lgkmcnt(0)
    v_fma_mix_f32 v36, v128, v60, v52 op_sel:[0,0,0] op_sel_hi:[1,0,0]
    v_fma_mix_f32 v37, v128, v61, v53 op_sel:[1,0,0] op_sel_hi:[1,0,0]
    v_cvt_pk_bf16_f32 v128, v36, v37
    v_fma_mix_f32 v38, v129, v62, v54 op_sel:[0,0,0] op_sel_hi:[1,0,0]
    v_fma_mix_f32 v39, v129, v63, v55 op_sel:[1,0,0] op_sel_hi:[1,0,0]
    v_cvt_pk_bf16_f32 v129, v38, v39
    v_fma_mix_f32 v36, v130, v64, v56 op_sel:[0,0,0] op_sel_hi:[1,0,0]
    v_fma_mix_f32 v37, v130, v65, v57 op_sel:[1,0,0] op_sel_hi:[1,0,0]
    v_cvt_pk_bf16_f32 v130, v36, v37
    v_fma_mix_f32 v38, v131, v66, v58 op_sel:[0,0,0] op_sel_hi:[1,0,0]
    v_fma_mix_f32 v39, v131, v67, v59 op_sel:[1,0,0] op_sel_hi:[1,0,0]
    v_cvt_pk_bf16_f32 v131, v38, v39
    v_fma_mix_f32 v36, v132, v60, v52 op_sel:[0,0,0] op_sel_hi:[1,0,0]
    v_fma_mix_f32 v37, v132, v61, v53 op_sel:[1,0,0] op_sel_hi:[1,0,0]
    v_cvt_pk_bf16_f32 v132, v36, v37
    v_fma_mix_f32 v38, v133, v62, v54 op_sel:[0,0,0] op_sel_hi:[1,0,0]
    v_fma_mix_f32 v39, v133, v63, v55 op_sel:[1,0,0] op_sel_hi:[1,0,0]
    v_cvt_pk_bf16_f32 v133, v38, v39
    v_fma_mix_f32 v36, v134, v64, v56 op_sel:[0,0,0] op_sel_hi:[1,0,0]
    v_fma_mix_f32 v37, v134, v65, v57 op_sel:[1,0,0] op_sel_hi:[1,0,0]
    v_cvt_pk_bf16_f32 v134, v36, v37
    v_fma_mix_f32 v38, v135, v66, v58 op_sel:[0,0,0] op_sel_hi:[1,0,0]
    v_fma_mix_f32 v39, v135, v67, v59 op_sel:[1,0,0] op_sel_hi:[1,0,0]
    v_cvt_pk_bf16_f32 v135, v38, v39
    v_fma_mix_f32 v36, v136, v60, v52 op_sel:[0,0,0] op_sel_hi:[1,0,0]
    v_fma_mix_f32 v37, v136, v61, v53 op_sel:[1,0,0] op_sel_hi:[1,0,0]
    v_cvt_pk_bf16_f32 v136, v36, v37
    v_fma_mix_f32 v38, v137, v62, v54 op_sel:[0,0,0] op_sel_hi:[1,0,0]
    v_fma_mix_f32 v39, v137, v63, v55 op_sel:[1,0,0] op_sel_hi:[1,0,0]
    v_cvt_pk_bf16_f32 v137, v38, v39
    v_fma_mix_f32 v36, v138, v64, v56 op_sel:[0,0,0] op_sel_hi:[1,0,0]
    v_fma_mix_f32 v37, v138, v65, v57 op_sel:[1,0,0] op_sel_hi:[1,0,0]
    v_cvt_pk_bf16_f32 v138, v36, v37
    v_fma_mix_f32 v38, v139, v66, v58 op_sel:[0,0,0] op_sel_hi:[1,0,0]
    v_fma_mix_f32 v39, v139, v67, v59 op_sel:[1,0,0] op_sel_hi:[1,0,0]
    v_cvt_pk_bf16_f32 v139, v38, v39
    v_fma_mix_f32 v36, v140, v60, v52 op_sel:[0,0,0] op_sel_hi:[1,0,0]
    v_fma_mix_f32 v37, v140, v61, v53 op_sel:[1,0,0] op_sel_hi:[1,0,0]
    v_cvt_pk_bf16_f32 v140, v36, v37
    v_fma_mix_f32 v38, v141, v62, v54 op_sel:[0,0,0] op_sel_hi:[1,0,0]
    v_fma_mix_f32 v39, v141, v63, v55 op_sel:[1,0,0] op_sel_hi:[1,0,0]
    v_cvt_pk_bf16_f32 v141, v38, v39
    v_fma_mix_f32 v36, v142, v64, v56 op_sel:[0,0,0] op_sel_hi:[1,0,0]
    v_fma_mix_f32 v37, v142, v65, v57 op_sel:[1,0,0] op_sel_hi:[1,0,0]
    v_cvt_pk_bf16_f32 v142, v36, v37
    v_fma_mix_f32 v38, v143, v66, v58 op_sel:[0,0,0] op_sel_hi:[1,0,0]
    v_fma_mix_f32 v39, v143, v67, v59 op_sel:[1,0,0] op_sel_hi:[1,0,0]
    v_cvt_pk_bf16_f32 v143, v38, v39
    s_nop 1
    v_mfma_f32_16x16x32_bf16 a[128:131], a[64:67], v[128:131], 0
    ds_read_b64_tr_b16 a[96:97], v44 offset:8192
    v_fma_mix_f32 v36, v144, v76, v68 op_sel:[0,0,0] op_sel_hi:[1,0,0]
    v_mfma_f32_16x16x32_bf16 a[132:135], a[64:67], v[132:135], 0
    ds_read_b64_tr_b16 a[98:99], v44 offset:9216
    v_fma_mix_f32 v37, v144, v77, v69 op_sel:[1,0,0] op_sel_hi:[1,0,0]
    v_mfma_f32_16x16x32_bf16 a[136:139], a[64:67], v[136:139], 0
    ds_read_b64_tr_b16 a[100:101], v45 offset:8192
    v_cvt_pk_bf16_f32 v144, v36, v37
    v_mfma_f32_16x16x32_bf16 a[140:143], a[64:67], v[140:143], 0
    ds_read_b64_tr_b16 a[102:103], v45 offset:9216
    v_fma_mix_f32 v38, v145, v78, v70 op_sel:[0,0,0] op_sel_hi:[1,0,0]
    buffer_load_dwordx4 v[224:227], v4, s[20:23], s41 offen offset:2048
    v_mfma_f32_16x16x32_bf16 a[144:147], a[68:71], v[128:131], 0
    ds_read_b64_tr_b16 a[104:105], v46 offset:8192
    v_fma_mix_f32 v39, v145, v79, v71 op_sel:[1,0,0] op_sel_hi:[1,0,0]
    v_mfma_f32_16x16x32_bf16 a[148:151], a[68:71], v[132:135], 0
    ds_read_b64_tr_b16 a[106:107], v46 offset:9216
    v_cvt_pk_bf16_f32 v145, v38, v39
    v_mfma_f32_16x16x32_bf16 a[152:155], a[68:71], v[136:139], 0
    ds_read_b64_tr_b16 a[108:109], v47 offset:8192
    v_fma_mix_f32 v36, v146, v80, v72 op_sel:[0,0,0] op_sel_hi:[1,0,0]
    v_mfma_f32_16x16x32_bf16 a[156:159], a[68:71], v[140:143], 0
    ds_read_b64_tr_b16 a[110:111], v47 offset:9216
    v_fma_mix_f32 v37, v146, v81, v73 op_sel:[1,0,0] op_sel_hi:[1,0,0]
    s_add_u32 m0, s36, 98304
    s_mov_b32 s38, 3145728
    buffer_load_dwordx4 v32, s[16:19], s38 offen lds
    v_mfma_f32_16x16x32_bf16 a[160:163], a[72:75], v[128:131], 0
    ds_read_b64_tr_b16 a[112:113], v48 offset:8192
    v_cvt_pk_bf16_f32 v146, v36, v37
    v_mfma_f32_16x16x32_bf16 a[164:167], a[72:75], v[132:135], 0
    ds_read_b64_tr_b16 a[114:115], v48 offset:9216
    v_fma_mix_f32 v38, v147, v82, v74 op_sel:[0,0,0] op_sel_hi:[1,0,0]
    v_mfma_f32_16x16x32_bf16 a[168:171], a[72:75], v[136:139], 0
    ds_read_b64_tr_b16 a[116:117], v49 offset:8192
    v_fma_mix_f32 v39, v147, v83, v75 op_sel:[1,0,0] op_sel_hi:[1,0,0]
    v_mfma_f32_16x16x32_bf16 a[172:175], a[72:75], v[140:143], 0
    ds_read_b64_tr_b16 a[118:119], v49 offset:9216
    v_cvt_pk_bf16_f32 v147, v38, v39
    buffer_load_dwordx4 v[228:231], v5, s[20:23], s41 offen offset:2048
    v_mfma_f32_16x16x32_bf16 a[176:179], a[76:79], v[128:131], 0
    ds_read_b64_tr_b16 a[120:121], v50 offset:8192
    v_fma_mix_f32 v36, v148, v76, v68 op_sel:[0,0,0] op_sel_hi:[1,0,0]
    v_mfma_f32_16x16x32_bf16 a[180:183], a[76:79], v[132:135], 0
    ds_read_b64_tr_b16 a[122:123], v50 offset:9216
    v_fma_mix_f32 v37, v148, v77, v69 op_sel:[1,0,0] op_sel_hi:[1,0,0]
    v_mfma_f32_16x16x32_bf16 a[184:187], a[76:79], v[136:139], 0
    ds_read_b64_tr_b16 a[124:125], v51 offset:8192
    v_cvt_pk_bf16_f32 v148, v36, v37
    v_mfma_f32_16x16x32_bf16 a[188:191], a[76:79], v[140:143], 0
    ds_read_b64_tr_b16 a[126:127], v51 offset:9216
    v_fma_mix_f32 v38, v149, v78, v70 op_sel:[0,0,0] op_sel_hi:[1,0,0]
    v_mfma_f32_16x16x32_bf16 a[192:195], a[80:83], v[128:131], 0
    ds_read_b128 v[52:55], v34 offset:256
    v_fma_mix_f32 v39, v149, v79, v71 op_sel:[1,0,0] op_sel_hi:[1,0,0]
    v_mfma_f32_16x16x32_bf16 a[196:199], a[80:83], v[132:135], 0
    ds_read_b128 v[56:59], v34 offset:272
    v_cvt_pk_bf16_f32 v149, v38, v39
    v_mfma_f32_16x16x32_bf16 a[200:203], a[80:83], v[136:139], 0
    ds_read_b128 v[60:63], v34 offset:2304
    v_fma_mix_f32 v36, v150, v80, v72 op_sel:[0,0,0] op_sel_hi:[1,0,0]
    v_mfma_f32_16x16x32_bf16 a[204:207], a[80:83], v[140:143], 0
    ds_read_b128 v[64:67], v34 offset:2320
    v_fma_mix_f32 v37, v150, v81, v73 op_sel:[1,0,0] op_sel_hi:[1,0,0]
    v_cvt_pk_bf16_f32 v150, v36, v37
    buffer_load_dwordx4 v[232:235], v6, s[20:23], s41 offen offset:2048
    v_mfma_f32_16x16x32_bf16 a[208:211], a[84:87], v[128:131], 0
    v_fma_mix_f32 v38, v151, v82, v74 op_sel:[0,0,0] op_sel_hi:[1,0,0]
    v_fma_mix_f32 v39, v151, v83, v75 op_sel:[1,0,0] op_sel_hi:[1,0,0]
    v_mfma_f32_16x16x32_bf16 a[212:215], a[84:87], v[132:135], 0
    v_cvt_pk_bf16_f32 v151, v38, v39
    v_fma_mix_f32 v36, v152, v76, v68 op_sel:[0,0,0] op_sel_hi:[1,0,0]
    v_mfma_f32_16x16x32_bf16 a[216:219], a[84:87], v[136:139], 0
    v_fma_mix_f32 v37, v152, v77, v69 op_sel:[1,0,0] op_sel_hi:[1,0,0]
    v_cvt_pk_bf16_f32 v152, v36, v37
    v_mfma_f32_16x16x32_bf16 a[220:223], a[84:87], v[140:143], 0
    v_fma_mix_f32 v38, v153, v78, v70 op_sel:[0,0,0] op_sel_hi:[1,0,0]
    v_fma_mix_f32 v39, v153, v79, v71 op_sel:[1,0,0] op_sel_hi:[1,0,0]
    v_cvt_pk_bf16_f32 v153, v38, v39
    s_add_u32 m0, s36, 99328
    s_mov_b32 s38, 3178496
    buffer_load_dwordx4 v32, s[16:19], s38 offen lds
    v_mfma_f32_16x16x32_bf16 a[224:227], a[88:91], v[128:131], 0
    v_fma_mix_f32 v36, v154, v80, v72 op_sel:[0,0,0] op_sel_hi:[1,0,0]
    v_fma_mix_f32 v37, v154, v81, v73 op_sel:[1,0,0] op_sel_hi:[1,0,0]
    v_mfma_f32_16x16x32_bf16 a[228:231], a[88:91], v[132:135], 0
    v_cvt_pk_bf16_f32 v154, v36, v37
    v_fma_mix_f32 v38, v155, v82, v74 op_sel:[0,0,0] op_sel_hi:[1,0,0]
    v_mfma_f32_16x16x32_bf16 a[232:235], a[88:91], v[136:139], 0
    v_fma_mix_f32 v39, v155, v83, v75 op_sel:[1,0,0] op_sel_hi:[1,0,0]
    v_cvt_pk_bf16_f32 v155, v38, v39
    v_mfma_f32_16x16x32_bf16 a[236:239], a[88:91], v[140:143], 0
    v_fma_mix_f32 v36, v156, v76, v68 op_sel:[0,0,0] op_sel_hi:[1,0,0]
    v_fma_mix_f32 v37, v156, v77, v69 op_sel:[1,0,0] op_sel_hi:[1,0,0]
    v_cvt_pk_bf16_f32 v156, v36, v37
    buffer_load_dwordx4 v[236:239], v7, s[20:23], s41 offen offset:2048
    v_mfma_f32_16x16x32_bf16 a[240:243], a[92:95], v[128:131], 0
    v_fma_mix_f32 v38, v157, v78, v70 op_sel:[0,0,0] op_sel_hi:[1,0,0]
    v_fma_mix_f32 v39, v157, v79, v71 op_sel:[1,0,0] op_sel_hi:[1,0,0]
    v_mfma_f32_16x16x32_bf16 a[244:247], a[92:95], v[132:135], 0
    v_cvt_pk_bf16_f32 v157, v38, v39
    v_fma_mix_f32 v36, v158, v80, v72 op_sel:[0,0,0] op_sel_hi:[1,0,0]
    v_mfma_f32_16x16x32_bf16 a[248:251], a[92:95], v[136:139], 0
    v_fma_mix_f32 v37, v158, v81, v73 op_sel:[1,0,0] op_sel_hi:[1,0,0]
    v_cvt_pk_bf16_f32 v158, v36, v37
    v_mfma_f32_16x16x32_bf16 a[252:255], a[92:95], v[140:143], 0
    v_fma_mix_f32 v38, v159, v82, v74 op_sel:[0,0,0] op_sel_hi:[1,0,0]
    v_fma_mix_f32 v39, v159, v83, v75 op_sel:[1,0,0] op_sel_hi:[1,0,0]
    v_cvt_pk_bf16_f32 v159, v38, v39
    s_waitcnt lgkmcnt(0)
    s_nop 0
    s_waitcnt vmcnt(34)
    v_mfma_f32_16x16x32_bf16 a[128:131], a[96:99], v[144:147], a[128:131]
    ds_read_b64_tr_b16 a[64:65], v44 offset:16384
    v_fma_mix_f32 v36, v160, v60, v52 op_sel:[0,0,0] op_sel_hi:[1,0,0]
    v_mfma_f32_16x16x32_bf16 a[132:135], a[96:99], v[148:151], a[132:135]
    ds_read_b64_tr_b16 a[66:67], v44 offset:17408
    v_fma_mix_f32 v37, v160, v61, v53 op_sel:[1,0,0] op_sel_hi:[1,0,0]
    v_mfma_f32_16x16x32_bf16 a[136:139], a[96:99], v[152:155], a[136:139]
    ds_read_b64_tr_b16 a[68:69], v45 offset:16384
    v_cvt_pk_bf16_f32 v160, v36, v37
    v_mfma_f32_16x16x32_bf16 a[140:143], a[96:99], v[156:159], a[140:143]
    ds_read_b64_tr_b16 a[70:71], v45 offset:17408
    v_fma_mix_f32 v38, v161, v62, v54 op_sel:[0,0,0] op_sel_hi:[1,0,0]
    buffer_load_dwordx4 v[240:243], v4, s[20:23], s41 offen offset:3072
    v_mfma_f32_16x16x32_bf16 a[144:147], a[100:103], v[144:147], a[144:147]
    ds_read_b64_tr_b16 a[72:73], v46 offset:16384
    v_fma_mix_f32 v39, v161, v63, v55 op_sel:[1,0,0] op_sel_hi:[1,0,0]
    v_mfma_f32_16x16x32_bf16 a[148:151], a[100:103], v[148:151], a[148:151]
    ds_read_b64_tr_b16 a[74:75], v46 offset:17408
    v_cvt_pk_bf16_f32 v161, v38, v39
    v_mfma_f32_16x16x32_bf16 a[152:155], a[100:103], v[152:155], a[152:155]
    ds_read_b64_tr_b16 a[76:77], v47 offset:16384
    v_fma_mix_f32 v36, v162, v64, v56 op_sel:[0,0,0] op_sel_hi:[1,0,0]
    v_mfma_f32_16x16x32_bf16 a[156:159], a[100:103], v[156:159], a[156:159]
    ds_read_b64_tr_b16 a[78:79], v47 offset:17408
    v_fma_mix_f32 v37, v162, v65, v57 op_sel:[1,0,0] op_sel_hi:[1,0,0]
    s_add_u32 m0, s36, 100352
    s_mov_b32 s38, 3211264
    buffer_load_dwordx4 v33, s[16:19], s38 offen lds
    v_mfma_f32_16x16x32_bf16 a[160:163], a[104:107], v[144:147], a[160:163]
    ds_read_b64_tr_b16 a[80:81], v48 offset:16384
    v_cvt_pk_bf16_f32 v162, v36, v37
    v_mfma_f32_16x16x32_bf16 a[164:167], a[104:107], v[148:151], a[164:167]
    ds_read_b64_tr_b16 a[82:83], v48 offset:17408
    v_fma_mix_f32 v38, v163, v66, v58 op_sel:[0,0,0] op_sel_hi:[1,0,0]
    v_mfma_f32_16x16x32_bf16 a[168:171], a[104:107], v[152:155], a[168:171]
    ds_read_b64_tr_b16 a[84:85], v49 offset:16384
    v_fma_mix_f32 v39, v163, v67, v59 op_sel:[1,0,0] op_sel_hi:[1,0,0]
    v_mfma_f32_16x16x32_bf16 a[172:175], a[104:107], v[156:159], a[172:175]
    ds_read_b64_tr_b16 a[86:87], v49 offset:17408
    v_cvt_pk_bf16_f32 v163, v38, v39
    buffer_load_dwordx4 v[244:247], v5, s[20:23], s41 offen offset:3072
    v_mfma_f32_16x16x32_bf16 a[176:179], a[108:111], v[144:147], a[176:179]
    ds_read_b64_tr_b16 a[88:89], v50 offset:16384
    v_fma_mix_f32 v36, v164, v60, v52 op_sel:[0,0,0] op_sel_hi:[1,0,0]
    v_mfma_f32_16x16x32_bf16 a[180:183], a[108:111], v[148:151], a[180:183]
    ds_read_b64_tr_b16 a[90:91], v50 offset:17408
    v_fma_mix_f32 v37, v164, v61, v53 op_sel:[1,0,0] op_sel_hi:[1,0,0]
    v_mfma_f32_16x16x32_bf16 a[184:187], a[108:111], v[152:155], a[184:187]
    ds_read_b64_tr_b16 a[92:93], v51 offset:16384
    v_cvt_pk_bf16_f32 v164, v36, v37
    v_mfma_f32_16x16x32_bf16 a[188:191], a[108:111], v[156:159], a[188:191]
    ds_read_b64_tr_b16 a[94:95], v51 offset:17408
    v_fma_mix_f32 v38, v165, v62, v54 op_sel:[0,0,0] op_sel_hi:[1,0,0]
    v_mfma_f32_16x16x32_bf16 a[192:195], a[112:115], v[144:147], a[192:195]
    ds_read_b128 v[68:71], v34 offset:384
    v_fma_mix_f32 v39, v165, v63, v55 op_sel:[1,0,0] op_sel_hi:[1,0,0]
    v_mfma_f32_16x16x32_bf16 a[196:199], a[112:115], v[148:151], a[196:199]
    ds_read_b128 v[72:75], v34 offset:400
    v_cvt_pk_bf16_f32 v165, v38, v39
    v_mfma_f32_16x16x32_bf16 a[200:203], a[112:115], v[152:155], a[200:203]
    ds_read_b128 v[76:79], v34 offset:2432
    v_fma_mix_f32 v36, v166, v64, v56 op_sel:[0,0,0] op_sel_hi:[1,0,0]
    v_mfma_f32_16x16x32_bf16 a[204:207], a[112:115], v[156:159], a[204:207]
    ds_read_b128 v[80:83], v34 offset:2448
    v_fma_mix_f32 v37, v166, v65, v57 op_sel:[1,0,0] op_sel_hi:[1,0,0]
    v_cvt_pk_bf16_f32 v166, v36, v37
    buffer_load_dwordx4 v[248:251], v6, s[20:23], s41 offen offset:3072
    v_mfma_f32_16x16x32_bf16 a[208:211], a[116:119], v[144:147], a[208:211]
    v_fma_mix_f32 v38, v167, v66, v58 op_sel:[0,0,0] op_sel_hi:[1,0,0]
    v_fma_mix_f32 v39, v167, v67, v59 op_sel:[1,0,0] op_sel_hi:[1,0,0]
    v_mfma_f32_16x16x32_bf16 a[212:215], a[116:119], v[148:151], a[212:215]
    v_cvt_pk_bf16_f32 v167, v38, v39
    v_fma_mix_f32 v36, v168, v60, v52 op_sel:[0,0,0] op_sel_hi:[1,0,0]
    v_mfma_f32_16x16x32_bf16 a[216:219], a[116:119], v[152:155], a[216:219]
    v_fma_mix_f32 v37, v168, v61, v53 op_sel:[1,0,0] op_sel_hi:[1,0,0]
    v_cvt_pk_bf16_f32 v168, v36, v37
    v_mfma_f32_16x16x32_bf16 a[220:223], a[116:119], v[156:159], a[220:223]
    v_fma_mix_f32 v38, v169, v62, v54 op_sel:[0,0,0] op_sel_hi:[1,0,0]
    v_fma_mix_f32 v39, v169, v63, v55 op_sel:[1,0,0] op_sel_hi:[1,0,0]
    v_cvt_pk_bf16_f32 v169, v38, v39
    s_add_u32 m0, s36, 101376
    s_mov_b32 s38, 3244032
    buffer_load_dwordx4 v33, s[16:19], s38 offen lds
    v_mfma_f32_16x16x32_bf16 a[224:227], a[120:123], v[144:147], a[224:227]
    v_fma_mix_f32 v36, v170, v64, v56 op_sel:[0,0,0] op_sel_hi:[1,0,0]
    v_fma_mix_f32 v37, v170, v65, v57 op_sel:[1,0,0] op_sel_hi:[1,0,0]
    v_mfma_f32_16x16x32_bf16 a[228:231], a[120:123], v[148:151], a[228:231]
    v_cvt_pk_bf16_f32 v170, v36, v37
    v_fma_mix_f32 v38, v171, v66, v58 op_sel:[0,0,0] op_sel_hi:[1,0,0]
    v_mfma_f32_16x16x32_bf16 a[232:235], a[120:123], v[152:155], a[232:235]
    v_fma_mix_f32 v39, v171, v67, v59 op_sel:[1,0,0] op_sel_hi:[1,0,0]
    v_cvt_pk_bf16_f32 v171, v38, v39
    v_mfma_f32_16x16x32_bf16 a[236:239], a[120:123], v[156:159], a[236:239]
    v_fma_mix_f32 v36, v172, v60, v52 op_sel:[0,0,0] op_sel_hi:[1,0,0]
    v_fma_mix_f32 v37, v172, v61, v53 op_sel:[1,0,0] op_sel_hi:[1,0,0]
    v_cvt_pk_bf16_f32 v172, v36, v37
    buffer_load_dwordx4 v[252:255], v7, s[20:23], s41 offen offset:3072
    v_mfma_f32_16x16x32_bf16 a[240:243], a[124:127], v[144:147], a[240:243]
    v_fma_mix_f32 v38, v173, v62, v54 op_sel:[0,0,0] op_sel_hi:[1,0,0]
    v_fma_mix_f32 v39, v173, v63, v55 op_sel:[1,0,0] op_sel_hi:[1,0,0]
    v_mfma_f32_16x16x32_bf16 a[244:247], a[124:127], v[148:151], a[244:247]
    v_cvt_pk_bf16_f32 v173, v38, v39
    v_fma_mix_f32 v36, v174, v64, v56 op_sel:[0,0,0] op_sel_hi:[1,0,0]
    v_mfma_f32_16x16x32_bf16 a[248:251], a[124:127], v[152:155], a[248:251]
    v_fma_mix_f32 v37, v174, v65, v57 op_sel:[1,0,0] op_sel_hi:[1,0,0]
    v_cvt_pk_bf16_f32 v174, v36, v37
    v_mfma_f32_16x16x32_bf16 a[252:255], a[124:127], v[156:159], a[252:255]
    v_fma_mix_f32 v38, v175, v66, v58 op_sel:[0,0,0] op_sel_hi:[1,0,0]
    v_fma_mix_f32 v39, v175, v67, v59 op_sel:[1,0,0] op_sel_hi:[1,0,0]
    v_cvt_pk_bf16_f32 v175, v38, v39
    s_waitcnt lgkmcnt(0)
    s_nop 0
    s_waitcnt vmcnt(36)
    v_mfma_f32_16x16x32_bf16 a[128:131], a[64:67], v[160:163], a[128:131]
    ds_read_b64_tr_b16 a[96:97], v44 offset:24576
    v_fma_mix_f32 v36, v176, v76, v68 op_sel:[0,0,0] op_sel_hi:[1,0,0]
    v_mfma_f32_16x16x32_bf16 a[132:135], a[64:67], v[164:167], a[132:135]
    ds_read_b64_tr_b16 a[98:99], v44 offset:25600
    v_fma_mix_f32 v37, v176, v77, v69 op_sel:[1,0,0] op_sel_hi:[1,0,0]
    v_mfma_f32_16x16x32_bf16 a[136:139], a[64:67], v[168:171], a[136:139]
    ds_read_b64_tr_b16 a[100:101], v45 offset:24576
    v_cvt_pk_bf16_f32 v176, v36, v37
    v_mfma_f32_16x16x32_bf16 a[140:143], a[64:67], v[172:175], a[140:143]
    ds_read_b64_tr_b16 a[102:103], v45 offset:25600
    v_fma_mix_f32 v38, v177, v78, v70 op_sel:[0,0,0] op_sel_hi:[1,0,0]
    buffer_load_dwordx4 v[128:131], v4, s[20:23], s42 offen offset:0
    v_mfma_f32_16x16x32_bf16 a[144:147], a[68:71], v[160:163], a[144:147]
    ds_read_b64_tr_b16 a[104:105], v46 offset:24576
    v_fma_mix_f32 v39, v177, v79, v71 op_sel:[1,0,0] op_sel_hi:[1,0,0]
    v_mfma_f32_16x16x32_bf16 a[148:151], a[68:71], v[164:167], a[148:151]
    ds_read_b64_tr_b16 a[106:107], v46 offset:25600
    v_cvt_pk_bf16_f32 v177, v38, v39
    v_mfma_f32_16x16x32_bf16 a[152:155], a[68:71], v[168:171], a[152:155]
    ds_read_b64_tr_b16 a[108:109], v47 offset:24576
    v_fma_mix_f32 v36, v178, v80, v72 op_sel:[0,0,0] op_sel_hi:[1,0,0]
    v_mfma_f32_16x16x32_bf16 a[156:159], a[68:71], v[172:175], a[156:159]
    ds_read_b64_tr_b16 a[110:111], v47 offset:25600
    v_fma_mix_f32 v37, v178, v81, v73 op_sel:[1,0,0] op_sel_hi:[1,0,0]
    s_add_u32 m0, s36, 102400
    s_mov_b32 s38, 3276800
    buffer_load_dwordx4 v32, s[16:19], s38 offen lds
    v_mfma_f32_16x16x32_bf16 a[160:163], a[72:75], v[160:163], a[160:163]
    ds_read_b64_tr_b16 a[112:113], v48 offset:24576
    v_cvt_pk_bf16_f32 v178, v36, v37
    v_mfma_f32_16x16x32_bf16 a[164:167], a[72:75], v[164:167], a[164:167]
    ds_read_b64_tr_b16 a[114:115], v48 offset:25600
    v_fma_mix_f32 v38, v179, v82, v74 op_sel:[0,0,0] op_sel_hi:[1,0,0]
    v_mfma_f32_16x16x32_bf16 a[168:171], a[72:75], v[168:171], a[168:171]
    ds_read_b64_tr_b16 a[116:117], v49 offset:24576
    v_fma_mix_f32 v39, v179, v83, v75 op_sel:[1,0,0] op_sel_hi:[1,0,0]
    v_mfma_f32_16x16x32_bf16 a[172:175], a[72:75], v[172:175], a[172:175]
    ds_read_b64_tr_b16 a[118:119], v49 offset:25600
    v_cvt_pk_bf16_f32 v179, v38, v39
    buffer_load_dwordx4 v[132:135], v5, s[20:23], s42 offen offset:0
    v_mfma_f32_16x16x32_bf16 a[176:179], a[76:79], v[160:163], a[176:179]
    ds_read_b64_tr_b16 a[120:121], v50 offset:24576
    v_fma_mix_f32 v36, v180, v76, v68 op_sel:[0,0,0] op_sel_hi:[1,0,0]
    v_mfma_f32_16x16x32_bf16 a[180:183], a[76:79], v[164:167], a[180:183]
    ds_read_b64_tr_b16 a[122:123], v50 offset:25600
    v_fma_mix_f32 v37, v180, v77, v69 op_sel:[1,0,0] op_sel_hi:[1,0,0]
    v_mfma_f32_16x16x32_bf16 a[184:187], a[76:79], v[168:171], a[184:187]
    ds_read_b64_tr_b16 a[124:125], v51 offset:24576
    v_cvt_pk_bf16_f32 v180, v36, v37
    v_mfma_f32_16x16x32_bf16 a[188:191], a[76:79], v[172:175], a[188:191]
    ds_read_b64_tr_b16 a[126:127], v51 offset:25600
    v_fma_mix_f32 v38, v181, v78, v70 op_sel:[0,0,0] op_sel_hi:[1,0,0]
    v_mfma_f32_16x16x32_bf16 a[192:195], a[80:83], v[160:163], a[192:195]
    ds_read_b128 v[52:55], v34 offset:512
    v_fma_mix_f32 v39, v181, v79, v71 op_sel:[1,0,0] op_sel_hi:[1,0,0]
    v_mfma_f32_16x16x32_bf16 a[196:199], a[80:83], v[164:167], a[196:199]
    ds_read_b128 v[56:59], v34 offset:528
    v_cvt_pk_bf16_f32 v181, v38, v39
    v_mfma_f32_16x16x32_bf16 a[200:203], a[80:83], v[168:171], a[200:203]
    ds_read_b128 v[60:63], v34 offset:2560
    v_fma_mix_f32 v36, v182, v80, v72 op_sel:[0,0,0] op_sel_hi:[1,0,0]
    v_mfma_f32_16x16x32_bf16 a[204:207], a[80:83], v[172:175], a[204:207]
    ds_read_b128 v[64:67], v34 offset:2576
    v_fma_mix_f32 v37, v182, v81, v73 op_sel:[1,0,0] op_sel_hi:[1,0,0]
    v_cvt_pk_bf16_f32 v182, v36, v37
    buffer_load_dwordx4 v[136:139], v6, s[20:23], s42 offen offset:0
    v_mfma_f32_16x16x32_bf16 a[208:211], a[84:87], v[160:163], a[208:211]
    v_fma_mix_f32 v38, v183, v82, v74 op_sel:[0,0,0] op_sel_hi:[1,0,0]
    v_fma_mix_f32 v39, v183, v83, v75 op_sel:[1,0,0] op_sel_hi:[1,0,0]
    v_mfma_f32_16x16x32_bf16 a[212:215], a[84:87], v[164:167], a[212:215]
    v_cvt_pk_bf16_f32 v183, v38, v39
    v_fma_mix_f32 v36, v184, v76, v68 op_sel:[0,0,0] op_sel_hi:[1,0,0]
    v_mfma_f32_16x16x32_bf16 a[216:219], a[84:87], v[168:171], a[216:219]
    v_fma_mix_f32 v37, v184, v77, v69 op_sel:[1,0,0] op_sel_hi:[1,0,0]
    v_cvt_pk_bf16_f32 v184, v36, v37
    v_mfma_f32_16x16x32_bf16 a[220:223], a[84:87], v[172:175], a[220:223]
    v_fma_mix_f32 v38, v185, v78, v70 op_sel:[0,0,0] op_sel_hi:[1,0,0]
    v_fma_mix_f32 v39, v185, v79, v71 op_sel:[1,0,0] op_sel_hi:[1,0,0]
    v_cvt_pk_bf16_f32 v185, v38, v39
    s_add_u32 m0, s36, 103424
    s_mov_b32 s38, 3309568
    buffer_load_dwordx4 v32, s[16:19], s38 offen lds
    v_mfma_f32_16x16x32_bf16 a[224:227], a[88:91], v[160:163], a[224:227]
    v_fma_mix_f32 v36, v186, v80, v72 op_sel:[0,0,0] op_sel_hi:[1,0,0]
    v_fma_mix_f32 v37, v186, v81, v73 op_sel:[1,0,0] op_sel_hi:[1,0,0]
    v_mfma_f32_16x16x32_bf16 a[228:231], a[88:91], v[164:167], a[228:231]
    v_cvt_pk_bf16_f32 v186, v36, v37
    v_fma_mix_f32 v38, v187, v82, v74 op_sel:[0,0,0] op_sel_hi:[1,0,0]
    v_mfma_f32_16x16x32_bf16 a[232:235], a[88:91], v[168:171], a[232:235]
    v_fma_mix_f32 v39, v187, v83, v75 op_sel:[1,0,0] op_sel_hi:[1,0,0]
    v_cvt_pk_bf16_f32 v187, v38, v39
    v_mfma_f32_16x16x32_bf16 a[236:239], a[88:91], v[172:175], a[236:239]
    v_fma_mix_f32 v36, v188, v76, v68 op_sel:[0,0,0] op_sel_hi:[1,0,0]
    v_fma_mix_f32 v37, v188, v77, v69 op_sel:[1,0,0] op_sel_hi:[1,0,0]
    v_cvt_pk_bf16_f32 v188, v36, v37
    buffer_load_dwordx4 v[140:143], v7, s[20:23], s42 offen offset:0
    v_mfma_f32_16x16x32_bf16 a[240:243], a[92:95], v[160:163], a[240:243]
    v_fma_mix_f32 v38, v189, v78, v70 op_sel:[0,0,0] op_sel_hi:[1,0,0]
    v_fma_mix_f32 v39, v189, v79, v71 op_sel:[1,0,0] op_sel_hi:[1,0,0]
    v_mfma_f32_16x16x32_bf16 a[244:247], a[92:95], v[164:167], a[244:247]
    v_cvt_pk_bf16_f32 v189, v38, v39
    v_fma_mix_f32 v36, v190, v80, v72 op_sel:[0,0,0] op_sel_hi:[1,0,0]
    v_mfma_f32_16x16x32_bf16 a[248:251], a[92:95], v[168:171], a[248:251]
    v_fma_mix_f32 v37, v190, v81, v73 op_sel:[1,0,0] op_sel_hi:[1,0,0]
    v_cvt_pk_bf16_f32 v190, v36, v37
    v_mfma_f32_16x16x32_bf16 a[252:255], a[92:95], v[172:175], a[252:255]
    v_fma_mix_f32 v38, v191, v82, v74 op_sel:[0,0,0] op_sel_hi:[1,0,0]
    v_fma_mix_f32 v39, v191, v83, v75 op_sel:[1,0,0] op_sel_hi:[1,0,0]
    v_cvt_pk_bf16_f32 v191, v38, v39
    s_waitcnt lgkmcnt(0)
    s_nop 0
    s_waitcnt vmcnt(34)
    s_barrier
    s_waitcnt vmcnt(30)
    v_mfma_f32_16x16x32_bf16 a[128:131], a[96:99], v[176:179], a[128:131]
    ds_read_b64_tr_b16 a[64:65], v44 offset:32768
    v_fma_mix_f32 v36, v192, v60, v52 op_sel:[0,0,0] op_sel_hi:[1,0,0]
    v_mfma_f32_16x16x32_bf16 a[132:135], a[96:99], v[180:183], a[132:135]
    ds_read_b64_tr_b16 a[66:67], v44 offset:33792
    v_fma_mix_f32 v37, v192, v61, v53 op_sel:[1,0,0] op_sel_hi:[1,0,0]
    v_mfma_f32_16x16x32_bf16 a[136:139], a[96:99], v[184:187], a[136:139]
    ds_read_b64_tr_b16 a[68:69], v45 offset:32768
    v_cvt_pk_bf16_f32 v192, v36, v37
    v_mfma_f32_16x16x32_bf16 a[140:143], a[96:99], v[188:191], a[140:143]
    ds_read_b64_tr_b16 a[70:71], v45 offset:33792
    v_fma_mix_f32 v38, v193, v62, v54 op_sel:[0,0,0] op_sel_hi:[1,0,0]
    buffer_load_dwordx4 v[144:147], v4, s[20:23], s42 offen offset:1024
    v_mfma_f32_16x16x32_bf16 a[144:147], a[100:103], v[176:179], a[144:147]
    ds_read_b64_tr_b16 a[72:73], v46 offset:32768
    v_fma_mix_f32 v39, v193, v63, v55 op_sel:[1,0,0] op_sel_hi:[1,0,0]
    v_mfma_f32_16x16x32_bf16 a[148:151], a[100:103], v[180:183], a[148:151]
    ds_read_b64_tr_b16 a[74:75], v46 offset:33792
    v_cvt_pk_bf16_f32 v193, v38, v39
    v_mfma_f32_16x16x32_bf16 a[152:155], a[100:103], v[184:187], a[152:155]
    ds_read_b64_tr_b16 a[76:77], v47 offset:32768
    v_fma_mix_f32 v36, v194, v64, v56 op_sel:[0,0,0] op_sel_hi:[1,0,0]
    v_mfma_f32_16x16x32_bf16 a[156:159], a[100:103], v[188:191], a[156:159]
    ds_read_b64_tr_b16 a[78:79], v47 offset:33792
    v_fma_mix_f32 v37, v194, v65, v57 op_sel:[1,0,0] op_sel_hi:[1,0,0]
    s_add_u32 m0, s36, 104448
    s_mov_b32 s38, 3342336
    buffer_load_dwordx4 v33, s[16:19], s38 offen lds
    v_mfma_f32_16x16x32_bf16 a[160:163], a[104:107], v[176:179], a[160:163]
    ds_read_b64_tr_b16 a[80:81], v48 offset:32768
    v_cvt_pk_bf16_f32 v194, v36, v37
    v_mfma_f32_16x16x32_bf16 a[164:167], a[104:107], v[180:183], a[164:167]
    ds_read_b64_tr_b16 a[82:83], v48 offset:33792
    v_fma_mix_f32 v38, v195, v66, v58 op_sel:[0,0,0] op_sel_hi:[1,0,0]
    v_mfma_f32_16x16x32_bf16 a[168:171], a[104:107], v[184:187], a[168:171]
    ds_read_b64_tr_b16 a[84:85], v49 offset:32768
    v_fma_mix_f32 v39, v195, v67, v59 op_sel:[1,0,0] op_sel_hi:[1,0,0]
    v_mfma_f32_16x16x32_bf16 a[172:175], a[104:107], v[188:191], a[172:175]
    ds_read_b64_tr_b16 a[86:87], v49 offset:33792
    v_cvt_pk_bf16_f32 v195, v38, v39
    buffer_load_dwordx4 v[148:151], v5, s[20:23], s42 offen offset:1024
    v_mfma_f32_16x16x32_bf16 a[176:179], a[108:111], v[176:179], a[176:179]
    ds_read_b64_tr_b16 a[88:89], v50 offset:32768
    v_fma_mix_f32 v36, v196, v60, v52 op_sel:[0,0,0] op_sel_hi:[1,0,0]
    v_mfma_f32_16x16x32_bf16 a[180:183], a[108:111], v[180:183], a[180:183]
    ds_read_b64_tr_b16 a[90:91], v50 offset:33792
    v_fma_mix_f32 v37, v196, v61, v53 op_sel:[1,0,0] op_sel_hi:[1,0,0]
    v_mfma_f32_16x16x32_bf16 a[184:187], a[108:111], v[184:187], a[184:187]
    ds_read_b64_tr_b16 a[92:93], v51 offset:32768
    v_cvt_pk_bf16_f32 v196, v36, v37
    v_mfma_f32_16x16x32_bf16 a[188:191], a[108:111], v[188:191], a[188:191]
    ds_read_b64_tr_b16 a[94:95], v51 offset:33792
    v_fma_mix_f32 v38, v197, v62, v54 op_sel:[0,0,0] op_sel_hi:[1,0,0]
    v_mfma_f32_16x16x32_bf16 a[192:195], a[112:115], v[176:179], a[192:195]
    ds_read_b128 v[68:71], v34 offset:640
    v_fma_mix_f32 v39, v197, v63, v55 op_sel:[1,0,0] op_sel_hi:[1,0,0]
    v_mfma_f32_16x16x32_bf16 a[196:199], a[112:115], v[180:183], a[196:199]
    ds_read_b128 v[72:75], v34 offset:656
    v_cvt_pk_bf16_f32 v197, v38, v39
    v_mfma_f32_16x16x32_bf16 a[200:203], a[112:115], v[184:187], a[200:203]
    ds_read_b128 v[76:79], v34 offset:2688
    v_fma_mix_f32 v36, v198, v64, v56 op_sel:[0,0,0] op_sel_hi:[1,0,0]
    v_mfma_f32_16x16x32_bf16 a[204:207], a[112:115], v[188:191], a[204:207]
    ds_read_b128 v[80:83], v34 offset:2704
    v_fma_mix_f32 v37, v198, v65, v57 op_sel:[1,0,0] op_sel_hi:[1,0,0]
    v_cvt_pk_bf16_f32 v198, v36, v37
    buffer_load_dwordx4 v[152:155], v6, s[20:23], s42 offen offset:1024
    v_mfma_f32_16x16x32_bf16 a[208:211], a[116:119], v[176:179], a[208:211]
    v_fma_mix_f32 v38, v199, v66, v58 op_sel:[0,0,0] op_sel_hi:[1,0,0]
    v_fma_mix_f32 v39, v199, v67, v59 op_sel:[1,0,0] op_sel_hi:[1,0,0]
    v_mfma_f32_16x16x32_bf16 a[212:215], a[116:119], v[180:183], a[212:215]
    v_cvt_pk_bf16_f32 v199, v38, v39
    v_fma_mix_f32 v36, v200, v60, v52 op_sel:[0,0,0] op_sel_hi:[1,0,0]
    v_mfma_f32_16x16x32_bf16 a[216:219], a[116:119], v[184:187], a[216:219]
    v_fma_mix_f32 v37, v200, v61, v53 op_sel:[1,0,0] op_sel_hi:[1,0,0]
    v_cvt_pk_bf16_f32 v200, v36, v37
    v_mfma_f32_16x16x32_bf16 a[220:223], a[116:119], v[188:191], a[220:223]
    v_fma_mix_f32 v38, v201, v62, v54 op_sel:[0,0,0] op_sel_hi:[1,0,0]
    v_fma_mix_f32 v39, v201, v63, v55 op_sel:[1,0,0] op_sel_hi:[1,0,0]
    v_cvt_pk_bf16_f32 v201, v38, v39
    s_add_u32 m0, s36, 105472
    s_mov_b32 s38, 3375104
    buffer_load_dwordx4 v33, s[16:19], s38 offen lds
    v_mfma_f32_16x16x32_bf16 a[224:227], a[120:123], v[176:179], a[224:227]
    v_fma_mix_f32 v36, v202, v64, v56 op_sel:[0,0,0] op_sel_hi:[1,0,0]
    v_fma_mix_f32 v37, v202, v65, v57 op_sel:[1,0,0] op_sel_hi:[1,0,0]
    v_mfma_f32_16x16x32_bf16 a[228:231], a[120:123], v[180:183], a[228:231]
    v_cvt_pk_bf16_f32 v202, v36, v37
    v_fma_mix_f32 v38, v203, v66, v58 op_sel:[0,0,0] op_sel_hi:[1,0,0]
    v_mfma_f32_16x16x32_bf16 a[232:235], a[120:123], v[184:187], a[232:235]
    v_fma_mix_f32 v39, v203, v67, v59 op_sel:[1,0,0] op_sel_hi:[1,0,0]
    v_cvt_pk_bf16_f32 v203, v38, v39
    v_mfma_f32_16x16x32_bf16 a[236:239], a[120:123], v[188:191], a[236:239]
    v_fma_mix_f32 v36, v204, v60, v52 op_sel:[0,0,0] op_sel_hi:[1,0,0]
    v_fma_mix_f32 v37, v204, v61, v53 op_sel:[1,0,0] op_sel_hi:[1,0,0]
    v_cvt_pk_bf16_f32 v204, v36, v37
    buffer_load_dwordx4 v[156:159], v7, s[20:23], s42 offen offset:1024
    v_mfma_f32_16x16x32_bf16 a[240:243], a[124:127], v[176:179], a[240:243]
    v_fma_mix_f32 v38, v205, v62, v54 op_sel:[0,0,0] op_sel_hi:[1,0,0]
    v_fma_mix_f32 v39, v205, v63, v55 op_sel:[1,0,0] op_sel_hi:[1,0,0]
    v_mfma_f32_16x16x32_bf16 a[244:247], a[124:127], v[180:183], a[244:247]
    v_cvt_pk_bf16_f32 v205, v38, v39
    v_fma_mix_f32 v36, v206, v64, v56 op_sel:[0,0,0] op_sel_hi:[1,0,0]
    v_mfma_f32_16x16x32_bf16 a[248:251], a[124:127], v[184:187], a[248:251]
    v_fma_mix_f32 v37, v206, v65, v57 op_sel:[1,0,0] op_sel_hi:[1,0,0]
    v_cvt_pk_bf16_f32 v206, v36, v37
    v_mfma_f32_16x16x32_bf16 a[252:255], a[124:127], v[188:191], a[252:255]
    v_fma_mix_f32 v38, v207, v66, v58 op_sel:[0,0,0] op_sel_hi:[1,0,0]
    v_fma_mix_f32 v39, v207, v67, v59 op_sel:[1,0,0] op_sel_hi:[1,0,0]
    v_cvt_pk_bf16_f32 v207, v38, v39
    s_waitcnt lgkmcnt(0)
    s_nop 0
    s_waitcnt vmcnt(32)
    v_mfma_f32_16x16x32_bf16 a[128:131], a[64:67], v[192:195], a[128:131]
    ds_read_b64_tr_b16 a[96:97], v44 offset:40960
    v_fma_mix_f32 v36, v208, v76, v68 op_sel:[0,0,0] op_sel_hi:[1,0,0]
    v_mfma_f32_16x16x32_bf16 a[132:135], a[64:67], v[196:199], a[132:135]
    ds_read_b64_tr_b16 a[98:99], v44 offset:41984
    v_fma_mix_f32 v37, v208, v77, v69 op_sel:[1,0,0] op_sel_hi:[1,0,0]
    v_mfma_f32_16x16x32_bf16 a[136:139], a[64:67], v[200:203], a[136:139]
    ds_read_b64_tr_b16 a[100:101], v45 offset:40960
    v_cvt_pk_bf16_f32 v208, v36, v37
    v_mfma_f32_16x16x32_bf16 a[140:143], a[64:67], v[204:207], a[140:143]
    ds_read_b64_tr_b16 a[102:103], v45 offset:41984
    v_fma_mix_f32 v38, v209, v78, v70 op_sel:[0,0,0] op_sel_hi:[1,0,0]
    buffer_load_dwordx4 v[160:163], v4, s[20:23], s42 offen offset:2048
    v_mfma_f32_16x16x32_bf16 a[144:147], a[68:71], v[192:195], a[144:147]
    ds_read_b64_tr_b16 a[104:105], v46 offset:40960
    v_fma_mix_f32 v39, v209, v79, v71 op_sel:[1,0,0] op_sel_hi:[1,0,0]
    v_mfma_f32_16x16x32_bf16 a[148:151], a[68:71], v[196:199], a[148:151]
    ds_read_b64_tr_b16 a[106:107], v46 offset:41984
    v_cvt_pk_bf16_f32 v209, v38, v39
    v_mfma_f32_16x16x32_bf16 a[152:155], a[68:71], v[200:203], a[152:155]
    ds_read_b64_tr_b16 a[108:109], v47 offset:40960
    v_fma_mix_f32 v36, v210, v80, v72 op_sel:[0,0,0] op_sel_hi:[1,0,0]
    v_mfma_f32_16x16x32_bf16 a[156:159], a[68:71], v[204:207], a[156:159]
    ds_read_b64_tr_b16 a[110:111], v47 offset:41984
    v_fma_mix_f32 v37, v210, v81, v73 op_sel:[1,0,0] op_sel_hi:[1,0,0]
    v_mfma_f32_16x16x32_bf16 a[160:163], a[72:75], v[192:195], a[160:163]
    ds_read_b64_tr_b16 a[112:113], v48 offset:40960
    v_cvt_pk_bf16_f32 v210, v36, v37
    v_mfma_f32_16x16x32_bf16 a[164:167], a[72:75], v[196:199], a[164:167]
    ds_read_b64_tr_b16 a[114:115], v48 offset:41984
    v_fma_mix_f32 v38, v211, v82, v74 op_sel:[0,0,0] op_sel_hi:[1,0,0]
    v_mfma_f32_16x16x32_bf16 a[168:171], a[72:75], v[200:203], a[168:171]
    ds_read_b64_tr_b16 a[116:117], v49 offset:40960
    v_fma_mix_f32 v39, v211, v83, v75 op_sel:[1,0,0] op_sel_hi:[1,0,0]
    v_mfma_f32_16x16x32_bf16 a[172:175], a[72:75], v[204:207], a[172:175]
    ds_read_b64_tr_b16 a[118:119], v49 offset:41984
    v_cvt_pk_bf16_f32 v211, v38, v39
    buffer_load_dwordx4 v[164:167], v5, s[20:23], s42 offen offset:2048
    v_mfma_f32_16x16x32_bf16 a[176:179], a[76:79], v[192:195], a[176:179]
    ds_read_b64_tr_b16 a[120:121], v50 offset:40960
    v_fma_mix_f32 v36, v212, v76, v68 op_sel:[0,0,0] op_sel_hi:[1,0,0]
    v_mfma_f32_16x16x32_bf16 a[180:183], a[76:79], v[196:199], a[180:183]
    ds_read_b64_tr_b16 a[122:123], v50 offset:41984
    v_fma_mix_f32 v37, v212, v77, v69 op_sel:[1,0,0] op_sel_hi:[1,0,0]
    v_mfma_f32_16x16x32_bf16 a[184:187], a[76:79], v[200:203], a[184:187]
    ds_read_b64_tr_b16 a[124:125], v51 offset:40960
    v_cvt_pk_bf16_f32 v212, v36, v37
    v_mfma_f32_16x16x32_bf16 a[188:191], a[76:79], v[204:207], a[188:191]
    ds_read_b64_tr_b16 a[126:127], v51 offset:41984
    v_fma_mix_f32 v38, v213, v78, v70 op_sel:[0,0,0] op_sel_hi:[1,0,0]
    v_mfma_f32_16x16x32_bf16 a[192:195], a[80:83], v[192:195], a[192:195]
    ds_read_b128 v[52:55], v34 offset:768
    v_fma_mix_f32 v39, v213, v79, v71 op_sel:[1,0,0] op_sel_hi:[1,0,0]
    v_mfma_f32_16x16x32_bf16 a[196:199], a[80:83], v[196:199], a[196:199]
    ds_read_b128 v[56:59], v34 offset:784
    v_cvt_pk_bf16_f32 v213, v38, v39
    v_mfma_f32_16x16x32_bf16 a[200:203], a[80:83], v[200:203], a[200:203]
    ds_read_b128 v[60:63], v34 offset:2816
    v_fma_mix_f32 v36, v214, v80, v72 op_sel:[0,0,0] op_sel_hi:[1,0,0]
    v_mfma_f32_16x16x32_bf16 a[204:207], a[80:83], v[204:207], a[204:207]
    ds_read_b128 v[64:67], v34 offset:2832
    v_fma_mix_f32 v37, v214, v81, v73 op_sel:[1,0,0] op_sel_hi:[1,0,0]
    v_cvt_pk_bf16_f32 v214, v36, v37
    buffer_load_dwordx4 v[168:171], v6, s[20:23], s42 offen offset:2048
    v_mfma_f32_16x16x32_bf16 a[208:211], a[84:87], v[192:195], a[208:211]
    v_fma_mix_f32 v38, v215, v82, v74 op_sel:[0,0,0] op_sel_hi:[1,0,0]
    v_fma_mix_f32 v39, v215, v83, v75 op_sel:[1,0,0] op_sel_hi:[1,0,0]
    v_mfma_f32_16x16x32_bf16 a[212:215], a[84:87], v[196:199], a[212:215]
    v_cvt_pk_bf16_f32 v215, v38, v39
    v_fma_mix_f32 v36, v216, v76, v68 op_sel:[0,0,0] op_sel_hi:[1,0,0]
    v_mfma_f32_16x16x32_bf16 a[216:219], a[84:87], v[200:203], a[216:219]
    v_fma_mix_f32 v37, v216, v77, v69 op_sel:[1,0,0] op_sel_hi:[1,0,0]
    v_cvt_pk_bf16_f32 v216, v36, v37
    v_mfma_f32_16x16x32_bf16 a[220:223], a[84:87], v[204:207], a[220:223]
    v_fma_mix_f32 v38, v217, v78, v70 op_sel:[0,0,0] op_sel_hi:[1,0,0]
    v_fma_mix_f32 v39, v217, v79, v71 op_sel:[1,0,0] op_sel_hi:[1,0,0]
    v_cvt_pk_bf16_f32 v217, v38, v39
    v_mfma_f32_16x16x32_bf16 a[224:227], a[88:91], v[192:195], a[224:227]
    v_fma_mix_f32 v36, v218, v80, v72 op_sel:[0,0,0] op_sel_hi:[1,0,0]
    v_fma_mix_f32 v37, v218, v81, v73 op_sel:[1,0,0] op_sel_hi:[1,0,0]
    v_mfma_f32_16x16x32_bf16 a[228:231], a[88:91], v[196:199], a[228:231]
    v_cvt_pk_bf16_f32 v218, v36, v37
    v_fma_mix_f32 v38, v219, v82, v74 op_sel:[0,0,0] op_sel_hi:[1,0,0]
    v_mfma_f32_16x16x32_bf16 a[232:235], a[88:91], v[200:203], a[232:235]
    v_fma_mix_f32 v39, v219, v83, v75 op_sel:[1,0,0] op_sel_hi:[1,0,0]
    v_cvt_pk_bf16_f32 v219, v38, v39
    v_mfma_f32_16x16x32_bf16 a[236:239], a[88:91], v[204:207], a[236:239]
    v_fma_mix_f32 v36, v220, v76, v68 op_sel:[0,0,0] op_sel_hi:[1,0,0]
    v_fma_mix_f32 v37, v220, v77, v69 op_sel:[1,0,0] op_sel_hi:[1,0,0]
    v_cvt_pk_bf16_f32 v220, v36, v37
    buffer_load_dwordx4 v[172:175], v7, s[20:23], s42 offen offset:2048
    v_mfma_f32_16x16x32_bf16 a[240:243], a[92:95], v[192:195], a[240:243]
    v_fma_mix_f32 v38, v221, v78, v70 op_sel:[0,0,0] op_sel_hi:[1,0,0]
    v_fma_mix_f32 v39, v221, v79, v71 op_sel:[1,0,0] op_sel_hi:[1,0,0]
    v_mfma_f32_16x16x32_bf16 a[244:247], a[92:95], v[196:199], a[244:247]
    v_cvt_pk_bf16_f32 v221, v38, v39
    v_fma_mix_f32 v36, v222, v80, v72 op_sel:[0,0,0] op_sel_hi:[1,0,0]
    v_mfma_f32_16x16x32_bf16 a[248:251], a[92:95], v[200:203], a[248:251]
    v_fma_mix_f32 v37, v222, v81, v73 op_sel:[1,0,0] op_sel_hi:[1,0,0]
    v_cvt_pk_bf16_f32 v222, v36, v37
    v_mfma_f32_16x16x32_bf16 a[252:255], a[92:95], v[204:207], a[252:255]
    v_fma_mix_f32 v38, v223, v82, v74 op_sel:[0,0,0] op_sel_hi:[1,0,0]
    v_fma_mix_f32 v39, v223, v83, v75 op_sel:[1,0,0] op_sel_hi:[1,0,0]
    v_cvt_pk_bf16_f32 v223, v38, v39
    s_waitcnt lgkmcnt(0)
    s_nop 0
    s_waitcnt vmcnt(22)
    v_mfma_f32_16x16x32_bf16 a[128:131], a[96:99], v[208:211], a[128:131]
    ds_read_b64_tr_b16 a[64:65], v44 offset:49152
    v_fma_mix_f32 v36, v224, v60, v52 op_sel:[0,0,0] op_sel_hi:[1,0,0]
    v_mfma_f32_16x16x32_bf16 a[132:135], a[96:99], v[212:215], a[132:135]
    ds_read_b64_tr_b16 a[66:67], v44 offset:50176
    v_fma_mix_f32 v37, v224, v61, v53 op_sel:[1,0,0] op_sel_hi:[1,0,0]
    v_mfma_f32_16x16x32_bf16 a[136:139], a[96:99], v[216:219], a[136:139]
    ds_read_b64_tr_b16 a[68:69], v45 offset:49152
    v_cvt_pk_bf16_f32 v224, v36, v37
    v_mfma_f32_16x16x32_bf16 a[140:143], a[96:99], v[220:223], a[140:143]
    ds_read_b64_tr_b16 a[70:71], v45 offset:50176
    v_fma_mix_f32 v38, v225, v62, v54 op_sel:[0,0,0] op_sel_hi:[1,0,0]
    buffer_load_dwordx4 v[176:179], v4, s[20:23], s42 offen offset:3072
    v_mfma_f32_16x16x32_bf16 a[144:147], a[100:103], v[208:211], a[144:147]
    ds_read_b64_tr_b16 a[72:73], v46 offset:49152
    v_fma_mix_f32 v39, v225, v63, v55 op_sel:[1,0,0] op_sel_hi:[1,0,0]
    v_mfma_f32_16x16x32_bf16 a[148:151], a[100:103], v[212:215], a[148:151]
    ds_read_b64_tr_b16 a[74:75], v46 offset:50176
    v_cvt_pk_bf16_f32 v225, v38, v39
    v_mfma_f32_16x16x32_bf16 a[152:155], a[100:103], v[216:219], a[152:155]
    ds_read_b64_tr_b16 a[76:77], v47 offset:49152
    v_fma_mix_f32 v36, v226, v64, v56 op_sel:[0,0,0] op_sel_hi:[1,0,0]
    v_mfma_f32_16x16x32_bf16 a[156:159], a[100:103], v[220:223], a[156:159]
    ds_read_b64_tr_b16 a[78:79], v47 offset:50176
    v_fma_mix_f32 v37, v226, v65, v57 op_sel:[1,0,0] op_sel_hi:[1,0,0]
    v_mfma_f32_16x16x32_bf16 a[160:163], a[104:107], v[208:211], a[160:163]
    ds_read_b64_tr_b16 a[80:81], v48 offset:49152
    v_cvt_pk_bf16_f32 v226, v36, v37
    v_mfma_f32_16x16x32_bf16 a[164:167], a[104:107], v[212:215], a[164:167]
    ds_read_b64_tr_b16 a[82:83], v48 offset:50176
    v_fma_mix_f32 v38, v227, v66, v58 op_sel:[0,0,0] op_sel_hi:[1,0,0]
    v_mfma_f32_16x16x32_bf16 a[168:171], a[104:107], v[216:219], a[168:171]
    ds_read_b64_tr_b16 a[84:85], v49 offset:49152
    v_fma_mix_f32 v39, v227, v67, v59 op_sel:[1,0,0] op_sel_hi:[1,0,0]
    v_mfma_f32_16x16x32_bf16 a[172:175], a[104:107], v[220:223], a[172:175]
    ds_read_b64_tr_b16 a[86:87], v49 offset:50176
    v_cvt_pk_bf16_f32 v227, v38, v39
    buffer_load_dwordx4 v[180:183], v5, s[20:23], s42 offen offset:3072
    v_mfma_f32_16x16x32_bf16 a[176:179], a[108:111], v[208:211], a[176:179]
    ds_read_b64_tr_b16 a[88:89], v50 offset:49152
    v_fma_mix_f32 v36, v228, v60, v52 op_sel:[0,0,0] op_sel_hi:[1,0,0]
    v_mfma_f32_16x16x32_bf16 a[180:183], a[108:111], v[212:215], a[180:183]
    ds_read_b64_tr_b16 a[90:91], v50 offset:50176
    v_fma_mix_f32 v37, v228, v61, v53 op_sel:[1,0,0] op_sel_hi:[1,0,0]
    v_mfma_f32_16x16x32_bf16 a[184:187], a[108:111], v[216:219], a[184:187]
    ds_read_b64_tr_b16 a[92:93], v51 offset:49152
    v_cvt_pk_bf16_f32 v228, v36, v37
    v_mfma_f32_16x16x32_bf16 a[188:191], a[108:111], v[220:223], a[188:191]
    ds_read_b64_tr_b16 a[94:95], v51 offset:50176
    v_fma_mix_f32 v38, v229, v62, v54 op_sel:[0,0,0] op_sel_hi:[1,0,0]
    v_mfma_f32_16x16x32_bf16 a[192:195], a[112:115], v[208:211], a[192:195]
    ds_read_b128 v[68:71], v34 offset:896
    v_fma_mix_f32 v39, v229, v63, v55 op_sel:[1,0,0] op_sel_hi:[1,0,0]
    v_mfma_f32_16x16x32_bf16 a[196:199], a[112:115], v[212:215], a[196:199]
    ds_read_b128 v[72:75], v34 offset:912
    v_cvt_pk_bf16_f32 v229, v38, v39
    v_mfma_f32_16x16x32_bf16 a[200:203], a[112:115], v[216:219], a[200:203]
    ds_read_b128 v[76:79], v34 offset:2944
    v_fma_mix_f32 v36, v230, v64, v56 op_sel:[0,0,0] op_sel_hi:[1,0,0]
    v_mfma_f32_16x16x32_bf16 a[204:207], a[112:115], v[220:223], a[204:207]
    ds_read_b128 v[80:83], v34 offset:2960
    v_fma_mix_f32 v37, v230, v65, v57 op_sel:[1,0,0] op_sel_hi:[1,0,0]
    v_cvt_pk_bf16_f32 v230, v36, v37
    buffer_load_dwordx4 v[184:187], v6, s[20:23], s42 offen offset:3072
    v_mfma_f32_16x16x32_bf16 a[208:211], a[116:119], v[208:211], a[208:211]
    v_fma_mix_f32 v38, v231, v66, v58 op_sel:[0,0,0] op_sel_hi:[1,0,0]
    v_fma_mix_f32 v39, v231, v67, v59 op_sel:[1,0,0] op_sel_hi:[1,0,0]
    v_mfma_f32_16x16x32_bf16 a[212:215], a[116:119], v[212:215], a[212:215]
    v_cvt_pk_bf16_f32 v231, v38, v39
    v_fma_mix_f32 v36, v232, v60, v52 op_sel:[0,0,0] op_sel_hi:[1,0,0]
    v_mfma_f32_16x16x32_bf16 a[216:219], a[116:119], v[216:219], a[216:219]
    v_fma_mix_f32 v37, v232, v61, v53 op_sel:[1,0,0] op_sel_hi:[1,0,0]
    v_cvt_pk_bf16_f32 v232, v36, v37
    v_mfma_f32_16x16x32_bf16 a[220:223], a[116:119], v[220:223], a[220:223]
    v_fma_mix_f32 v38, v233, v62, v54 op_sel:[0,0,0] op_sel_hi:[1,0,0]
    v_fma_mix_f32 v39, v233, v63, v55 op_sel:[1,0,0] op_sel_hi:[1,0,0]
    v_cvt_pk_bf16_f32 v233, v38, v39
    v_mfma_f32_16x16x32_bf16 a[224:227], a[120:123], v[208:211], a[224:227]
    v_fma_mix_f32 v36, v234, v64, v56 op_sel:[0,0,0] op_sel_hi:[1,0,0]
    v_fma_mix_f32 v37, v234, v65, v57 op_sel:[1,0,0] op_sel_hi:[1,0,0]
    v_mfma_f32_16x16x32_bf16 a[228:231], a[120:123], v[212:215], a[228:231]
    v_cvt_pk_bf16_f32 v234, v36, v37
    v_fma_mix_f32 v38, v235, v66, v58 op_sel:[0,0,0] op_sel_hi:[1,0,0]
    v_mfma_f32_16x16x32_bf16 a[232:235], a[120:123], v[216:219], a[232:235]
    v_fma_mix_f32 v39, v235, v67, v59 op_sel:[1,0,0] op_sel_hi:[1,0,0]
    v_cvt_pk_bf16_f32 v235, v38, v39
    v_mfma_f32_16x16x32_bf16 a[236:239], a[120:123], v[220:223], a[236:239]
    v_fma_mix_f32 v36, v236, v60, v52 op_sel:[0,0,0] op_sel_hi:[1,0,0]
    v_fma_mix_f32 v37, v236, v61, v53 op_sel:[1,0,0] op_sel_hi:[1,0,0]
    v_cvt_pk_bf16_f32 v236, v36, v37
    buffer_load_dwordx4 v[188:191], v7, s[20:23], s42 offen offset:3072
    v_mfma_f32_16x16x32_bf16 a[240:243], a[124:127], v[208:211], a[240:243]
    v_fma_mix_f32 v38, v237, v62, v54 op_sel:[0,0,0] op_sel_hi:[1,0,0]
    v_fma_mix_f32 v39, v237, v63, v55 op_sel:[1,0,0] op_sel_hi:[1,0,0]
    v_mfma_f32_16x16x32_bf16 a[244:247], a[124:127], v[212:215], a[244:247]
    v_cvt_pk_bf16_f32 v237, v38, v39
    v_fma_mix_f32 v36, v238, v64, v56 op_sel:[0,0,0] op_sel_hi:[1,0,0]
    v_mfma_f32_16x16x32_bf16 a[248:251], a[124:127], v[216:219], a[248:251]
    v_fma_mix_f32 v37, v238, v65, v57 op_sel:[1,0,0] op_sel_hi:[1,0,0]
    v_cvt_pk_bf16_f32 v238, v36, v37
    v_mfma_f32_16x16x32_bf16 a[252:255], a[124:127], v[220:223], a[252:255]
    v_fma_mix_f32 v38, v239, v66, v58 op_sel:[0,0,0] op_sel_hi:[1,0,0]
    v_fma_mix_f32 v39, v239, v67, v59 op_sel:[1,0,0] op_sel_hi:[1,0,0]
    v_cvt_pk_bf16_f32 v239, v38, v39
    s_waitcnt lgkmcnt(0)
    s_nop 0
    s_waitcnt vmcnt(20)
    v_mfma_f32_16x16x32_bf16 a[128:131], a[64:67], v[224:227], a[128:131]
    ds_read_b64_tr_b16 a[96:97], v44 offset:57344
    v_fma_mix_f32 v36, v240, v76, v68 op_sel:[0,0,0] op_sel_hi:[1,0,0]
    v_mfma_f32_16x16x32_bf16 a[132:135], a[64:67], v[228:231], a[132:135]
    ds_read_b64_tr_b16 a[98:99], v44 offset:58368
    v_fma_mix_f32 v37, v240, v77, v69 op_sel:[1,0,0] op_sel_hi:[1,0,0]
    v_mfma_f32_16x16x32_bf16 a[136:139], a[64:67], v[232:235], a[136:139]
    ds_read_b64_tr_b16 a[100:101], v45 offset:57344
    v_cvt_pk_bf16_f32 v240, v36, v37
    v_mfma_f32_16x16x32_bf16 a[140:143], a[64:67], v[236:239], a[140:143]
    ds_read_b64_tr_b16 a[102:103], v45 offset:58368
    v_fma_mix_f32 v38, v241, v78, v70 op_sel:[0,0,0] op_sel_hi:[1,0,0]
    buffer_load_dwordx4 v[192:195], v4, s[20:23], s43 offen offset:0
    v_mfma_f32_16x16x32_bf16 a[144:147], a[68:71], v[224:227], a[144:147]
    ds_read_b64_tr_b16 a[104:105], v46 offset:57344
    v_fma_mix_f32 v39, v241, v79, v71 op_sel:[1,0,0] op_sel_hi:[1,0,0]
    v_mfma_f32_16x16x32_bf16 a[148:151], a[68:71], v[228:231], a[148:151]
    ds_read_b64_tr_b16 a[106:107], v46 offset:58368
    v_cvt_pk_bf16_f32 v241, v38, v39
    v_mfma_f32_16x16x32_bf16 a[152:155], a[68:71], v[232:235], a[152:155]
    ds_read_b64_tr_b16 a[108:109], v47 offset:57344
    v_fma_mix_f32 v36, v242, v80, v72 op_sel:[0,0,0] op_sel_hi:[1,0,0]
    v_mfma_f32_16x16x32_bf16 a[156:159], a[68:71], v[236:239], a[156:159]
    ds_read_b64_tr_b16 a[110:111], v47 offset:58368
    v_fma_mix_f32 v37, v242, v81, v73 op_sel:[1,0,0] op_sel_hi:[1,0,0]
    v_mfma_f32_16x16x32_bf16 a[160:163], a[72:75], v[224:227], a[160:163]
    ds_read_b64_tr_b16 a[112:113], v48 offset:57344
    v_cvt_pk_bf16_f32 v242, v36, v37
    v_mfma_f32_16x16x32_bf16 a[164:167], a[72:75], v[228:231], a[164:167]
    ds_read_b64_tr_b16 a[114:115], v48 offset:58368
    v_fma_mix_f32 v38, v243, v82, v74 op_sel:[0,0,0] op_sel_hi:[1,0,0]
    v_mfma_f32_16x16x32_bf16 a[168:171], a[72:75], v[232:235], a[168:171]
    ds_read_b64_tr_b16 a[116:117], v49 offset:57344
    v_fma_mix_f32 v39, v243, v83, v75 op_sel:[1,0,0] op_sel_hi:[1,0,0]
    v_mfma_f32_16x16x32_bf16 a[172:175], a[72:75], v[236:239], a[172:175]
    ds_read_b64_tr_b16 a[118:119], v49 offset:58368
    v_cvt_pk_bf16_f32 v243, v38, v39
    buffer_load_dwordx4 v[196:199], v5, s[20:23], s43 offen offset:0
    v_mfma_f32_16x16x32_bf16 a[176:179], a[76:79], v[224:227], a[176:179]
    ds_read_b64_tr_b16 a[120:121], v50 offset:57344
    v_fma_mix_f32 v36, v244, v76, v68 op_sel:[0,0,0] op_sel_hi:[1,0,0]
    v_mfma_f32_16x16x32_bf16 a[180:183], a[76:79], v[228:231], a[180:183]
    ds_read_b64_tr_b16 a[122:123], v50 offset:58368
    v_fma_mix_f32 v37, v244, v77, v69 op_sel:[1,0,0] op_sel_hi:[1,0,0]
    v_mfma_f32_16x16x32_bf16 a[184:187], a[76:79], v[232:235], a[184:187]
    ds_read_b64_tr_b16 a[124:125], v51 offset:57344
    v_cvt_pk_bf16_f32 v244, v36, v37
    v_mfma_f32_16x16x32_bf16 a[188:191], a[76:79], v[236:239], a[188:191]
    ds_read_b64_tr_b16 a[126:127], v51 offset:58368
    v_fma_mix_f32 v38, v245, v78, v70 op_sel:[0,0,0] op_sel_hi:[1,0,0]
    v_mfma_f32_16x16x32_bf16 a[192:195], a[80:83], v[224:227], a[192:195]
    ds_read_b128 v[52:55], v34 offset:1024
    v_fma_mix_f32 v39, v245, v79, v71 op_sel:[1,0,0] op_sel_hi:[1,0,0]
    v_mfma_f32_16x16x32_bf16 a[196:199], a[80:83], v[228:231], a[196:199]
    ds_read_b128 v[56:59], v34 offset:1040
    v_cvt_pk_bf16_f32 v245, v38, v39
    v_mfma_f32_16x16x32_bf16 a[200:203], a[80:83], v[232:235], a[200:203]
    ds_read_b128 v[60:63], v34 offset:3072
    v_fma_mix_f32 v36, v246, v80, v72 op_sel:[0,0,0] op_sel_hi:[1,0,0]
    v_mfma_f32_16x16x32_bf16 a[204:207], a[80:83], v[236:239], a[204:207]
    ds_read_b128 v[64:67], v34 offset:3088
    v_fma_mix_f32 v37, v246, v81, v73 op_sel:[1,0,0] op_sel_hi:[1,0,0]
    v_cvt_pk_bf16_f32 v246, v36, v37
    buffer_load_dwordx4 v[200:203], v6, s[20:23], s43 offen offset:0
    v_mfma_f32_16x16x32_bf16 a[208:211], a[84:87], v[224:227], a[208:211]
    v_fma_mix_f32 v38, v247, v82, v74 op_sel:[0,0,0] op_sel_hi:[1,0,0]
    v_fma_mix_f32 v39, v247, v83, v75 op_sel:[1,0,0] op_sel_hi:[1,0,0]
    v_mfma_f32_16x16x32_bf16 a[212:215], a[84:87], v[228:231], a[212:215]
    v_cvt_pk_bf16_f32 v247, v38, v39
    v_fma_mix_f32 v36, v248, v76, v68 op_sel:[0,0,0] op_sel_hi:[1,0,0]
    v_mfma_f32_16x16x32_bf16 a[216:219], a[84:87], v[232:235], a[216:219]
    v_fma_mix_f32 v37, v248, v77, v69 op_sel:[1,0,0] op_sel_hi:[1,0,0]
    v_cvt_pk_bf16_f32 v248, v36, v37
    v_mfma_f32_16x16x32_bf16 a[220:223], a[84:87], v[236:239], a[220:223]
    v_fma_mix_f32 v38, v249, v78, v70 op_sel:[0,0,0] op_sel_hi:[1,0,0]
    v_fma_mix_f32 v39, v249, v79, v71 op_sel:[1,0,0] op_sel_hi:[1,0,0]
    v_cvt_pk_bf16_f32 v249, v38, v39
    v_mfma_f32_16x16x32_bf16 a[224:227], a[88:91], v[224:227], a[224:227]
    v_fma_mix_f32 v36, v250, v80, v72 op_sel:[0,0,0] op_sel_hi:[1,0,0]
    v_fma_mix_f32 v37, v250, v81, v73 op_sel:[1,0,0] op_sel_hi:[1,0,0]
    v_mfma_f32_16x16x32_bf16 a[228:231], a[88:91], v[228:231], a[228:231]
    v_cvt_pk_bf16_f32 v250, v36, v37
    v_fma_mix_f32 v38, v251, v82, v74 op_sel:[0,0,0] op_sel_hi:[1,0,0]
    v_mfma_f32_16x16x32_bf16 a[232:235], a[88:91], v[232:235], a[232:235]
    v_fma_mix_f32 v39, v251, v83, v75 op_sel:[1,0,0] op_sel_hi:[1,0,0]
    v_cvt_pk_bf16_f32 v251, v38, v39
    v_mfma_f32_16x16x32_bf16 a[236:239], a[88:91], v[236:239], a[236:239]
    v_fma_mix_f32 v36, v252, v76, v68 op_sel:[0,0,0] op_sel_hi:[1,0,0]
    v_fma_mix_f32 v37, v252, v77, v69 op_sel:[1,0,0] op_sel_hi:[1,0,0]
    v_cvt_pk_bf16_f32 v252, v36, v37
    buffer_load_dwordx4 v[204:207], v7, s[20:23], s43 offen offset:0
    v_mfma_f32_16x16x32_bf16 a[240:243], a[92:95], v[224:227], a[240:243]
    v_fma_mix_f32 v38, v253, v78, v70 op_sel:[0,0,0] op_sel_hi:[1,0,0]
    v_fma_mix_f32 v39, v253, v79, v71 op_sel:[1,0,0] op_sel_hi:[1,0,0]
    v_mfma_f32_16x16x32_bf16 a[244:247], a[92:95], v[228:231], a[244:247]
    v_cvt_pk_bf16_f32 v253, v38, v39
    v_fma_mix_f32 v36, v254, v80, v72 op_sel:[0,0,0] op_sel_hi:[1,0,0]
    v_mfma_f32_16x16x32_bf16 a[248:251], a[92:95], v[232:235], a[248:251]
    v_fma_mix_f32 v37, v254, v81, v73 op_sel:[1,0,0] op_sel_hi:[1,0,0]
    v_cvt_pk_bf16_f32 v254, v36, v37
    v_mfma_f32_16x16x32_bf16 a[252:255], a[92:95], v[236:239], a[252:255]
    v_fma_mix_f32 v38, v255, v82, v74 op_sel:[0,0,0] op_sel_hi:[1,0,0]
    v_fma_mix_f32 v39, v255, v83, v75 op_sel:[1,0,0] op_sel_hi:[1,0,0]
    v_cvt_pk_bf16_f32 v255, v38, v39
    s_waitcnt lgkmcnt(0)
    s_nop 0
    s_barrier
    v_add_u32 v44, 0x10000, v44
    v_add_u32 v45, 0x10000, v45
    v_add_u32 v46, 0x10000, v46
    v_add_u32 v47, 0x10000, v47
    v_add_u32 v48, 0x10000, v48
    v_add_u32 v49, 0x10000, v49
    v_add_u32 v50, 0x10000, v50
    v_add_u32 v51, 0x10000, v51
    s_waitcnt vmcnt(18)
    v_mfma_f32_16x16x32_bf16 a[128:131], a[96:99], v[240:243], a[128:131]
    ds_read_b64_tr_b16 a[64:65], v44 offset:0
    v_fma_mix_f32 v36, v128, v60, v52 op_sel:[0,0,0] op_sel_hi:[1,0,0]
    v_mfma_f32_16x16x32_bf16 a[132:135], a[96:99], v[244:247], a[132:135]
    ds_read_b64_tr_b16 a[66:67], v44 offset:1024
    v_fma_mix_f32 v37, v128, v61, v53 op_sel:[1,0,0] op_sel_hi:[1,0,0]
    v_mfma_f32_16x16x32_bf16 a[136:139], a[96:99], v[248:251], a[136:139]
    ds_read_b64_tr_b16 a[68:69], v45 offset:0
    v_cvt_pk_bf16_f32 v128, v36, v37
    v_mfma_f32_16x16x32_bf16 a[140:143], a[96:99], v[252:255], a[140:143]
    ds_read_b64_tr_b16 a[70:71], v45 offset:1024
    v_fma_mix_f32 v38, v129, v62, v54 op_sel:[0,0,0] op_sel_hi:[1,0,0]
    buffer_load_dwordx4 v[208:211], v4, s[20:23], s43 offen offset:1024
    v_mfma_f32_16x16x32_bf16 a[144:147], a[100:103], v[240:243], a[144:147]
    ds_read_b64_tr_b16 a[72:73], v46 offset:0
    v_fma_mix_f32 v39, v129, v63, v55 op_sel:[1,0,0] op_sel_hi:[1,0,0]
    v_mfma_f32_16x16x32_bf16 a[148:151], a[100:103], v[244:247], a[148:151]
    ds_read_b64_tr_b16 a[74:75], v46 offset:1024
    v_cvt_pk_bf16_f32 v129, v38, v39
    v_mfma_f32_16x16x32_bf16 a[152:155], a[100:103], v[248:251], a[152:155]
    ds_read_b64_tr_b16 a[76:77], v47 offset:0
    v_fma_mix_f32 v36, v130, v64, v56 op_sel:[0,0,0] op_sel_hi:[1,0,0]
    v_mfma_f32_16x16x32_bf16 a[156:159], a[100:103], v[252:255], a[156:159]
    ds_read_b64_tr_b16 a[78:79], v47 offset:1024
    v_fma_mix_f32 v37, v130, v65, v57 op_sel:[1,0,0] op_sel_hi:[1,0,0]
    v_mfma_f32_16x16x32_bf16 a[160:163], a[104:107], v[240:243], a[160:163]
    ds_read_b64_tr_b16 a[80:81], v48 offset:0
    v_cvt_pk_bf16_f32 v130, v36, v37
    v_mfma_f32_16x16x32_bf16 a[164:167], a[104:107], v[244:247], a[164:167]
    ds_read_b64_tr_b16 a[82:83], v48 offset:1024
    v_fma_mix_f32 v38, v131, v66, v58 op_sel:[0,0,0] op_sel_hi:[1,0,0]
    v_mfma_f32_16x16x32_bf16 a[168:171], a[104:107], v[248:251], a[168:171]
    ds_read_b64_tr_b16 a[84:85], v49 offset:0
    v_fma_mix_f32 v39, v131, v67, v59 op_sel:[1,0,0] op_sel_hi:[1,0,0]
    v_mfma_f32_16x16x32_bf16 a[172:175], a[104:107], v[252:255], a[172:175]
    ds_read_b64_tr_b16 a[86:87], v49 offset:1024
    v_cvt_pk_bf16_f32 v131, v38, v39
    buffer_load_dwordx4 v[212:215], v5, s[20:23], s43 offen offset:1024
    v_mfma_f32_16x16x32_bf16 a[176:179], a[108:111], v[240:243], a[176:179]
    ds_read_b64_tr_b16 a[88:89], v50 offset:0
    v_fma_mix_f32 v36, v132, v60, v52 op_sel:[0,0,0] op_sel_hi:[1,0,0]
    v_mfma_f32_16x16x32_bf16 a[180:183], a[108:111], v[244:247], a[180:183]
    ds_read_b64_tr_b16 a[90:91], v50 offset:1024
    v_fma_mix_f32 v37, v132, v61, v53 op_sel:[1,0,0] op_sel_hi:[1,0,0]
    v_mfma_f32_16x16x32_bf16 a[184:187], a[108:111], v[248:251], a[184:187]
    ds_read_b64_tr_b16 a[92:93], v51 offset:0
    v_cvt_pk_bf16_f32 v132, v36, v37
    v_mfma_f32_16x16x32_bf16 a[188:191], a[108:111], v[252:255], a[188:191]
    ds_read_b64_tr_b16 a[94:95], v51 offset:1024
    v_fma_mix_f32 v38, v133, v62, v54 op_sel:[0,0,0] op_sel_hi:[1,0,0]
    v_mfma_f32_16x16x32_bf16 a[192:195], a[112:115], v[240:243], a[192:195]
    ds_read_b128 v[68:71], v34 offset:1152
    v_fma_mix_f32 v39, v133, v63, v55 op_sel:[1,0,0] op_sel_hi:[1,0,0]
    v_mfma_f32_16x16x32_bf16 a[196:199], a[112:115], v[244:247], a[196:199]
    ds_read_b128 v[72:75], v34 offset:1168
    v_cvt_pk_bf16_f32 v133, v38, v39
    v_mfma_f32_16x16x32_bf16 a[200:203], a[112:115], v[248:251], a[200:203]
    ds_read_b128 v[76:79], v34 offset:3200
    v_fma_mix_f32 v36, v134, v64, v56 op_sel:[0,0,0] op_sel_hi:[1,0,0]
    v_mfma_f32_16x16x32_bf16 a[204:207], a[112:115], v[252:255], a[204:207]
    ds_read_b128 v[80:83], v34 offset:3216
    v_fma_mix_f32 v37, v134, v65, v57 op_sel:[1,0,0] op_sel_hi:[1,0,0]
    v_cvt_pk_bf16_f32 v134, v36, v37
    buffer_load_dwordx4 v[216:219], v6, s[20:23], s43 offen offset:1024
    v_mfma_f32_16x16x32_bf16 a[208:211], a[116:119], v[240:243], a[208:211]
    v_fma_mix_f32 v38, v135, v66, v58 op_sel:[0,0,0] op_sel_hi:[1,0,0]
    v_fma_mix_f32 v39, v135, v67, v59 op_sel:[1,0,0] op_sel_hi:[1,0,0]
    v_mfma_f32_16x16x32_bf16 a[212:215], a[116:119], v[244:247], a[212:215]
    v_cvt_pk_bf16_f32 v135, v38, v39
    v_fma_mix_f32 v36, v136, v60, v52 op_sel:[0,0,0] op_sel_hi:[1,0,0]
    v_mfma_f32_16x16x32_bf16 a[216:219], a[116:119], v[248:251], a[216:219]
    v_fma_mix_f32 v37, v136, v61, v53 op_sel:[1,0,0] op_sel_hi:[1,0,0]
    v_cvt_pk_bf16_f32 v136, v36, v37
    v_mfma_f32_16x16x32_bf16 a[220:223], a[116:119], v[252:255], a[220:223]
    v_fma_mix_f32 v38, v137, v62, v54 op_sel:[0,0,0] op_sel_hi:[1,0,0]
    v_fma_mix_f32 v39, v137, v63, v55 op_sel:[1,0,0] op_sel_hi:[1,0,0]
    v_cvt_pk_bf16_f32 v137, v38, v39
    v_mfma_f32_16x16x32_bf16 a[224:227], a[120:123], v[240:243], a[224:227]
    v_fma_mix_f32 v36, v138, v64, v56 op_sel:[0,0,0] op_sel_hi:[1,0,0]
    v_fma_mix_f32 v37, v138, v65, v57 op_sel:[1,0,0] op_sel_hi:[1,0,0]
    v_mfma_f32_16x16x32_bf16 a[228:231], a[120:123], v[244:247], a[228:231]
    v_cvt_pk_bf16_f32 v138, v36, v37
    v_fma_mix_f32 v38, v139, v66, v58 op_sel:[0,0,0] op_sel_hi:[1,0,0]
    v_mfma_f32_16x16x32_bf16 a[232:235], a[120:123], v[248:251], a[232:235]
    v_fma_mix_f32 v39, v139, v67, v59 op_sel:[1,0,0] op_sel_hi:[1,0,0]
    v_cvt_pk_bf16_f32 v139, v38, v39
    v_mfma_f32_16x16x32_bf16 a[236:239], a[120:123], v[252:255], a[236:239]
    v_fma_mix_f32 v36, v140, v60, v52 op_sel:[0,0,0] op_sel_hi:[1,0,0]
    v_fma_mix_f32 v37, v140, v61, v53 op_sel:[1,0,0] op_sel_hi:[1,0,0]
    v_cvt_pk_bf16_f32 v140, v36, v37
    buffer_load_dwordx4 v[220:223], v7, s[20:23], s43 offen offset:1024
    v_mfma_f32_16x16x32_bf16 a[240:243], a[124:127], v[240:243], a[240:243]
    v_fma_mix_f32 v38, v141, v62, v54 op_sel:[0,0,0] op_sel_hi:[1,0,0]
    v_fma_mix_f32 v39, v141, v63, v55 op_sel:[1,0,0] op_sel_hi:[1,0,0]
    v_mfma_f32_16x16x32_bf16 a[244:247], a[124:127], v[244:247], a[244:247]
    v_cvt_pk_bf16_f32 v141, v38, v39
    v_fma_mix_f32 v36, v142, v64, v56 op_sel:[0,0,0] op_sel_hi:[1,0,0]
    v_mfma_f32_16x16x32_bf16 a[248:251], a[124:127], v[248:251], a[248:251]
    v_fma_mix_f32 v37, v142, v65, v57 op_sel:[1,0,0] op_sel_hi:[1,0,0]
    v_cvt_pk_bf16_f32 v142, v36, v37
    v_mfma_f32_16x16x32_bf16 a[252:255], a[124:127], v[252:255], a[252:255]
    v_fma_mix_f32 v38, v143, v66, v58 op_sel:[0,0,0] op_sel_hi:[1,0,0]
    v_fma_mix_f32 v39, v143, v67, v59 op_sel:[1,0,0] op_sel_hi:[1,0,0]
    v_cvt_pk_bf16_f32 v143, v38, v39
    s_waitcnt lgkmcnt(0)
    s_nop 0
    s_waitcnt vmcnt(16)
    v_mfma_f32_16x16x32_bf16 a[128:131], a[64:67], v[128:131], a[128:131]
    ds_read_b64_tr_b16 a[96:97], v44 offset:8192
    v_fma_mix_f32 v36, v144, v76, v68 op_sel:[0,0,0] op_sel_hi:[1,0,0]
    v_mfma_f32_16x16x32_bf16 a[132:135], a[64:67], v[132:135], a[132:135]
    ds_read_b64_tr_b16 a[98:99], v44 offset:9216
    v_fma_mix_f32 v37, v144, v77, v69 op_sel:[1,0,0] op_sel_hi:[1,0,0]
    v_mfma_f32_16x16x32_bf16 a[136:139], a[64:67], v[136:139], a[136:139]
    ds_read_b64_tr_b16 a[100:101], v45 offset:8192
    v_cvt_pk_bf16_f32 v144, v36, v37
    v_mfma_f32_16x16x32_bf16 a[140:143], a[64:67], v[140:143], a[140:143]
    ds_read_b64_tr_b16 a[102:103], v45 offset:9216
    v_fma_mix_f32 v38, v145, v78, v70 op_sel:[0,0,0] op_sel_hi:[1,0,0]
    buffer_load_dwordx4 v[224:227], v4, s[20:23], s43 offen offset:2048
    v_mfma_f32_16x16x32_bf16 a[144:147], a[68:71], v[128:131], a[144:147]
    ds_read_b64_tr_b16 a[104:105], v46 offset:8192
    v_fma_mix_f32 v39, v145, v79, v71 op_sel:[1,0,0] op_sel_hi:[1,0,0]
    v_mfma_f32_16x16x32_bf16 a[148:151], a[68:71], v[132:135], a[148:151]
    ds_read_b64_tr_b16 a[106:107], v46 offset:9216
    v_cvt_pk_bf16_f32 v145, v38, v39
    s_mov_b32 s35, 0
    s_lshl_b32 s36, s32, 12
    s_add_u32 m0, s36, 0
    s_nop 0
    buffer_load_dwordx4 v124, s[8:11], s35 offen offset:0 lds
    v_mfma_f32_16x16x32_bf16 a[152:155], a[68:71], v[136:139], a[152:155]
    ds_read_b64_tr_b16 a[108:109], v47 offset:8192
    v_fma_mix_f32 v36, v146, v80, v72 op_sel:[0,0,0] op_sel_hi:[1,0,0]
    v_mfma_f32_16x16x32_bf16 a[156:159], a[68:71], v[140:143], a[156:159]
    ds_read_b64_tr_b16 a[110:111], v47 offset:9216
    v_fma_mix_f32 v37, v146, v81, v73 op_sel:[1,0,0] op_sel_hi:[1,0,0]
    v_mfma_f32_16x16x32_bf16 a[160:163], a[72:75], v[128:131], a[160:163]
    ds_read_b64_tr_b16 a[112:113], v48 offset:8192
    v_cvt_pk_bf16_f32 v146, v36, v37
    v_mfma_f32_16x16x32_bf16 a[164:167], a[72:75], v[132:135], a[164:167]
    ds_read_b64_tr_b16 a[114:115], v48 offset:9216
    v_fma_mix_f32 v38, v147, v82, v74 op_sel:[0,0,0] op_sel_hi:[1,0,0]
    v_mfma_f32_16x16x32_bf16 a[168:171], a[72:75], v[136:139], a[168:171]
    ds_read_b64_tr_b16 a[116:117], v49 offset:8192
    v_fma_mix_f32 v39, v147, v83, v75 op_sel:[1,0,0] op_sel_hi:[1,0,0]
    v_mfma_f32_16x16x32_bf16 a[172:175], a[72:75], v[140:143], a[172:175]
    ds_read_b64_tr_b16 a[118:119], v49 offset:9216
    v_cvt_pk_bf16_f32 v147, v38, v39
    buffer_load_dwordx4 v[228:231], v5, s[20:23], s43 offen offset:2048
    v_mfma_f32_16x16x32_bf16 a[176:179], a[76:79], v[128:131], a[176:179]
    ds_read_b64_tr_b16 a[120:121], v50 offset:8192
    v_fma_mix_f32 v36, v148, v76, v68 op_sel:[0,0,0] op_sel_hi:[1,0,0]
    v_mfma_f32_16x16x32_bf16 a[180:183], a[76:79], v[132:135], a[180:183]
    ds_read_b64_tr_b16 a[122:123], v50 offset:9216
    v_fma_mix_f32 v37, v148, v77, v69 op_sel:[1,0,0] op_sel_hi:[1,0,0]
    v_mfma_f32_16x16x32_bf16 a[184:187], a[76:79], v[136:139], a[184:187]
    ds_read_b64_tr_b16 a[124:125], v51 offset:8192
    v_cvt_pk_bf16_f32 v148, v36, v37
    v_mfma_f32_16x16x32_bf16 a[188:191], a[76:79], v[140:143], a[188:191]
    ds_read_b64_tr_b16 a[126:127], v51 offset:9216
    v_fma_mix_f32 v38, v149, v78, v70 op_sel:[0,0,0] op_sel_hi:[1,0,0]
    v_mfma_f32_16x16x32_bf16 a[192:195], a[80:83], v[128:131], a[192:195]
    ds_read_b128 v[52:55], v34 offset:1280
    v_fma_mix_f32 v39, v149, v79, v71 op_sel:[1,0,0] op_sel_hi:[1,0,0]
    v_mfma_f32_16x16x32_bf16 a[196:199], a[80:83], v[132:135], a[196:199]
    ds_read_b128 v[56:59], v34 offset:1296
    v_cvt_pk_bf16_f32 v149, v38, v39
    v_mfma_f32_16x16x32_bf16 a[200:203], a[80:83], v[136:139], a[200:203]
    ds_read_b128 v[60:63], v34 offset:3328
    v_fma_mix_f32 v36, v150, v80, v72 op_sel:[0,0,0] op_sel_hi:[1,0,0]
    v_mfma_f32_16x16x32_bf16 a[204:207], a[80:83], v[140:143], a[204:207]
    ds_read_b128 v[64:67], v34 offset:3344
    v_fma_mix_f32 v37, v150, v81, v73 op_sel:[1,0,0] op_sel_hi:[1,0,0]
    v_cvt_pk_bf16_f32 v150, v36, v37
    buffer_load_dwordx4 v[232:235], v6, s[20:23], s43 offen offset:2048
    v_mfma_f32_16x16x32_bf16 a[208:211], a[84:87], v[128:131], a[208:211]
    v_fma_mix_f32 v38, v151, v82, v74 op_sel:[0,0,0] op_sel_hi:[1,0,0]
    v_fma_mix_f32 v39, v151, v83, v75 op_sel:[1,0,0] op_sel_hi:[1,0,0]
    v_mfma_f32_16x16x32_bf16 a[212:215], a[84:87], v[132:135], a[212:215]
    v_cvt_pk_bf16_f32 v151, v38, v39
    v_fma_mix_f32 v36, v152, v76, v68 op_sel:[0,0,0] op_sel_hi:[1,0,0]
    s_nop 0
    buffer_load_dwordx4 v125, s[8:11], s35 offen offset:1024 lds
    v_mfma_f32_16x16x32_bf16 a[216:219], a[84:87], v[136:139], a[216:219]
    v_fma_mix_f32 v37, v152, v77, v69 op_sel:[1,0,0] op_sel_hi:[1,0,0]
    v_cvt_pk_bf16_f32 v152, v36, v37
    v_mfma_f32_16x16x32_bf16 a[220:223], a[84:87], v[140:143], a[220:223]
    v_fma_mix_f32 v38, v153, v78, v70 op_sel:[0,0,0] op_sel_hi:[1,0,0]
    v_fma_mix_f32 v39, v153, v79, v71 op_sel:[1,0,0] op_sel_hi:[1,0,0]
    v_cvt_pk_bf16_f32 v153, v38, v39
    v_mfma_f32_16x16x32_bf16 a[224:227], a[88:91], v[128:131], a[224:227]
    v_fma_mix_f32 v36, v154, v80, v72 op_sel:[0,0,0] op_sel_hi:[1,0,0]
    v_fma_mix_f32 v37, v154, v81, v73 op_sel:[1,0,0] op_sel_hi:[1,0,0]
    v_mfma_f32_16x16x32_bf16 a[228:231], a[88:91], v[132:135], a[228:231]
    v_cvt_pk_bf16_f32 v154, v36, v37
    v_fma_mix_f32 v38, v155, v82, v74 op_sel:[0,0,0] op_sel_hi:[1,0,0]
    v_mfma_f32_16x16x32_bf16 a[232:235], a[88:91], v[136:139], a[232:235]
    v_fma_mix_f32 v39, v155, v83, v75 op_sel:[1,0,0] op_sel_hi:[1,0,0]
    v_cvt_pk_bf16_f32 v155, v38, v39
    v_mfma_f32_16x16x32_bf16 a[236:239], a[88:91], v[140:143], a[236:239]
    v_fma_mix_f32 v36, v156, v76, v68 op_sel:[0,0,0] op_sel_hi:[1,0,0]
    v_fma_mix_f32 v37, v156, v77, v69 op_sel:[1,0,0] op_sel_hi:[1,0,0]
    v_cvt_pk_bf16_f32 v156, v36, v37
    buffer_load_dwordx4 v[236:239], v7, s[20:23], s43 offen offset:2048
    v_mfma_f32_16x16x32_bf16 a[240:243], a[92:95], v[128:131], a[240:243]
    v_fma_mix_f32 v38, v157, v78, v70 op_sel:[0,0,0] op_sel_hi:[1,0,0]
    v_fma_mix_f32 v39, v157, v79, v71 op_sel:[1,0,0] op_sel_hi:[1,0,0]
    v_mfma_f32_16x16x32_bf16 a[244:247], a[92:95], v[132:135], a[244:247]
    v_cvt_pk_bf16_f32 v157, v38, v39
    v_fma_mix_f32 v36, v158, v80, v72 op_sel:[0,0,0] op_sel_hi:[1,0,0]
    v_mfma_f32_16x16x32_bf16 a[248:251], a[92:95], v[136:139], a[248:251]
    v_fma_mix_f32 v37, v158, v81, v73 op_sel:[1,0,0] op_sel_hi:[1,0,0]
    v_cvt_pk_bf16_f32 v158, v36, v37
    v_mfma_f32_16x16x32_bf16 a[252:255], a[92:95], v[140:143], a[252:255]
    v_fma_mix_f32 v38, v159, v82, v74 op_sel:[0,0,0] op_sel_hi:[1,0,0]
    v_fma_mix_f32 v39, v159, v83, v75 op_sel:[1,0,0] op_sel_hi:[1,0,0]
    v_cvt_pk_bf16_f32 v159, v38, v39
    s_waitcnt lgkmcnt(0)
    s_nop 0
    s_waitcnt vmcnt(18)
    v_mfma_f32_16x16x32_bf16 a[128:131], a[96:99], v[144:147], a[128:131]
    ds_read_b64_tr_b16 a[64:65], v44 offset:16384
    v_fma_mix_f32 v36, v160, v60, v52 op_sel:[0,0,0] op_sel_hi:[1,0,0]
    v_mfma_f32_16x16x32_bf16 a[132:135], a[96:99], v[148:151], a[132:135]
    ds_read_b64_tr_b16 a[66:67], v44 offset:17408
    v_fma_mix_f32 v37, v160, v61, v53 op_sel:[1,0,0] op_sel_hi:[1,0,0]
    v_mfma_f32_16x16x32_bf16 a[136:139], a[96:99], v[152:155], a[136:139]
    ds_read_b64_tr_b16 a[68:69], v45 offset:16384
    v_cvt_pk_bf16_f32 v160, v36, v37
    v_mfma_f32_16x16x32_bf16 a[140:143], a[96:99], v[156:159], a[140:143]
    ds_read_b64_tr_b16 a[70:71], v45 offset:17408
    v_fma_mix_f32 v38, v161, v62, v54 op_sel:[0,0,0] op_sel_hi:[1,0,0]
    buffer_load_dwordx4 v[240:243], v4, s[20:23], s43 offen offset:3072
    v_mfma_f32_16x16x32_bf16 a[144:147], a[100:103], v[144:147], a[144:147]
    ds_read_b64_tr_b16 a[72:73], v46 offset:16384
    v_fma_mix_f32 v39, v161, v63, v55 op_sel:[1,0,0] op_sel_hi:[1,0,0]
    v_mfma_f32_16x16x32_bf16 a[148:151], a[100:103], v[148:151], a[148:151]
    ds_read_b64_tr_b16 a[74:75], v46 offset:17408
    v_cvt_pk_bf16_f32 v161, v38, v39
    s_nop 0
    buffer_load_dwordx4 v126, s[8:11], s35 offen offset:2048 lds
    v_mfma_f32_16x16x32_bf16 a[152:155], a[100:103], v[152:155], a[152:155]
    ds_read_b64_tr_b16 a[76:77], v47 offset:16384
    v_fma_mix_f32 v36, v162, v64, v56 op_sel:[0,0,0] op_sel_hi:[1,0,0]
    v_mfma_f32_16x16x32_bf16 a[156:159], a[100:103], v[156:159], a[156:159]
    ds_read_b64_tr_b16 a[78:79], v47 offset:17408
    v_fma_mix_f32 v37, v162, v65, v57 op_sel:[1,0,0] op_sel_hi:[1,0,0]
    v_mfma_f32_16x16x32_bf16 a[160:163], a[104:107], v[144:147], a[160:163]
    ds_read_b64_tr_b16 a[80:81], v48 offset:16384
    v_cvt_pk_bf16_f32 v162, v36, v37
    v_mfma_f32_16x16x32_bf16 a[164:167], a[104:107], v[148:151], a[164:167]
    ds_read_b64_tr_b16 a[82:83], v48 offset:17408
    v_fma_mix_f32 v38, v163, v66, v58 op_sel:[0,0,0] op_sel_hi:[1,0,0]
    v_mfma_f32_16x16x32_bf16 a[168:171], a[104:107], v[152:155], a[168:171]
    ds_read_b64_tr_b16 a[84:85], v49 offset:16384
    v_fma_mix_f32 v39, v163, v67, v59 op_sel:[1,0,0] op_sel_hi:[1,0,0]
    v_mfma_f32_16x16x32_bf16 a[172:175], a[104:107], v[156:159], a[172:175]
    ds_read_b64_tr_b16 a[86:87], v49 offset:17408
    v_cvt_pk_bf16_f32 v163, v38, v39
    buffer_load_dwordx4 v[244:247], v5, s[20:23], s43 offen offset:3072
    v_mfma_f32_16x16x32_bf16 a[176:179], a[108:111], v[144:147], a[176:179]
    ds_read_b64_tr_b16 a[88:89], v50 offset:16384
    v_fma_mix_f32 v36, v164, v60, v52 op_sel:[0,0,0] op_sel_hi:[1,0,0]
    v_mfma_f32_16x16x32_bf16 a[180:183], a[108:111], v[148:151], a[180:183]
    ds_read_b64_tr_b16 a[90:91], v50 offset:17408
    v_fma_mix_f32 v37, v164, v61, v53 op_sel:[1,0,0] op_sel_hi:[1,0,0]
    v_mfma_f32_16x16x32_bf16 a[184:187], a[108:111], v[152:155], a[184:187]
    ds_read_b64_tr_b16 a[92:93], v51 offset:16384
    v_cvt_pk_bf16_f32 v164, v36, v37
    v_mfma_f32_16x16x32_bf16 a[188:191], a[108:111], v[156:159], a[188:191]
    ds_read_b64_tr_b16 a[94:95], v51 offset:17408
    v_fma_mix_f32 v38, v165, v62, v54 op_sel:[0,0,0] op_sel_hi:[1,0,0]
    v_mfma_f32_16x16x32_bf16 a[192:195], a[112:115], v[144:147], a[192:195]
    ds_read_b128 v[68:71], v34 offset:1408
    v_fma_mix_f32 v39, v165, v63, v55 op_sel:[1,0,0] op_sel_hi:[1,0,0]
    v_mfma_f32_16x16x32_bf16 a[196:199], a[112:115], v[148:151], a[196:199]
    ds_read_b128 v[72:75], v34 offset:1424
    v_cvt_pk_bf16_f32 v165, v38, v39
    v_mfma_f32_16x16x32_bf16 a[200:203], a[112:115], v[152:155], a[200:203]
    ds_read_b128 v[76:79], v34 offset:3456
    v_fma_mix_f32 v36, v166, v64, v56 op_sel:[0,0,0] op_sel_hi:[1,0,0]
    v_mfma_f32_16x16x32_bf16 a[204:207], a[112:115], v[156:159], a[204:207]
    ds_read_b128 v[80:83], v34 offset:3472
    v_fma_mix_f32 v37, v166, v65, v57 op_sel:[1,0,0] op_sel_hi:[1,0,0]
    v_cvt_pk_bf16_f32 v166, v36, v37
    buffer_load_dwordx4 v[248:251], v6, s[20:23], s43 offen offset:3072
    v_mfma_f32_16x16x32_bf16 a[208:211], a[116:119], v[144:147], a[208:211]
    v_fma_mix_f32 v38, v167, v66, v58 op_sel:[0,0,0] op_sel_hi:[1,0,0]
    v_fma_mix_f32 v39, v167, v67, v59 op_sel:[1,0,0] op_sel_hi:[1,0,0]
    v_mfma_f32_16x16x32_bf16 a[212:215], a[116:119], v[148:151], a[212:215]
    v_cvt_pk_bf16_f32 v167, v38, v39
    v_fma_mix_f32 v36, v168, v60, v52 op_sel:[0,0,0] op_sel_hi:[1,0,0]
    s_nop 0
    buffer_load_dwordx4 v127, s[8:11], s35 offen offset:3072 lds
    v_mfma_f32_16x16x32_bf16 a[216:219], a[116:119], v[152:155], a[216:219]
    v_fma_mix_f32 v37, v168, v61, v53 op_sel:[1,0,0] op_sel_hi:[1,0,0]
    v_cvt_pk_bf16_f32 v168, v36, v37
    v_mfma_f32_16x16x32_bf16 a[220:223], a[116:119], v[156:159], a[220:223]
    v_fma_mix_f32 v38, v169, v62, v54 op_sel:[0,0,0] op_sel_hi:[1,0,0]
    v_fma_mix_f32 v39, v169, v63, v55 op_sel:[1,0,0] op_sel_hi:[1,0,0]
    v_cvt_pk_bf16_f32 v169, v38, v39
    v_mfma_f32_16x16x32_bf16 a[224:227], a[120:123], v[144:147], a[224:227]
    v_fma_mix_f32 v36, v170, v64, v56 op_sel:[0,0,0] op_sel_hi:[1,0,0]
    v_fma_mix_f32 v37, v170, v65, v57 op_sel:[1,0,0] op_sel_hi:[1,0,0]
    v_mfma_f32_16x16x32_bf16 a[228:231], a[120:123], v[148:151], a[228:231]
    v_cvt_pk_bf16_f32 v170, v36, v37
    v_fma_mix_f32 v38, v171, v66, v58 op_sel:[0,0,0] op_sel_hi:[1,0,0]
    v_mfma_f32_16x16x32_bf16 a[232:235], a[120:123], v[152:155], a[232:235]
    v_fma_mix_f32 v39, v171, v67, v59 op_sel:[1,0,0] op_sel_hi:[1,0,0]
    v_cvt_pk_bf16_f32 v171, v38, v39
    v_mfma_f32_16x16x32_bf16 a[236:239], a[120:123], v[156:159], a[236:239]
    v_fma_mix_f32 v36, v172, v60, v52 op_sel:[0,0,0] op_sel_hi:[1,0,0]
    v_fma_mix_f32 v37, v172, v61, v53 op_sel:[1,0,0] op_sel_hi:[1,0,0]
    v_cvt_pk_bf16_f32 v172, v36, v37
    buffer_load_dwordx4 v[252:255], v7, s[20:23], s43 offen offset:3072
    v_mfma_f32_16x16x32_bf16 a[240:243], a[124:127], v[144:147], a[240:243]
    v_fma_mix_f32 v38, v173, v62, v54 op_sel:[0,0,0] op_sel_hi:[1,0,0]
    v_fma_mix_f32 v39, v173, v63, v55 op_sel:[1,0,0] op_sel_hi:[1,0,0]
    v_mfma_f32_16x16x32_bf16 a[244:247], a[124:127], v[148:151], a[244:247]
    v_cvt_pk_bf16_f32 v173, v38, v39
    v_fma_mix_f32 v36, v174, v64, v56 op_sel:[0,0,0] op_sel_hi:[1,0,0]
    v_mfma_f32_16x16x32_bf16 a[248:251], a[124:127], v[152:155], a[248:251]
    v_fma_mix_f32 v37, v174, v65, v57 op_sel:[1,0,0] op_sel_hi:[1,0,0]
    v_cvt_pk_bf16_f32 v174, v36, v37
    v_mfma_f32_16x16x32_bf16 a[252:255], a[124:127], v[156:159], a[252:255]
    v_fma_mix_f32 v38, v175, v66, v58 op_sel:[0,0,0] op_sel_hi:[1,0,0]
    v_fma_mix_f32 v39, v175, v67, v59 op_sel:[1,0,0] op_sel_hi:[1,0,0]
    v_cvt_pk_bf16_f32 v175, v38, v39
    s_waitcnt lgkmcnt(0)
    s_nop 0
    s_waitcnt vmcnt(20)
    v_mfma_f32_16x16x32_bf16 a[128:131], a[64:67], v[160:163], a[128:131]
    ds_read_b64_tr_b16 a[96:97], v44 offset:24576
    v_fma_mix_f32 v36, v176, v76, v68 op_sel:[0,0,0] op_sel_hi:[1,0,0]
    v_mfma_f32_16x16x32_bf16 a[132:135], a[64:67], v[164:167], a[132:135]
    ds_read_b64_tr_b16 a[98:99], v44 offset:25600
    v_fma_mix_f32 v37, v176, v77, v69 op_sel:[1,0,0] op_sel_hi:[1,0,0]
    v_mfma_f32_16x16x32_bf16 a[136:139], a[64:67], v[168:171], a[136:139]
    ds_read_b64_tr_b16 a[100:101], v45 offset:24576
    v_cvt_pk_bf16_f32 v176, v36, v37
    v_mfma_f32_16x16x32_bf16 a[140:143], a[64:67], v[172:175], a[140:143]
    ds_read_b64_tr_b16 a[102:103], v45 offset:25600
    v_fma_mix_f32 v38, v177, v78, v70 op_sel:[0,0,0] op_sel_hi:[1,0,0]
    v_mfma_f32_16x16x32_bf16 a[144:147], a[68:71], v[160:163], a[144:147]
    ds_read_b64_tr_b16 a[104:105], v46 offset:24576
    v_fma_mix_f32 v39, v177, v79, v71 op_sel:[1,0,0] op_sel_hi:[1,0,0]
    v_mfma_f32_16x16x32_bf16 a[148:151], a[68:71], v[164:167], a[148:151]
    ds_read_b64_tr_b16 a[106:107], v46 offset:25600
    v_cvt_pk_bf16_f32 v177, v38, v39
    s_add_u32 m0, s36, 16384
    s_nop 0
    buffer_load_dwordx4 v2, s[12:15], s35 offen offset:0 lds
    v_mfma_f32_16x16x32_bf16 a[152:155], a[68:71], v[168:171], a[152:155]
    ds_read_b64_tr_b16 a[108:109], v47 offset:24576
    v_fma_mix_f32 v36, v178, v80, v72 op_sel:[0,0,0] op_sel_hi:[1,0,0]
    v_mfma_f32_16x16x32_bf16 a[156:159], a[68:71], v[172:175], a[156:159]
    ds_read_b64_tr_b16 a[110:111], v47 offset:25600
    v_fma_mix_f32 v37, v178, v81, v73 op_sel:[1,0,0] op_sel_hi:[1,0,0]
    v_mfma_f32_16x16x32_bf16 a[160:163], a[72:75], v[160:163], a[160:163]
    ds_read_b64_tr_b16 a[112:113], v48 offset:24576
    v_cvt_pk_bf16_f32 v178, v36, v37
    v_mfma_f32_16x16x32_bf16 a[164:167], a[72:75], v[164:167], a[164:167]
    ds_read_b64_tr_b16 a[114:115], v48 offset:25600
    v_fma_mix_f32 v38, v179, v82, v74 op_sel:[0,0,0] op_sel_hi:[1,0,0]
    v_mfma_f32_16x16x32_bf16 a[168:171], a[72:75], v[168:171], a[168:171]
    ds_read_b64_tr_b16 a[116:117], v49 offset:24576
    v_fma_mix_f32 v39, v179, v83, v75 op_sel:[1,0,0] op_sel_hi:[1,0,0]
    v_mfma_f32_16x16x32_bf16 a[172:175], a[72:75], v[172:175], a[172:175]
    ds_read_b64_tr_b16 a[118:119], v49 offset:25600
    v_cvt_pk_bf16_f32 v179, v38, v39
    v_mfma_f32_16x16x32_bf16 a[176:179], a[76:79], v[160:163], a[176:179]
    ds_read_b64_tr_b16 a[120:121], v50 offset:24576
    v_fma_mix_f32 v36, v180, v76, v68 op_sel:[0,0,0] op_sel_hi:[1,0,0]
    v_mfma_f32_16x16x32_bf16 a[180:183], a[76:79], v[164:167], a[180:183]
    ds_read_b64_tr_b16 a[122:123], v50 offset:25600
    v_fma_mix_f32 v37, v180, v77, v69 op_sel:[1,0,0] op_sel_hi:[1,0,0]
    v_mfma_f32_16x16x32_bf16 a[184:187], a[76:79], v[168:171], a[184:187]
    ds_read_b64_tr_b16 a[124:125], v51 offset:24576
    v_cvt_pk_bf16_f32 v180, v36, v37
    v_mfma_f32_16x16x32_bf16 a[188:191], a[76:79], v[172:175], a[188:191]
    ds_read_b64_tr_b16 a[126:127], v51 offset:25600
    v_fma_mix_f32 v38, v181, v78, v70 op_sel:[0,0,0] op_sel_hi:[1,0,0]
    v_mfma_f32_16x16x32_bf16 a[192:195], a[80:83], v[160:163], a[192:195]
    ds_read_b128 v[52:55], v34 offset:1536
    v_fma_mix_f32 v39, v181, v79, v71 op_sel:[1,0,0] op_sel_hi:[1,0,0]
    v_mfma_f32_16x16x32_bf16 a[196:199], a[80:83], v[164:167], a[196:199]
    ds_read_b128 v[56:59], v34 offset:1552
    v_cvt_pk_bf16_f32 v181, v38, v39
    v_mfma_f32_16x16x32_bf16 a[200:203], a[80:83], v[168:171], a[200:203]
    ds_read_b128 v[60:63], v34 offset:3584
    v_fma_mix_f32 v36, v182, v80, v72 op_sel:[0,0,0] op_sel_hi:[1,0,0]
    v_mfma_f32_16x16x32_bf16 a[204:207], a[80:83], v[172:175], a[204:207]
    ds_read_b128 v[64:67], v34 offset:3600
    v_fma_mix_f32 v37, v182, v81, v73 op_sel:[1,0,0] op_sel_hi:[1,0,0]
    v_cvt_pk_bf16_f32 v182, v36, v37
    v_mfma_f32_16x16x32_bf16 a[208:211], a[84:87], v[160:163], a[208:211]
    v_fma_mix_f32 v38, v183, v82, v74 op_sel:[0,0,0] op_sel_hi:[1,0,0]
    v_fma_mix_f32 v39, v183, v83, v75 op_sel:[1,0,0] op_sel_hi:[1,0,0]
    v_mfma_f32_16x16x32_bf16 a[212:215], a[84:87], v[164:167], a[212:215]
    v_cvt_pk_bf16_f32 v183, v38, v39
    v_fma_mix_f32 v36, v184, v76, v68 op_sel:[0,0,0] op_sel_hi:[1,0,0]
    s_nop 0
    buffer_load_dwordx4 v3, s[12:15], s35 offen offset:1024 lds
    v_mfma_f32_16x16x32_bf16 a[216:219], a[84:87], v[168:171], a[216:219]
    v_fma_mix_f32 v37, v184, v77, v69 op_sel:[1,0,0] op_sel_hi:[1,0,0]
    v_cvt_pk_bf16_f32 v184, v36, v37
    v_mfma_f32_16x16x32_bf16 a[220:223], a[84:87], v[172:175], a[220:223]
    v_fma_mix_f32 v38, v185, v78, v70 op_sel:[0,0,0] op_sel_hi:[1,0,0]
    v_fma_mix_f32 v39, v185, v79, v71 op_sel:[1,0,0] op_sel_hi:[1,0,0]
    v_cvt_pk_bf16_f32 v185, v38, v39
    v_mfma_f32_16x16x32_bf16 a[224:227], a[88:91], v[160:163], a[224:227]
    v_fma_mix_f32 v36, v186, v80, v72 op_sel:[0,0,0] op_sel_hi:[1,0,0]
    v_fma_mix_f32 v37, v186, v81, v73 op_sel:[1,0,0] op_sel_hi:[1,0,0]
    v_mfma_f32_16x16x32_bf16 a[228:231], a[88:91], v[164:167], a[228:231]
    v_cvt_pk_bf16_f32 v186, v36, v37
    v_fma_mix_f32 v38, v187, v82, v74 op_sel:[0,0,0] op_sel_hi:[1,0,0]
    v_mfma_f32_16x16x32_bf16 a[232:235], a[88:91], v[168:171], a[232:235]
    v_fma_mix_f32 v39, v187, v83, v75 op_sel:[1,0,0] op_sel_hi:[1,0,0]
    v_cvt_pk_bf16_f32 v187, v38, v39
    v_mfma_f32_16x16x32_bf16 a[236:239], a[88:91], v[172:175], a[236:239]
    v_fma_mix_f32 v36, v188, v76, v68 op_sel:[0,0,0] op_sel_hi:[1,0,0]
    v_fma_mix_f32 v37, v188, v77, v69 op_sel:[1,0,0] op_sel_hi:[1,0,0]
    v_cvt_pk_bf16_f32 v188, v36, v37
    v_mfma_f32_16x16x32_bf16 a[240:243], a[92:95], v[160:163], a[240:243]
    v_fma_mix_f32 v38, v189, v78, v70 op_sel:[0,0,0] op_sel_hi:[1,0,0]
    v_fma_mix_f32 v39, v189, v79, v71 op_sel:[1,0,0] op_sel_hi:[1,0,0]
    v_mfma_f32_16x16x32_bf16 a[244:247], a[92:95], v[164:167], a[244:247]
    v_cvt_pk_bf16_f32 v189, v38, v39
    v_fma_mix_f32 v36, v190, v80, v72 op_sel:[0,0,0] op_sel_hi:[1,0,0]
    v_mfma_f32_16x16x32_bf16 a[248:251], a[92:95], v[168:171], a[248:251]
    v_fma_mix_f32 v37, v190, v81, v73 op_sel:[1,0,0] op_sel_hi:[1,0,0]
    v_cvt_pk_bf16_f32 v190, v36, v37
    v_mfma_f32_16x16x32_bf16 a[252:255], a[92:95], v[172:175], a[252:255]
    v_fma_mix_f32 v38, v191, v82, v74 op_sel:[0,0,0] op_sel_hi:[1,0,0]
    v_fma_mix_f32 v39, v191, v83, v75 op_sel:[1,0,0] op_sel_hi:[1,0,0]
    v_cvt_pk_bf16_f32 v191, v38, v39
    s_waitcnt lgkmcnt(0)
    s_nop 0
    s_barrier
    s_waitcnt vmcnt(18)
    v_mfma_f32_16x16x32_bf16 a[128:131], a[96:99], v[176:179], a[128:131]
    ds_read_b64_tr_b16 a[64:65], v44 offset:32768
    v_fma_mix_f32 v36, v192, v60, v52 op_sel:[0,0,0] op_sel_hi:[1,0,0]
    v_mfma_f32_16x16x32_bf16 a[132:135], a[96:99], v[180:183], a[132:135]
    ds_read_b64_tr_b16 a[66:67], v44 offset:33792
    v_fma_mix_f32 v37, v192, v61, v53 op_sel:[1,0,0] op_sel_hi:[1,0,0]
    v_mfma_f32_16x16x32_bf16 a[136:139], a[96:99], v[184:187], a[136:139]
    ds_read_b64_tr_b16 a[68:69], v45 offset:32768
    v_cvt_pk_bf16_f32 v192, v36, v37
    v_mfma_f32_16x16x32_bf16 a[140:143], a[96:99], v[188:191], a[140:143]
    ds_read_b64_tr_b16 a[70:71], v45 offset:33792
    v_fma_mix_f32 v38, v193, v62, v54 op_sel:[0,0,0] op_sel_hi:[1,0,0]
    v_mfma_f32_16x16x32_bf16 a[144:147], a[100:103], v[176:179], a[144:147]
    ds_read_b64_tr_b16 a[72:73], v46 offset:32768
    v_fma_mix_f32 v39, v193, v63, v55 op_sel:[1,0,0] op_sel_hi:[1,0,0]
    v_mfma_f32_16x16x32_bf16 a[148:151], a[100:103], v[180:183], a[148:151]
    ds_read_b64_tr_b16 a[74:75], v46 offset:33792
    v_cvt_pk_bf16_f32 v193, v38, v39
    s_nop 0
    buffer_load_dwordx4 v2, s[12:15], s35 offen offset:2048 lds
    v_mfma_f32_16x16x32_bf16 a[152:155], a[100:103], v[184:187], a[152:155]
    ds_read_b64_tr_b16 a[76:77], v47 offset:32768
    v_fma_mix_f32 v36, v194, v64, v56 op_sel:[0,0,0] op_sel_hi:[1,0,0]
    v_mfma_f32_16x16x32_bf16 a[156:159], a[100:103], v[188:191], a[156:159]
    ds_read_b64_tr_b16 a[78:79], v47 offset:33792
    v_fma_mix_f32 v37, v194, v65, v57 op_sel:[1,0,0] op_sel_hi:[1,0,0]
    v_mfma_f32_16x16x32_bf16 a[160:163], a[104:107], v[176:179], a[160:163]
    ds_read_b64_tr_b16 a[80:81], v48 offset:32768
    v_cvt_pk_bf16_f32 v194, v36, v37
    v_mfma_f32_16x16x32_bf16 a[164:167], a[104:107], v[180:183], a[164:167]
    ds_read_b64_tr_b16 a[82:83], v48 offset:33792
    v_fma_mix_f32 v38, v195, v66, v58 op_sel:[0,0,0] op_sel_hi:[1,0,0]
    v_mfma_f32_16x16x32_bf16 a[168:171], a[104:107], v[184:187], a[168:171]
    ds_read_b64_tr_b16 a[84:85], v49 offset:32768
    v_fma_mix_f32 v39, v195, v67, v59 op_sel:[1,0,0] op_sel_hi:[1,0,0]
    v_mfma_f32_16x16x32_bf16 a[172:175], a[104:107], v[188:191], a[172:175]
    ds_read_b64_tr_b16 a[86:87], v49 offset:33792
    v_cvt_pk_bf16_f32 v195, v38, v39
    v_mfma_f32_16x16x32_bf16 a[176:179], a[108:111], v[176:179], a[176:179]
    ds_read_b64_tr_b16 a[88:89], v50 offset:32768
    v_fma_mix_f32 v36, v196, v60, v52 op_sel:[0,0,0] op_sel_hi:[1,0,0]
    v_mfma_f32_16x16x32_bf16 a[180:183], a[108:111], v[180:183], a[180:183]
    ds_read_b64_tr_b16 a[90:91], v50 offset:33792
    v_fma_mix_f32 v37, v196, v61, v53 op_sel:[1,0,0] op_sel_hi:[1,0,0]
    v_mfma_f32_16x16x32_bf16 a[184:187], a[108:111], v[184:187], a[184:187]
    ds_read_b64_tr_b16 a[92:93], v51 offset:32768
    v_cvt_pk_bf16_f32 v196, v36, v37
    v_mfma_f32_16x16x32_bf16 a[188:191], a[108:111], v[188:191], a[188:191]
    ds_read_b64_tr_b16 a[94:95], v51 offset:33792
    v_fma_mix_f32 v38, v197, v62, v54 op_sel:[0,0,0] op_sel_hi:[1,0,0]
    v_mfma_f32_16x16x32_bf16 a[192:195], a[112:115], v[176:179], a[192:195]
    ds_read_b128 v[68:71], v34 offset:1664
    v_fma_mix_f32 v39, v197, v63, v55 op_sel:[1,0,0] op_sel_hi:[1,0,0]
    v_mfma_f32_16x16x32_bf16 a[196:199], a[112:115], v[180:183], a[196:199]
    ds_read_b128 v[72:75], v34 offset:1680
    v_cvt_pk_bf16_f32 v197, v38, v39
    v_mfma_f32_16x16x32_bf16 a[200:203], a[112:115], v[184:187], a[200:203]
    ds_read_b128 v[76:79], v34 offset:3712
    v_fma_mix_f32 v36, v198, v64, v56 op_sel:[0,0,0] op_sel_hi:[1,0,0]
    v_mfma_f32_16x16x32_bf16 a[204:207], a[112:115], v[188:191], a[204:207]
    ds_read_b128 v[80:83], v34 offset:3728
    v_fma_mix_f32 v37, v198, v65, v57 op_sel:[1,0,0] op_sel_hi:[1,0,0]
    v_cvt_pk_bf16_f32 v198, v36, v37
    v_mfma_f32_16x16x32_bf16 a[208:211], a[116:119], v[176:179], a[208:211]
    v_fma_mix_f32 v38, v199, v66, v58 op_sel:[0,0,0] op_sel_hi:[1,0,0]
    v_fma_mix_f32 v39, v199, v67, v59 op_sel:[1,0,0] op_sel_hi:[1,0,0]
    v_mfma_f32_16x16x32_bf16 a[212:215], a[116:119], v[180:183], a[212:215]
    v_cvt_pk_bf16_f32 v199, v38, v39
    v_fma_mix_f32 v36, v200, v60, v52 op_sel:[0,0,0] op_sel_hi:[1,0,0]
    s_nop 0
    buffer_load_dwordx4 v3, s[12:15], s35 offen offset:3072 lds
    v_mfma_f32_16x16x32_bf16 a[216:219], a[116:119], v[184:187], a[216:219]
    v_fma_mix_f32 v37, v200, v61, v53 op_sel:[1,0,0] op_sel_hi:[1,0,0]
    v_cvt_pk_bf16_f32 v200, v36, v37
    v_mfma_f32_16x16x32_bf16 a[220:223], a[116:119], v[188:191], a[220:223]
    v_fma_mix_f32 v38, v201, v62, v54 op_sel:[0,0,0] op_sel_hi:[1,0,0]
    v_fma_mix_f32 v39, v201, v63, v55 op_sel:[1,0,0] op_sel_hi:[1,0,0]
    v_cvt_pk_bf16_f32 v201, v38, v39
    v_mfma_f32_16x16x32_bf16 a[224:227], a[120:123], v[176:179], a[224:227]
    v_fma_mix_f32 v36, v202, v64, v56 op_sel:[0,0,0] op_sel_hi:[1,0,0]
    v_fma_mix_f32 v37, v202, v65, v57 op_sel:[1,0,0] op_sel_hi:[1,0,0]
    v_mfma_f32_16x16x32_bf16 a[228:231], a[120:123], v[180:183], a[228:231]
    v_cvt_pk_bf16_f32 v202, v36, v37
    v_fma_mix_f32 v38, v203, v66, v58 op_sel:[0,0,0] op_sel_hi:[1,0,0]
    v_mfma_f32_16x16x32_bf16 a[232:235], a[120:123], v[184:187], a[232:235]
    v_fma_mix_f32 v39, v203, v67, v59 op_sel:[1,0,0] op_sel_hi:[1,0,0]
    v_cvt_pk_bf16_f32 v203, v38, v39
    v_mfma_f32_16x16x32_bf16 a[236:239], a[120:123], v[188:191], a[236:239]
    v_fma_mix_f32 v36, v204, v60, v52 op_sel:[0,0,0] op_sel_hi:[1,0,0]
    v_fma_mix_f32 v37, v204, v61, v53 op_sel:[1,0,0] op_sel_hi:[1,0,0]
    v_cvt_pk_bf16_f32 v204, v36, v37
    v_mfma_f32_16x16x32_bf16 a[240:243], a[124:127], v[176:179], a[240:243]
    v_fma_mix_f32 v38, v205, v62, v54 op_sel:[0,0,0] op_sel_hi:[1,0,0]
    v_fma_mix_f32 v39, v205, v63, v55 op_sel:[1,0,0] op_sel_hi:[1,0,0]
    v_mfma_f32_16x16x32_bf16 a[244:247], a[124:127], v[180:183], a[244:247]
    v_cvt_pk_bf16_f32 v205, v38, v39
    v_fma_mix_f32 v36, v206, v64, v56 op_sel:[0,0,0] op_sel_hi:[1,0,0]
    v_mfma_f32_16x16x32_bf16 a[248:251], a[124:127], v[184:187], a[248:251]
    v_fma_mix_f32 v37, v206, v65, v57 op_sel:[1,0,0] op_sel_hi:[1,0,0]
    v_cvt_pk_bf16_f32 v206, v36, v37
    v_mfma_f32_16x16x32_bf16 a[252:255], a[124:127], v[188:191], a[252:255]
    v_fma_mix_f32 v38, v207, v66, v58 op_sel:[0,0,0] op_sel_hi:[1,0,0]
    v_fma_mix_f32 v39, v207, v67, v59 op_sel:[1,0,0] op_sel_hi:[1,0,0]
    v_cvt_pk_bf16_f32 v207, v38, v39
    s_waitcnt lgkmcnt(0)
    s_nop 0
    s_waitcnt vmcnt(16)
    v_mfma_f32_16x16x32_bf16 a[128:131], a[64:67], v[192:195], a[128:131]
    ds_read_b64_tr_b16 a[96:97], v44 offset:40960
    v_fma_mix_f32 v36, v208, v76, v68 op_sel:[0,0,0] op_sel_hi:[1,0,0]
    v_mfma_f32_16x16x32_bf16 a[132:135], a[64:67], v[196:199], a[132:135]
    ds_read_b64_tr_b16 a[98:99], v44 offset:41984
    v_fma_mix_f32 v37, v208, v77, v69 op_sel:[1,0,0] op_sel_hi:[1,0,0]
    v_mfma_f32_16x16x32_bf16 a[136:139], a[64:67], v[200:203], a[136:139]
    ds_read_b64_tr_b16 a[100:101], v45 offset:40960
    v_cvt_pk_bf16_f32 v208, v36, v37
    v_mfma_f32_16x16x32_bf16 a[140:143], a[64:67], v[204:207], a[140:143]
    ds_read_b64_tr_b16 a[102:103], v45 offset:41984
    v_fma_mix_f32 v38, v209, v78, v70 op_sel:[0,0,0] op_sel_hi:[1,0,0]
    v_mfma_f32_16x16x32_bf16 a[144:147], a[68:71], v[192:195], a[144:147]
    ds_read_b64_tr_b16 a[104:105], v46 offset:40960
    v_fma_mix_f32 v39, v209, v79, v71 op_sel:[1,0,0] op_sel_hi:[1,0,0]
    v_mfma_f32_16x16x32_bf16 a[148:151], a[68:71], v[196:199], a[148:151]
    ds_read_b64_tr_b16 a[106:107], v46 offset:41984
    v_cvt_pk_bf16_f32 v209, v38, v39
    s_mov_b32 s35, 16384
    s_add_u32 m0, s36, 32768
    s_nop 0
    buffer_load_dwordx4 v124, s[8:11], s35 offen offset:0 lds
    v_mfma_f32_16x16x32_bf16 a[152:155], a[68:71], v[200:203], a[152:155]
    ds_read_b64_tr_b16 a[108:109], v47 offset:40960
    v_fma_mix_f32 v36, v210, v80, v72 op_sel:[0,0,0] op_sel_hi:[1,0,0]
    v_mfma_f32_16x16x32_bf16 a[156:159], a[68:71], v[204:207], a[156:159]
    ds_read_b64_tr_b16 a[110:111], v47 offset:41984
    v_fma_mix_f32 v37, v210, v81, v73 op_sel:[1,0,0] op_sel_hi:[1,0,0]
    v_mfma_f32_16x16x32_bf16 a[160:163], a[72:75], v[192:195], a[160:163]
    ds_read_b64_tr_b16 a[112:113], v48 offset:40960
    v_cvt_pk_bf16_f32 v210, v36, v37
    v_mfma_f32_16x16x32_bf16 a[164:167], a[72:75], v[196:199], a[164:167]
    ds_read_b64_tr_b16 a[114:115], v48 offset:41984
    v_fma_mix_f32 v38, v211, v82, v74 op_sel:[0,0,0] op_sel_hi:[1,0,0]
    v_mfma_f32_16x16x32_bf16 a[168:171], a[72:75], v[200:203], a[168:171]
    ds_read_b64_tr_b16 a[116:117], v49 offset:40960
    v_fma_mix_f32 v39, v211, v83, v75 op_sel:[1,0,0] op_sel_hi:[1,0,0]
    v_mfma_f32_16x16x32_bf16 a[172:175], a[72:75], v[204:207], a[172:175]
    ds_read_b64_tr_b16 a[118:119], v49 offset:41984
    v_cvt_pk_bf16_f32 v211, v38, v39
    v_mfma_f32_16x16x32_bf16 a[176:179], a[76:79], v[192:195], a[176:179]
    ds_read_b64_tr_b16 a[120:121], v50 offset:40960
    v_fma_mix_f32 v36, v212, v76, v68 op_sel:[0,0,0] op_sel_hi:[1,0,0]
    v_mfma_f32_16x16x32_bf16 a[180:183], a[76:79], v[196:199], a[180:183]
    ds_read_b64_tr_b16 a[122:123], v50 offset:41984
    v_fma_mix_f32 v37, v212, v77, v69 op_sel:[1,0,0] op_sel_hi:[1,0,0]
    v_mfma_f32_16x16x32_bf16 a[184:187], a[76:79], v[200:203], a[184:187]
    ds_read_b64_tr_b16 a[124:125], v51 offset:40960
    v_cvt_pk_bf16_f32 v212, v36, v37
    v_mfma_f32_16x16x32_bf16 a[188:191], a[76:79], v[204:207], a[188:191]
    ds_read_b64_tr_b16 a[126:127], v51 offset:41984
    v_fma_mix_f32 v38, v213, v78, v70 op_sel:[0,0,0] op_sel_hi:[1,0,0]
    v_mfma_f32_16x16x32_bf16 a[192:195], a[80:83], v[192:195], a[192:195]
    ds_read_b128 v[52:55], v34 offset:1792
    v_fma_mix_f32 v39, v213, v79, v71 op_sel:[1,0,0] op_sel_hi:[1,0,0]
    v_mfma_f32_16x16x32_bf16 a[196:199], a[80:83], v[196:199], a[196:199]
    ds_read_b128 v[56:59], v34 offset:1808
    v_cvt_pk_bf16_f32 v213, v38, v39
    v_mfma_f32_16x16x32_bf16 a[200:203], a[80:83], v[200:203], a[200:203]
    ds_read_b128 v[60:63], v34 offset:3840
    v_fma_mix_f32 v36, v214, v80, v72 op_sel:[0,0,0] op_sel_hi:[1,0,0]
    v_mfma_f32_16x16x32_bf16 a[204:207], a[80:83], v[204:207], a[204:207]
    ds_read_b128 v[64:67], v34 offset:3856
    v_fma_mix_f32 v37, v214, v81, v73 op_sel:[1,0,0] op_sel_hi:[1,0,0]
    v_cvt_pk_bf16_f32 v214, v36, v37
    v_mfma_f32_16x16x32_bf16 a[208:211], a[84:87], v[192:195], a[208:211]
    v_fma_mix_f32 v38, v215, v82, v74 op_sel:[0,0,0] op_sel_hi:[1,0,0]
    v_fma_mix_f32 v39, v215, v83, v75 op_sel:[1,0,0] op_sel_hi:[1,0,0]
    v_mfma_f32_16x16x32_bf16 a[212:215], a[84:87], v[196:199], a[212:215]
    v_cvt_pk_bf16_f32 v215, v38, v39
    v_fma_mix_f32 v36, v216, v76, v68 op_sel:[0,0,0] op_sel_hi:[1,0,0]
    s_nop 0
    buffer_load_dwordx4 v125, s[8:11], s35 offen offset:1024 lds
    v_mfma_f32_16x16x32_bf16 a[216:219], a[84:87], v[200:203], a[216:219]
    v_fma_mix_f32 v37, v216, v77, v69 op_sel:[1,0,0] op_sel_hi:[1,0,0]
    v_cvt_pk_bf16_f32 v216, v36, v37
    v_mfma_f32_16x16x32_bf16 a[220:223], a[84:87], v[204:207], a[220:223]
    v_fma_mix_f32 v38, v217, v78, v70 op_sel:[0,0,0] op_sel_hi:[1,0,0]
    v_fma_mix_f32 v39, v217, v79, v71 op_sel:[1,0,0] op_sel_hi:[1,0,0]
    v_cvt_pk_bf16_f32 v217, v38, v39
    v_mfma_f32_16x16x32_bf16 a[224:227], a[88:91], v[192:195], a[224:227]
    v_fma_mix_f32 v36, v218, v80, v72 op_sel:[0,0,0] op_sel_hi:[1,0,0]
    v_fma_mix_f32 v37, v218, v81, v73 op_sel:[1,0,0] op_sel_hi:[1,0,0]
    v_mfma_f32_16x16x32_bf16 a[228:231], a[88:91], v[196:199], a[228:231]
    v_cvt_pk_bf16_f32 v218, v36, v37
    v_fma_mix_f32 v38, v219, v82, v74 op_sel:[0,0,0] op_sel_hi:[1,0,0]
    v_mfma_f32_16x16x32_bf16 a[232:235], a[88:91], v[200:203], a[232:235]
    v_fma_mix_f32 v39, v219, v83, v75 op_sel:[1,0,0] op_sel_hi:[1,0,0]
    v_cvt_pk_bf16_f32 v219, v38, v39
    v_mfma_f32_16x16x32_bf16 a[236:239], a[88:91], v[204:207], a[236:239]
    v_fma_mix_f32 v36, v220, v76, v68 op_sel:[0,0,0] op_sel_hi:[1,0,0]
    v_fma_mix_f32 v37, v220, v77, v69 op_sel:[1,0,0] op_sel_hi:[1,0,0]
    v_cvt_pk_bf16_f32 v220, v36, v37
    v_mfma_f32_16x16x32_bf16 a[240:243], a[92:95], v[192:195], a[240:243]
    v_fma_mix_f32 v38, v221, v78, v70 op_sel:[0,0,0] op_sel_hi:[1,0,0]
    v_fma_mix_f32 v39, v221, v79, v71 op_sel:[1,0,0] op_sel_hi:[1,0,0]
    v_mfma_f32_16x16x32_bf16 a[244:247], a[92:95], v[196:199], a[244:247]
    v_cvt_pk_bf16_f32 v221, v38, v39
    v_fma_mix_f32 v36, v222, v80, v72 op_sel:[0,0,0] op_sel_hi:[1,0,0]
    v_mfma_f32_16x16x32_bf16 a[248:251], a[92:95], v[200:203], a[248:251]
    v_fma_mix_f32 v37, v222, v81, v73 op_sel:[1,0,0] op_sel_hi:[1,0,0]
    v_cvt_pk_bf16_f32 v222, v36, v37
    v_mfma_f32_16x16x32_bf16 a[252:255], a[92:95], v[204:207], a[252:255]
    v_fma_mix_f32 v38, v223, v82, v74 op_sel:[0,0,0] op_sel_hi:[1,0,0]
    v_fma_mix_f32 v39, v223, v83, v75 op_sel:[1,0,0] op_sel_hi:[1,0,0]
    v_cvt_pk_bf16_f32 v223, v38, v39
    s_waitcnt lgkmcnt(0)
    s_nop 0
    s_waitcnt vmcnt(12)
    v_mfma_f32_16x16x32_bf16 a[128:131], a[96:99], v[208:211], a[128:131]
    ds_read_b64_tr_b16 a[64:65], v44 offset:49152
    v_fma_mix_f32 v36, v224, v60, v52 op_sel:[0,0,0] op_sel_hi:[1,0,0]
    v_mfma_f32_16x16x32_bf16 a[132:135], a[96:99], v[212:215], a[132:135]
    ds_read_b64_tr_b16 a[66:67], v44 offset:50176
    v_fma_mix_f32 v37, v224, v61, v53 op_sel:[1,0,0] op_sel_hi:[1,0,0]
    v_mfma_f32_16x16x32_bf16 a[136:139], a[96:99], v[216:219], a[136:139]
    ds_read_b64_tr_b16 a[68:69], v45 offset:49152
    v_cvt_pk_bf16_f32 v224, v36, v37
    v_mfma_f32_16x16x32_bf16 a[140:143], a[96:99], v[220:223], a[140:143]
    ds_read_b64_tr_b16 a[70:71], v45 offset:50176
    v_fma_mix_f32 v38, v225, v62, v54 op_sel:[0,0,0] op_sel_hi:[1,0,0]
    v_mfma_f32_16x16x32_bf16 a[144:147], a[100:103], v[208:211], a[144:147]
    ds_read_b64_tr_b16 a[72:73], v46 offset:49152
    v_fma_mix_f32 v39, v225, v63, v55 op_sel:[1,0,0] op_sel_hi:[1,0,0]
    v_mfma_f32_16x16x32_bf16 a[148:151], a[100:103], v[212:215], a[148:151]
    ds_read_b64_tr_b16 a[74:75], v46 offset:50176
    v_cvt_pk_bf16_f32 v225, v38, v39
    s_nop 0
    buffer_load_dwordx4 v126, s[8:11], s35 offen offset:2048 lds
    v_mfma_f32_16x16x32_bf16 a[152:155], a[100:103], v[216:219], a[152:155]
    ds_read_b64_tr_b16 a[76:77], v47 offset:49152
    v_fma_mix_f32 v36, v226, v64, v56 op_sel:[0,0,0] op_sel_hi:[1,0,0]
    v_mfma_f32_16x16x32_bf16 a[156:159], a[100:103], v[220:223], a[156:159]
    ds_read_b64_tr_b16 a[78:79], v47 offset:50176
    v_fma_mix_f32 v37, v226, v65, v57 op_sel:[1,0,0] op_sel_hi:[1,0,0]
    v_mfma_f32_16x16x32_bf16 a[160:163], a[104:107], v[208:211], a[160:163]
    ds_read_b64_tr_b16 a[80:81], v48 offset:49152
    v_cvt_pk_bf16_f32 v226, v36, v37
    v_mfma_f32_16x16x32_bf16 a[164:167], a[104:107], v[212:215], a[164:167]
    ds_read_b64_tr_b16 a[82:83], v48 offset:50176
    v_fma_mix_f32 v38, v227, v66, v58 op_sel:[0,0,0] op_sel_hi:[1,0,0]
    v_mfma_f32_16x16x32_bf16 a[168:171], a[104:107], v[216:219], a[168:171]
    ds_read_b64_tr_b16 a[84:85], v49 offset:49152
    v_fma_mix_f32 v39, v227, v67, v59 op_sel:[1,0,0] op_sel_hi:[1,0,0]
    v_mfma_f32_16x16x32_bf16 a[172:175], a[104:107], v[220:223], a[172:175]
    ds_read_b64_tr_b16 a[86:87], v49 offset:50176
    v_cvt_pk_bf16_f32 v227, v38, v39
    v_mfma_f32_16x16x32_bf16 a[176:179], a[108:111], v[208:211], a[176:179]
    ds_read_b64_tr_b16 a[88:89], v50 offset:49152
    v_fma_mix_f32 v36, v228, v60, v52 op_sel:[0,0,0] op_sel_hi:[1,0,0]
    v_mfma_f32_16x16x32_bf16 a[180:183], a[108:111], v[212:215], a[180:183]
    ds_read_b64_tr_b16 a[90:91], v50 offset:50176
    v_fma_mix_f32 v37, v228, v61, v53 op_sel:[1,0,0] op_sel_hi:[1,0,0]
    v_mfma_f32_16x16x32_bf16 a[184:187], a[108:111], v[216:219], a[184:187]
    ds_read_b64_tr_b16 a[92:93], v51 offset:49152
    v_cvt_pk_bf16_f32 v228, v36, v37
    v_mfma_f32_16x16x32_bf16 a[188:191], a[108:111], v[220:223], a[188:191]
    ds_read_b64_tr_b16 a[94:95], v51 offset:50176
    v_fma_mix_f32 v38, v229, v62, v54 op_sel:[0,0,0] op_sel_hi:[1,0,0]
    v_mfma_f32_16x16x32_bf16 a[192:195], a[112:115], v[208:211], a[192:195]
    ds_read_b128 v[68:71], v34 offset:1920
    v_fma_mix_f32 v39, v229, v63, v55 op_sel:[1,0,0] op_sel_hi:[1,0,0]
    v_mfma_f32_16x16x32_bf16 a[196:199], a[112:115], v[212:215], a[196:199]
    ds_read_b128 v[72:75], v34 offset:1936
    v_cvt_pk_bf16_f32 v229, v38, v39
    v_mfma_f32_16x16x32_bf16 a[200:203], a[112:115], v[216:219], a[200:203]
    ds_read_b128 v[76:79], v34 offset:3968
    v_fma_mix_f32 v36, v230, v64, v56 op_sel:[0,0,0] op_sel_hi:[1,0,0]
    v_mfma_f32_16x16x32_bf16 a[204:207], a[112:115], v[220:223], a[204:207]
    ds_read_b128 v[80:83], v34 offset:3984
    v_fma_mix_f32 v37, v230, v65, v57 op_sel:[1,0,0] op_sel_hi:[1,0,0]
    v_cvt_pk_bf16_f32 v230, v36, v37
    v_mfma_f32_16x16x32_bf16 a[208:211], a[116:119], v[208:211], a[208:211]
    v_fma_mix_f32 v38, v231, v66, v58 op_sel:[0,0,0] op_sel_hi:[1,0,0]
    v_fma_mix_f32 v39, v231, v67, v59 op_sel:[1,0,0] op_sel_hi:[1,0,0]
    v_mfma_f32_16x16x32_bf16 a[212:215], a[116:119], v[212:215], a[212:215]
    v_cvt_pk_bf16_f32 v231, v38, v39
    v_fma_mix_f32 v36, v232, v60, v52 op_sel:[0,0,0] op_sel_hi:[1,0,0]
    s_nop 0
    buffer_load_dwordx4 v127, s[8:11], s35 offen offset:3072 lds
    v_mfma_f32_16x16x32_bf16 a[216:219], a[116:119], v[216:219], a[216:219]
    v_fma_mix_f32 v37, v232, v61, v53 op_sel:[1,0,0] op_sel_hi:[1,0,0]
    v_cvt_pk_bf16_f32 v232, v36, v37
    v_mfma_f32_16x16x32_bf16 a[220:223], a[116:119], v[220:223], a[220:223]
    v_fma_mix_f32 v38, v233, v62, v54 op_sel:[0,0,0] op_sel_hi:[1,0,0]
    v_fma_mix_f32 v39, v233, v63, v55 op_sel:[1,0,0] op_sel_hi:[1,0,0]
    v_cvt_pk_bf16_f32 v233, v38, v39
    v_mfma_f32_16x16x32_bf16 a[224:227], a[120:123], v[208:211], a[224:227]
    v_fma_mix_f32 v36, v234, v64, v56 op_sel:[0,0,0] op_sel_hi:[1,0,0]
    v_fma_mix_f32 v37, v234, v65, v57 op_sel:[1,0,0] op_sel_hi:[1,0,0]
    v_mfma_f32_16x16x32_bf16 a[228:231], a[120:123], v[212:215], a[228:231]
    v_cvt_pk_bf16_f32 v234, v36, v37
    v_fma_mix_f32 v38, v235, v66, v58 op_sel:[0,0,0] op_sel_hi:[1,0,0]
    v_mfma_f32_16x16x32_bf16 a[232:235], a[120:123], v[216:219], a[232:235]
    v_fma_mix_f32 v39, v235, v67, v59 op_sel:[1,0,0] op_sel_hi:[1,0,0]
    v_cvt_pk_bf16_f32 v235, v38, v39
    v_mfma_f32_16x16x32_bf16 a[236:239], a[120:123], v[220:223], a[236:239]
    v_fma_mix_f32 v36, v236, v60, v52 op_sel:[0,0,0] op_sel_hi:[1,0,0]
    v_fma_mix_f32 v37, v236, v61, v53 op_sel:[1,0,0] op_sel_hi:[1,0,0]
    v_cvt_pk_bf16_f32 v236, v36, v37
    v_mfma_f32_16x16x32_bf16 a[240:243], a[124:127], v[208:211], a[240:243]
    v_fma_mix_f32 v38, v237, v62, v54 op_sel:[0,0,0] op_sel_hi:[1,0,0]
    v_fma_mix_f32 v39, v237, v63, v55 op_sel:[1,0,0] op_sel_hi:[1,0,0]
    v_mfma_f32_16x16x32_bf16 a[244:247], a[124:127], v[212:215], a[244:247]
    v_cvt_pk_bf16_f32 v237, v38, v39
    v_fma_mix_f32 v36, v238, v64, v56 op_sel:[0,0,0] op_sel_hi:[1,0,0]
    v_mfma_f32_16x16x32_bf16 a[248:251], a[124:127], v[216:219], a[248:251]
    v_fma_mix_f32 v37, v238, v65, v57 op_sel:[1,0,0] op_sel_hi:[1,0,0]
    v_cvt_pk_bf16_f32 v238, v36, v37
    v_mfma_f32_16x16x32_bf16 a[252:255], a[124:127], v[220:223], a[252:255]
    v_fma_mix_f32 v38, v239, v66, v58 op_sel:[0,0,0] op_sel_hi:[1,0,0]
    v_fma_mix_f32 v39, v239, v67, v59 op_sel:[1,0,0] op_sel_hi:[1,0,0]
    v_cvt_pk_bf16_f32 v239, v38, v39
    s_waitcnt lgkmcnt(0)
    s_nop 0
    s_waitcnt vmcnt(8)
    v_mfma_f32_16x16x32_bf16 a[128:131], a[64:67], v[224:227], a[128:131]
    ds_read_b64_tr_b16 a[96:97], v44 offset:57344
    v_fma_mix_f32 v36, v240, v76, v68 op_sel:[0,0,0] op_sel_hi:[1,0,0]
    v_mfma_f32_16x16x32_bf16 a[132:135], a[64:67], v[228:231], a[132:135]
    ds_read_b64_tr_b16 a[98:99], v44 offset:58368
    v_fma_mix_f32 v37, v240, v77, v69 op_sel:[1,0,0] op_sel_hi:[1,0,0]
    v_mfma_f32_16x16x32_bf16 a[136:139], a[64:67], v[232:235], a[136:139]
    ds_read_b64_tr_b16 a[100:101], v45 offset:57344
    v_cvt_pk_bf16_f32 v240, v36, v37
    v_mfma_f32_16x16x32_bf16 a[140:143], a[64:67], v[236:239], a[140:143]
    ds_read_b64_tr_b16 a[102:103], v45 offset:58368
    v_fma_mix_f32 v38, v241, v78, v70 op_sel:[0,0,0] op_sel_hi:[1,0,0]
    v_mfma_f32_16x16x32_bf16 a[144:147], a[68:71], v[224:227], a[144:147]
    ds_read_b64_tr_b16 a[104:105], v46 offset:57344
    v_fma_mix_f32 v39, v241, v79, v71 op_sel:[1,0,0] op_sel_hi:[1,0,0]
    v_mfma_f32_16x16x32_bf16 a[148:151], a[68:71], v[228:231], a[148:151]
    ds_read_b64_tr_b16 a[106:107], v46 offset:58368
    v_cvt_pk_bf16_f32 v241, v38, v39
    s_add_u32 m0, s36, 49152
    s_nop 0
    buffer_load_dwordx4 v2, s[12:15], s35 offen offset:0 lds
    v_mfma_f32_16x16x32_bf16 a[152:155], a[68:71], v[232:235], a[152:155]
    ds_read_b64_tr_b16 a[108:109], v47 offset:57344
    v_fma_mix_f32 v36, v242, v80, v72 op_sel:[0,0,0] op_sel_hi:[1,0,0]
    v_mfma_f32_16x16x32_bf16 a[156:159], a[68:71], v[236:239], a[156:159]
    ds_read_b64_tr_b16 a[110:111], v47 offset:58368
    v_fma_mix_f32 v37, v242, v81, v73 op_sel:[1,0,0] op_sel_hi:[1,0,0]
    v_mfma_f32_16x16x32_bf16 a[160:163], a[72:75], v[224:227], a[160:163]
    ds_read_b64_tr_b16 a[112:113], v48 offset:57344
    v_cvt_pk_bf16_f32 v242, v36, v37
    v_mfma_f32_16x16x32_bf16 a[164:167], a[72:75], v[228:231], a[164:167]
    ds_read_b64_tr_b16 a[114:115], v48 offset:58368
    v_fma_mix_f32 v38, v243, v82, v74 op_sel:[0,0,0] op_sel_hi:[1,0,0]
    v_mfma_f32_16x16x32_bf16 a[168:171], a[72:75], v[232:235], a[168:171]
    ds_read_b64_tr_b16 a[116:117], v49 offset:57344
    v_fma_mix_f32 v39, v243, v83, v75 op_sel:[1,0,0] op_sel_hi:[1,0,0]
    v_mfma_f32_16x16x32_bf16 a[172:175], a[72:75], v[236:239], a[172:175]
    ds_read_b64_tr_b16 a[118:119], v49 offset:58368
    v_cvt_pk_bf16_f32 v243, v38, v39
    v_mfma_f32_16x16x32_bf16 a[176:179], a[76:79], v[224:227], a[176:179]
    ds_read_b64_tr_b16 a[120:121], v50 offset:57344
    v_fma_mix_f32 v36, v244, v76, v68 op_sel:[0,0,0] op_sel_hi:[1,0,0]
    v_mfma_f32_16x16x32_bf16 a[180:183], a[76:79], v[228:231], a[180:183]
    ds_read_b64_tr_b16 a[122:123], v50 offset:58368
    v_fma_mix_f32 v37, v244, v77, v69 op_sel:[1,0,0] op_sel_hi:[1,0,0]
    v_mfma_f32_16x16x32_bf16 a[184:187], a[76:79], v[232:235], a[184:187]
    ds_read_b64_tr_b16 a[124:125], v51 offset:57344
    v_cvt_pk_bf16_f32 v244, v36, v37
    v_mfma_f32_16x16x32_bf16 a[188:191], a[76:79], v[236:239], a[188:191]
    ds_read_b64_tr_b16 a[126:127], v51 offset:58368
    v_fma_mix_f32 v38, v245, v78, v70 op_sel:[0,0,0] op_sel_hi:[1,0,0]
    v_mfma_f32_16x16x32_bf16 a[192:195], a[80:83], v[224:227], a[192:195]
    v_fma_mix_f32 v39, v245, v79, v71 op_sel:[1,0,0] op_sel_hi:[1,0,0]
    v_cvt_pk_bf16_f32 v245, v38, v39
    v_mfma_f32_16x16x32_bf16 a[196:199], a[80:83], v[228:231], a[196:199]
    v_fma_mix_f32 v36, v246, v80, v72 op_sel:[0,0,0] op_sel_hi:[1,0,0]
    v_fma_mix_f32 v37, v246, v81, v73 op_sel:[1,0,0] op_sel_hi:[1,0,0]
    v_mfma_f32_16x16x32_bf16 a[200:203], a[80:83], v[232:235], a[200:203]
    v_cvt_pk_bf16_f32 v246, v36, v37
    v_fma_mix_f32 v38, v247, v82, v74 op_sel:[0,0,0] op_sel_hi:[1,0,0]
    v_mfma_f32_16x16x32_bf16 a[204:207], a[80:83], v[236:239], a[204:207]
    v_fma_mix_f32 v39, v247, v83, v75 op_sel:[1,0,0] op_sel_hi:[1,0,0]
    v_cvt_pk_bf16_f32 v247, v38, v39
    v_mfma_f32_16x16x32_bf16 a[208:211], a[84:87], v[224:227], a[208:211]
    v_fma_mix_f32 v36, v248, v76, v68 op_sel:[0,0,0] op_sel_hi:[1,0,0]
    v_fma_mix_f32 v37, v248, v77, v69 op_sel:[1,0,0] op_sel_hi:[1,0,0]
    v_mfma_f32_16x16x32_bf16 a[212:215], a[84:87], v[228:231], a[212:215]
    v_cvt_pk_bf16_f32 v248, v36, v37
    v_fma_mix_f32 v38, v249, v78, v70 op_sel:[0,0,0] op_sel_hi:[1,0,0]
    s_nop 0
    buffer_load_dwordx4 v3, s[12:15], s35 offen offset:1024 lds
    v_mfma_f32_16x16x32_bf16 a[216:219], a[84:87], v[232:235], a[216:219]
    v_fma_mix_f32 v39, v249, v79, v71 op_sel:[1,0,0] op_sel_hi:[1,0,0]
    v_cvt_pk_bf16_f32 v249, v38, v39
    v_mfma_f32_16x16x32_bf16 a[220:223], a[84:87], v[236:239], a[220:223]
    v_fma_mix_f32 v36, v250, v80, v72 op_sel:[0,0,0] op_sel_hi:[1,0,0]
    v_fma_mix_f32 v37, v250, v81, v73 op_sel:[1,0,0] op_sel_hi:[1,0,0]
    v_mfma_f32_16x16x32_bf16 a[224:227], a[88:91], v[224:227], a[224:227]
    v_cvt_pk_bf16_f32 v250, v36, v37
    v_fma_mix_f32 v38, v251, v82, v74 op_sel:[0,0,0] op_sel_hi:[1,0,0]
    v_mfma_f32_16x16x32_bf16 a[228:231], a[88:91], v[228:231], a[228:231]
    v_fma_mix_f32 v39, v251, v83, v75 op_sel:[1,0,0] op_sel_hi:[1,0,0]
    v_cvt_pk_bf16_f32 v251, v38, v39
    v_mfma_f32_16x16x32_bf16 a[232:235], a[88:91], v[232:235], a[232:235]
    v_fma_mix_f32 v36, v252, v76, v68 op_sel:[0,0,0] op_sel_hi:[1,0,0]
    v_fma_mix_f32 v37, v252, v77, v69 op_sel:[1,0,0] op_sel_hi:[1,0,0]
    v_mfma_f32_16x16x32_bf16 a[236:239], a[88:91], v[236:239], a[236:239]
    v_cvt_pk_bf16_f32 v252, v36, v37
    v_fma_mix_f32 v38, v253, v78, v70 op_sel:[0,0,0] op_sel_hi:[1,0,0]
    v_mfma_f32_16x16x32_bf16 a[240:243], a[92:95], v[224:227], a[240:243]
    v_fma_mix_f32 v39, v253, v79, v71 op_sel:[1,0,0] op_sel_hi:[1,0,0]
    v_cvt_pk_bf16_f32 v253, v38, v39
    v_mfma_f32_16x16x32_bf16 a[244:247], a[92:95], v[228:231], a[244:247]
    v_fma_mix_f32 v36, v254, v80, v72 op_sel:[0,0,0] op_sel_hi:[1,0,0]
    v_fma_mix_f32 v37, v254, v81, v73 op_sel:[1,0,0] op_sel_hi:[1,0,0]
    v_mfma_f32_16x16x32_bf16 a[248:251], a[92:95], v[232:235], a[248:251]
    v_cvt_pk_bf16_f32 v254, v36, v37
    v_fma_mix_f32 v38, v255, v82, v74 op_sel:[0,0,0] op_sel_hi:[1,0,0]
    v_mfma_f32_16x16x32_bf16 a[252:255], a[92:95], v[236:239], a[252:255]
    v_fma_mix_f32 v39, v255, v83, v75 op_sel:[1,0,0] op_sel_hi:[1,0,0]
    v_cvt_pk_bf16_f32 v255, v38, v39
    s_waitcnt lgkmcnt(0)
    s_nop 0
    v_mfma_f32_16x16x32_bf16 a[128:131], a[96:99], v[240:243], a[128:131]
    s_lshl_b32 s46, s2, 2
    s_add_u32 s46, s46, s32
    v_mfma_f32_16x16x32_bf16 a[132:135], a[96:99], v[244:247], a[132:135]
    s_cmp_lt_u32 s46, 512
    s_cselect_b32 s92, s56, s58
    s_cselect_b32 s93, s57, s59
    s_and_b32 s93, s93, 0xffff
    v_mfma_f32_16x16x32_bf16 a[136:139], a[96:99], v[248:251], a[136:139]
    s_mov_b32 s94, 524288
    s_mov_b32 s95, 0x20000
    v_mfma_f32_16x16x32_bf16 a[140:143], a[96:99], v[252:255], a[140:143]
    s_and_b32 s37, s46, 511
    s_lshl_b32 s37, s37, 10
    v_mfma_f32_16x16x32_bf16 a[144:147], a[100:103], v[240:243], a[144:147]
    v_lshlrev_b32 v120, 4, v1
    v_add_u32 v121, s37, v120
    v_mfma_f32_16x16x32_bf16 a[148:151], a[100:103], v[244:247], a[148:151]
    buffer_load_dwordx4 v[116:119], v121, s[92:95], 0 offen
    s_mov_b32 s92, s60
    s_nop 0
    buffer_load_dwordx4 v2, s[12:15], s35 offen offset:2048 lds
    v_mfma_f32_16x16x32_bf16 a[152:155], a[100:103], v[248:251], a[152:155]
    s_and_b32 s93, s61, 0xffff
    s_and_b32 s37, s46, 7
    v_mfma_f32_16x16x32_bf16 a[156:159], a[100:103], v[252:255], a[156:159]
    s_lshr_b32 s38, s46, 3
    s_lshl_b32 s26, s38, 15
    v_mfma_f32_16x16x32_bf16 a[160:163], a[104:107], v[240:243], a[160:163]
    s_lshl_b32 s3, s37, 7
    s_add_u32 s26, s26, s3
    v_mfma_f32_16x16x32_bf16 a[164:167], a[104:107], v[244:247], a[164:167]
    s_lshl_b32 s27, s37, 7
    s_add_u32 s27, s27, s38
    v_mfma_f32_16x16x32_bf16 a[168:171], a[104:107], v[248:251], a[168:171]
    s_lshl_b32 s27, s27, 12
    s_mul_i32 s88, s37, 56
    v_mfma_f32_16x16x32_bf16 a[172:175], a[104:107], v[252:255], a[172:175]
    s_add_u32 s88, s88, s38
    s_lshl_b32 s88, s88, 12
    v_mfma_f32_16x16x32_bf16 a[176:179], a[108:111], v[240:243], a[176:179]
    s_add_u32 s88, s88, 4194304
    s_cmp_lt_u32 s46, 448
    s_cselect_b32 s89, 1, 0
    v_mfma_f32_16x16x32_bf16 a[180:183], a[108:111], v[244:247], a[180:183]
    s_lshl_b32 s46, s46, 10
    s_add_u32 s20, s4, 50331648
    s_addc_u32 s21, s5, 0
    v_mfma_f32_16x16x32_bf16 a[184:187], a[108:111], v[248:251], a[184:187]
    s_and_b32 s21, s21, 0xffff
    s_mov_b32 s22, 6029312
    v_mfma_f32_16x16x32_bf16 a[188:191], a[108:111], v[252:255], a[188:191]
    s_mov_b32 s23, 0x20000
    s_mov_b32 s19, 0x20000
    v_mfma_f32_16x16x32_bf16 a[192:195], a[112:115], v[240:243], a[192:195]
    v_lshrrev_b32 v102, 3, v1
    v_and_b32 v101, 7, v1
    v_mfma_f32_16x16x32_bf16 a[196:199], a[112:115], v[244:247], a[196:199]
    v_and_b32 v105, 6, v102
    v_xor_b32 v101, v101, v105
    v_mfma_f32_16x16x32_bf16 a[200:203], a[112:115], v[248:251], a[200:203]
    v_lshlrev_b32 v102, 10, v102
    v_lshl_add_u32 v92, v101, 4, v102
    v_mfma_f32_16x16x32_bf16 a[204:207], a[112:115], v[252:255], a[204:207]
    v_add_u32 v93, 7168, v92
    v_add_u32 v94, 14336, v92
    v_mfma_f32_16x16x32_bf16 a[208:211], a[116:119], v[240:243], a[208:211]
    v_add_u32 v95, 21504, v92
    s_lshl_b32 s47, s32, 12
    v_mfma_f32_16x16x32_bf16 a[212:215], a[116:119], v[244:247], a[212:215]
    s_add_u32 s47, s47, 136192
    v_and_b32 v101, 15, v1
    s_nop 0
    buffer_load_dwordx4 v3, s[12:15], s35 offen offset:3072 lds
    v_mfma_f32_16x16x32_bf16 a[216:219], a[116:119], v[248:251], a[216:219]
    v_lshrrev_b32 v102, 4, v1
    v_lshrrev_b32 v103, 2, v101
    v_mfma_f32_16x16x32_bf16 a[220:223], a[116:119], v[252:255], a[220:223]
    v_and_b32 v104, 3, v101
    v_lshl_add_u32 v106, v102, 2, v103
    v_mfma_f32_16x16x32_bf16 a[224:227], a[120:123], v[240:243], a[224:227]
    v_lshrrev_b32 v105, 1, v106
    v_and_b32 v105, 3, v105
    v_mfma_f32_16x16x32_bf16 a[228:231], a[120:123], v[244:247], a[228:231]
    v_lshlrev_b32 v106, 7, v106
    v_lshl_add_u32 v106, v104, 3, v106
    v_mfma_f32_16x16x32_bf16 a[232:235], a[120:123], v[248:251], a[232:235]
    v_add_u32 v106, s47, v106
    v_xor_b32 v103, 0, v105
    v_mfma_f32_16x16x32_bf16 a[236:239], a[120:123], v[252:255], a[236:239]
    v_lshl_add_u32 v96, v103, 5, v106
    v_xor_b32 v103, 1, v105
    v_mfma_f32_16x16x32_bf16 a[240:243], a[124:127], v[240:243], a[240:243]
    v_lshl_add_u32 v97, v103, 5, v106
    v_xor_b32 v103, 2, v105
    v_mfma_f32_16x16x32_bf16 a[244:247], a[124:127], v[244:247], a[244:247]
    v_lshl_add_u32 v98, v103, 5, v106
    v_xor_b32 v103, 3, v105
    v_mfma_f32_16x16x32_bf16 a[248:251], a[124:127], v[248:251], a[248:251]
    v_lshl_add_u32 v99, v103, 5, v106
    v_lshlrev_b32 v100, 4, v1
    v_mfma_f32_16x16x32_bf16 a[252:255], a[124:127], v[252:255], a[252:255]
    s_mov_b32 s35, 32768
    s_add_u32 m0, s36, 65536
    s_nop 0
    buffer_load_dwordx4 v124, s[8:11], s35 offen offset:0 lds
    s_nop 0
    buffer_load_dwordx4 v125, s[8:11], s35 offen offset:1024 lds
    s_nop 0
    buffer_load_dwordx4 v126, s[8:11], s35 offen offset:2048 lds
    s_nop 0
    buffer_load_dwordx4 v127, s[8:11], s35 offen offset:3072 lds
    s_add_u32 m0, s36, 81920
    s_nop 0
    buffer_load_dwordx4 v2, s[12:15], s35 offen offset:0 lds
    s_nop 3
    v_accvgpr_read_b32 v105, a128
    v_accvgpr_read_b32 v106, a129
    v_accvgpr_read_b32 v107, a130
    v_accvgpr_read_b32 v108, a131
    v_accvgpr_read_b32 v109, a144
    v_accvgpr_read_b32 v110, a145
    v_accvgpr_read_b32 v111, a146
    v_accvgpr_read_b32 v112, a147
    v_cvt_pk_bf16_f32 v101, v105, v106
    v_cvt_pk_bf16_f32 v102, v107, v108
    v_cvt_pk_bf16_f32 v103, v109, v110
    v_cvt_pk_bf16_f32 v104, v111, v112
    v_pk_mov_b32 v[128:129], 0, 0
    v_pk_mov_b32 v[130:131], 0, 0
    v_permlane16_swap_b32 v101, v103
    v_permlane16_swap_b32 v102, v104
    v_pk_mov_b32 v[132:133], 0, 0
    v_pk_mov_b32 v[134:135], 0, 0
    v_accvgpr_write_b32 a0, v101
    v_accvgpr_write_b32 a1, v102
    v_accvgpr_write_b32 a2, v103
    v_accvgpr_write_b32 a3, v104
    v_accvgpr_read_b32 v76, a160
    v_accvgpr_read_b32 v77, a161
    v_accvgpr_read_b32 v78, a162
    v_accvgpr_read_b32 v79, a163
    v_accvgpr_read_b32 v80, a176
    v_accvgpr_read_b32 v81, a177
    v_accvgpr_read_b32 v82, a178
    v_accvgpr_read_b32 v83, a179
    v_cvt_pk_bf16_f32 v72, v76, v77
    v_cvt_pk_bf16_f32 v73, v78, v79
    v_cvt_pk_bf16_f32 v74, v80, v81
    v_cvt_pk_bf16_f32 v75, v82, v83
    v_pk_mov_b32 v[136:137], 0, 0
    v_pk_mov_b32 v[138:139], 0, 0
    v_permlane16_swap_b32 v72, v74
    v_permlane16_swap_b32 v73, v75
    v_pk_mov_b32 v[140:141], 0, 0
    v_pk_mov_b32 v[142:143], 0, 0
    v_accvgpr_write_b32 a4, v72
    v_accvgpr_write_b32 a5, v73
    v_accvgpr_write_b32 a6, v74
    v_accvgpr_write_b32 a7, v75
    v_accvgpr_read_b32 v105, a192
    v_accvgpr_read_b32 v106, a193
    v_accvgpr_read_b32 v107, a194
    v_accvgpr_read_b32 v108, a195
    v_accvgpr_read_b32 v109, a208
    v_accvgpr_read_b32 v110, a209
    v_accvgpr_read_b32 v111, a210
    v_accvgpr_read_b32 v112, a211
    v_cvt_pk_bf16_f32 v101, v105, v106
    v_cvt_pk_bf16_f32 v102, v107, v108
    v_cvt_pk_bf16_f32 v103, v109, v110
    v_cvt_pk_bf16_f32 v104, v111, v112
    v_pk_mov_b32 v[144:145], 0, 0
    v_pk_mov_b32 v[146:147], 0, 0
    v_permlane16_swap_b32 v101, v103
    v_permlane16_swap_b32 v102, v104
    v_pk_mov_b32 v[148:149], 0, 0
    v_pk_mov_b32 v[150:151], 0, 0
    v_accvgpr_write_b32 a8, v101
    v_accvgpr_write_b32 a9, v102
    v_accvgpr_write_b32 a10, v103
    v_accvgpr_write_b32 a11, v104
    v_accvgpr_read_b32 v76, a224
    v_accvgpr_read_b32 v77, a225
    v_accvgpr_read_b32 v78, a226
    v_accvgpr_read_b32 v79, a227
    v_accvgpr_read_b32 v80, a240
    v_accvgpr_read_b32 v81, a241
    v_accvgpr_read_b32 v82, a242
    v_accvgpr_read_b32 v83, a243
    v_cvt_pk_bf16_f32 v72, v76, v77
    v_cvt_pk_bf16_f32 v73, v78, v79
    v_cvt_pk_bf16_f32 v74, v80, v81
    v_cvt_pk_bf16_f32 v75, v82, v83
    v_pk_mov_b32 v[152:153], 0, 0
    v_pk_mov_b32 v[154:155], 0, 0
    v_permlane16_swap_b32 v72, v74
    v_permlane16_swap_b32 v73, v75
    v_pk_mov_b32 v[156:157], 0, 0
    v_pk_mov_b32 v[158:159], 0, 0
    v_accvgpr_write_b32 a12, v72
    v_accvgpr_write_b32 a13, v73
    v_accvgpr_write_b32 a14, v74
    v_accvgpr_write_b32 a15, v75
    v_accvgpr_read_b32 v105, a132
    v_accvgpr_read_b32 v106, a133
    v_accvgpr_read_b32 v107, a134
    v_accvgpr_read_b32 v108, a135
    v_accvgpr_read_b32 v109, a148
    v_accvgpr_read_b32 v110, a149
    v_accvgpr_read_b32 v111, a150
    v_accvgpr_read_b32 v112, a151
    v_cvt_pk_bf16_f32 v101, v105, v106
    v_cvt_pk_bf16_f32 v102, v107, v108
    v_cvt_pk_bf16_f32 v103, v109, v110
    v_cvt_pk_bf16_f32 v104, v111, v112
    v_pk_mov_b32 v[160:161], 0, 0
    v_pk_mov_b32 v[162:163], 0, 0
    v_permlane16_swap_b32 v101, v103
    v_permlane16_swap_b32 v102, v104
    v_pk_mov_b32 v[164:165], 0, 0
    v_pk_mov_b32 v[166:167], 0, 0
    v_accvgpr_write_b32 a16, v101
    v_accvgpr_write_b32 a17, v102
    v_accvgpr_write_b32 a18, v103
    v_accvgpr_write_b32 a19, v104
    v_accvgpr_read_b32 v76, a164
    v_accvgpr_read_b32 v77, a165
    v_accvgpr_read_b32 v78, a166
    v_accvgpr_read_b32 v79, a167
    v_accvgpr_read_b32 v80, a180
    v_accvgpr_read_b32 v81, a181
    v_accvgpr_read_b32 v82, a182
    v_accvgpr_read_b32 v83, a183
    v_cvt_pk_bf16_f32 v72, v76, v77
    v_cvt_pk_bf16_f32 v73, v78, v79
    v_cvt_pk_bf16_f32 v74, v80, v81
    v_cvt_pk_bf16_f32 v75, v82, v83
    v_pk_mov_b32 v[168:169], 0, 0
    v_pk_mov_b32 v[170:171], 0, 0
    v_permlane16_swap_b32 v72, v74
    v_permlane16_swap_b32 v73, v75
    v_pk_mov_b32 v[172:173], 0, 0
    v_pk_mov_b32 v[174:175], 0, 0
    v_accvgpr_write_b32 a20, v72
    v_accvgpr_write_b32 a21, v73
    v_accvgpr_write_b32 a22, v74
    v_accvgpr_write_b32 a23, v75
    v_accvgpr_read_b32 v105, a196
    v_accvgpr_read_b32 v106, a197
    v_accvgpr_read_b32 v107, a198
    v_accvgpr_read_b32 v108, a199
    v_accvgpr_read_b32 v109, a212
    v_accvgpr_read_b32 v110, a213
    v_accvgpr_read_b32 v111, a214
    v_accvgpr_read_b32 v112, a215
    v_cvt_pk_bf16_f32 v101, v105, v106
    v_cvt_pk_bf16_f32 v102, v107, v108
    v_cvt_pk_bf16_f32 v103, v109, v110
    v_cvt_pk_bf16_f32 v104, v111, v112
    v_pk_mov_b32 v[176:177], 0, 0
    v_pk_mov_b32 v[178:179], 0, 0
    v_permlane16_swap_b32 v101, v103
    v_permlane16_swap_b32 v102, v104
    v_pk_mov_b32 v[180:181], 0, 0
    v_pk_mov_b32 v[182:183], 0, 0
    v_accvgpr_write_b32 a24, v101
    v_accvgpr_write_b32 a25, v102
    v_accvgpr_write_b32 a26, v103
    v_accvgpr_write_b32 a27, v104
    v_accvgpr_read_b32 v76, a228
    v_accvgpr_read_b32 v77, a229
    v_accvgpr_read_b32 v78, a230
    v_accvgpr_read_b32 v79, a231
    v_accvgpr_read_b32 v80, a244
    v_accvgpr_read_b32 v81, a245
    v_accvgpr_read_b32 v82, a246
    v_accvgpr_read_b32 v83, a247
    v_cvt_pk_bf16_f32 v72, v76, v77
    v_cvt_pk_bf16_f32 v73, v78, v79
    v_cvt_pk_bf16_f32 v74, v80, v81
    v_cvt_pk_bf16_f32 v75, v82, v83
    v_pk_mov_b32 v[184:185], 0, 0
    v_pk_mov_b32 v[186:187], 0, 0
    v_permlane16_swap_b32 v72, v74
    v_permlane16_swap_b32 v73, v75
    v_pk_mov_b32 v[188:189], 0, 0
    v_pk_mov_b32 v[190:191], 0, 0
    v_accvgpr_write_b32 a28, v72
    v_accvgpr_write_b32 a29, v73
    v_accvgpr_write_b32 a30, v74
    v_accvgpr_write_b32 a31, v75
    s_waitcnt vmcnt(13)
    s_cmp_eq_u32 s45, 0
    s_cbranch_scc1 mega_kernel_sj2
    v_mov_b32 v48, 0
    v_mov_b32 v49, 1
    s_mov_b32 s37, 22528
    s_mov_b64 exec, 1
    buffer_atomic_add v49, v48, s[72:75], s37 offen sc1
    s_mov_b64 exec, -1
mega_kernel_sj2:
    s_mov_b32 s45, 0
    s_barrier
    ds_read_b128 a[64:67], v8 offset:0
    ds_read_b128 a[68:71], v10 offset:0
    ds_read_b128 a[72:75], v12 offset:0
    ds_read_b128 a[76:79], v14 offset:0
    ds_read_b128 a[80:83], v8 offset:4096
    ds_read_b128 a[84:87], v10 offset:4096
    ds_read_b128 a[88:91], v12 offset:4096
    ds_read_b128 a[92:95], v14 offset:4096
    v_accvgpr_read_b32 v105, a136
    v_accvgpr_read_b32 v106, a137
    v_accvgpr_read_b32 v107, a138
    v_accvgpr_read_b32 v108, a139
    v_accvgpr_read_b32 v109, a152
    v_accvgpr_read_b32 v110, a153
    v_accvgpr_read_b32 v111, a154
    v_accvgpr_read_b32 v112, a155
    v_cvt_pk_bf16_f32 v101, v105, v106
    v_cvt_pk_bf16_f32 v102, v107, v108
    v_cvt_pk_bf16_f32 v103, v109, v110
    v_cvt_pk_bf16_f32 v104, v111, v112
    v_pk_mov_b32 v[192:193], 0, 0
    v_pk_mov_b32 v[194:195], 0, 0
    v_permlane16_swap_b32 v101, v103
    v_permlane16_swap_b32 v102, v104
    v_pk_mov_b32 v[196:197], 0, 0
    v_pk_mov_b32 v[198:199], 0, 0
    v_accvgpr_write_b32 a32, v101
    v_accvgpr_write_b32 a33, v102
    v_accvgpr_write_b32 a34, v103
    v_accvgpr_write_b32 a35, v104
    s_waitcnt lgkmcnt(0)
    v_mfma_f32_16x16x32_bf16 v[32:35], a[64:67], a[0:3], 0
    v_accvgpr_read_b32 v76, a168
    v_accvgpr_read_b32 v77, a169
    v_accvgpr_read_b32 v78, a170
    v_accvgpr_read_b32 v79, a171
    v_accvgpr_read_b32 v80, a184
    v_accvgpr_read_b32 v81, a185
    v_accvgpr_read_b32 v82, a186
    v_accvgpr_read_b32 v83, a187
    v_mfma_f32_16x16x32_bf16 v[32:35], a[68:71], a[4:7], v[32:35]
    v_cvt_pk_bf16_f32 v72, v76, v77
    v_cvt_pk_bf16_f32 v73, v78, v79
    v_cvt_pk_bf16_f32 v74, v80, v81
    v_cvt_pk_bf16_f32 v75, v82, v83
    v_pk_mov_b32 v[200:201], 0, 0
    v_pk_mov_b32 v[202:203], 0, 0
    v_permlane16_swap_b32 v72, v74
    v_permlane16_swap_b32 v73, v75
    v_mfma_f32_16x16x32_bf16 v[32:35], a[72:75], a[8:11], v[32:35]
    v_pk_mov_b32 v[204:205], 0, 0
    v_pk_mov_b32 v[206:207], 0, 0
    v_accvgpr_write_b32 a36, v72
    v_accvgpr_write_b32 a37, v73
    v_accvgpr_write_b32 a38, v74
    v_accvgpr_write_b32 a39, v75
    v_accvgpr_read_b32 v105, a200
    v_accvgpr_read_b32 v106, a201
    v_mfma_f32_16x16x32_bf16 v[32:35], a[76:79], a[12:15], v[32:35]
    v_accvgpr_read_b32 v107, a202
    v_accvgpr_read_b32 v108, a203
    v_accvgpr_read_b32 v109, a216
    v_accvgpr_read_b32 v110, a217
    v_accvgpr_read_b32 v111, a218
    v_accvgpr_read_b32 v112, a219
    v_cvt_pk_bf16_f32 v101, v105, v106
    v_cvt_pk_bf16_f32 v102, v107, v108
    v_mfma_f32_16x16x32_bf16 v[36:39], a[80:83], a[0:3], 0
    v_cvt_pk_bf16_f32 v103, v109, v110
    v_cvt_pk_bf16_f32 v104, v111, v112
    v_pk_mov_b32 v[208:209], 0, 0
    v_pk_mov_b32 v[210:211], 0, 0
    v_permlane16_swap_b32 v101, v103
    v_permlane16_swap_b32 v102, v104
    v_pk_mov_b32 v[212:213], 0, 0
    v_pk_mov_b32 v[214:215], 0, 0
    v_mfma_f32_16x16x32_bf16 v[36:39], a[84:87], a[4:7], v[36:39]
    v_accvgpr_write_b32 a40, v101
    v_accvgpr_write_b32 a41, v102
    v_accvgpr_write_b32 a42, v103
    v_accvgpr_write_b32 a43, v104
    v_accvgpr_read_b32 v76, a232
    v_accvgpr_read_b32 v77, a233
    v_accvgpr_read_b32 v78, a234
    v_accvgpr_read_b32 v79, a235
    v_mfma_f32_16x16x32_bf16 v[36:39], a[88:91], a[8:11], v[36:39]
    v_accvgpr_read_b32 v80, a248
    v_accvgpr_read_b32 v81, a249
    v_accvgpr_read_b32 v82, a250
    v_accvgpr_read_b32 v83, a251
    v_cvt_pk_bf16_f32 v72, v76, v77
    v_cvt_pk_bf16_f32 v73, v78, v79
    v_cvt_pk_bf16_f32 v74, v80, v81
    v_cvt_pk_bf16_f32 v75, v82, v83
    v_mfma_f32_16x16x32_bf16 v[36:39], a[92:95], a[12:15], v[36:39]
    v_pk_mov_b32 v[216:217], 0, 0
    v_pk_mov_b32 v[218:219], 0, 0
    v_permlane16_swap_b32 v72, v74
    v_permlane16_swap_b32 v73, v75
    v_pk_mov_b32 v[220:221], 0, 0
    v_pk_mov_b32 v[222:223], 0, 0
    v_accvgpr_write_b32 a44, v72
    v_accvgpr_write_b32 a45, v73
    v_accvgpr_write_b32 a46, v74
    v_accvgpr_write_b32 a47, v75
    v_mfma_f32_16x16x32_bf16 v[40:43], a[64:67], a[16:19], 0
    v_accvgpr_read_b32 v105, a140
    v_accvgpr_read_b32 v106, a141
    v_accvgpr_read_b32 v107, a142
    v_accvgpr_read_b32 v108, a143
    v_accvgpr_read_b32 v109, a156
    v_accvgpr_read_b32 v110, a157
    v_accvgpr_read_b32 v111, a158
    v_accvgpr_read_b32 v112, a159
    v_cvt_pk_bf16_f32 v101, v105, v106
    v_cvt_pk_bf16_f32 v102, v107, v108
    v_cvt_pk_bf16_f32 v103, v109, v110
    v_mfma_f32_16x16x32_bf16 v[40:43], a[68:71], a[20:23], v[40:43]
    v_cvt_pk_bf16_f32 v104, v111, v112
    v_pk_mov_b32 v[224:225], 0, 0
    v_pk_mov_b32 v[226:227], 0, 0
    v_permlane16_swap_b32 v101, v103
    v_permlane16_swap_b32 v102, v104
    v_pk_mov_b32 v[228:229], 0, 0
    v_pk_mov_b32 v[230:231], 0, 0
    v_accvgpr_write_b32 a48, v101
    v_accvgpr_write_b32 a49, v102
    v_accvgpr_write_b32 a50, v103
    v_accvgpr_write_b32 a51, v104
    v_mfma_f32_16x16x32_bf16 v[40:43], a[72:75], a[24:27], v[40:43]
    v_accvgpr_read_b32 v76, a172
    v_accvgpr_read_b32 v77, a173
    v_accvgpr_read_b32 v78, a174
    v_accvgpr_read_b32 v79, a175
    v_accvgpr_read_b32 v80, a188
    v_accvgpr_read_b32 v81, a189
    v_accvgpr_read_b32 v82, a190
    v_accvgpr_read_b32 v83, a191
    v_cvt_pk_bf16_f32 v72, v76, v77
    v_cvt_pk_bf16_f32 v73, v78, v79
    v_cvt_pk_bf16_f32 v74, v80, v81
    v_mfma_f32_16x16x32_bf16 v[40:43], a[76:79], a[28:31], v[40:43]
    v_cvt_pk_bf16_f32 v75, v82, v83
    v_pk_mov_b32 v[232:233], 0, 0
    v_pk_mov_b32 v[234:235], 0, 0
    v_permlane16_swap_b32 v72, v74
    v_permlane16_swap_b32 v73, v75
    v_pk_mov_b32 v[236:237], 0, 0
    v_pk_mov_b32 v[238:239], 0, 0
    v_accvgpr_write_b32 a52, v72
    v_accvgpr_write_b32 a53, v73
    v_accvgpr_write_b32 a54, v74
    v_accvgpr_write_b32 a55, v75
    v_mfma_f32_16x16x32_bf16 v[44:47], a[80:83], a[16:19], 0
    v_accvgpr_read_b32 v105, a204
    v_accvgpr_read_b32 v106, a205
    v_accvgpr_read_b32 v107, a206
    v_accvgpr_read_b32 v108, a207
    v_accvgpr_read_b32 v109, a220
    v_accvgpr_read_b32 v110, a221
    v_accvgpr_read_b32 v111, a222
    v_accvgpr_read_b32 v112, a223
    v_cvt_pk_bf16_f32 v101, v105, v106
    v_cvt_pk_bf16_f32 v102, v107, v108
    v_cvt_pk_bf16_f32 v103, v109, v110
    v_mfma_f32_16x16x32_bf16 v[44:47], a[84:87], a[20:23], v[44:47]
    v_cvt_pk_bf16_f32 v104, v111, v112
    v_pk_mov_b32 v[240:241], 0, 0
    v_pk_mov_b32 v[242:243], 0, 0
    v_permlane16_swap_b32 v101, v103
    v_permlane16_swap_b32 v102, v104
    v_pk_mov_b32 v[244:245], 0, 0
    v_pk_mov_b32 v[246:247], 0, 0
    v_accvgpr_write_b32 a56, v101
    v_accvgpr_write_b32 a57, v102
    v_accvgpr_write_b32 a58, v103
    v_accvgpr_write_b32 a59, v104
    v_mfma_f32_16x16x32_bf16 v[44:47], a[88:91], a[24:27], v[44:47]
    v_accvgpr_read_b32 v76, a236
    v_accvgpr_read_b32 v77, a237
    v_accvgpr_read_b32 v78, a238
    v_accvgpr_read_b32 v79, a239
    v_accvgpr_read_b32 v80, a252
    v_accvgpr_read_b32 v81, a253
    v_accvgpr_read_b32 v82, a254
    v_accvgpr_read_b32 v83, a255
    v_cvt_pk_bf16_f32 v72, v76, v77
    v_cvt_pk_bf16_f32 v73, v78, v79
    v_cvt_pk_bf16_f32 v74, v80, v81
    v_mfma_f32_16x16x32_bf16 v[44:47], a[92:95], a[28:31], v[44:47]
    v_cvt_pk_bf16_f32 v75, v82, v83
    v_pk_mov_b32 v[248:249], 0, 0
    v_pk_mov_b32 v[250:251], 0, 0
    v_permlane16_swap_b32 v72, v74
    v_permlane16_swap_b32 v73, v75
    v_pk_mov_b32 v[252:253], 0, 0
    v_pk_mov_b32 v[254:255], 0, 0
    v_accvgpr_write_b32 a60, v72
    v_accvgpr_write_b32 a61, v73
    v_accvgpr_write_b32 a62, v74
    v_accvgpr_write_b32 a63, v75
    ds_read_b64_tr_b16 a[160:161], v16 offset:24576
    ds_read_b64_tr_b16 a[162:163], v16 offset:28672
    ds_read_b64_tr_b16 a[164:165], v18 offset:24576
    ds_read_b64_tr_b16 a[166:167], v18 offset:28672
    ds_read_b64_tr_b16 a[168:169], v20 offset:24576
    ds_read_b64_tr_b16 a[170:171], v20 offset:28672
    ds_read_b64_tr_b16 a[172:173], v22 offset:24576
    ds_read_b64_tr_b16 a[174:175], v22 offset:28672
    ds_read_b64_tr_b16 a[176:177], v24 offset:24576
    ds_read_b64_tr_b16 a[178:179], v24 offset:28672
    ds_read_b64_tr_b16 a[180:181], v26 offset:24576
    ds_read_b64_tr_b16 a[182:183], v26 offset:28672
    ds_read_b64_tr_b16 a[184:185], v28 offset:24576
    ds_read_b64_tr_b16 a[186:187], v28 offset:28672
    ds_read_b64_tr_b16 a[188:189], v30 offset:24576
    ds_read_b64_tr_b16 a[190:191], v30 offset:28672
    s_nop 1
    v_mfma_f32_16x16x32_bf16 v[56:59], a[64:67], a[32:35], 0
    v_mfma_f32_16x16x32_bf16 v[56:59], a[68:71], a[36:39], v[56:59]
    v_mfma_f32_16x16x32_bf16 v[56:59], a[72:75], a[40:43], v[56:59]
    v_mfma_f32_16x16x32_bf16 v[56:59], a[76:79], a[44:47], v[56:59]
    v_mfma_f32_16x16x32_bf16 v[60:63], a[80:83], a[32:35], 0
    v_mfma_f32_16x16x32_bf16 v[60:63], a[84:87], a[36:39], v[60:63]
    v_mfma_f32_16x16x32_bf16 v[60:63], a[88:91], a[40:43], v[60:63]
    v_mfma_f32_16x16x32_bf16 v[60:63], a[92:95], a[44:47], v[60:63]
    v_mfma_f32_16x16x32_bf16 v[64:67], a[64:67], a[48:51], 0
    v_mfma_f32_16x16x32_bf16 v[64:67], a[68:71], a[52:55], v[64:67]
    v_mfma_f32_16x16x32_bf16 v[64:67], a[72:75], a[56:59], v[64:67]
    v_mfma_f32_16x16x32_bf16 v[64:67], a[76:79], a[60:63], v[64:67]
    v_mfma_f32_16x16x32_bf16 v[68:71], a[80:83], a[48:51], 0
    v_mfma_f32_16x16x32_bf16 v[68:71], a[84:87], a[52:55], v[68:71]
    v_mfma_f32_16x16x32_bf16 v[68:71], a[88:91], a[56:59], v[68:71]
    v_mfma_f32_16x16x32_bf16 v[68:71], a[92:95], a[60:63], v[68:71]
    ds_read_b128 a[96:99], v8 offset:8192
    ds_read_b128 a[100:103], v10 offset:8192
    ds_read_b64_tr_b16 a[128:129], v16 offset:16384
    ds_read_b64_tr_b16 a[130:131], v16 offset:20480
    ds_read_b64_tr_b16 a[132:133], v18 offset:16384
    ds_read_b64_tr_b16 a[134:135], v18 offset:20480
    ds_read_b64_tr_b16 a[136:137], v20 offset:16384
    ds_read_b64_tr_b16 a[138:139], v20 offset:20480
    ds_read_b64_tr_b16 a[140:141], v22 offset:16384
    ds_read_b64_tr_b16 a[142:143], v22 offset:20480
    ds_read_b64_tr_b16 a[144:145], v24 offset:16384
    ds_read_b64_tr_b16 a[146:147], v24 offset:20480
    ds_read_b64_tr_b16 a[148:149], v26 offset:16384
    ds_read_b64_tr_b16 a[150:151], v26 offset:20480
    v_pk_mov_b32 v[72:73], 0, 0
    v_pk_mov_b32 v[74:75], 0, 0
    v_pk_mov_b32 v[76:77], 0, 0
    v_pk_mov_b32 v[78:79], 0, 0
    v_pk_mov_b32 v[80:81], 0, 0
    v_pk_mov_b32 v[82:83], 0, 0
    v_pk_mov_b32 v[84:85], 0, 0
    v_pk_mov_b32 v[86:87], 0, 0
    v_max3_f32 v48, v32, v33, v34
    v_max3_f32 v49, v40, v41, v42
    v_max3_f32 v50, v56, v57, v58
    v_max3_f32 v51, v64, v65, v66
    v_max3_f32 v48, v48, v35, v36
    v_max3_f32 v49, v49, v43, v44
    v_max3_f32 v50, v50, v59, v60
    v_max3_f32 v51, v51, v67, v68
    v_max3_f32 v48, v48, v37, v38
    v_max3_f32 v49, v49, v45, v46
    v_max3_f32 v50, v50, v61, v62
    v_max3_f32 v51, v51, v69, v70
    v_max_f32 v48, v48, v39
    v_max_f32 v49, v49, v47
    v_max_f32 v50, v50, v63
    v_max_f32 v51, v51, v71
    v_mov_b32 v52, v48
    v_mov_b32 v53, v49
    v_mov_b32 v54, v50
    v_mov_b32 v55, v51
    s_nop 1
    v_permlane16_swap_b32 v48, v52
    v_permlane16_swap_b32 v49, v53
    v_permlane16_swap_b32 v50, v54
    v_permlane16_swap_b32 v51, v55
    s_nop 1
    v_max_f32 v48, v48, v52
    v_max_f32 v49, v49, v53
    v_max_f32 v50, v50, v54
    v_max_f32 v51, v51, v55
    s_nop 0
    v_mov_b32 v52, v48
    v_mov_b32 v53, v49
    v_mov_b32 v54, v50
    v_mov_b32 v55, v51
    s_nop 1
    v_permlane32_swap_b32 v48, v52
    v_permlane32_swap_b32 v49, v53
    v_permlane32_swap_b32 v50, v54
    v_permlane32_swap_b32 v51, v55
    s_nop 1
    v_max_f32 v48, v48, v52
    v_max_f32 v49, v49, v53
    v_max_f32 v50, v50, v54
    v_max_f32 v51, v51, v55
    s_nop 0
    v_sub_f32 v56, 0, v48
    v_sub_f32 v57, 0, v48
    v_sub_f32 v58, 0, v48
    v_sub_f32 v59, 0, v48
    v_sub_f32 v60, 0, v49
    v_sub_f32 v61, 0, v49
    v_sub_f32 v62, 0, v49
    v_sub_f32 v63, 0, v49
    v_sub_f32 v64, 0, v50
    v_sub_f32 v65, 0, v50
    v_sub_f32 v66, 0, v50
    v_sub_f32 v67, 0, v50
    v_sub_f32 v68, 0, v51
    v_sub_f32 v69, 0, v51
    v_sub_f32 v70, 0, v51
    v_sub_f32 v71, 0, v51
    v_pk_mov_b32 v[52:53], 0, 0
    v_pk_mov_b32 v[54:55], 0, 0
    s_waitcnt vmcnt(5)
    s_nop 1
    v_mfma_f32_16x16x32_bf16 v[32:35], a[64:67], a[0:3], v[56:59]
    v_mfma_f32_16x16x32_bf16 v[32:35], a[68:71], a[4:7], v[32:35]
    v_mfma_f32_16x16x32_bf16 v[32:35], a[72:75], a[8:11], v[32:35]
    v_mfma_f32_16x16x32_bf16 v[32:35], a[76:79], a[12:15], v[32:35]
    v_mfma_f32_16x16x32_bf16 v[36:39], a[80:83], a[0:3], v[56:59]
    v_mfma_f32_16x16x32_bf16 v[36:39], a[84:87], a[4:7], v[36:39]
    v_mfma_f32_16x16x32_bf16 v[36:39], a[88:91], a[8:11], v[36:39]
    v_mfma_f32_16x16x32_bf16 v[36:39], a[92:95], a[12:15], v[36:39]
    s_waitcnt lgkmcnt(0)
    s_mov_b32 s39, 8
    s_mov_b32 s40, 1835008
    s_nop 5
.p2align 6
mega_kernel_loopj:
    v_mfma_f32_16x16x32_bf16 v[40:43], a[64:67], a[16:19], v[60:63]
    v_exp_f32 v32, v32
    v_mfma_f32_16x16x32_bf16 v[40:43], a[68:71], a[20:23], v[40:43]
    ds_read_b128 a[104:107], v12 offset:8192
    s_sub_u32 s41, 4, s39
    v_mfma_f32_16x16x32_bf16 v[40:43], a[72:75], a[24:27], v[40:43]
    v_exp_f32 v33, v33
    v_mfma_f32_16x16x32_bf16 v[40:43], a[76:79], a[28:31], v[40:43]
    ds_read_b128 a[108:111], v14 offset:8192
    v_cvt_pk_bf16_f32 v48, v32, v33
    s_cmp_lt_u32 s41, 2
    v_mfma_f32_16x16x32_bf16 v[44:47], a[80:83], a[16:19], v[60:63]
    v_exp_f32 v34, v34
    v_mfma_f32_16x16x32_bf16 v[44:47], a[84:87], a[20:23], v[44:47]
    ds_read_b64_tr_b16 a[152:153], v28 offset:16384
    s_cselect_b32 s94, s40, 0
    v_mfma_f32_16x16x32_bf16 v[44:47], a[88:91], a[24:27], v[44:47]
    v_exp_f32 v35, v35
    v_mfma_f32_16x16x32_bf16 v[44:47], a[92:95], a[28:31], v[44:47]
    ds_read_b64_tr_b16 a[154:155], v28 offset:20480
    v_cvt_pk_bf16_f32 v49, v34, v35
    s_lshl_b32 s41, s41, 20
    v_mfma_f32_16x16x32_bf16 v[140:143], a[160:163], v[52:55], v[140:143]
    v_exp_f32 v36, v36
    v_mfma_f32_16x16x32_bf16 v[156:159], a[164:167], v[52:55], v[156:159]
    ds_read_b64_tr_b16 a[156:157], v30 offset:16384
    s_add_u32 s41, s41, s46
    v_mfma_f32_16x16x32_bf16 v[172:175], a[168:171], v[52:55], v[172:175]
    v_exp_f32 v37, v37
    v_mfma_f32_16x16x32_bf16 v[188:191], a[172:175], v[52:55], v[188:191]
    ds_read_b64_tr_b16 a[158:159], v30 offset:20480
    v_cvt_pk_bf16_f32 v50, v36, v37
    v_mfma_f32_16x16x32_bf16 v[204:207], a[176:179], v[52:55], v[204:207]
    v_exp_f32 v38, v38
    v_mfma_f32_16x16x32_bf16 v[220:223], a[180:183], v[52:55], v[220:223]
    buffer_load_dwordx4 v3, s[12:15], s35 offen offset:1024 lds
    v_mfma_f32_16x16x32_bf16 v[236:239], a[184:187], v[52:55], v[236:239]
    v_exp_f32 v39, v39
    v_mfma_f32_16x16x32_bf16 v[252:255], a[188:191], v[52:55], v[252:255]
    v_cvt_pk_bf16_f32 v51, v38, v39
    v_mfma_f32_16x16x32_bf16 v[84:87], v[88:91], v[52:55], v[84:87]
    v_mfma_f32_16x16x32_bf16 v[32:35], a[64:67], a[32:35], v[64:67]
    v_exp_f32 v40, v40
    v_mfma_f32_16x16x32_bf16 v[32:35], a[68:71], a[36:39], v[32:35]
    ds_read_b128 a[112:115], v8 offset:12288
    s_cmp_eq_u32 s39, 8
    v_mfma_f32_16x16x32_bf16 v[32:35], a[72:75], a[40:43], v[32:35]
    v_exp_f32 v41, v41
    v_mfma_f32_16x16x32_bf16 v[32:35], a[76:79], a[44:47], v[32:35]
    ds_read_b128 a[116:119], v10 offset:12288
    v_cvt_pk_bf16_f32 v52, v40, v41
    s_cselect_b32 s16, s54, s62
    v_mfma_f32_16x16x32_bf16 v[36:39], a[80:83], a[32:35], v[64:67]
    v_exp_f32 v42, v42
    v_mfma_f32_16x16x32_bf16 v[36:39], a[84:87], a[36:39], v[36:39]
    ds_read_b64_tr_b16 a[160:161], v16 offset:24576
    s_waitcnt lgkmcnt(3)
    s_cselect_b32 s17, s55, s63
    v_mfma_f32_16x16x32_bf16 v[36:39], a[88:91], a[40:43], v[36:39]
    v_exp_f32 v43, v43
    v_mfma_f32_16x16x32_bf16 v[36:39], a[92:95], a[44:47], v[36:39]
    ds_read_b64_tr_b16 a[162:163], v16 offset:28672
    v_cvt_pk_bf16_f32 v53, v42, v43
    s_cselect_b32 s25, s27, s88
    v_mfma_f32_16x16x32_bf16 v[128:131], a[128:131], v[48:51], v[128:131]
    v_exp_f32 v44, v44
    v_mfma_f32_16x16x32_bf16 v[144:147], a[132:135], v[48:51], v[144:147]
    ds_read_b64_tr_b16 a[164:165], v18 offset:24576
    s_cselect_b32 s42, 1, 0
    v_mfma_f32_16x16x32_bf16 v[160:163], a[136:139], v[48:51], v[160:163]
    v_exp_f32 v45, v45
    v_mfma_f32_16x16x32_bf16 v[176:179], a[140:143], v[48:51], v[176:179]
    ds_read_b64_tr_b16 a[166:167], v18 offset:28672
    v_cvt_pk_bf16_f32 v54, v44, v45
    s_and_b32 s17, s17, 0xffff
    v_mfma_f32_16x16x32_bf16 v[192:195], a[144:147], v[48:51], v[192:195]
    v_exp_f32 v46, v46
    v_mfma_f32_16x16x32_bf16 v[208:211], a[148:151], v[48:51], v[208:211]
    buffer_load_dwordx4 v2, s[12:15], s35 offen offset:2048 lds
    v_mfma_f32_16x16x32_bf16 v[224:227], a[152:155], v[48:51], v[224:227]
    v_exp_f32 v47, v47
    v_mfma_f32_16x16x32_bf16 v[240:243], a[156:159], v[48:51], v[240:243]
    v_cvt_pk_bf16_f32 v55, v46, v47
    s_cmp_eq_u32 s39, 7
    v_mfma_f32_16x16x32_bf16 v[72:75], v[88:91], v[48:51], v[72:75]
    s_cselect_b32 s43, s89, 0
    v_mfma_f32_16x16x32_bf16 v[40:43], a[64:67], a[48:51], v[68:71]
    v_exp_f32 v32, v32
    v_mfma_f32_16x16x32_bf16 v[40:43], a[68:71], a[52:55], v[40:43]
    ds_read_b128 a[120:123], v12 offset:12288
    s_or_b32 s42, s42, s43
    v_mfma_f32_16x16x32_bf16 v[40:43], a[72:75], a[56:59], v[40:43]
    v_exp_f32 v33, v33
    v_mfma_f32_16x16x32_bf16 v[40:43], a[76:79], a[60:63], v[40:43]
    ds_read_b128 a[124:127], v14 offset:12288
    v_cvt_pk_bf16_f32 v48, v32, v33
    s_cmp_lg_u32 s42, 0
    v_mfma_f32_16x16x32_bf16 v[44:47], a[80:83], a[48:51], v[68:71]
    v_exp_f32 v34, v34
    v_mfma_f32_16x16x32_bf16 v[44:47], a[84:87], a[52:55], v[44:47]
    ds_read_b64_tr_b16 a[168:169], v20 offset:24576
    v_add_u32 v121, s41, v120
    v_mfma_f32_16x16x32_bf16 v[44:47], a[88:91], a[56:59], v[44:47]
    v_exp_f32 v35, v35
    v_mfma_f32_16x16x32_bf16 v[44:47], a[92:95], a[60:63], v[44:47]
    ds_read_b64_tr_b16 a[170:171], v20 offset:28672
    v_cvt_pk_bf16_f32 v49, v34, v35
    s_cselect_b32 s18, 4194304, 0
    v_mfma_f32_16x16x32_bf16 v[132:135], a[128:131], v[52:55], v[132:135]
    v_exp_f32 v36, v36
    v_mfma_f32_16x16x32_bf16 v[148:151], a[132:135], v[52:55], v[148:151]
    ds_read_b64_tr_b16 a[172:173], v22 offset:24576
    s_cselect_b32 s22, 6029312, 0
    v_mfma_f32_16x16x32_bf16 v[164:167], a[136:139], v[52:55], v[164:167]
    v_exp_f32 v37, v37
    v_mfma_f32_16x16x32_bf16 v[180:183], a[140:143], v[52:55], v[180:183]
    ds_read_b64_tr_b16 a[174:175], v22 offset:28672
    v_cvt_pk_bf16_f32 v50, v36, v37
    v_mfma_f32_16x16x32_bf16 v[196:199], a[144:147], v[52:55], v[196:199]
    v_exp_f32 v38, v38
    v_mfma_f32_16x16x32_bf16 v[212:215], a[148:151], v[52:55], v[212:215]
    buffer_load_dwordx4 v3, s[12:15], s35 offen offset:3072 lds
    v_mfma_f32_16x16x32_bf16 v[228:231], a[152:155], v[52:55], v[228:231]
    v_exp_f32 v39, v39
    v_mfma_f32_16x16x32_bf16 v[244:247], a[156:159], v[52:55], v[244:247]
    v_cvt_pk_bf16_f32 v51, v38, v39
    buffer_load_dwordx4 v[116:119], v121, s[92:95], 0 offen
    s_add_u32 s35, s35, 16384
    v_mfma_f32_16x16x32_bf16 v[76:79], v[88:91], v[52:55], v[76:79]
    s_waitcnt vmcnt(13) lgkmcnt(4)
    s_barrier
    s_min_u32 s35, s35, 507904
    v_mfma_f32_16x16x32_bf16 v[32:35], a[96:99], a[0:3], v[56:59]
    v_exp_f32 v40, v40
    v_mfma_f32_16x16x32_bf16 v[32:35], a[100:103], a[4:7], v[32:35]
    ds_read_b128 a[64:67], v8 offset:32768
    s_mov_b32 m0, s47
    v_mfma_f32_16x16x32_bf16 v[32:35], a[104:107], a[8:11], v[32:35]
    v_exp_f32 v41, v41
    v_mfma_f32_16x16x32_bf16 v[32:35], a[108:111], a[12:15], v[32:35]
    ds_read_b128 a[68:71], v10 offset:32768
    v_cvt_pk_bf16_f32 v52, v40, v41
    buffer_load_dwordx4 v92, s[16:19], s26 offen offset:0 lds
    v_mfma_f32_16x16x32_bf16 v[36:39], a[112:115], a[0:3], v[56:59]
    v_exp_f32 v42, v42
    v_mfma_f32_16x16x32_bf16 v[36:39], a[116:119], a[4:7], v[36:39]
    ds_read_b64_tr_b16 a[176:177], v24 offset:24576
    buffer_load_dwordx4 v93, s[16:19], s26 offen offset:1024 lds
    v_mfma_f32_16x16x32_bf16 v[36:39], a[120:123], a[8:11], v[36:39]
    v_exp_f32 v43, v43
    v_mfma_f32_16x16x32_bf16 v[36:39], a[124:127], a[12:15], v[36:39]
    ds_read_b64_tr_b16 a[178:179], v24 offset:28672
    v_cvt_pk_bf16_f32 v53, v42, v43
    buffer_load_dwordx4 v94, s[16:19], s26 offen offset:2048 lds
    v_mfma_f32_16x16x32_bf16 v[136:139], a[128:131], v[48:51], v[136:139]
    v_exp_f32 v44, v44
    buffer_load_dwordx4 v95, s[16:19], s26 offen offset:3072 lds
    v_mfma_f32_16x16x32_bf16 v[152:155], a[132:135], v[48:51], v[152:155]
    ds_read_b64_tr_b16 a[180:181], v26 offset:24576
    s_add_u32 m0, s36, 98304
    v_mfma_f32_16x16x32_bf16 v[168:171], a[136:139], v[48:51], v[168:171]
    v_exp_f32 v45, v45
    v_mfma_f32_16x16x32_bf16 v[184:187], a[140:143], v[48:51], v[184:187]
    ds_read_b64_tr_b16 a[182:183], v26 offset:28672
    v_cvt_pk_bf16_f32 v54, v44, v45
    v_mfma_f32_16x16x32_bf16 v[200:203], a[144:147], v[48:51], v[200:203]
    v_exp_f32 v46, v46
    v_mfma_f32_16x16x32_bf16 v[216:219], a[148:151], v[48:51], v[216:219]
    buffer_load_dwordx4 v124, s[8:11], s35 offen offset:0 lds
    v_mfma_f32_16x16x32_bf16 v[232:235], a[152:155], v[48:51], v[232:235]
    v_exp_f32 v47, v47
    v_mfma_f32_16x16x32_bf16 v[248:251], a[156:159], v[48:51], v[248:251]
    v_cvt_pk_bf16_f32 v55, v46, v47
    v_mfma_f32_16x16x32_bf16 v[80:83], v[88:91], v[48:51], v[80:83]
    v_mfma_f32_16x16x32_bf16 v[40:43], a[96:99], a[16:19], v[60:63]
    v_exp_f32 v32, v32
    v_mfma_f32_16x16x32_bf16 v[40:43], a[100:103], a[20:23], v[40:43]
    ds_read_b128 a[72:75], v12 offset:32768
    v_mfma_f32_16x16x32_bf16 v[40:43], a[104:107], a[24:27], v[40:43]
    v_exp_f32 v33, v33
    v_mfma_f32_16x16x32_bf16 v[40:43], a[108:111], a[28:31], v[40:43]
    ds_read_b128 a[76:79], v14 offset:32768
    v_cvt_pk_bf16_f32 v48, v32, v33
    v_mfma_f32_16x16x32_bf16 v[44:47], a[112:115], a[16:19], v[60:63]
    v_exp_f32 v34, v34
    v_mfma_f32_16x16x32_bf16 v[44:47], a[116:119], a[20:23], v[44:47]
    ds_read_b64_tr_b16 a[184:185], v28 offset:24576
    v_mfma_f32_16x16x32_bf16 v[44:47], a[120:123], a[24:27], v[44:47]
    v_exp_f32 v35, v35
    v_mfma_f32_16x16x32_bf16 v[44:47], a[124:127], a[28:31], v[44:47]
    ds_read_b64_tr_b16 a[186:187], v28 offset:28672
    v_cvt_pk_bf16_f32 v49, v34, v35
    v_mfma_f32_16x16x32_bf16 v[140:143], a[128:131], v[52:55], v[140:143]
    v_exp_f32 v36, v36
    v_mfma_f32_16x16x32_bf16 v[156:159], a[132:135], v[52:55], v[156:159]
    ds_read_b64_tr_b16 a[188:189], v30 offset:24576
    v_mfma_f32_16x16x32_bf16 v[172:175], a[136:139], v[52:55], v[172:175]
    v_exp_f32 v37, v37
    v_mfma_f32_16x16x32_bf16 v[188:191], a[140:143], v[52:55], v[188:191]
    ds_read_b64_tr_b16 a[190:191], v30 offset:28672
    v_cvt_pk_bf16_f32 v50, v36, v37
    v_mfma_f32_16x16x32_bf16 v[204:207], a[144:147], v[52:55], v[204:207]
    v_exp_f32 v38, v38
    v_mfma_f32_16x16x32_bf16 v[220:223], a[148:151], v[52:55], v[220:223]
    buffer_load_dwordx4 v125, s[8:11], s35 offen offset:1024 lds
    v_mfma_f32_16x16x32_bf16 v[236:239], a[152:155], v[52:55], v[236:239]
    v_exp_f32 v39, v39
    v_mfma_f32_16x16x32_bf16 v[252:255], a[156:159], v[52:55], v[252:255]
    v_cvt_pk_bf16_f32 v51, v38, v39
    v_mfma_f32_16x16x32_bf16 v[84:87], v[88:91], v[52:55], v[84:87]
    v_mfma_f32_16x16x32_bf16 v[32:35], a[96:99], a[32:35], v[64:67]
    v_exp_f32 v40, v40
    v_mfma_f32_16x16x32_bf16 v[32:35], a[100:103], a[36:39], v[32:35]
    ds_read_b128 a[80:83], v8 offset:36864
    v_mfma_f32_16x16x32_bf16 v[32:35], a[104:107], a[40:43], v[32:35]
    v_exp_f32 v41, v41
    v_mfma_f32_16x16x32_bf16 v[32:35], a[108:111], a[44:47], v[32:35]
    ds_read_b128 a[84:87], v10 offset:36864
    v_cvt_pk_bf16_f32 v52, v40, v41
    v_mfma_f32_16x16x32_bf16 v[36:39], a[112:115], a[32:35], v[64:67]
    v_exp_f32 v42, v42
    v_mfma_f32_16x16x32_bf16 v[36:39], a[116:119], a[36:39], v[36:39]
    ds_read_b64_tr_b16 a[128:129], v16 offset:49152
    s_waitcnt lgkmcnt(3)
    v_mfma_f32_16x16x32_bf16 v[36:39], a[120:123], a[40:43], v[36:39]
    v_exp_f32 v43, v43
    v_mfma_f32_16x16x32_bf16 v[36:39], a[124:127], a[44:47], v[36:39]
    ds_read_b64_tr_b16 a[130:131], v16 offset:53248
    v_cvt_pk_bf16_f32 v53, v42, v43
    v_mfma_f32_16x16x32_bf16 v[128:131], a[160:163], v[48:51], v[128:131]
    v_exp_f32 v44, v44
    v_mfma_f32_16x16x32_bf16 v[144:147], a[164:167], v[48:51], v[144:147]
    ds_read_b64_tr_b16 a[132:133], v18 offset:49152
    v_mfma_f32_16x16x32_bf16 v[160:163], a[168:171], v[48:51], v[160:163]
    v_exp_f32 v45, v45
    v_mfma_f32_16x16x32_bf16 v[176:179], a[172:175], v[48:51], v[176:179]
    ds_read_b64_tr_b16 a[134:135], v18 offset:53248
    v_cvt_pk_bf16_f32 v54, v44, v45
    v_mfma_f32_16x16x32_bf16 v[192:195], a[176:179], v[48:51], v[192:195]
    v_exp_f32 v46, v46
    v_mfma_f32_16x16x32_bf16 v[208:211], a[180:183], v[48:51], v[208:211]
    buffer_load_dwordx4 v126, s[8:11], s35 offen offset:2048 lds
    v_mfma_f32_16x16x32_bf16 v[224:227], a[184:187], v[48:51], v[224:227]
    v_exp_f32 v47, v47
    v_mfma_f32_16x16x32_bf16 v[240:243], a[188:191], v[48:51], v[240:243]
    v_cvt_pk_bf16_f32 v55, v46, v47
    v_mfma_f32_16x16x32_bf16 v[72:75], v[88:91], v[48:51], v[72:75]
    v_mfma_f32_16x16x32_bf16 v[40:43], a[96:99], a[48:51], v[68:71]
    v_exp_f32 v32, v32
    v_mfma_f32_16x16x32_bf16 v[40:43], a[100:103], a[52:55], v[40:43]
    ds_read_b128 a[88:91], v12 offset:36864
    v_mfma_f32_16x16x32_bf16 v[40:43], a[104:107], a[56:59], v[40:43]
    v_exp_f32 v33, v33
    v_mfma_f32_16x16x32_bf16 v[40:43], a[108:111], a[60:63], v[40:43]
    ds_read_b128 a[92:95], v14 offset:36864
    v_cvt_pk_bf16_f32 v48, v32, v33
    v_mfma_f32_16x16x32_bf16 v[44:47], a[112:115], a[48:51], v[68:71]
    v_exp_f32 v34, v34
    v_mfma_f32_16x16x32_bf16 v[44:47], a[116:119], a[52:55], v[44:47]
    ds_read_b64_tr_b16 a[136:137], v20 offset:49152
    v_mfma_f32_16x16x32_bf16 v[44:47], a[120:123], a[56:59], v[44:47]
    v_exp_f32 v35, v35
    v_mfma_f32_16x16x32_bf16 v[44:47], a[124:127], a[60:63], v[44:47]
    ds_read_b64_tr_b16 a[138:139], v20 offset:53248
    v_cvt_pk_bf16_f32 v49, v34, v35
    v_mfma_f32_16x16x32_bf16 v[132:135], a[160:163], v[52:55], v[132:135]
    v_exp_f32 v36, v36
    v_mfma_f32_16x16x32_bf16 v[148:151], a[164:167], v[52:55], v[148:151]
    ds_read_b64_tr_b16 a[140:141], v22 offset:49152
    v_mfma_f32_16x16x32_bf16 v[164:167], a[168:171], v[52:55], v[164:167]
    v_exp_f32 v37, v37
    v_mfma_f32_16x16x32_bf16 v[180:183], a[172:175], v[52:55], v[180:183]
    ds_read_b64_tr_b16 a[142:143], v22 offset:53248
    v_cvt_pk_bf16_f32 v50, v36, v37
    v_mfma_f32_16x16x32_bf16 v[196:199], a[176:179], v[52:55], v[196:199]
    v_exp_f32 v38, v38
    v_mfma_f32_16x16x32_bf16 v[212:215], a[180:183], v[52:55], v[212:215]
    buffer_load_dwordx4 v127, s[8:11], s35 offen offset:3072 lds
    v_mfma_f32_16x16x32_bf16 v[228:231], a[184:187], v[52:55], v[228:231]
    v_exp_f32 v39, v39
    v_mfma_f32_16x16x32_bf16 v[244:247], a[188:191], v[52:55], v[244:247]
    v_cvt_pk_bf16_f32 v51, v38, v39
    v_mfma_f32_16x16x32_bf16 v[76:79], v[88:91], v[52:55], v[76:79]
    s_waitcnt lgkmcnt(4)
    v_mfma_f32_16x16x32_bf16 v[32:35], a[64:67], a[0:3], v[56:59]
    v_exp_f32 v40, v40
    v_mfma_f32_16x16x32_bf16 v[32:35], a[68:71], a[4:7], v[32:35]
    ds_read_b128 a[96:99], v8 offset:40960
    v_mfma_f32_16x16x32_bf16 v[32:35], a[72:75], a[8:11], v[32:35]
    v_exp_f32 v41, v41
    v_mfma_f32_16x16x32_bf16 v[32:35], a[76:79], a[12:15], v[32:35]
    ds_read_b128 a[100:103], v10 offset:40960
    v_cvt_pk_bf16_f32 v52, v40, v41
    v_mfma_f32_16x16x32_bf16 v[36:39], a[80:83], a[0:3], v[56:59]
    v_exp_f32 v42, v42
    v_mfma_f32_16x16x32_bf16 v[36:39], a[84:87], a[4:7], v[36:39]
    ds_read_b64_tr_b16 a[144:145], v24 offset:49152
    v_mfma_f32_16x16x32_bf16 v[36:39], a[88:91], a[8:11], v[36:39]
    v_exp_f32 v43, v43
    v_mfma_f32_16x16x32_bf16 v[36:39], a[92:95], a[12:15], v[36:39]
    ds_read_b64_tr_b16 a[146:147], v24 offset:53248
    v_cvt_pk_bf16_f32 v53, v42, v43
    v_mfma_f32_16x16x32_bf16 v[136:139], a[160:163], v[48:51], v[136:139]
    v_exp_f32 v44, v44
    v_mfma_f32_16x16x32_bf16 v[152:155], a[164:167], v[48:51], v[152:155]
    ds_read_b64_tr_b16 a[148:149], v26 offset:49152
    s_add_u32 m0, s36, 114688
    v_mfma_f32_16x16x32_bf16 v[168:171], a[168:171], v[48:51], v[168:171]
    v_exp_f32 v45, v45
    v_mfma_f32_16x16x32_bf16 v[184:187], a[172:175], v[48:51], v[184:187]
    ds_read_b64_tr_b16 a[150:151], v26 offset:53248
    v_cvt_pk_bf16_f32 v54, v44, v45
    v_mfma_f32_16x16x32_bf16 v[200:203], a[176:179], v[48:51], v[200:203]
    v_exp_f32 v46, v46
    v_mfma_f32_16x16x32_bf16 v[216:219], a[180:183], v[48:51], v[216:219]
    buffer_load_dwordx4 v2, s[12:15], s35 offen offset:0 lds
    v_mfma_f32_16x16x32_bf16 v[232:235], a[184:187], v[48:51], v[232:235]
    v_exp_f32 v47, v47
    v_mfma_f32_16x16x32_bf16 v[248:251], a[188:191], v[48:51], v[248:251]
    v_cvt_pk_bf16_f32 v55, v46, v47
    v_mfma_f32_16x16x32_bf16 v[80:83], v[88:91], v[48:51], v[80:83]
    v_mfma_f32_16x16x32_bf16 v[40:43], a[64:67], a[16:19], v[60:63]
    v_exp_f32 v32, v32
    v_mfma_f32_16x16x32_bf16 v[40:43], a[68:71], a[20:23], v[40:43]
    ds_read_b128 a[104:107], v12 offset:40960
    v_mfma_f32_16x16x32_bf16 v[40:43], a[72:75], a[24:27], v[40:43]
    v_exp_f32 v33, v33
    v_mfma_f32_16x16x32_bf16 v[40:43], a[76:79], a[28:31], v[40:43]
    ds_read_b128 a[108:111], v14 offset:40960
    v_cvt_pk_bf16_f32 v48, v32, v33
    v_mfma_f32_16x16x32_bf16 v[44:47], a[80:83], a[16:19], v[60:63]
    v_exp_f32 v34, v34
    v_mfma_f32_16x16x32_bf16 v[44:47], a[84:87], a[20:23], v[44:47]
    ds_read_b64_tr_b16 a[152:153], v28 offset:49152
    v_mfma_f32_16x16x32_bf16 v[44:47], a[88:91], a[24:27], v[44:47]
    v_exp_f32 v35, v35
    v_mfma_f32_16x16x32_bf16 v[44:47], a[92:95], a[28:31], v[44:47]
    ds_read_b64_tr_b16 a[154:155], v28 offset:53248
    v_cvt_pk_bf16_f32 v49, v34, v35
    v_mfma_f32_16x16x32_bf16 v[140:143], a[160:163], v[52:55], v[140:143]
    v_exp_f32 v36, v36
    v_mfma_f32_16x16x32_bf16 v[156:159], a[164:167], v[52:55], v[156:159]
    ds_read_b64_tr_b16 a[156:157], v30 offset:49152
    v_mfma_f32_16x16x32_bf16 v[172:175], a[168:171], v[52:55], v[172:175]
    v_exp_f32 v37, v37
    v_mfma_f32_16x16x32_bf16 v[188:191], a[172:175], v[52:55], v[188:191]
    ds_read_b64_tr_b16 a[158:159], v30 offset:53248
    v_cvt_pk_bf16_f32 v50, v36, v37
    v_mfma_f32_16x16x32_bf16 v[204:207], a[176:179], v[52:55], v[204:207]
    v_exp_f32 v38, v38
    v_mfma_f32_16x16x32_bf16 v[220:223], a[180:183], v[52:55], v[220:223]
    buffer_load_dwordx4 v3, s[12:15], s35 offen offset:1024 lds
    v_mfma_f32_16x16x32_bf16 v[236:239], a[184:187], v[52:55], v[236:239]
    v_exp_f32 v39, v39
    v_mfma_f32_16x16x32_bf16 v[252:255], a[188:191], v[52:55], v[252:255]
    v_cvt_pk_bf16_f32 v51, v38, v39
    v_mfma_f32_16x16x32_bf16 v[84:87], v[88:91], v[52:55], v[84:87]
    v_mfma_f32_16x16x32_bf16 v[32:35], a[64:67], a[32:35], v[64:67]
    v_exp_f32 v40, v40
    v_mfma_f32_16x16x32_bf16 v[32:35], a[68:71], a[36:39], v[32:35]
    ds_read_b128 a[112:115], v8 offset:45056
    v_mfma_f32_16x16x32_bf16 v[32:35], a[72:75], a[40:43], v[32:35]
    v_exp_f32 v41, v41
    v_mfma_f32_16x16x32_bf16 v[32:35], a[76:79], a[44:47], v[32:35]
    ds_read_b128 a[116:119], v10 offset:45056
    v_cvt_pk_bf16_f32 v52, v40, v41
    v_mfma_f32_16x16x32_bf16 v[36:39], a[80:83], a[32:35], v[64:67]
    v_exp_f32 v42, v42
    v_mfma_f32_16x16x32_bf16 v[36:39], a[84:87], a[36:39], v[36:39]
    ds_read_b64_tr_b16 a[160:161], v16 offset:57344
    s_waitcnt lgkmcnt(3)
    v_mfma_f32_16x16x32_bf16 v[36:39], a[88:91], a[40:43], v[36:39]
    v_exp_f32 v43, v43
    v_mfma_f32_16x16x32_bf16 v[36:39], a[92:95], a[44:47], v[36:39]
    ds_read_b64_tr_b16 a[162:163], v16 offset:61440
    v_cvt_pk_bf16_f32 v53, v42, v43
    v_mfma_f32_16x16x32_bf16 v[128:131], a[128:131], v[48:51], v[128:131]
    v_exp_f32 v44, v44
    v_mfma_f32_16x16x32_bf16 v[144:147], a[132:135], v[48:51], v[144:147]
    ds_read_b64_tr_b16 a[164:165], v18 offset:57344
    v_mfma_f32_16x16x32_bf16 v[160:163], a[136:139], v[48:51], v[160:163]
    v_exp_f32 v45, v45
    v_mfma_f32_16x16x32_bf16 v[176:179], a[140:143], v[48:51], v[176:179]
    ds_read_b64_tr_b16 a[166:167], v18 offset:61440
    v_cvt_pk_bf16_f32 v54, v44, v45
    v_mfma_f32_16x16x32_bf16 v[192:195], a[144:147], v[48:51], v[192:195]
    v_exp_f32 v46, v46
    v_mfma_f32_16x16x32_bf16 v[208:211], a[148:151], v[48:51], v[208:211]
    buffer_load_dwordx4 v2, s[12:15], s35 offen offset:2048 lds
    v_mfma_f32_16x16x32_bf16 v[224:227], a[152:155], v[48:51], v[224:227]
    v_exp_f32 v47, v47
    v_mfma_f32_16x16x32_bf16 v[240:243], a[156:159], v[48:51], v[240:243]
    v_cvt_pk_bf16_f32 v55, v46, v47
    v_mfma_f32_16x16x32_bf16 v[72:75], v[88:91], v[48:51], v[72:75]
    v_mfma_f32_16x16x32_bf16 v[40:43], a[64:67], a[48:51], v[68:71]
    v_exp_f32 v32, v32
    v_mfma_f32_16x16x32_bf16 v[40:43], a[68:71], a[52:55], v[40:43]
    ds_read_b128 a[120:123], v12 offset:45056
    v_mfma_f32_16x16x32_bf16 v[40:43], a[72:75], a[56:59], v[40:43]
    v_exp_f32 v33, v33
    v_mfma_f32_16x16x32_bf16 v[40:43], a[76:79], a[60:63], v[40:43]
    ds_read_b128 a[124:127], v14 offset:45056
    v_cvt_pk_bf16_f32 v48, v32, v33
    v_mfma_f32_16x16x32_bf16 v[44:47], a[80:83], a[48:51], v[68:71]
    v_exp_f32 v34, v34
    v_mfma_f32_16x16x32_bf16 v[44:47], a[84:87], a[52:55], v[44:47]
    ds_read_b64_tr_b16 a[168:169], v20 offset:57344
    v_mfma_f32_16x16x32_bf16 v[44:47], a[88:91], a[56:59], v[44:47]
    v_exp_f32 v35, v35
    v_mfma_f32_16x16x32_bf16 v[44:47], a[92:95], a[60:63], v[44:47]
    ds_read_b64_tr_b16 a[170:171], v20 offset:61440
    v_cvt_pk_bf16_f32 v49, v34, v35
    v_mfma_f32_16x16x32_bf16 v[132:135], a[128:131], v[52:55], v[132:135]
    v_exp_f32 v36, v36
    v_mfma_f32_16x16x32_bf16 v[148:151], a[132:135], v[52:55], v[148:151]
    ds_read_b64_tr_b16 a[172:173], v22 offset:57344
    v_mfma_f32_16x16x32_bf16 v[164:167], a[136:139], v[52:55], v[164:167]
    v_exp_f32 v37, v37
    v_mfma_f32_16x16x32_bf16 v[180:183], a[140:143], v[52:55], v[180:183]
    ds_read_b64_tr_b16 a[174:175], v22 offset:61440
    v_cvt_pk_bf16_f32 v50, v36, v37
    v_mfma_f32_16x16x32_bf16 v[196:199], a[144:147], v[52:55], v[196:199]
    v_exp_f32 v38, v38
    v_mfma_f32_16x16x32_bf16 v[212:215], a[148:151], v[52:55], v[212:215]
    buffer_load_dwordx4 v3, s[12:15], s35 offen offset:3072 lds
    v_mfma_f32_16x16x32_bf16 v[228:231], a[152:155], v[52:55], v[228:231]
    v_exp_f32 v39, v39
    v_mfma_f32_16x16x32_bf16 v[244:247], a[156:159], v[52:55], v[244:247]
    v_cvt_pk_bf16_f32 v51, v38, v39
    s_add_u32 s35, s35, 16384
    v_mfma_f32_16x16x32_bf16 v[76:79], v[88:91], v[52:55], v[76:79]
    s_waitcnt vmcnt(13) lgkmcnt(4)
    s_barrier
    s_min_u32 s35, s35, 507904
    v_mfma_f32_16x16x32_bf16 v[32:35], a[96:99], a[0:3], v[56:59]
    v_exp_f32 v40, v40
    v_mfma_f32_16x16x32_bf16 v[32:35], a[100:103], a[4:7], v[32:35]
    ds_read_b128 a[64:67], v9 offset:0
    v_mfma_f32_16x16x32_bf16 v[32:35], a[104:107], a[8:11], v[32:35]
    v_exp_f32 v41, v41
    v_mfma_f32_16x16x32_bf16 v[32:35], a[108:111], a[12:15], v[32:35]
    ds_read_b128 a[68:71], v11 offset:0
    v_cvt_pk_bf16_f32 v52, v40, v41
    v_mfma_f32_16x16x32_bf16 v[36:39], a[112:115], a[0:3], v[56:59]
    v_exp_f32 v42, v42
    v_mfma_f32_16x16x32_bf16 v[36:39], a[116:119], a[4:7], v[36:39]
    ds_read_b64_tr_b16 a[176:177], v24 offset:57344
    v_mfma_f32_16x16x32_bf16 v[36:39], a[120:123], a[8:11], v[36:39]
    v_exp_f32 v43, v43
    v_mfma_f32_16x16x32_bf16 v[36:39], a[124:127], a[12:15], v[36:39]
    ds_read_b64_tr_b16 a[178:179], v24 offset:61440
    v_cvt_pk_bf16_f32 v53, v42, v43
    v_mfma_f32_16x16x32_bf16 v[136:139], a[128:131], v[48:51], v[136:139]
    v_exp_f32 v44, v44
    v_mfma_f32_16x16x32_bf16 v[152:155], a[132:135], v[48:51], v[152:155]
    ds_read_b64_tr_b16 a[180:181], v26 offset:57344
    s_add_u32 m0, s36, 0
    v_mfma_f32_16x16x32_bf16 v[168:171], a[136:139], v[48:51], v[168:171]
    v_exp_f32 v45, v45
    v_mfma_f32_16x16x32_bf16 v[184:187], a[140:143], v[48:51], v[184:187]
    ds_read_b64_tr_b16 a[182:183], v26 offset:61440
    v_cvt_pk_bf16_f32 v54, v44, v45
    v_mfma_f32_16x16x32_bf16 v[200:203], a[144:147], v[48:51], v[200:203]
    v_exp_f32 v46, v46
    v_mfma_f32_16x16x32_bf16 v[216:219], a[148:151], v[48:51], v[216:219]
    buffer_load_dwordx4 v124, s[8:11], s35 offen offset:0 lds
    v_mfma_f32_16x16x32_bf16 v[232:235], a[152:155], v[48:51], v[232:235]
    v_exp_f32 v47, v47
    v_mfma_f32_16x16x32_bf16 v[248:251], a[156:159], v[48:51], v[248:251]
    v_cvt_pk_bf16_f32 v55, v46, v47
    v_mfma_f32_16x16x32_bf16 v[80:83], v[88:91], v[48:51], v[80:83]
    v_mfma_f32_16x16x32_bf16 v[40:43], a[96:99], a[16:19], v[60:63]
    v_exp_f32 v32, v32
    v_mfma_f32_16x16x32_bf16 v[40:43], a[100:103], a[20:23], v[40:43]
    ds_read_b128 a[72:75], v13 offset:0
    v_mfma_f32_16x16x32_bf16 v[40:43], a[104:107], a[24:27], v[40:43]
    v_exp_f32 v33, v33
    v_mfma_f32_16x16x32_bf16 v[40:43], a[108:111], a[28:31], v[40:43]
    ds_read_b128 a[76:79], v15 offset:0
    v_cvt_pk_bf16_f32 v48, v32, v33
    v_mfma_f32_16x16x32_bf16 v[44:47], a[112:115], a[16:19], v[60:63]
    v_exp_f32 v34, v34
    v_mfma_f32_16x16x32_bf16 v[44:47], a[116:119], a[20:23], v[44:47]
    ds_read_b64_tr_b16 a[184:185], v28 offset:57344
    v_mfma_f32_16x16x32_bf16 v[44:47], a[120:123], a[24:27], v[44:47]
    v_exp_f32 v35, v35
    v_mfma_f32_16x16x32_bf16 v[44:47], a[124:127], a[28:31], v[44:47]
    ds_read_b64_tr_b16 a[186:187], v28 offset:61440
    v_cvt_pk_bf16_f32 v49, v34, v35
    v_mfma_f32_16x16x32_bf16 v[140:143], a[128:131], v[52:55], v[140:143]
    v_exp_f32 v36, v36
    v_mfma_f32_16x16x32_bf16 v[156:159], a[132:135], v[52:55], v[156:159]
    ds_read_b64_tr_b16 a[188:189], v30 offset:57344
    v_mfma_f32_16x16x32_bf16 v[172:175], a[136:139], v[52:55], v[172:175]
    v_exp_f32 v37, v37
    v_mfma_f32_16x16x32_bf16 v[188:191], a[140:143], v[52:55], v[188:191]
    ds_read_b64_tr_b16 a[190:191], v30 offset:61440
    v_cvt_pk_bf16_f32 v50, v36, v37
    v_mfma_f32_16x16x32_bf16 v[204:207], a[144:147], v[52:55], v[204:207]
    v_exp_f32 v38, v38
    v_mfma_f32_16x16x32_bf16 v[220:223], a[148:151], v[52:55], v[220:223]
    buffer_load_dwordx4 v125, s[8:11], s35 offen offset:1024 lds
    v_mfma_f32_16x16x32_bf16 v[236:239], a[152:155], v[52:55], v[236:239]
    v_exp_f32 v39, v39
    v_mfma_f32_16x16x32_bf16 v[252:255], a[156:159], v[52:55], v[252:255]
    v_cvt_pk_bf16_f32 v51, v38, v39
    v_mfma_f32_16x16x32_bf16 v[84:87], v[88:91], v[52:55], v[84:87]
    v_mfma_f32_16x16x32_bf16 v[32:35], a[96:99], a[32:35], v[64:67]
    v_exp_f32 v40, v40
    v_mfma_f32_16x16x32_bf16 v[32:35], a[100:103], a[36:39], v[32:35]
    ds_read_b128 a[80:83], v9 offset:4096
    v_mfma_f32_16x16x32_bf16 v[32:35], a[104:107], a[40:43], v[32:35]
    v_exp_f32 v41, v41
    v_mfma_f32_16x16x32_bf16 v[32:35], a[108:111], a[44:47], v[32:35]
    ds_read_b128 a[84:87], v11 offset:4096
    v_cvt_pk_bf16_f32 v52, v40, v41
    v_mfma_f32_16x16x32_bf16 v[36:39], a[112:115], a[32:35], v[64:67]
    v_exp_f32 v42, v42
    v_mfma_f32_16x16x32_bf16 v[36:39], a[116:119], a[36:39], v[36:39]
    ds_read_b64_tr_b16 a[128:129], v17 offset:16384
    s_waitcnt lgkmcnt(3)
    v_mfma_f32_16x16x32_bf16 v[36:39], a[120:123], a[40:43], v[36:39]
    v_exp_f32 v43, v43
    v_mfma_f32_16x16x32_bf16 v[36:39], a[124:127], a[44:47], v[36:39]
    ds_read_b64_tr_b16 a[130:131], v17 offset:20480
    v_cvt_pk_bf16_f32 v53, v42, v43
    v_mfma_f32_16x16x32_bf16 v[128:131], a[160:163], v[48:51], v[128:131]
    v_exp_f32 v44, v44
    v_mfma_f32_16x16x32_bf16 v[144:147], a[164:167], v[48:51], v[144:147]
    ds_read_b64_tr_b16 a[132:133], v19 offset:16384
    v_mfma_f32_16x16x32_bf16 v[160:163], a[168:171], v[48:51], v[160:163]
    v_exp_f32 v45, v45
    v_mfma_f32_16x16x32_bf16 v[176:179], a[172:175], v[48:51], v[176:179]
    ds_read_b64_tr_b16 a[134:135], v19 offset:20480
    v_cvt_pk_bf16_f32 v54, v44, v45
    v_mfma_f32_16x16x32_bf16 v[192:195], a[176:179], v[48:51], v[192:195]
    v_exp_f32 v46, v46
    v_mfma_f32_16x16x32_bf16 v[208:211], a[180:183], v[48:51], v[208:211]
    buffer_load_dwordx4 v126, s[8:11], s35 offen offset:2048 lds
    v_mfma_f32_16x16x32_bf16 v[224:227], a[184:187], v[48:51], v[224:227]
    v_exp_f32 v47, v47
    v_mfma_f32_16x16x32_bf16 v[240:243], a[188:191], v[48:51], v[240:243]
    v_cvt_pk_bf16_f32 v55, v46, v47
    v_mfma_f32_16x16x32_bf16 v[72:75], v[88:91], v[48:51], v[72:75]
    v_mfma_f32_16x16x32_bf16 v[40:43], a[96:99], a[48:51], v[68:71]
    v_exp_f32 v32, v32
    v_mfma_f32_16x16x32_bf16 v[40:43], a[100:103], a[52:55], v[40:43]
    ds_read_b128 a[88:91], v13 offset:4096
    v_mfma_f32_16x16x32_bf16 v[40:43], a[104:107], a[56:59], v[40:43]
    v_exp_f32 v33, v33
    v_mfma_f32_16x16x32_bf16 v[40:43], a[108:111], a[60:63], v[40:43]
    ds_read_b128 a[92:95], v15 offset:4096
    v_cvt_pk_bf16_f32 v48, v32, v33
    v_mfma_f32_16x16x32_bf16 v[44:47], a[112:115], a[48:51], v[68:71]
    v_exp_f32 v34, v34
    v_mfma_f32_16x16x32_bf16 v[44:47], a[116:119], a[52:55], v[44:47]
    ds_read_b64_tr_b16 a[136:137], v21 offset:16384
    v_mfma_f32_16x16x32_bf16 v[44:47], a[120:123], a[56:59], v[44:47]
    v_exp_f32 v35, v35
    v_mfma_f32_16x16x32_bf16 v[44:47], a[124:127], a[60:63], v[44:47]
    ds_read_b64_tr_b16 a[138:139], v21 offset:20480
    v_cvt_pk_bf16_f32 v49, v34, v35
    v_mfma_f32_16x16x32_bf16 v[132:135], a[160:163], v[52:55], v[132:135]
    v_exp_f32 v36, v36
    v_mfma_f32_16x16x32_bf16 v[148:151], a[164:167], v[52:55], v[148:151]
    ds_read_b64_tr_b16 a[140:141], v23 offset:16384
    v_mfma_f32_16x16x32_bf16 v[164:167], a[168:171], v[52:55], v[164:167]
    v_exp_f32 v37, v37
    v_mfma_f32_16x16x32_bf16 v[180:183], a[172:175], v[52:55], v[180:183]
    ds_read_b64_tr_b16 a[142:143], v23 offset:20480
    v_cvt_pk_bf16_f32 v50, v36, v37
    v_mfma_f32_16x16x32_bf16 v[196:199], a[176:179], v[52:55], v[196:199]
    v_exp_f32 v38, v38
    v_mfma_f32_16x16x32_bf16 v[212:215], a[180:183], v[52:55], v[212:215]
    buffer_load_dwordx4 v127, s[8:11], s35 offen offset:3072 lds
    v_mfma_f32_16x16x32_bf16 v[228:231], a[184:187], v[52:55], v[228:231]
    v_exp_f32 v39, v39
    v_mfma_f32_16x16x32_bf16 v[244:247], a[188:191], v[52:55], v[244:247]
    v_cvt_pk_bf16_f32 v51, v38, v39
    v_mfma_f32_16x16x32_bf16 v[76:79], v[88:91], v[52:55], v[76:79]
    s_waitcnt lgkmcnt(4)
    v_mfma_f32_16x16x32_bf16 v[32:35], a[64:67], a[0:3], v[56:59]
    v_exp_f32 v40, v40
    v_mfma_f32_16x16x32_bf16 v[32:35], a[68:71], a[4:7], v[32:35]
    ds_read_b128 a[96:99], v9 offset:8192
    v_mfma_f32_16x16x32_bf16 v[32:35], a[72:75], a[8:11], v[32:35]
    v_exp_f32 v41, v41
    v_mfma_f32_16x16x32_bf16 v[32:35], a[76:79], a[12:15], v[32:35]
    ds_read_b128 a[100:103], v11 offset:8192
    v_cvt_pk_bf16_f32 v52, v40, v41
    v_mfma_f32_16x16x32_bf16 v[36:39], a[80:83], a[0:3], v[56:59]
    v_exp_f32 v42, v42
    v_mfma_f32_16x16x32_bf16 v[36:39], a[84:87], a[4:7], v[36:39]
    ds_read_b64_tr_b16 a[144:145], v25 offset:16384
    v_mfma_f32_16x16x32_bf16 v[36:39], a[88:91], a[8:11], v[36:39]
    v_exp_f32 v43, v43
    v_mfma_f32_16x16x32_bf16 v[36:39], a[92:95], a[12:15], v[36:39]
    ds_read_b64_tr_b16 a[146:147], v25 offset:20480
    v_cvt_pk_bf16_f32 v53, v42, v43
    v_mfma_f32_16x16x32_bf16 v[136:139], a[160:163], v[48:51], v[136:139]
    v_exp_f32 v44, v44
    v_mfma_f32_16x16x32_bf16 v[152:155], a[164:167], v[48:51], v[152:155]
    ds_read_b64_tr_b16 a[148:149], v27 offset:16384
    s_add_u32 m0, s36, 16384
    v_mfma_f32_16x16x32_bf16 v[168:171], a[168:171], v[48:51], v[168:171]
    v_exp_f32 v45, v45
    v_mfma_f32_16x16x32_bf16 v[184:187], a[172:175], v[48:51], v[184:187]
    ds_read_b64_tr_b16 a[150:151], v27 offset:20480
    v_cvt_pk_bf16_f32 v54, v44, v45
    v_mfma_f32_16x16x32_bf16 v[200:203], a[176:179], v[48:51], v[200:203]
    v_exp_f32 v46, v46
    v_mfma_f32_16x16x32_bf16 v[216:219], a[180:183], v[48:51], v[216:219]
    buffer_load_dwordx4 v2, s[12:15], s35 offen offset:0 lds
    v_mfma_f32_16x16x32_bf16 v[232:235], a[184:187], v[48:51], v[232:235]
    v_exp_f32 v47, v47
    v_mfma_f32_16x16x32_bf16 v[248:251], a[188:191], v[48:51], v[248:251]
    v_cvt_pk_bf16_f32 v55, v46, v47
    v_mfma_f32_16x16x32_bf16 v[80:83], v[88:91], v[48:51], v[80:83]
    v_mfma_f32_16x16x32_bf16 v[40:43], a[64:67], a[16:19], v[60:63]
    v_exp_f32 v32, v32
    v_mfma_f32_16x16x32_bf16 v[40:43], a[68:71], a[20:23], v[40:43]
    ds_read_b128 a[104:107], v13 offset:8192
    v_mfma_f32_16x16x32_bf16 v[40:43], a[72:75], a[24:27], v[40:43]
    v_exp_f32 v33, v33
    v_mfma_f32_16x16x32_bf16 v[40:43], a[76:79], a[28:31], v[40:43]
    ds_read_b128 a[108:111], v15 offset:8192
    v_cvt_pk_bf16_f32 v48, v32, v33
    v_mfma_f32_16x16x32_bf16 v[44:47], a[80:83], a[16:19], v[60:63]
    v_exp_f32 v34, v34
    v_mfma_f32_16x16x32_bf16 v[44:47], a[84:87], a[20:23], v[44:47]
    ds_read_b64_tr_b16 a[152:153], v29 offset:16384
    v_mfma_f32_16x16x32_bf16 v[44:47], a[88:91], a[24:27], v[44:47]
    v_exp_f32 v35, v35
    v_mfma_f32_16x16x32_bf16 v[44:47], a[92:95], a[28:31], v[44:47]
    ds_read_b64_tr_b16 a[154:155], v29 offset:20480
    v_cvt_pk_bf16_f32 v49, v34, v35
    v_mfma_f32_16x16x32_bf16 v[140:143], a[160:163], v[52:55], v[140:143]
    v_exp_f32 v36, v36
    v_mfma_f32_16x16x32_bf16 v[156:159], a[164:167], v[52:55], v[156:159]
    ds_read_b64_tr_b16 a[156:157], v31 offset:16384
    v_mfma_f32_16x16x32_bf16 v[172:175], a[168:171], v[52:55], v[172:175]
    v_exp_f32 v37, v37
    v_mfma_f32_16x16x32_bf16 v[188:191], a[172:175], v[52:55], v[188:191]
    ds_read_b64_tr_b16 a[158:159], v31 offset:20480
    v_cvt_pk_bf16_f32 v50, v36, v37
    v_mfma_f32_16x16x32_bf16 v[204:207], a[176:179], v[52:55], v[204:207]
    v_exp_f32 v38, v38
    v_mfma_f32_16x16x32_bf16 v[220:223], a[180:183], v[52:55], v[220:223]
    buffer_load_dwordx4 v3, s[12:15], s35 offen offset:1024 lds
    v_mfma_f32_16x16x32_bf16 v[236:239], a[184:187], v[52:55], v[236:239]
    v_exp_f32 v39, v39
    v_mfma_f32_16x16x32_bf16 v[252:255], a[188:191], v[52:55], v[252:255]
    v_cvt_pk_bf16_f32 v51, v38, v39
    v_mfma_f32_16x16x32_bf16 v[84:87], v[88:91], v[52:55], v[84:87]
    v_mfma_f32_16x16x32_bf16 v[32:35], a[64:67], a[32:35], v[64:67]
    v_exp_f32 v40, v40
    v_mfma_f32_16x16x32_bf16 v[32:35], a[68:71], a[36:39], v[32:35]
    ds_read_b128 a[112:115], v9 offset:12288
    v_mfma_f32_16x16x32_bf16 v[32:35], a[72:75], a[40:43], v[32:35]
    v_exp_f32 v41, v41
    v_mfma_f32_16x16x32_bf16 v[32:35], a[76:79], a[44:47], v[32:35]
    ds_read_b128 a[116:119], v11 offset:12288
    v_cvt_pk_bf16_f32 v52, v40, v41
    v_mfma_f32_16x16x32_bf16 v[36:39], a[80:83], a[32:35], v[64:67]
    v_exp_f32 v42, v42
    v_mfma_f32_16x16x32_bf16 v[36:39], a[84:87], a[36:39], v[36:39]
    ds_read_b64_tr_b16 a[160:161], v17 offset:24576
    s_waitcnt lgkmcnt(3)
    v_mfma_f32_16x16x32_bf16 v[36:39], a[88:91], a[40:43], v[36:39]
    v_exp_f32 v43, v43
    v_mfma_f32_16x16x32_bf16 v[36:39], a[92:95], a[44:47], v[36:39]
    ds_read_b64_tr_b16 a[162:163], v17 offset:28672
    v_cvt_pk_bf16_f32 v53, v42, v43
    v_mfma_f32_16x16x32_bf16 v[128:131], a[128:131], v[48:51], v[128:131]
    v_exp_f32 v44, v44
    v_mfma_f32_16x16x32_bf16 v[144:147], a[132:135], v[48:51], v[144:147]
    ds_read_b64_tr_b16 a[164:165], v19 offset:24576
    v_mfma_f32_16x16x32_bf16 v[160:163], a[136:139], v[48:51], v[160:163]
    v_exp_f32 v45, v45
    v_mfma_f32_16x16x32_bf16 v[176:179], a[140:143], v[48:51], v[176:179]
    ds_read_b64_tr_b16 a[166:167], v19 offset:28672
    v_cvt_pk_bf16_f32 v54, v44, v45
    v_mfma_f32_16x16x32_bf16 v[192:195], a[144:147], v[48:51], v[192:195]
    v_exp_f32 v46, v46
    v_mfma_f32_16x16x32_bf16 v[208:211], a[148:151], v[48:51], v[208:211]
    buffer_load_dwordx4 v2, s[12:15], s35 offen offset:2048 lds
    v_mfma_f32_16x16x32_bf16 v[224:227], a[152:155], v[48:51], v[224:227]
    v_exp_f32 v47, v47
    v_mfma_f32_16x16x32_bf16 v[240:243], a[156:159], v[48:51], v[240:243]
    v_cvt_pk_bf16_f32 v55, v46, v47
    v_mfma_f32_16x16x32_bf16 v[72:75], v[88:91], v[48:51], v[72:75]
    v_mfma_f32_16x16x32_bf16 v[40:43], a[64:67], a[48:51], v[68:71]
    v_exp_f32 v32, v32
    v_mfma_f32_16x16x32_bf16 v[40:43], a[68:71], a[52:55], v[40:43]
    ds_read_b128 a[120:123], v13 offset:12288
    v_mfma_f32_16x16x32_bf16 v[40:43], a[72:75], a[56:59], v[40:43]
    v_exp_f32 v33, v33
    v_mfma_f32_16x16x32_bf16 v[40:43], a[76:79], a[60:63], v[40:43]
    ds_read_b128 a[124:127], v15 offset:12288
    v_cvt_pk_bf16_f32 v48, v32, v33
    v_mfma_f32_16x16x32_bf16 v[44:47], a[80:83], a[48:51], v[68:71]
    v_exp_f32 v34, v34
    v_mfma_f32_16x16x32_bf16 v[44:47], a[84:87], a[52:55], v[44:47]
    ds_read_b64_tr_b16 a[168:169], v21 offset:24576
    v_mfma_f32_16x16x32_bf16 v[44:47], a[88:91], a[56:59], v[44:47]
    v_exp_f32 v35, v35
    v_mfma_f32_16x16x32_bf16 v[44:47], a[92:95], a[60:63], v[44:47]
    ds_read_b64_tr_b16 a[170:171], v21 offset:28672
    v_cvt_pk_bf16_f32 v49, v34, v35
    v_mfma_f32_16x16x32_bf16 v[132:135], a[128:131], v[52:55], v[132:135]
    v_exp_f32 v36, v36
    v_mfma_f32_16x16x32_bf16 v[148:151], a[132:135], v[52:55], v[148:151]
    ds_read_b64_tr_b16 a[172:173], v23 offset:24576
    v_mfma_f32_16x16x32_bf16 v[164:167], a[136:139], v[52:55], v[164:167]
    v_exp_f32 v37, v37
    v_mfma_f32_16x16x32_bf16 v[180:183], a[140:143], v[52:55], v[180:183]
    ds_read_b64_tr_b16 a[174:175], v23 offset:28672
    v_cvt_pk_bf16_f32 v50, v36, v37
    v_mfma_f32_16x16x32_bf16 v[196:199], a[144:147], v[52:55], v[196:199]
    v_exp_f32 v38, v38
    v_mfma_f32_16x16x32_bf16 v[212:215], a[148:151], v[52:55], v[212:215]
    buffer_load_dwordx4 v3, s[12:15], s35 offen offset:3072 lds
    v_mfma_f32_16x16x32_bf16 v[228:231], a[152:155], v[52:55], v[228:231]
    v_exp_f32 v39, v39
    v_mfma_f32_16x16x32_bf16 v[244:247], a[156:159], v[52:55], v[244:247]
    v_cvt_pk_bf16_f32 v51, v38, v39
    s_add_u32 s35, s35, 16384
    v_mfma_f32_16x16x32_bf16 v[76:79], v[88:91], v[52:55], v[76:79]
    s_waitcnt vmcnt(8) lgkmcnt(4)
    s_barrier
    s_min_u32 s35, s35, 507904
    v_mfma_f32_16x16x32_bf16 v[32:35], a[96:99], a[0:3], v[56:59]
    v_exp_f32 v40, v40
    v_mfma_f32_16x16x32_bf16 v[32:35], a[100:103], a[4:7], v[32:35]
    ds_read_b128 a[64:67], v9 offset:32768
    v_mfma_f32_16x16x32_bf16 v[32:35], a[104:107], a[8:11], v[32:35]
    v_exp_f32 v41, v41
    v_mfma_f32_16x16x32_bf16 v[32:35], a[108:111], a[12:15], v[32:35]
    ds_read_b128 a[68:71], v11 offset:32768
    v_cvt_pk_bf16_f32 v52, v40, v41
    v_mfma_f32_16x16x32_bf16 v[36:39], a[112:115], a[0:3], v[56:59]
    v_exp_f32 v42, v42
    v_mfma_f32_16x16x32_bf16 v[36:39], a[116:119], a[4:7], v[36:39]
    ds_read_b64_tr_b16 a[176:177], v25 offset:24576
    v_mfma_f32_16x16x32_bf16 v[36:39], a[120:123], a[8:11], v[36:39]
    v_exp_f32 v43, v43
    v_mfma_f32_16x16x32_bf16 v[36:39], a[124:127], a[12:15], v[36:39]
    ds_read_b64_tr_b16 a[178:179], v25 offset:28672
    v_cvt_pk_bf16_f32 v53, v42, v43
    v_mfma_f32_16x16x32_bf16 v[136:139], a[128:131], v[48:51], v[136:139]
    v_exp_f32 v44, v44
    v_mfma_f32_16x16x32_bf16 v[152:155], a[132:135], v[48:51], v[152:155]
    ds_read_b64_tr_b16 a[180:181], v27 offset:24576
    s_add_u32 m0, s36, 32768
    v_mfma_f32_16x16x32_bf16 v[168:171], a[136:139], v[48:51], v[168:171]
    v_exp_f32 v45, v45
    v_mfma_f32_16x16x32_bf16 v[184:187], a[140:143], v[48:51], v[184:187]
    ds_read_b64_tr_b16 a[182:183], v27 offset:28672
    v_cvt_pk_bf16_f32 v54, v44, v45
    v_mfma_f32_16x16x32_bf16 v[200:203], a[144:147], v[48:51], v[200:203]
    v_exp_f32 v46, v46
    v_mfma_f32_16x16x32_bf16 v[216:219], a[148:151], v[48:51], v[216:219]
    buffer_load_dwordx4 v124, s[8:11], s35 offen offset:0 lds
    v_mfma_f32_16x16x32_bf16 v[232:235], a[152:155], v[48:51], v[232:235]
    v_exp_f32 v47, v47
    v_mfma_f32_16x16x32_bf16 v[248:251], a[156:159], v[48:51], v[248:251]
    ds_read_b64_tr_b16 a[192:193], v96
    v_cvt_pk_bf16_f32 v55, v46, v47
    v_mfma_f32_16x16x32_bf16 v[80:83], v[88:91], v[48:51], v[80:83]
    ds_read_b64_tr_b16 a[194:195], v96 offset:2048
    v_mfma_f32_16x16x32_bf16 v[40:43], a[96:99], a[16:19], v[60:63]
    v_exp_f32 v32, v32
    v_mfma_f32_16x16x32_bf16 v[40:43], a[100:103], a[20:23], v[40:43]
    ds_read_b128 a[72:75], v13 offset:32768
    v_mfma_f32_16x16x32_bf16 v[40:43], a[104:107], a[24:27], v[40:43]
    v_exp_f32 v33, v33
    v_mfma_f32_16x16x32_bf16 v[40:43], a[108:111], a[28:31], v[40:43]
    ds_read_b128 a[76:79], v15 offset:32768
    v_cvt_pk_bf16_f32 v48, v32, v33
    v_mfma_f32_16x16x32_bf16 v[44:47], a[112:115], a[16:19], v[60:63]
    v_exp_f32 v34, v34
    v_mfma_f32_16x16x32_bf16 v[44:47], a[116:119], a[20:23], v[44:47]
    ds_read_b64_tr_b16 a[184:185], v29 offset:24576
    v_mfma_f32_16x16x32_bf16 v[44:47], a[120:123], a[24:27], v[44:47]
    v_exp_f32 v35, v35
    v_mfma_f32_16x16x32_bf16 v[44:47], a[124:127], a[28:31], v[44:47]
    ds_read_b64_tr_b16 a[186:187], v29 offset:28672
    v_cvt_pk_bf16_f32 v49, v34, v35
    v_mfma_f32_16x16x32_bf16 v[140:143], a[128:131], v[52:55], v[140:143]
    v_exp_f32 v36, v36
    v_mfma_f32_16x16x32_bf16 v[156:159], a[132:135], v[52:55], v[156:159]
    ds_read_b64_tr_b16 a[188:189], v31 offset:24576
    v_mfma_f32_16x16x32_bf16 v[172:175], a[136:139], v[52:55], v[172:175]
    v_exp_f32 v37, v37
    v_mfma_f32_16x16x32_bf16 v[188:191], a[140:143], v[52:55], v[188:191]
    ds_read_b64_tr_b16 a[190:191], v31 offset:28672
    v_cvt_pk_bf16_f32 v50, v36, v37
    v_mfma_f32_16x16x32_bf16 v[204:207], a[144:147], v[52:55], v[204:207]
    v_exp_f32 v38, v38
    v_mfma_f32_16x16x32_bf16 v[220:223], a[148:151], v[52:55], v[220:223]
    buffer_load_dwordx4 v125, s[8:11], s35 offen offset:1024 lds
    v_mfma_f32_16x16x32_bf16 v[236:239], a[152:155], v[52:55], v[236:239]
    v_exp_f32 v39, v39
    v_mfma_f32_16x16x32_bf16 v[252:255], a[156:159], v[52:55], v[252:255]
    ds_read_b64_tr_b16 a[196:197], v97
    v_cvt_pk_bf16_f32 v51, v38, v39
    v_mfma_f32_16x16x32_bf16 v[84:87], v[88:91], v[52:55], v[84:87]
    ds_read_b64_tr_b16 a[198:199], v97 offset:2048
    v_mfma_f32_16x16x32_bf16 v[32:35], a[96:99], a[32:35], v[64:67]
    v_exp_f32 v40, v40
    v_mfma_f32_16x16x32_bf16 v[32:35], a[100:103], a[36:39], v[32:35]
    ds_read_b128 a[80:83], v9 offset:36864
    v_mfma_f32_16x16x32_bf16 v[32:35], a[104:107], a[40:43], v[32:35]
    v_exp_f32 v41, v41
    v_mfma_f32_16x16x32_bf16 v[32:35], a[108:111], a[44:47], v[32:35]
    ds_read_b128 a[84:87], v11 offset:36864
    v_cvt_pk_bf16_f32 v52, v40, v41
    v_mfma_f32_16x16x32_bf16 v[36:39], a[112:115], a[32:35], v[64:67]
    v_exp_f32 v42, v42
    v_mfma_f32_16x16x32_bf16 v[36:39], a[116:119], a[36:39], v[36:39]
    ds_read_b64_tr_b16 a[128:129], v17 offset:49152
    s_waitcnt lgkmcnt(3)
    v_mfma_f32_16x16x32_bf16 v[36:39], a[120:123], a[40:43], v[36:39]
    v_exp_f32 v43, v43
    v_mfma_f32_16x16x32_bf16 v[36:39], a[124:127], a[44:47], v[36:39]
    ds_read_b64_tr_b16 a[130:131], v17 offset:53248
    v_cvt_pk_bf16_f32 v53, v42, v43
    v_mfma_f32_16x16x32_bf16 v[128:131], a[160:163], v[48:51], v[128:131]
    v_exp_f32 v44, v44
    v_mfma_f32_16x16x32_bf16 v[144:147], a[164:167], v[48:51], v[144:147]
    ds_read_b64_tr_b16 a[132:133], v19 offset:49152
    v_mfma_f32_16x16x32_bf16 v[160:163], a[168:171], v[48:51], v[160:163]
    v_exp_f32 v45, v45
    v_mfma_f32_16x16x32_bf16 v[176:179], a[172:175], v[48:51], v[176:179]
    ds_read_b64_tr_b16 a[134:135], v19 offset:53248
    v_cvt_pk_bf16_f32 v54, v44, v45
    v_mfma_f32_16x16x32_bf16 v[192:195], a[176:179], v[48:51], v[192:195]
    v_exp_f32 v46, v46
    v_mfma_f32_16x16x32_bf16 v[208:211], a[180:183], v[48:51], v[208:211]
    buffer_load_dwordx4 v126, s[8:11], s35 offen offset:2048 lds
    v_mfma_f32_16x16x32_bf16 v[224:227], a[184:187], v[48:51], v[224:227]
    v_exp_f32 v47, v47
    v_mfma_f32_16x16x32_bf16 v[240:243], a[188:191], v[48:51], v[240:243]
    ds_read_b64_tr_b16 a[200:201], v98
    v_cvt_pk_bf16_f32 v55, v46, v47
    v_mfma_f32_16x16x32_bf16 v[72:75], v[88:91], v[48:51], v[72:75]
    ds_read_b64_tr_b16 a[202:203], v98 offset:2048
    v_mfma_f32_16x16x32_bf16 v[40:43], a[96:99], a[48:51], v[68:71]
    v_exp_f32 v32, v32
    v_mfma_f32_16x16x32_bf16 v[40:43], a[100:103], a[52:55], v[40:43]
    ds_read_b128 a[88:91], v13 offset:36864
    v_mfma_f32_16x16x32_bf16 v[40:43], a[104:107], a[56:59], v[40:43]
    v_exp_f32 v33, v33
    v_mfma_f32_16x16x32_bf16 v[40:43], a[108:111], a[60:63], v[40:43]
    ds_read_b128 a[92:95], v15 offset:36864
    v_cvt_pk_bf16_f32 v48, v32, v33
    v_mfma_f32_16x16x32_bf16 v[44:47], a[112:115], a[48:51], v[68:71]
    v_exp_f32 v34, v34
    v_mfma_f32_16x16x32_bf16 v[44:47], a[116:119], a[52:55], v[44:47]
    ds_read_b64_tr_b16 a[136:137], v21 offset:49152
    v_mfma_f32_16x16x32_bf16 v[44:47], a[120:123], a[56:59], v[44:47]
    v_exp_f32 v35, v35
    v_mfma_f32_16x16x32_bf16 v[44:47], a[124:127], a[60:63], v[44:47]
    ds_read_b64_tr_b16 a[138:139], v21 offset:53248
    v_cvt_pk_bf16_f32 v49, v34, v35
    v_mfma_f32_16x16x32_bf16 v[132:135], a[160:163], v[52:55], v[132:135]
    v_exp_f32 v36, v36
    v_mfma_f32_16x16x32_bf16 v[148:151], a[164:167], v[52:55], v[148:151]
    ds_read_b64_tr_b16 a[140:141], v23 offset:49152
    v_mfma_f32_16x16x32_bf16 v[164:167], a[168:171], v[52:55], v[164:167]
    v_exp_f32 v37, v37
    v_mfma_f32_16x16x32_bf16 v[180:183], a[172:175], v[52:55], v[180:183]
    ds_read_b64_tr_b16 a[142:143], v23 offset:53248
    v_cvt_pk_bf16_f32 v50, v36, v37
    v_mfma_f32_16x16x32_bf16 v[196:199], a[176:179], v[52:55], v[196:199]
    v_exp_f32 v38, v38
    v_mfma_f32_16x16x32_bf16 v[212:215], a[180:183], v[52:55], v[212:215]
    buffer_load_dwordx4 v127, s[8:11], s35 offen offset:3072 lds
    v_mfma_f32_16x16x32_bf16 v[228:231], a[184:187], v[52:55], v[228:231]
    v_exp_f32 v39, v39
    v_mfma_f32_16x16x32_bf16 v[244:247], a[188:191], v[52:55], v[244:247]
    v_cvt_pk_bf16_f32 v51, v38, v39
    v_mfma_f32_16x16x32_bf16 v[76:79], v[88:91], v[52:55], v[76:79]
    s_waitcnt lgkmcnt(4)
    v_mfma_f32_16x16x32_bf16 v[32:35], a[64:67], a[0:3], v[56:59]
    v_exp_f32 v40, v40
    v_mfma_f32_16x16x32_bf16 v[32:35], a[68:71], a[4:7], v[32:35]
    ds_read_b128 a[96:99], v9 offset:40960
    v_mfma_f32_16x16x32_bf16 v[32:35], a[72:75], a[8:11], v[32:35]
    v_exp_f32 v41, v41
    v_mfma_f32_16x16x32_bf16 v[32:35], a[76:79], a[12:15], v[32:35]
    ds_read_b128 a[100:103], v11 offset:40960
    v_cvt_pk_bf16_f32 v52, v40, v41
    v_mfma_f32_16x16x32_bf16 v[36:39], a[80:83], a[0:3], v[56:59]
    v_exp_f32 v42, v42
    v_mfma_f32_16x16x32_bf16 v[36:39], a[84:87], a[4:7], v[36:39]
    ds_read_b64_tr_b16 a[144:145], v25 offset:49152
    v_mfma_f32_16x16x32_bf16 v[36:39], a[88:91], a[8:11], v[36:39]
    v_exp_f32 v43, v43
    v_mfma_f32_16x16x32_bf16 v[36:39], a[92:95], a[12:15], v[36:39]
    ds_read_b64_tr_b16 a[146:147], v25 offset:53248
    v_cvt_pk_bf16_f32 v53, v42, v43
    v_mfma_f32_16x16x32_bf16 v[136:139], a[160:163], v[48:51], v[136:139]
    v_exp_f32 v44, v44
    v_mfma_f32_16x16x32_bf16 v[152:155], a[164:167], v[48:51], v[152:155]
    ds_read_b64_tr_b16 a[148:149], v27 offset:49152
    s_add_u32 m0, s36, 49152
    v_mfma_f32_16x16x32_bf16 v[168:171], a[168:171], v[48:51], v[168:171]
    v_exp_f32 v45, v45
    v_mfma_f32_16x16x32_bf16 v[184:187], a[172:175], v[48:51], v[184:187]
    ds_read_b64_tr_b16 a[150:151], v27 offset:53248
    v_cvt_pk_bf16_f32 v54, v44, v45
    v_mfma_f32_16x16x32_bf16 v[200:203], a[176:179], v[48:51], v[200:203]
    v_exp_f32 v46, v46
    v_mfma_f32_16x16x32_bf16 v[216:219], a[180:183], v[48:51], v[216:219]
    buffer_load_dwordx4 v2, s[12:15], s35 offen offset:0 lds
    v_mfma_f32_16x16x32_bf16 v[232:235], a[184:187], v[48:51], v[232:235]
    v_exp_f32 v47, v47
    v_mfma_f32_16x16x32_bf16 v[248:251], a[188:191], v[48:51], v[248:251]
    ds_read_b64_tr_b16 a[204:205], v99
    v_cvt_pk_bf16_f32 v55, v46, v47
    v_mfma_f32_16x16x32_bf16 v[80:83], v[88:91], v[48:51], v[80:83]
    ds_read_b64_tr_b16 a[206:207], v99 offset:2048
    v_mfma_f32_16x16x32_bf16 v[40:43], a[64:67], a[16:19], v[60:63]
    v_exp_f32 v32, v32
    v_mfma_f32_16x16x32_bf16 v[40:43], a[68:71], a[20:23], v[40:43]
    ds_read_b128 a[104:107], v13 offset:40960
    v_mfma_f32_16x16x32_bf16 v[40:43], a[72:75], a[24:27], v[40:43]
    v_exp_f32 v33, v33
    v_mfma_f32_16x16x32_bf16 v[40:43], a[76:79], a[28:31], v[40:43]
    ds_read_b128 a[108:111], v15 offset:40960
    v_cvt_pk_bf16_f32 v48, v32, v33
    v_mfma_f32_16x16x32_bf16 v[44:47], a[80:83], a[16:19], v[60:63]
    v_exp_f32 v34, v34
    v_mfma_f32_16x16x32_bf16 v[44:47], a[84:87], a[20:23], v[44:47]
    ds_read_b64_tr_b16 a[152:153], v29 offset:49152
    v_mfma_f32_16x16x32_bf16 v[44:47], a[88:91], a[24:27], v[44:47]
    v_exp_f32 v35, v35
    v_mfma_f32_16x16x32_bf16 v[44:47], a[92:95], a[28:31], v[44:47]
    ds_read_b64_tr_b16 a[154:155], v29 offset:53248
    v_cvt_pk_bf16_f32 v49, v34, v35
    v_mfma_f32_16x16x32_bf16 v[140:143], a[160:163], v[52:55], v[140:143]
    v_exp_f32 v36, v36
    v_mfma_f32_16x16x32_bf16 v[156:159], a[164:167], v[52:55], v[156:159]
    ds_read_b64_tr_b16 a[156:157], v31 offset:49152
    v_mfma_f32_16x16x32_bf16 v[172:175], a[168:171], v[52:55], v[172:175]
    v_exp_f32 v37, v37
    v_mfma_f32_16x16x32_bf16 v[188:191], a[172:175], v[52:55], v[188:191]
    ds_read_b64_tr_b16 a[158:159], v31 offset:53248
    v_cvt_pk_bf16_f32 v50, v36, v37
    v_mfma_f32_16x16x32_bf16 v[204:207], a[176:179], v[52:55], v[204:207]
    v_exp_f32 v38, v38
    v_mfma_f32_16x16x32_bf16 v[220:223], a[180:183], v[52:55], v[220:223]
    buffer_load_dwordx4 v3, s[12:15], s35 offen offset:1024 lds
    v_mfma_f32_16x16x32_bf16 v[236:239], a[184:187], v[52:55], v[236:239]
    v_exp_f32 v39, v39
    v_mfma_f32_16x16x32_bf16 v[252:255], a[188:191], v[52:55], v[252:255]
    v_cvt_pk_bf16_f32 v51, v38, v39
    v_mfma_f32_16x16x32_bf16 v[84:87], v[88:91], v[52:55], v[84:87]
    v_mfma_f32_16x16x32_bf16 v[32:35], a[64:67], a[32:35], v[64:67]
    v_exp_f32 v40, v40
    v_mfma_f32_16x16x32_bf16 v[32:35], a[68:71], a[36:39], v[32:35]
    ds_read_b128 a[112:115], v9 offset:45056
    v_mfma_f32_16x16x32_bf16 v[32:35], a[72:75], a[40:43], v[32:35]
    v_exp_f32 v41, v41
    v_mfma_f32_16x16x32_bf16 v[32:35], a[76:79], a[44:47], v[32:35]
    ds_read_b128 a[116:119], v11 offset:45056
    v_cvt_pk_bf16_f32 v52, v40, v41
    v_mfma_f32_16x16x32_bf16 v[36:39], a[80:83], a[32:35], v[64:67]
    v_exp_f32 v42, v42
    v_mfma_f32_16x16x32_bf16 v[36:39], a[84:87], a[36:39], v[36:39]
    ds_read_b64_tr_b16 a[160:161], v17 offset:57344
    s_waitcnt lgkmcnt(3)
    v_mfma_f32_16x16x32_bf16 v[36:39], a[88:91], a[40:43], v[36:39]
    v_exp_f32 v43, v43
    v_mfma_f32_16x16x32_bf16 v[36:39], a[92:95], a[44:47], v[36:39]
    ds_read_b64_tr_b16 a[162:163], v17 offset:61440
    v_cvt_pk_bf16_f32 v53, v42, v43
    v_mfma_f32_16x16x32_bf16 v[128:131], a[128:131], v[48:51], v[128:131]
    v_exp_f32 v44, v44
    v_mfma_f32_16x16x32_bf16 v[144:147], a[132:135], v[48:51], v[144:147]
    ds_read_b64_tr_b16 a[164:165], v19 offset:57344
    v_mfma_f32_16x16x32_bf16 v[160:163], a[136:139], v[48:51], v[160:163]
    v_exp_f32 v45, v45
    v_mfma_f32_16x16x32_bf16 v[176:179], a[140:143], v[48:51], v[176:179]
    ds_read_b64_tr_b16 a[166:167], v19 offset:61440
    v_cvt_pk_bf16_f32 v54, v44, v45
    v_mfma_f32_16x16x32_bf16 v[192:195], a[144:147], v[48:51], v[192:195]
    v_exp_f32 v46, v46
    v_mfma_f32_16x16x32_bf16 v[208:211], a[148:151], v[48:51], v[208:211]
    buffer_load_dwordx4 v2, s[12:15], s35 offen offset:2048 lds
    v_mfma_f32_16x16x32_bf16 v[224:227], a[152:155], v[48:51], v[224:227]
    v_exp_f32 v47, v47
    v_mfma_f32_16x16x32_bf16 v[240:243], a[156:159], v[48:51], v[240:243]
    v_cvt_pk_bf16_f32 v55, v46, v47
    v_mfma_f32_16x16x32_bf16 v[72:75], v[88:91], v[48:51], v[72:75]
    v_mfma_f32_16x16x32_bf16 v[40:43], a[64:67], a[48:51], v[68:71]
    v_exp_f32 v32, v32
    v_mfma_f32_16x16x32_bf16 v[40:43], a[68:71], a[52:55], v[40:43]
    ds_read_b128 a[120:123], v13 offset:45056
    v_mfma_f32_16x16x32_bf16 v[40:43], a[72:75], a[56:59], v[40:43]
    v_exp_f32 v33, v33
    v_mfma_f32_16x16x32_bf16 v[40:43], a[76:79], a[60:63], v[40:43]
    ds_read_b128 a[124:127], v15 offset:45056
    v_cvt_pk_bf16_f32 v48, v32, v33
    v_mfma_f32_16x16x32_bf16 v[44:47], a[80:83], a[48:51], v[68:71]
    v_exp_f32 v34, v34
    v_mfma_f32_16x16x32_bf16 v[44:47], a[84:87], a[52:55], v[44:47]
    ds_read_b64_tr_b16 a[168:169], v21 offset:57344
    v_mfma_f32_16x16x32_bf16 v[44:47], a[88:91], a[56:59], v[44:47]
    v_exp_f32 v35, v35
    v_mfma_f32_16x16x32_bf16 v[44:47], a[92:95], a[60:63], v[44:47]
    ds_read_b64_tr_b16 a[170:171], v21 offset:61440
    v_cvt_pk_bf16_f32 v49, v34, v35
    v_mfma_f32_16x16x32_bf16 v[132:135], a[128:131], v[52:55], v[132:135]
    v_exp_f32 v36, v36
    v_mfma_f32_16x16x32_bf16 v[148:151], a[132:135], v[52:55], v[148:151]
    ds_read_b64_tr_b16 a[172:173], v23 offset:57344
    v_mfma_f32_16x16x32_bf16 v[164:167], a[136:139], v[52:55], v[164:167]
    v_exp_f32 v37, v37
    v_mfma_f32_16x16x32_bf16 v[180:183], a[140:143], v[52:55], v[180:183]
    ds_read_b64_tr_b16 a[174:175], v23 offset:61440
    v_cvt_pk_bf16_f32 v50, v36, v37
    v_mfma_f32_16x16x32_bf16 v[196:199], a[144:147], v[52:55], v[196:199]
    v_exp_f32 v38, v38
    v_mfma_f32_16x16x32_bf16 v[212:215], a[148:151], v[52:55], v[212:215]
    buffer_load_dwordx4 v3, s[12:15], s35 offen offset:3072 lds
    v_mfma_f32_16x16x32_bf16 v[228:231], a[152:155], v[52:55], v[228:231]
    v_exp_f32 v39, v39
    v_mfma_f32_16x16x32_bf16 v[244:247], a[156:159], v[52:55], v[244:247]
    v_cvt_pk_bf16_f32 v51, v38, v39
    s_add_u32 s35, s35, 16384
    v_mfma_f32_16x16x32_bf16 v[76:79], v[88:91], v[52:55], v[76:79]
    s_waitcnt vmcnt(8) lgkmcnt(4)
    s_barrier
    s_min_u32 s35, s35, 507904
    v_mfma_f32_16x16x32_bf16 v[32:35], a[96:99], a[0:3], v[56:59]
    v_exp_f32 v40, v40
    v_mfma_f32_16x16x32_bf16 v[32:35], a[100:103], a[4:7], v[32:35]
    ds_read_b128 a[64:67], v8 offset:0
    v_mfma_f32_16x16x32_bf16 v[32:35], a[104:107], a[8:11], v[32:35]
    v_exp_f32 v41, v41
    v_mfma_f32_16x16x32_bf16 v[32:35], a[108:111], a[12:15], v[32:35]
    ds_read_b128 a[68:71], v10 offset:0
    v_cvt_pk_bf16_f32 v52, v40, v41
    buffer_store_dwordx4 a[192:195], v100, s[20:23], s25 offen offset:0 sc1
    v_mfma_f32_16x16x32_bf16 v[36:39], a[112:115], a[0:3], v[56:59]
    v_exp_f32 v42, v42
    v_mfma_f32_16x16x32_bf16 v[36:39], a[116:119], a[4:7], v[36:39]
    ds_read_b64_tr_b16 a[176:177], v25 offset:57344
    buffer_store_dwordx4 a[196:199], v100, s[20:23], s25 offen offset:1024 sc1
    v_mfma_f32_16x16x32_bf16 v[36:39], a[120:123], a[8:11], v[36:39]
    v_exp_f32 v43, v43
    v_mfma_f32_16x16x32_bf16 v[36:39], a[124:127], a[12:15], v[36:39]
    ds_read_b64_tr_b16 a[178:179], v25 offset:61440
    v_cvt_pk_bf16_f32 v53, v42, v43
    buffer_store_dwordx4 a[200:203], v100, s[20:23], s25 offen offset:2048 sc1
    v_mfma_f32_16x16x32_bf16 v[136:139], a[128:131], v[48:51], v[136:139]
    v_exp_f32 v44, v44
    v_mfma_f32_16x16x32_bf16 v[152:155], a[132:135], v[48:51], v[152:155]
    ds_read_b64_tr_b16 a[180:181], v27 offset:57344
    s_add_u32 m0, s36, 65536
    v_mfma_f32_16x16x32_bf16 v[168:171], a[136:139], v[48:51], v[168:171]
    v_exp_f32 v45, v45
    v_mfma_f32_16x16x32_bf16 v[184:187], a[140:143], v[48:51], v[184:187]
    ds_read_b64_tr_b16 a[182:183], v27 offset:61440
    v_cvt_pk_bf16_f32 v54, v44, v45
    buffer_store_dwordx4 a[204:207], v100, s[20:23], s25 offen offset:3072 sc1
    v_mfma_f32_16x16x32_bf16 v[200:203], a[144:147], v[48:51], v[200:203]
    v_exp_f32 v46, v46
    v_mfma_f32_16x16x32_bf16 v[216:219], a[148:151], v[48:51], v[216:219]
    buffer_load_dwordx4 v124, s[8:11], s35 offen offset:0 lds
    v_mfma_f32_16x16x32_bf16 v[232:235], a[152:155], v[48:51], v[232:235]
    v_exp_f32 v47, v47
    v_mfma_f32_16x16x32_bf16 v[248:251], a[156:159], v[48:51], v[248:251]
    v_cvt_pk_bf16_f32 v55, v46, v47
    v_mfma_f32_16x16x32_bf16 v[80:83], v[88:91], v[48:51], v[80:83]
    v_mfma_f32_16x16x32_bf16 v[40:43], a[96:99], a[16:19], v[60:63]
    v_exp_f32 v32, v32
    v_mfma_f32_16x16x32_bf16 v[40:43], a[100:103], a[20:23], v[40:43]
    ds_read_b128 a[72:75], v12 offset:0
    v_mfma_f32_16x16x32_bf16 v[40:43], a[104:107], a[24:27], v[40:43]
    v_exp_f32 v33, v33
    v_mfma_f32_16x16x32_bf16 v[40:43], a[108:111], a[28:31], v[40:43]
    ds_read_b128 a[76:79], v14 offset:0
    v_cvt_pk_bf16_f32 v48, v32, v33
    v_mfma_f32_16x16x32_bf16 v[44:47], a[112:115], a[16:19], v[60:63]
    v_exp_f32 v34, v34
    v_mfma_f32_16x16x32_bf16 v[44:47], a[116:119], a[20:23], v[44:47]
    ds_read_b64_tr_b16 a[184:185], v29 offset:57344
    v_mfma_f32_16x16x32_bf16 v[44:47], a[120:123], a[24:27], v[44:47]
    v_exp_f32 v35, v35
    v_mfma_f32_16x16x32_bf16 v[44:47], a[124:127], a[28:31], v[44:47]
    ds_read_b64_tr_b16 a[186:187], v29 offset:61440
    v_cvt_pk_bf16_f32 v49, v34, v35
    v_mfma_f32_16x16x32_bf16 v[140:143], a[128:131], v[52:55], v[140:143]
    v_exp_f32 v36, v36
    v_mfma_f32_16x16x32_bf16 v[156:159], a[132:135], v[52:55], v[156:159]
    ds_read_b64_tr_b16 a[188:189], v31 offset:57344
    v_mfma_f32_16x16x32_bf16 v[172:175], a[136:139], v[52:55], v[172:175]
    v_exp_f32 v37, v37
    v_mfma_f32_16x16x32_bf16 v[188:191], a[140:143], v[52:55], v[188:191]
    ds_read_b64_tr_b16 a[190:191], v31 offset:61440
    v_cvt_pk_bf16_f32 v50, v36, v37
    v_mfma_f32_16x16x32_bf16 v[204:207], a[144:147], v[52:55], v[204:207]
    v_exp_f32 v38, v38
    v_mfma_f32_16x16x32_bf16 v[220:223], a[148:151], v[52:55], v[220:223]
    buffer_load_dwordx4 v125, s[8:11], s35 offen offset:1024 lds
    v_mfma_f32_16x16x32_bf16 v[236:239], a[152:155], v[52:55], v[236:239]
    v_exp_f32 v39, v39
    v_mfma_f32_16x16x32_bf16 v[252:255], a[156:159], v[52:55], v[252:255]
    v_cvt_pk_bf16_f32 v51, v38, v39
    v_mfma_f32_16x16x32_bf16 v[84:87], v[88:91], v[52:55], v[84:87]
    v_mfma_f32_16x16x32_bf16 v[32:35], a[96:99], a[32:35], v[64:67]
    v_exp_f32 v40, v40
    v_mfma_f32_16x16x32_bf16 v[32:35], a[100:103], a[36:39], v[32:35]
    ds_read_b128 a[80:83], v8 offset:4096
    v_mfma_f32_16x16x32_bf16 v[32:35], a[104:107], a[40:43], v[32:35]
    v_exp_f32 v41, v41
    v_mfma_f32_16x16x32_bf16 v[32:35], a[108:111], a[44:47], v[32:35]
    ds_read_b128 a[84:87], v10 offset:4096
    v_cvt_pk_bf16_f32 v52, v40, v41
    v_mfma_f32_16x16x32_bf16 v[36:39], a[112:115], a[32:35], v[64:67]
    v_exp_f32 v42, v42
    v_mfma_f32_16x16x32_bf16 v[36:39], a[116:119], a[36:39], v[36:39]
    ds_read_b64_tr_b16 a[128:129], v16 offset:16384
    s_waitcnt lgkmcnt(3)
    v_mfma_f32_16x16x32_bf16 v[36:39], a[120:123], a[40:43], v[36:39]
    v_exp_f32 v43, v43
    v_mfma_f32_16x16x32_bf16 v[36:39], a[124:127], a[44:47], v[36:39]
    ds_read_b64_tr_b16 a[130:131], v16 offset:20480
    v_cvt_pk_bf16_f32 v53, v42, v43
    v_mfma_f32_16x16x32_bf16 v[128:131], a[160:163], v[48:51], v[128:131]
    v_exp_f32 v44, v44
    v_mfma_f32_16x16x32_bf16 v[144:147], a[164:167], v[48:51], v[144:147]
    ds_read_b64_tr_b16 a[132:133], v18 offset:16384
    v_mfma_f32_16x16x32_bf16 v[160:163], a[168:171], v[48:51], v[160:163]
    v_exp_f32 v45, v45
    v_mfma_f32_16x16x32_bf16 v[176:179], a[172:175], v[48:51], v[176:179]
    ds_read_b64_tr_b16 a[134:135], v18 offset:20480
    v_cvt_pk_bf16_f32 v54, v44, v45
    v_mfma_f32_16x16x32_bf16 v[192:195], a[176:179], v[48:51], v[192:195]
    v_exp_f32 v46, v46
    v_mfma_f32_16x16x32_bf16 v[208:211], a[180:183], v[48:51], v[208:211]
    buffer_load_dwordx4 v126, s[8:11], s35 offen offset:2048 lds
    v_mfma_f32_16x16x32_bf16 v[224:227], a[184:187], v[48:51], v[224:227]
    v_exp_f32 v47, v47
    v_mfma_f32_16x16x32_bf16 v[240:243], a[188:191], v[48:51], v[240:243]
    v_cvt_pk_bf16_f32 v55, v46, v47
    v_mfma_f32_16x16x32_bf16 v[72:75], v[88:91], v[48:51], v[72:75]
    v_mfma_f32_16x16x32_bf16 v[40:43], a[96:99], a[48:51], v[68:71]
    v_exp_f32 v32, v32
    v_mfma_f32_16x16x32_bf16 v[40:43], a[100:103], a[52:55], v[40:43]
    ds_read_b128 a[88:91], v12 offset:4096
    v_mfma_f32_16x16x32_bf16 v[40:43], a[104:107], a[56:59], v[40:43]
    v_exp_f32 v33, v33
    v_mfma_f32_16x16x32_bf16 v[40:43], a[108:111], a[60:63], v[40:43]
    ds_read_b128 a[92:95], v14 offset:4096
    v_cvt_pk_bf16_f32 v48, v32, v33
    v_mfma_f32_16x16x32_bf16 v[44:47], a[112:115], a[48:51], v[68:71]
    v_exp_f32 v34, v34
    v_mfma_f32_16x16x32_bf16 v[44:47], a[116:119], a[52:55], v[44:47]
    ds_read_b64_tr_b16 a[136:137], v20 offset:16384
    v_mfma_f32_16x16x32_bf16 v[44:47], a[120:123], a[56:59], v[44:47]
    v_exp_f32 v35, v35
    v_mfma_f32_16x16x32_bf16 v[44:47], a[124:127], a[60:63], v[44:47]
    ds_read_b64_tr_b16 a[138:139], v20 offset:20480
    v_cvt_pk_bf16_f32 v49, v34, v35
    v_mfma_f32_16x16x32_bf16 v[132:135], a[160:163], v[52:55], v[132:135]
    v_exp_f32 v36, v36
    v_mfma_f32_16x16x32_bf16 v[148:151], a[164:167], v[52:55], v[148:151]
    ds_read_b64_tr_b16 a[140:141], v22 offset:16384
    v_mfma_f32_16x16x32_bf16 v[164:167], a[168:171], v[52:55], v[164:167]
    v_exp_f32 v37, v37
    v_mfma_f32_16x16x32_bf16 v[180:183], a[172:175], v[52:55], v[180:183]
    ds_read_b64_tr_b16 a[142:143], v22 offset:20480
    v_cvt_pk_bf16_f32 v50, v36, v37
    v_mfma_f32_16x16x32_bf16 v[196:199], a[176:179], v[52:55], v[196:199]
    v_exp_f32 v38, v38
    v_mfma_f32_16x16x32_bf16 v[212:215], a[180:183], v[52:55], v[212:215]
    buffer_load_dwordx4 v127, s[8:11], s35 offen offset:3072 lds
    v_mfma_f32_16x16x32_bf16 v[228:231], a[184:187], v[52:55], v[228:231]
    v_exp_f32 v39, v39
    v_mfma_f32_16x16x32_bf16 v[244:247], a[188:191], v[52:55], v[244:247]
    v_cvt_pk_bf16_f32 v51, v38, v39
    v_mfma_f32_16x16x32_bf16 v[76:79], v[88:91], v[52:55], v[76:79]
    s_waitcnt lgkmcnt(4)
    v_mfma_f32_16x16x32_bf16 v[32:35], a[64:67], a[0:3], v[56:59]
    v_exp_f32 v40, v40
    v_mfma_f32_16x16x32_bf16 v[32:35], a[68:71], a[4:7], v[32:35]
    ds_read_b128 a[96:99], v8 offset:8192
    s_sub_u32 s39, s39, 1
    v_mfma_f32_16x16x32_bf16 v[32:35], a[72:75], a[8:11], v[32:35]
    v_exp_f32 v41, v41
    v_mfma_f32_16x16x32_bf16 v[32:35], a[76:79], a[12:15], v[32:35]
    ds_read_b128 a[100:103], v10 offset:8192
    v_cvt_pk_bf16_f32 v52, v40, v41
    v_mfma_f32_16x16x32_bf16 v[36:39], a[80:83], a[0:3], v[56:59]
    v_exp_f32 v42, v42
    v_mfma_f32_16x16x32_bf16 v[36:39], a[84:87], a[4:7], v[36:39]
    ds_read_b64_tr_b16 a[144:145], v24 offset:16384
    v_mfma_f32_16x16x32_bf16 v[36:39], a[88:91], a[8:11], v[36:39]
    v_exp_f32 v43, v43
    v_mfma_f32_16x16x32_bf16 v[36:39], a[92:95], a[12:15], v[36:39]
    ds_read_b64_tr_b16 a[146:147], v24 offset:20480
    v_cvt_pk_bf16_f32 v53, v42, v43
    v_mfma_f32_16x16x32_bf16 v[136:139], a[160:163], v[48:51], v[136:139]
    v_exp_f32 v44, v44
    v_mfma_f32_16x16x32_bf16 v[152:155], a[164:167], v[48:51], v[152:155]
    ds_read_b64_tr_b16 a[148:149], v26 offset:16384
    s_add_u32 m0, s36, 81920
    v_mfma_f32_16x16x32_bf16 v[168:171], a[168:171], v[48:51], v[168:171]
    v_exp_f32 v45, v45
    v_mfma_f32_16x16x32_bf16 v[184:187], a[172:175], v[48:51], v[184:187]
    ds_read_b64_tr_b16 a[150:151], v26 offset:20480
    v_cvt_pk_bf16_f32 v54, v44, v45
    v_mfma_f32_16x16x32_bf16 v[200:203], a[176:179], v[48:51], v[200:203]
    v_exp_f32 v46, v46
    v_mfma_f32_16x16x32_bf16 v[216:219], a[180:183], v[48:51], v[216:219]
    buffer_load_dwordx4 v2, s[12:15], s35 offen offset:0 lds
    v_mfma_f32_16x16x32_bf16 v[232:235], a[184:187], v[48:51], v[232:235]
    v_exp_f32 v47, v47
    v_mfma_f32_16x16x32_bf16 v[248:251], a[188:191], v[48:51], v[248:251]
    v_cvt_pk_bf16_f32 v55, v46, v47
    v_mfma_f32_16x16x32_bf16 v[80:83], v[88:91], v[48:51], v[80:83]
    s_cmp_lg_u32 s39, 5
    s_cbranch_scc1 mega_kernel_loopj
    s_cmp_eq_u32 s45, 0
    s_cbranch_scc0 mega_kernel_nosh
    v_mov_b32 v101, 0
    v_mov_b32 v102, 1
    s_and_b32 s3, s2, 7
    s_lshl_b32 s3, s3, 7
    s_add_u32 s3, s3, 23552
    s_mov_b64 exec, 1
    buffer_atomic_add v102, v101, s[72:75], s3 offen sc1
    s_mov_b64 exec, -1
mega_kernel_nosh:
.p2align 6
mega_kernel_loop:
    v_mfma_f32_16x16x32_bf16 v[40:43], a[64:67], a[16:19], v[60:63]
    v_exp_f32 v32, v32
    v_mfma_f32_16x16x32_bf16 v[40:43], a[68:71], a[20:23], v[40:43]
    ds_read_b128 a[104:107], v12 offset:8192
    s_sub_u32 s41, 4, s39
    v_mfma_f32_16x16x32_bf16 v[40:43], a[72:75], a[24:27], v[40:43]
    v_exp_f32 v33, v33
    v_mfma_f32_16x16x32_bf16 v[40:43], a[76:79], a[28:31], v[40:43]
    ds_read_b128 a[108:111], v14 offset:8192
    v_cvt_pk_bf16_f32 v48, v32, v33
    s_cmp_lt_u32 s41, 2
    v_mfma_f32_16x16x32_bf16 v[44:47], a[80:83], a[16:19], v[60:63]
    v_exp_f32 v34, v34
    v_mfma_f32_16x16x32_bf16 v[44:47], a[84:87], a[20:23], v[44:47]
    ds_read_b64_tr_b16 a[152:153], v28 offset:16384
    s_cselect_b32 s94, s40, 0
    v_mfma_f32_16x16x32_bf16 v[44:47], a[88:91], a[24:27], v[44:47]
    v_exp_f32 v35, v35
    v_mfma_f32_16x16x32_bf16 v[44:47], a[92:95], a[28:31], v[44:47]
    ds_read_b64_tr_b16 a[154:155], v28 offset:20480
    v_cvt_pk_bf16_f32 v49, v34, v35
    s_lshl_b32 s41, s41, 20
    v_mfma_f32_16x16x32_bf16 v[140:143], a[160:163], v[52:55], v[140:143]
    v_exp_f32 v36, v36
    v_mfma_f32_16x16x32_bf16 v[156:159], a[164:167], v[52:55], v[156:159]
    ds_read_b64_tr_b16 a[156:157], v30 offset:16384
    s_add_u32 s41, s41, s46
    v_mfma_f32_16x16x32_bf16 v[172:175], a[168:171], v[52:55], v[172:175]
    v_exp_f32 v37, v37
    v_mfma_f32_16x16x32_bf16 v[188:191], a[172:175], v[52:55], v[188:191]
    ds_read_b64_tr_b16 a[158:159], v30 offset:20480
    v_cvt_pk_bf16_f32 v50, v36, v37
    v_mfma_f32_16x16x32_bf16 v[204:207], a[176:179], v[52:55], v[204:207]
    v_exp_f32 v38, v38
    v_mfma_f32_16x16x32_bf16 v[220:223], a[180:183], v[52:55], v[220:223]
    buffer_load_dwordx4 v3, s[12:15], s35 offen offset:1024 lds
    v_mfma_f32_16x16x32_bf16 v[236:239], a[184:187], v[52:55], v[236:239]
    v_exp_f32 v39, v39
    v_mfma_f32_16x16x32_bf16 v[252:255], a[188:191], v[52:55], v[252:255]
    v_cvt_pk_bf16_f32 v51, v38, v39
    v_mfma_f32_16x16x32_bf16 v[84:87], v[88:91], v[52:55], v[84:87]
    v_mfma_f32_16x16x32_bf16 v[32:35], a[64:67], a[32:35], v[64:67]
    v_exp_f32 v40, v40
    v_mfma_f32_16x16x32_bf16 v[32:35], a[68:71], a[36:39], v[32:35]
    ds_read_b128 a[112:115], v8 offset:12288
    v_mfma_f32_16x16x32_bf16 v[32:35], a[72:75], a[40:43], v[32:35]
    v_exp_f32 v41, v41
    v_mfma_f32_16x16x32_bf16 v[32:35], a[76:79], a[44:47], v[32:35]
    ds_read_b128 a[116:119], v10 offset:12288
    v_cvt_pk_bf16_f32 v52, v40, v41
    v_mfma_f32_16x16x32_bf16 v[36:39], a[80:83], a[32:35], v[64:67]
    v_exp_f32 v42, v42
    v_mfma_f32_16x16x32_bf16 v[36:39], a[84:87], a[36:39], v[36:39]
    ds_read_b64_tr_b16 a[160:161], v16 offset:24576
    s_waitcnt lgkmcnt(3)
    v_mfma_f32_16x16x32_bf16 v[36:39], a[88:91], a[40:43], v[36:39]
    v_exp_f32 v43, v43
    v_mfma_f32_16x16x32_bf16 v[36:39], a[92:95], a[44:47], v[36:39]
    ds_read_b64_tr_b16 a[162:163], v16 offset:28672
    v_cvt_pk_bf16_f32 v53, v42, v43
    v_mfma_f32_16x16x32_bf16 v[128:131], a[128:131], v[48:51], v[128:131]
    v_exp_f32 v44, v44
    v_mfma_f32_16x16x32_bf16 v[144:147], a[132:135], v[48:51], v[144:147]
    ds_read_b64_tr_b16 a[164:165], v18 offset:24576
    v_mfma_f32_16x16x32_bf16 v[160:163], a[136:139], v[48:51], v[160:163]
    v_exp_f32 v45, v45
    v_mfma_f32_16x16x32_bf16 v[176:179], a[140:143], v[48:51], v[176:179]
    ds_read_b64_tr_b16 a[166:167], v18 offset:28672
    v_cvt_pk_bf16_f32 v54, v44, v45
    v_mfma_f32_16x16x32_bf16 v[192:195], a[144:147], v[48:51], v[192:195]
    v_exp_f32 v46, v46
    v_mfma_f32_16x16x32_bf16 v[208:211], a[148:151], v[48:51], v[208:211]
    buffer_load_dwordx4 v2, s[12:15], s35 offen offset:2048 lds
    v_mfma_f32_16x16x32_bf16 v[224:227], a[152:155], v[48:51], v[224:227]
    v_exp_f32 v47, v47
    v_mfma_f32_16x16x32_bf16 v[240:243], a[156:159], v[48:51], v[240:243]
    v_cvt_pk_bf16_f32 v55, v46, v47
    v_mfma_f32_16x16x32_bf16 v[72:75], v[88:91], v[48:51], v[72:75]
    v_mfma_f32_16x16x32_bf16 v[40:43], a[64:67], a[48:51], v[68:71]
    v_exp_f32 v32, v32
    v_mfma_f32_16x16x32_bf16 v[40:43], a[68:71], a[52:55], v[40:43]
    ds_read_b128 a[120:123], v12 offset:12288
    v_mfma_f32_16x16x32_bf16 v[40:43], a[72:75], a[56:59], v[40:43]
    v_exp_f32 v33, v33
    v_mfma_f32_16x16x32_bf16 v[40:43], a[76:79], a[60:63], v[40:43]
    ds_read_b128 a[124:127], v14 offset:12288
    v_cvt_pk_bf16_f32 v48, v32, v33
    v_mfma_f32_16x16x32_bf16 v[44:47], a[80:83], a[48:51], v[68:71]
    v_exp_f32 v34, v34
    v_mfma_f32_16x16x32_bf16 v[44:47], a[84:87], a[52:55], v[44:47]
    ds_read_b64_tr_b16 a[168:169], v20 offset:24576
    v_add_u32 v121, s41, v120
    v_mfma_f32_16x16x32_bf16 v[44:47], a[88:91], a[56:59], v[44:47]
    v_exp_f32 v35, v35
    v_mfma_f32_16x16x32_bf16 v[44:47], a[92:95], a[60:63], v[44:47]
    ds_read_b64_tr_b16 a[170:171], v20 offset:28672
    v_cvt_pk_bf16_f32 v49, v34, v35
    v_mfma_f32_16x16x32_bf16 v[132:135], a[128:131], v[52:55], v[132:135]
    v_exp_f32 v36, v36
    v_mfma_f32_16x16x32_bf16 v[148:151], a[132:135], v[52:55], v[148:151]
    ds_read_b64_tr_b16 a[172:173], v22 offset:24576
    v_mfma_f32_16x16x32_bf16 v[164:167], a[136:139], v[52:55], v[164:167]
    v_exp_f32 v37, v37
    v_mfma_f32_16x16x32_bf16 v[180:183], a[140:143], v[52:55], v[180:183]
    ds_read_b64_tr_b16 a[174:175], v22 offset:28672
    v_cvt_pk_bf16_f32 v50, v36, v37
    v_mfma_f32_16x16x32_bf16 v[196:199], a[144:147], v[52:55], v[196:199]
    v_exp_f32 v38, v38
    v_mfma_f32_16x16x32_bf16 v[212:215], a[148:151], v[52:55], v[212:215]
    buffer_load_dwordx4 v3, s[12:15], s35 offen offset:3072 lds
    v_mfma_f32_16x16x32_bf16 v[228:231], a[152:155], v[52:55], v[228:231]
    v_exp_f32 v39, v39
    v_mfma_f32_16x16x32_bf16 v[244:247], a[156:159], v[52:55], v[244:247]
    v_cvt_pk_bf16_f32 v51, v38, v39
    buffer_load_dwordx4 v[116:119], v121, s[92:95], 0 offen
    s_add_u32 s35, s35, 16384
    v_mfma_f32_16x16x32_bf16 v[76:79], v[88:91], v[52:55], v[76:79]
    s_waitcnt vmcnt(9) lgkmcnt(4)
    s_barrier
    s_min_u32 s35, s35, 507904
    v_mfma_f32_16x16x32_bf16 v[32:35], a[96:99], a[0:3], v[56:59]
    v_exp_f32 v40, v40
    v_mfma_f32_16x16x32_bf16 v[32:35], a[100:103], a[4:7], v[32:35]
    ds_read_b128 a[64:67], v8 offset:32768
    v_mfma_f32_16x16x32_bf16 v[32:35], a[104:107], a[8:11], v[32:35]
    v_exp_f32 v41, v41
    v_mfma_f32_16x16x32_bf16 v[32:35], a[108:111], a[12:15], v[32:35]
    ds_read_b128 a[68:71], v10 offset:32768
    v_cvt_pk_bf16_f32 v52, v40, v41
    v_mfma_f32_16x16x32_bf16 v[36:39], a[112:115], a[0:3], v[56:59]
    v_exp_f32 v42, v42
    v_mfma_f32_16x16x32_bf16 v[36:39], a[116:119], a[4:7], v[36:39]
    ds_read_b64_tr_b16 a[176:177], v24 offset:24576
    v_mfma_f32_16x16x32_bf16 v[36:39], a[120:123], a[8:11], v[36:39]
    v_exp_f32 v43, v43
    v_mfma_f32_16x16x32_bf16 v[36:39], a[124:127], a[12:15], v[36:39]
    ds_read_b64_tr_b16 a[178:179], v24 offset:28672
    v_cvt_pk_bf16_f32 v53, v42, v43
    v_mfma_f32_16x16x32_bf16 v[136:139], a[128:131], v[48:51], v[136:139]
    v_exp_f32 v44, v44
    v_mfma_f32_16x16x32_bf16 v[152:155], a[132:135], v[48:51], v[152:155]
    ds_read_b64_tr_b16 a[180:181], v26 offset:24576
    s_add_u32 m0, s36, 98304
    v_mfma_f32_16x16x32_bf16 v[168:171], a[136:139], v[48:51], v[168:171]
    v_exp_f32 v45, v45
    v_mfma_f32_16x16x32_bf16 v[184:187], a[140:143], v[48:51], v[184:187]
    ds_read_b64_tr_b16 a[182:183], v26 offset:28672
    v_cvt_pk_bf16_f32 v54, v44, v45
    v_mfma_f32_16x16x32_bf16 v[200:203], a[144:147], v[48:51], v[200:203]
    v_exp_f32 v46, v46
    v_mfma_f32_16x16x32_bf16 v[216:219], a[148:151], v[48:51], v[216:219]
    buffer_load_dwordx4 v124, s[8:11], s35 offen offset:0 lds
    v_mfma_f32_16x16x32_bf16 v[232:235], a[152:155], v[48:51], v[232:235]
    v_exp_f32 v47, v47
    v_mfma_f32_16x16x32_bf16 v[248:251], a[156:159], v[48:51], v[248:251]
    v_cvt_pk_bf16_f32 v55, v46, v47
    v_mfma_f32_16x16x32_bf16 v[80:83], v[88:91], v[48:51], v[80:83]
    v_mfma_f32_16x16x32_bf16 v[40:43], a[96:99], a[16:19], v[60:63]
    v_exp_f32 v32, v32
    v_mfma_f32_16x16x32_bf16 v[40:43], a[100:103], a[20:23], v[40:43]
    ds_read_b128 a[72:75], v12 offset:32768
    v_mfma_f32_16x16x32_bf16 v[40:43], a[104:107], a[24:27], v[40:43]
    v_exp_f32 v33, v33
    v_mfma_f32_16x16x32_bf16 v[40:43], a[108:111], a[28:31], v[40:43]
    ds_read_b128 a[76:79], v14 offset:32768
    v_cvt_pk_bf16_f32 v48, v32, v33
    v_mfma_f32_16x16x32_bf16 v[44:47], a[112:115], a[16:19], v[60:63]
    v_exp_f32 v34, v34
    v_mfma_f32_16x16x32_bf16 v[44:47], a[116:119], a[20:23], v[44:47]
    ds_read_b64_tr_b16 a[184:185], v28 offset:24576
    v_mfma_f32_16x16x32_bf16 v[44:47], a[120:123], a[24:27], v[44:47]
    v_exp_f32 v35, v35
    v_mfma_f32_16x16x32_bf16 v[44:47], a[124:127], a[28:31], v[44:47]
    ds_read_b64_tr_b16 a[186:187], v28 offset:28672
    v_cvt_pk_bf16_f32 v49, v34, v35
    v_mfma_f32_16x16x32_bf16 v[140:143], a[128:131], v[52:55], v[140:143]
    v_exp_f32 v36, v36
    v_mfma_f32_16x16x32_bf16 v[156:159], a[132:135], v[52:55], v[156:159]
    ds_read_b64_tr_b16 a[188:189], v30 offset:24576
    v_mfma_f32_16x16x32_bf16 v[172:175], a[136:139], v[52:55], v[172:175]
    v_exp_f32 v37, v37
    v_mfma_f32_16x16x32_bf16 v[188:191], a[140:143], v[52:55], v[188:191]
    ds_read_b64_tr_b16 a[190:191], v30 offset:28672
    v_cvt_pk_bf16_f32 v50, v36, v37
    v_mfma_f32_16x16x32_bf16 v[204:207], a[144:147], v[52:55], v[204:207]
    v_exp_f32 v38, v38
    v_mfma_f32_16x16x32_bf16 v[220:223], a[148:151], v[52:55], v[220:223]
    buffer_load_dwordx4 v125, s[8:11], s35 offen offset:1024 lds
    v_mfma_f32_16x16x32_bf16 v[236:239], a[152:155], v[52:55], v[236:239]
    v_exp_f32 v39, v39
    v_mfma_f32_16x16x32_bf16 v[252:255], a[156:159], v[52:55], v[252:255]
    v_cvt_pk_bf16_f32 v51, v38, v39
    v_mfma_f32_16x16x32_bf16 v[84:87], v[88:91], v[52:55], v[84:87]
    v_mfma_f32_16x16x32_bf16 v[32:35], a[96:99], a[32:35], v[64:67]
    v_exp_f32 v40, v40
    v_mfma_f32_16x16x32_bf16 v[32:35], a[100:103], a[36:39], v[32:35]
    ds_read_b128 a[80:83], v8 offset:36864
    v_mfma_f32_16x16x32_bf16 v[32:35], a[104:107], a[40:43], v[32:35]
    v_exp_f32 v41, v41
    v_mfma_f32_16x16x32_bf16 v[32:35], a[108:111], a[44:47], v[32:35]
    ds_read_b128 a[84:87], v10 offset:36864
    v_cvt_pk_bf16_f32 v52, v40, v41
    v_mfma_f32_16x16x32_bf16 v[36:39], a[112:115], a[32:35], v[64:67]
    v_exp_f32 v42, v42
    v_mfma_f32_16x16x32_bf16 v[36:39], a[116:119], a[36:39], v[36:39]
    ds_read_b64_tr_b16 a[128:129], v16 offset:49152
    s_waitcnt lgkmcnt(3)
    v_mfma_f32_16x16x32_bf16 v[36:39], a[120:123], a[40:43], v[36:39]
    v_exp_f32 v43, v43
    v_mfma_f32_16x16x32_bf16 v[36:39], a[124:127], a[44:47], v[36:39]
    ds_read_b64_tr_b16 a[130:131], v16 offset:53248
    v_cvt_pk_bf16_f32 v53, v42, v43
    v_mfma_f32_16x16x32_bf16 v[128:131], a[160:163], v[48:51], v[128:131]
    v_exp_f32 v44, v44
    v_mfma_f32_16x16x32_bf16 v[144:147], a[164:167], v[48:51], v[144:147]
    ds_read_b64_tr_b16 a[132:133], v18 offset:49152
    v_mfma_f32_16x16x32_bf16 v[160:163], a[168:171], v[48:51], v[160:163]
    v_exp_f32 v45, v45
    v_mfma_f32_16x16x32_bf16 v[176:179], a[172:175], v[48:51], v[176:179]
    ds_read_b64_tr_b16 a[134:135], v18 offset:53248
    v_cvt_pk_bf16_f32 v54, v44, v45
    v_mfma_f32_16x16x32_bf16 v[192:195], a[176:179], v[48:51], v[192:195]
    v_exp_f32 v46, v46
    v_mfma_f32_16x16x32_bf16 v[208:211], a[180:183], v[48:51], v[208:211]
    buffer_load_dwordx4 v126, s[8:11], s35 offen offset:2048 lds
    v_mfma_f32_16x16x32_bf16 v[224:227], a[184:187], v[48:51], v[224:227]
    v_exp_f32 v47, v47
    v_mfma_f32_16x16x32_bf16 v[240:243], a[188:191], v[48:51], v[240:243]
    v_cvt_pk_bf16_f32 v55, v46, v47
    v_mfma_f32_16x16x32_bf16 v[72:75], v[88:91], v[48:51], v[72:75]
    v_mfma_f32_16x16x32_bf16 v[40:43], a[96:99], a[48:51], v[68:71]
    v_exp_f32 v32, v32
    v_mfma_f32_16x16x32_bf16 v[40:43], a[100:103], a[52:55], v[40:43]
    ds_read_b128 a[88:91], v12 offset:36864
    v_mfma_f32_16x16x32_bf16 v[40:43], a[104:107], a[56:59], v[40:43]
    v_exp_f32 v33, v33
    v_mfma_f32_16x16x32_bf16 v[40:43], a[108:111], a[60:63], v[40:43]
    ds_read_b128 a[92:95], v14 offset:36864
    v_cvt_pk_bf16_f32 v48, v32, v33
    v_mfma_f32_16x16x32_bf16 v[44:47], a[112:115], a[48:51], v[68:71]
    v_exp_f32 v34, v34
    v_mfma_f32_16x16x32_bf16 v[44:47], a[116:119], a[52:55], v[44:47]
    ds_read_b64_tr_b16 a[136:137], v20 offset:49152
    v_mfma_f32_16x16x32_bf16 v[44:47], a[120:123], a[56:59], v[44:47]
    v_exp_f32 v35, v35
    v_mfma_f32_16x16x32_bf16 v[44:47], a[124:127], a[60:63], v[44:47]
    ds_read_b64_tr_b16 a[138:139], v20 offset:53248
    v_cvt_pk_bf16_f32 v49, v34, v35
    v_mfma_f32_16x16x32_bf16 v[132:135], a[160:163], v[52:55], v[132:135]
    v_exp_f32 v36, v36
    v_mfma_f32_16x16x32_bf16 v[148:151], a[164:167], v[52:55], v[148:151]
    ds_read_b64_tr_b16 a[140:141], v22 offset:49152
    v_mfma_f32_16x16x32_bf16 v[164:167], a[168:171], v[52:55], v[164:167]
    v_exp_f32 v37, v37
    v_mfma_f32_16x16x32_bf16 v[180:183], a[172:175], v[52:55], v[180:183]
    ds_read_b64_tr_b16 a[142:143], v22 offset:53248
    v_cvt_pk_bf16_f32 v50, v36, v37
    v_mfma_f32_16x16x32_bf16 v[196:199], a[176:179], v[52:55], v[196:199]
    v_exp_f32 v38, v38
    v_mfma_f32_16x16x32_bf16 v[212:215], a[180:183], v[52:55], v[212:215]
    buffer_load_dwordx4 v127, s[8:11], s35 offen offset:3072 lds
    v_mfma_f32_16x16x32_bf16 v[228:231], a[184:187], v[52:55], v[228:231]
    v_exp_f32 v39, v39
    v_mfma_f32_16x16x32_bf16 v[244:247], a[188:191], v[52:55], v[244:247]
    v_cvt_pk_bf16_f32 v51, v38, v39
    v_mfma_f32_16x16x32_bf16 v[76:79], v[88:91], v[52:55], v[76:79]
    s_waitcnt lgkmcnt(4)
    v_mfma_f32_16x16x32_bf16 v[32:35], a[64:67], a[0:3], v[56:59]
    v_exp_f32 v40, v40
    v_mfma_f32_16x16x32_bf16 v[32:35], a[68:71], a[4:7], v[32:35]
    ds_read_b128 a[96:99], v8 offset:40960
    v_mfma_f32_16x16x32_bf16 v[32:35], a[72:75], a[8:11], v[32:35]
    v_exp_f32 v41, v41
    v_mfma_f32_16x16x32_bf16 v[32:35], a[76:79], a[12:15], v[32:35]
    ds_read_b128 a[100:103], v10 offset:40960
    v_cvt_pk_bf16_f32 v52, v40, v41
    v_mfma_f32_16x16x32_bf16 v[36:39], a[80:83], a[0:3], v[56:59]
    v_exp_f32 v42, v42
    v_mfma_f32_16x16x32_bf16 v[36:39], a[84:87], a[4:7], v[36:39]
    ds_read_b64_tr_b16 a[144:145], v24 offset:49152
    v_mfma_f32_16x16x32_bf16 v[36:39], a[88:91], a[8:11], v[36:39]
    v_exp_f32 v43, v43
    v_mfma_f32_16x16x32_bf16 v[36:39], a[92:95], a[12:15], v[36:39]
    ds_read_b64_tr_b16 a[146:147], v24 offset:53248
    v_cvt_pk_bf16_f32 v53, v42, v43
    v_mfma_f32_16x16x32_bf16 v[136:139], a[160:163], v[48:51], v[136:139]
    v_exp_f32 v44, v44
    v_mfma_f32_16x16x32_bf16 v[152:155], a[164:167], v[48:51], v[152:155]
    ds_read_b64_tr_b16 a[148:149], v26 offset:49152
    s_add_u32 m0, s36, 114688
    v_mfma_f32_16x16x32_bf16 v[168:171], a[168:171], v[48:51], v[168:171]
    v_exp_f32 v45, v45
    v_mfma_f32_16x16x32_bf16 v[184:187], a[172:175], v[48:51], v[184:187]
    ds_read_b64_tr_b16 a[150:151], v26 offset:53248
    v_cvt_pk_bf16_f32 v54, v44, v45
    v_mfma_f32_16x16x32_bf16 v[200:203], a[176:179], v[48:51], v[200:203]
    v_exp_f32 v46, v46
    v_mfma_f32_16x16x32_bf16 v[216:219], a[180:183], v[48:51], v[216:219]
    buffer_load_dwordx4 v2, s[12:15], s35 offen offset:0 lds
    v_mfma_f32_16x16x32_bf16 v[232:235], a[184:187], v[48:51], v[232:235]
    v_exp_f32 v47, v47
    v_mfma_f32_16x16x32_bf16 v[248:251], a[188:191], v[48:51], v[248:251]
    v_cvt_pk_bf16_f32 v55, v46, v47
    v_mfma_f32_16x16x32_bf16 v[80:83], v[88:91], v[48:51], v[80:83]
    v_mfma_f32_16x16x32_bf16 v[40:43], a[64:67], a[16:19], v[60:63]
    v_exp_f32 v32, v32
    v_mfma_f32_16x16x32_bf16 v[40:43], a[68:71], a[20:23], v[40:43]
    ds_read_b128 a[104:107], v12 offset:40960
    v_mfma_f32_16x16x32_bf16 v[40:43], a[72:75], a[24:27], v[40:43]
    v_exp_f32 v33, v33
    v_mfma_f32_16x16x32_bf16 v[40:43], a[76:79], a[28:31], v[40:43]
    ds_read_b128 a[108:111], v14 offset:40960
    v_cvt_pk_bf16_f32 v48, v32, v33
    v_mfma_f32_16x16x32_bf16 v[44:47], a[80:83], a[16:19], v[60:63]
    v_exp_f32 v34, v34
    v_mfma_f32_16x16x32_bf16 v[44:47], a[84:87], a[20:23], v[44:47]
    ds_read_b64_tr_b16 a[152:153], v28 offset:49152
    v_mfma_f32_16x16x32_bf16 v[44:47], a[88:91], a[24:27], v[44:47]
    v_exp_f32 v35, v35
    v_mfma_f32_16x16x32_bf16 v[44:47], a[92:95], a[28:31], v[44:47]
    ds_read_b64_tr_b16 a[154:155], v28 offset:53248
    v_cvt_pk_bf16_f32 v49, v34, v35
    v_mfma_f32_16x16x32_bf16 v[140:143], a[160:163], v[52:55], v[140:143]
    v_exp_f32 v36, v36
    v_mfma_f32_16x16x32_bf16 v[156:159], a[164:167], v[52:55], v[156:159]
    ds_read_b64_tr_b16 a[156:157], v30 offset:49152
    v_mfma_f32_16x16x32_bf16 v[172:175], a[168:171], v[52:55], v[172:175]
    v_exp_f32 v37, v37
    v_mfma_f32_16x16x32_bf16 v[188:191], a[172:175], v[52:55], v[188:191]
    ds_read_b64_tr_b16 a[158:159], v30 offset:53248
    v_cvt_pk_bf16_f32 v50, v36, v37
    v_mfma_f32_16x16x32_bf16 v[204:207], a[176:179], v[52:55], v[204:207]
    v_exp_f32 v38, v38
    v_mfma_f32_16x16x32_bf16 v[220:223], a[180:183], v[52:55], v[220:223]
    buffer_load_dwordx4 v3, s[12:15], s35 offen offset:1024 lds
    v_mfma_f32_16x16x32_bf16 v[236:239], a[184:187], v[52:55], v[236:239]
    v_exp_f32 v39, v39
    v_mfma_f32_16x16x32_bf16 v[252:255], a[188:191], v[52:55], v[252:255]
    v_cvt_pk_bf16_f32 v51, v38, v39
    v_mfma_f32_16x16x32_bf16 v[84:87], v[88:91], v[52:55], v[84:87]
    v_mfma_f32_16x16x32_bf16 v[32:35], a[64:67], a[32:35], v[64:67]
    v_exp_f32 v40, v40
    v_mfma_f32_16x16x32_bf16 v[32:35], a[68:71], a[36:39], v[32:35]
    ds_read_b128 a[112:115], v8 offset:45056
    v_mfma_f32_16x16x32_bf16 v[32:35], a[72:75], a[40:43], v[32:35]
    v_exp_f32 v41, v41
    v_mfma_f32_16x16x32_bf16 v[32:35], a[76:79], a[44:47], v[32:35]
    ds_read_b128 a[116:119], v10 offset:45056
    v_cvt_pk_bf16_f32 v52, v40, v41
    v_mfma_f32_16x16x32_bf16 v[36:39], a[80:83], a[32:35], v[64:67]
    v_exp_f32 v42, v42
    v_mfma_f32_16x16x32_bf16 v[36:39], a[84:87], a[36:39], v[36:39]
    ds_read_b64_tr_b16 a[160:161], v16 offset:57344
    s_waitcnt lgkmcnt(3)
    v_mfma_f32_16x16x32_bf16 v[36:39], a[88:91], a[40:43], v[36:39]
    v_exp_f32 v43, v43
    v_mfma_f32_16x16x32_bf16 v[36:39], a[92:95], a[44:47], v[36:39]
    ds_read_b64_tr_b16 a[162:163], v16 offset:61440
    v_cvt_pk_bf16_f32 v53, v42, v43
    v_mfma_f32_16x16x32_bf16 v[128:131], a[128:131], v[48:51], v[128:131]
    v_exp_f32 v44, v44
    v_mfma_f32_16x16x32_bf16 v[144:147], a[132:135], v[48:51], v[144:147]
    ds_read_b64_tr_b16 a[164:165], v18 offset:57344
    v_mfma_f32_16x16x32_bf16 v[160:163], a[136:139], v[48:51], v[160:163]
    v_exp_f32 v45, v45
    v_mfma_f32_16x16x32_bf16 v[176:179], a[140:143], v[48:51], v[176:179]
    ds_read_b64_tr_b16 a[166:167], v18 offset:61440
    v_cvt_pk_bf16_f32 v54, v44, v45
    v_mfma_f32_16x16x32_bf16 v[192:195], a[144:147], v[48:51], v[192:195]
    v_exp_f32 v46, v46
    v_mfma_f32_16x16x32_bf16 v[208:211], a[148:151], v[48:51], v[208:211]
    buffer_load_dwordx4 v2, s[12:15], s35 offen offset:2048 lds
    v_mfma_f32_16x16x32_bf16 v[224:227], a[152:155], v[48:51], v[224:227]
    v_exp_f32 v47, v47
    v_mfma_f32_16x16x32_bf16 v[240:243], a[156:159], v[48:51], v[240:243]
    v_cvt_pk_bf16_f32 v55, v46, v47
    v_mfma_f32_16x16x32_bf16 v[72:75], v[88:91], v[48:51], v[72:75]
    v_mfma_f32_16x16x32_bf16 v[40:43], a[64:67], a[48:51], v[68:71]
    v_exp_f32 v32, v32
    v_mfma_f32_16x16x32_bf16 v[40:43], a[68:71], a[52:55], v[40:43]
    ds_read_b128 a[120:123], v12 offset:45056
    v_mfma_f32_16x16x32_bf16 v[40:43], a[72:75], a[56:59], v[40:43]
    v_exp_f32 v33, v33
    v_mfma_f32_16x16x32_bf16 v[40:43], a[76:79], a[60:63], v[40:43]
    ds_read_b128 a[124:127], v14 offset:45056
    v_cvt_pk_bf16_f32 v48, v32, v33
    v_mfma_f32_16x16x32_bf16 v[44:47], a[80:83], a[48:51], v[68:71]
    v_exp_f32 v34, v34
    v_mfma_f32_16x16x32_bf16 v[44:47], a[84:87], a[52:55], v[44:47]
    ds_read_b64_tr_b16 a[168:169], v20 offset:57344
    v_mfma_f32_16x16x32_bf16 v[44:47], a[88:91], a[56:59], v[44:47]
    v_exp_f32 v35, v35
    v_mfma_f32_16x16x32_bf16 v[44:47], a[92:95], a[60:63], v[44:47]
    ds_read_b64_tr_b16 a[170:171], v20 offset:61440
    v_cvt_pk_bf16_f32 v49, v34, v35
    v_mfma_f32_16x16x32_bf16 v[132:135], a[128:131], v[52:55], v[132:135]
    v_exp_f32 v36, v36
    v_mfma_f32_16x16x32_bf16 v[148:151], a[132:135], v[52:55], v[148:151]
    ds_read_b64_tr_b16 a[172:173], v22 offset:57344
    v_mfma_f32_16x16x32_bf16 v[164:167], a[136:139], v[52:55], v[164:167]
    v_exp_f32 v37, v37
    v_mfma_f32_16x16x32_bf16 v[180:183], a[140:143], v[52:55], v[180:183]
    ds_read_b64_tr_b16 a[174:175], v22 offset:61440
    v_cvt_pk_bf16_f32 v50, v36, v37
    v_mfma_f32_16x16x32_bf16 v[196:199], a[144:147], v[52:55], v[196:199]
    v_exp_f32 v38, v38
    v_mfma_f32_16x16x32_bf16 v[212:215], a[148:151], v[52:55], v[212:215]
    buffer_load_dwordx4 v3, s[12:15], s35 offen offset:3072 lds
    v_mfma_f32_16x16x32_bf16 v[228:231], a[152:155], v[52:55], v[228:231]
    v_exp_f32 v39, v39
    v_mfma_f32_16x16x32_bf16 v[244:247], a[156:159], v[52:55], v[244:247]
    v_cvt_pk_bf16_f32 v51, v38, v39
    s_add_u32 s35, s35, 16384
    v_mfma_f32_16x16x32_bf16 v[76:79], v[88:91], v[52:55], v[76:79]
    s_waitcnt vmcnt(9) lgkmcnt(4)
    s_barrier
    s_min_u32 s35, s35, 507904
    v_mfma_f32_16x16x32_bf16 v[32:35], a[96:99], a[0:3], v[56:59]
    v_exp_f32 v40, v40
    v_mfma_f32_16x16x32_bf16 v[32:35], a[100:103], a[4:7], v[32:35]
    ds_read_b128 a[64:67], v9 offset:0
    v_mfma_f32_16x16x32_bf16 v[32:35], a[104:107], a[8:11], v[32:35]
    v_exp_f32 v41, v41
    v_mfma_f32_16x16x32_bf16 v[32:35], a[108:111], a[12:15], v[32:35]
    ds_read_b128 a[68:71], v11 offset:0
    v_cvt_pk_bf16_f32 v52, v40, v41
    v_mfma_f32_16x16x32_bf16 v[36:39], a[112:115], a[0:3], v[56:59]
    v_exp_f32 v42, v42
    v_mfma_f32_16x16x32_bf16 v[36:39], a[116:119], a[4:7], v[36:39]
    ds_read_b64_tr_b16 a[176:177], v24 offset:57344
    v_mfma_f32_16x16x32_bf16 v[36:39], a[120:123], a[8:11], v[36:39]
    v_exp_f32 v43, v43
    v_mfma_f32_16x16x32_bf16 v[36:39], a[124:127], a[12:15], v[36:39]
    ds_read_b64_tr_b16 a[178:179], v24 offset:61440
    v_cvt_pk_bf16_f32 v53, v42, v43
    v_mfma_f32_16x16x32_bf16 v[136:139], a[128:131], v[48:51], v[136:139]
    v_exp_f32 v44, v44
    v_mfma_f32_16x16x32_bf16 v[152:155], a[132:135], v[48:51], v[152:155]
    ds_read_b64_tr_b16 a[180:181], v26 offset:57344
    s_add_u32 m0, s36, 0
    v_mfma_f32_16x16x32_bf16 v[168:171], a[136:139], v[48:51], v[168:171]
    v_exp_f32 v45, v45
    v_mfma_f32_16x16x32_bf16 v[184:187], a[140:143], v[48:51], v[184:187]
    ds_read_b64_tr_b16 a[182:183], v26 offset:61440
    v_cvt_pk_bf16_f32 v54, v44, v45
    v_mfma_f32_16x16x32_bf16 v[200:203], a[144:147], v[48:51], v[200:203]
    v_exp_f32 v46, v46
    v_mfma_f32_16x16x32_bf16 v[216:219], a[148:151], v[48:51], v[216:219]
    buffer_load_dwordx4 v124, s[8:11], s35 offen offset:0 lds
    v_mfma_f32_16x16x32_bf16 v[232:235], a[152:155], v[48:51], v[232:235]
    v_exp_f32 v47, v47
    v_mfma_f32_16x16x32_bf16 v[248:251], a[156:159], v[48:51], v[248:251]
    v_cvt_pk_bf16_f32 v55, v46, v47
    v_mfma_f32_16x16x32_bf16 v[80:83], v[88:91], v[48:51], v[80:83]
    v_mfma_f32_16x16x32_bf16 v[40:43], a[96:99], a[16:19], v[60:63]
    v_exp_f32 v32, v32
    v_mfma_f32_16x16x32_bf16 v[40:43], a[100:103], a[20:23], v[40:43]
    ds_read_b128 a[72:75], v13 offset:0
    v_mfma_f32_16x16x32_bf16 v[40:43], a[104:107], a[24:27], v[40:43]
    v_exp_f32 v33, v33
    v_mfma_f32_16x16x32_bf16 v[40:43], a[108:111], a[28:31], v[40:43]
    ds_read_b128 a[76:79], v15 offset:0
    v_cvt_pk_bf16_f32 v48, v32, v33
    v_mfma_f32_16x16x32_bf16 v[44:47], a[112:115], a[16:19], v[60:63]
    v_exp_f32 v34, v34
    v_mfma_f32_16x16x32_bf16 v[44:47], a[116:119], a[20:23], v[44:47]
    ds_read_b64_tr_b16 a[184:185], v28 offset:57344
    v_mfma_f32_16x16x32_bf16 v[44:47], a[120:123], a[24:27], v[44:47]
    v_exp_f32 v35, v35
    v_mfma_f32_16x16x32_bf16 v[44:47], a[124:127], a[28:31], v[44:47]
    ds_read_b64_tr_b16 a[186:187], v28 offset:61440
    v_cvt_pk_bf16_f32 v49, v34, v35
    v_mfma_f32_16x16x32_bf16 v[140:143], a[128:131], v[52:55], v[140:143]
    v_exp_f32 v36, v36
    v_mfma_f32_16x16x32_bf16 v[156:159], a[132:135], v[52:55], v[156:159]
    ds_read_b64_tr_b16 a[188:189], v30 offset:57344
    v_mfma_f32_16x16x32_bf16 v[172:175], a[136:139], v[52:55], v[172:175]
    v_exp_f32 v37, v37
    v_mfma_f32_16x16x32_bf16 v[188:191], a[140:143], v[52:55], v[188:191]
    ds_read_b64_tr_b16 a[190:191], v30 offset:61440
    v_cvt_pk_bf16_f32 v50, v36, v37
    v_mfma_f32_16x16x32_bf16 v[204:207], a[144:147], v[52:55], v[204:207]
    v_exp_f32 v38, v38
    v_mfma_f32_16x16x32_bf16 v[220:223], a[148:151], v[52:55], v[220:223]
    buffer_load_dwordx4 v125, s[8:11], s35 offen offset:1024 lds
    v_mfma_f32_16x16x32_bf16 v[236:239], a[152:155], v[52:55], v[236:239]
    v_exp_f32 v39, v39
    v_mfma_f32_16x16x32_bf16 v[252:255], a[156:159], v[52:55], v[252:255]
    v_cvt_pk_bf16_f32 v51, v38, v39
    v_mfma_f32_16x16x32_bf16 v[84:87], v[88:91], v[52:55], v[84:87]
    v_mfma_f32_16x16x32_bf16 v[32:35], a[96:99], a[32:35], v[64:67]
    v_exp_f32 v40, v40
    v_mfma_f32_16x16x32_bf16 v[32:35], a[100:103], a[36:39], v[32:35]
    ds_read_b128 a[80:83], v9 offset:4096
    v_mfma_f32_16x16x32_bf16 v[32:35], a[104:107], a[40:43], v[32:35]
    v_exp_f32 v41, v41
    v_mfma_f32_16x16x32_bf16 v[32:35], a[108:111], a[44:47], v[32:35]
    ds_read_b128 a[84:87], v11 offset:4096
    v_cvt_pk_bf16_f32 v52, v40, v41
    v_mfma_f32_16x16x32_bf16 v[36:39], a[112:115], a[32:35], v[64:67]
    v_exp_f32 v42, v42
    v_mfma_f32_16x16x32_bf16 v[36:39], a[116:119], a[36:39], v[36:39]
    ds_read_b64_tr_b16 a[128:129], v17 offset:16384
    s_waitcnt lgkmcnt(3)
    v_mfma_f32_16x16x32_bf16 v[36:39], a[120:123], a[40:43], v[36:39]
    v_exp_f32 v43, v43
    v_mfma_f32_16x16x32_bf16 v[36:39], a[124:127], a[44:47], v[36:39]
    ds_read_b64_tr_b16 a[130:131], v17 offset:20480
    v_cvt_pk_bf16_f32 v53, v42, v43
    v_mfma_f32_16x16x32_bf16 v[128:131], a[160:163], v[48:51], v[128:131]
    v_exp_f32 v44, v44
    v_mfma_f32_16x16x32_bf16 v[144:147], a[164:167], v[48:51], v[144:147]
    ds_read_b64_tr_b16 a[132:133], v19 offset:16384
    v_mfma_f32_16x16x32_bf16 v[160:163], a[168:171], v[48:51], v[160:163]
    v_exp_f32 v45, v45
    v_mfma_f32_16x16x32_bf16 v[176:179], a[172:175], v[48:51], v[176:179]
    ds_read_b64_tr_b16 a[134:135], v19 offset:20480
    v_cvt_pk_bf16_f32 v54, v44, v45
    v_mfma_f32_16x16x32_bf16 v[192:195], a[176:179], v[48:51], v[192:195]
    v_exp_f32 v46, v46
    v_mfma_f32_16x16x32_bf16 v[208:211], a[180:183], v[48:51], v[208:211]
    buffer_load_dwordx4 v126, s[8:11], s35 offen offset:2048 lds
    v_mfma_f32_16x16x32_bf16 v[224:227], a[184:187], v[48:51], v[224:227]
    v_exp_f32 v47, v47
    v_mfma_f32_16x16x32_bf16 v[240:243], a[188:191], v[48:51], v[240:243]
    v_cvt_pk_bf16_f32 v55, v46, v47
    v_mfma_f32_16x16x32_bf16 v[72:75], v[88:91], v[48:51], v[72:75]
    v_mfma_f32_16x16x32_bf16 v[40:43], a[96:99], a[48:51], v[68:71]
    v_exp_f32 v32, v32
    v_mfma_f32_16x16x32_bf16 v[40:43], a[100:103], a[52:55], v[40:43]
    ds_read_b128 a[88:91], v13 offset:4096
    v_mfma_f32_16x16x32_bf16 v[40:43], a[104:107], a[56:59], v[40:43]
    v_exp_f32 v33, v33
    v_mfma_f32_16x16x32_bf16 v[40:43], a[108:111], a[60:63], v[40:43]
    ds_read_b128 a[92:95], v15 offset:4096
    v_cvt_pk_bf16_f32 v48, v32, v33
    v_mfma_f32_16x16x32_bf16 v[44:47], a[112:115], a[48:51], v[68:71]
    v_exp_f32 v34, v34
    v_mfma_f32_16x16x32_bf16 v[44:47], a[116:119], a[52:55], v[44:47]
    ds_read_b64_tr_b16 a[136:137], v21 offset:16384
    v_mfma_f32_16x16x32_bf16 v[44:47], a[120:123], a[56:59], v[44:47]
    v_exp_f32 v35, v35
    v_mfma_f32_16x16x32_bf16 v[44:47], a[124:127], a[60:63], v[44:47]
    ds_read_b64_tr_b16 a[138:139], v21 offset:20480
    v_cvt_pk_bf16_f32 v49, v34, v35
    v_mfma_f32_16x16x32_bf16 v[132:135], a[160:163], v[52:55], v[132:135]
    v_exp_f32 v36, v36
    v_mfma_f32_16x16x32_bf16 v[148:151], a[164:167], v[52:55], v[148:151]
    ds_read_b64_tr_b16 a[140:141], v23 offset:16384
    v_mfma_f32_16x16x32_bf16 v[164:167], a[168:171], v[52:55], v[164:167]
    v_exp_f32 v37, v37
    v_mfma_f32_16x16x32_bf16 v[180:183], a[172:175], v[52:55], v[180:183]
    ds_read_b64_tr_b16 a[142:143], v23 offset:20480
    v_cvt_pk_bf16_f32 v50, v36, v37
    v_mfma_f32_16x16x32_bf16 v[196:199], a[176:179], v[52:55], v[196:199]
    v_exp_f32 v38, v38
    v_mfma_f32_16x16x32_bf16 v[212:215], a[180:183], v[52:55], v[212:215]
    buffer_load_dwordx4 v127, s[8:11], s35 offen offset:3072 lds
    v_mfma_f32_16x16x32_bf16 v[228:231], a[184:187], v[52:55], v[228:231]
    v_exp_f32 v39, v39
    v_mfma_f32_16x16x32_bf16 v[244:247], a[188:191], v[52:55], v[244:247]
    v_cvt_pk_bf16_f32 v51, v38, v39
    v_mfma_f32_16x16x32_bf16 v[76:79], v[88:91], v[52:55], v[76:79]
    s_waitcnt lgkmcnt(4)
    v_mfma_f32_16x16x32_bf16 v[32:35], a[64:67], a[0:3], v[56:59]
    v_exp_f32 v40, v40
    v_mfma_f32_16x16x32_bf16 v[32:35], a[68:71], a[4:7], v[32:35]
    ds_read_b128 a[96:99], v9 offset:8192
    v_mfma_f32_16x16x32_bf16 v[32:35], a[72:75], a[8:11], v[32:35]
    v_exp_f32 v41, v41
    v_mfma_f32_16x16x32_bf16 v[32:35], a[76:79], a[12:15], v[32:35]
    ds_read_b128 a[100:103], v11 offset:8192
    v_cvt_pk_bf16_f32 v52, v40, v41
    v_mfma_f32_16x16x32_bf16 v[36:39], a[80:83], a[0:3], v[56:59]
    v_exp_f32 v42, v42
    v_mfma_f32_16x16x32_bf16 v[36:39], a[84:87], a[4:7], v[36:39]
    ds_read_b64_tr_b16 a[144:145], v25 offset:16384
    v_mfma_f32_16x16x32_bf16 v[36:39], a[88:91], a[8:11], v[36:39]
    v_exp_f32 v43, v43
    v_mfma_f32_16x16x32_bf16 v[36:39], a[92:95], a[12:15], v[36:39]
    ds_read_b64_tr_b16 a[146:147], v25 offset:20480
    v_cvt_pk_bf16_f32 v53, v42, v43
    v_mfma_f32_16x16x32_bf16 v[136:139], a[160:163], v[48:51], v[136:139]
    v_exp_f32 v44, v44
    v_mfma_f32_16x16x32_bf16 v[152:155], a[164:167], v[48:51], v[152:155]
    ds_read_b64_tr_b16 a[148:149], v27 offset:16384
    s_add_u32 m0, s36, 16384
    v_mfma_f32_16x16x32_bf16 v[168:171], a[168:171], v[48:51], v[168:171]
    v_exp_f32 v45, v45
    v_mfma_f32_16x16x32_bf16 v[184:187], a[172:175], v[48:51], v[184:187]
    ds_read_b64_tr_b16 a[150:151], v27 offset:20480
    v_cvt_pk_bf16_f32 v54, v44, v45
    v_mfma_f32_16x16x32_bf16 v[200:203], a[176:179], v[48:51], v[200:203]
    v_exp_f32 v46, v46
    v_mfma_f32_16x16x32_bf16 v[216:219], a[180:183], v[48:51], v[216:219]
    buffer_load_dwordx4 v2, s[12:15], s35 offen offset:0 lds
    v_mfma_f32_16x16x32_bf16 v[232:235], a[184:187], v[48:51], v[232:235]
    v_exp_f32 v47, v47
    v_mfma_f32_16x16x32_bf16 v[248:251], a[188:191], v[48:51], v[248:251]
    v_cvt_pk_bf16_f32 v55, v46, v47
    v_mfma_f32_16x16x32_bf16 v[80:83], v[88:91], v[48:51], v[80:83]
    v_mfma_f32_16x16x32_bf16 v[40:43], a[64:67], a[16:19], v[60:63]
    v_exp_f32 v32, v32
    v_mfma_f32_16x16x32_bf16 v[40:43], a[68:71], a[20:23], v[40:43]
    ds_read_b128 a[104:107], v13 offset:8192
    v_mfma_f32_16x16x32_bf16 v[40:43], a[72:75], a[24:27], v[40:43]
    v_exp_f32 v33, v33
    v_mfma_f32_16x16x32_bf16 v[40:43], a[76:79], a[28:31], v[40:43]
    ds_read_b128 a[108:111], v15 offset:8192
    v_cvt_pk_bf16_f32 v48, v32, v33
    v_mfma_f32_16x16x32_bf16 v[44:47], a[80:83], a[16:19], v[60:63]
    v_exp_f32 v34, v34
    v_mfma_f32_16x16x32_bf16 v[44:47], a[84:87], a[20:23], v[44:47]
    ds_read_b64_tr_b16 a[152:153], v29 offset:16384
    v_mfma_f32_16x16x32_bf16 v[44:47], a[88:91], a[24:27], v[44:47]
    v_exp_f32 v35, v35
    v_mfma_f32_16x16x32_bf16 v[44:47], a[92:95], a[28:31], v[44:47]
    ds_read_b64_tr_b16 a[154:155], v29 offset:20480
    v_cvt_pk_bf16_f32 v49, v34, v35
    v_mfma_f32_16x16x32_bf16 v[140:143], a[160:163], v[52:55], v[140:143]
    v_exp_f32 v36, v36
    v_mfma_f32_16x16x32_bf16 v[156:159], a[164:167], v[52:55], v[156:159]
    ds_read_b64_tr_b16 a[156:157], v31 offset:16384
    v_mfma_f32_16x16x32_bf16 v[172:175], a[168:171], v[52:55], v[172:175]
    v_exp_f32 v37, v37
    v_mfma_f32_16x16x32_bf16 v[188:191], a[172:175], v[52:55], v[188:191]
    ds_read_b64_tr_b16 a[158:159], v31 offset:20480
    v_cvt_pk_bf16_f32 v50, v36, v37
    v_mfma_f32_16x16x32_bf16 v[204:207], a[176:179], v[52:55], v[204:207]
    v_exp_f32 v38, v38
    v_mfma_f32_16x16x32_bf16 v[220:223], a[180:183], v[52:55], v[220:223]
    buffer_load_dwordx4 v3, s[12:15], s35 offen offset:1024 lds
    v_mfma_f32_16x16x32_bf16 v[236:239], a[184:187], v[52:55], v[236:239]
    v_exp_f32 v39, v39
    v_mfma_f32_16x16x32_bf16 v[252:255], a[188:191], v[52:55], v[252:255]
    v_cvt_pk_bf16_f32 v51, v38, v39
    v_mfma_f32_16x16x32_bf16 v[84:87], v[88:91], v[52:55], v[84:87]
    v_mfma_f32_16x16x32_bf16 v[32:35], a[64:67], a[32:35], v[64:67]
    v_exp_f32 v40, v40
    v_mfma_f32_16x16x32_bf16 v[32:35], a[68:71], a[36:39], v[32:35]
    ds_read_b128 a[112:115], v9 offset:12288
    v_mfma_f32_16x16x32_bf16 v[32:35], a[72:75], a[40:43], v[32:35]
    v_exp_f32 v41, v41
    v_mfma_f32_16x16x32_bf16 v[32:35], a[76:79], a[44:47], v[32:35]
    ds_read_b128 a[116:119], v11 offset:12288
    v_cvt_pk_bf16_f32 v52, v40, v41
    v_mfma_f32_16x16x32_bf16 v[36:39], a[80:83], a[32:35], v[64:67]
    v_exp_f32 v42, v42
    v_mfma_f32_16x16x32_bf16 v[36:39], a[84:87], a[36:39], v[36:39]
    ds_read_b64_tr_b16 a[160:161], v17 offset:24576
    s_waitcnt lgkmcnt(3)
    v_mfma_f32_16x16x32_bf16 v[36:39], a[88:91], a[40:43], v[36:39]
    v_exp_f32 v43, v43
    v_mfma_f32_16x16x32_bf16 v[36:39], a[92:95], a[44:47], v[36:39]
    ds_read_b64_tr_b16 a[162:163], v17 offset:28672
    v_cvt_pk_bf16_f32 v53, v42, v43
    v_mfma_f32_16x16x32_bf16 v[128:131], a[128:131], v[48:51], v[128:131]
    v_exp_f32 v44, v44
    v_mfma_f32_16x16x32_bf16 v[144:147], a[132:135], v[48:51], v[144:147]
    ds_read_b64_tr_b16 a[164:165], v19 offset:24576
    v_mfma_f32_16x16x32_bf16 v[160:163], a[136:139], v[48:51], v[160:163]
    v_exp_f32 v45, v45
    v_mfma_f32_16x16x32_bf16 v[176:179], a[140:143], v[48:51], v[176:179]
    ds_read_b64_tr_b16 a[166:167], v19 offset:28672
    v_cvt_pk_bf16_f32 v54, v44, v45
    v_mfma_f32_16x16x32_bf16 v[192:195], a[144:147], v[48:51], v[192:195]
    v_exp_f32 v46, v46
    v_mfma_f32_16x16x32_bf16 v[208:211], a[148:151], v[48:51], v[208:211]
    buffer_load_dwordx4 v2, s[12:15], s35 offen offset:2048 lds
    v_mfma_f32_16x16x32_bf16 v[224:227], a[152:155], v[48:51], v[224:227]
    v_exp_f32 v47, v47
    v_mfma_f32_16x16x32_bf16 v[240:243], a[156:159], v[48:51], v[240:243]
    v_cvt_pk_bf16_f32 v55, v46, v47
    v_mfma_f32_16x16x32_bf16 v[72:75], v[88:91], v[48:51], v[72:75]
    v_mfma_f32_16x16x32_bf16 v[40:43], a[64:67], a[48:51], v[68:71]
    v_exp_f32 v32, v32
    v_mfma_f32_16x16x32_bf16 v[40:43], a[68:71], a[52:55], v[40:43]
    ds_read_b128 a[120:123], v13 offset:12288
    v_mfma_f32_16x16x32_bf16 v[40:43], a[72:75], a[56:59], v[40:43]
    v_exp_f32 v33, v33
    v_mfma_f32_16x16x32_bf16 v[40:43], a[76:79], a[60:63], v[40:43]
    ds_read_b128 a[124:127], v15 offset:12288
    v_cvt_pk_bf16_f32 v48, v32, v33
    v_mfma_f32_16x16x32_bf16 v[44:47], a[80:83], a[48:51], v[68:71]
    v_exp_f32 v34, v34
    v_mfma_f32_16x16x32_bf16 v[44:47], a[84:87], a[52:55], v[44:47]
    ds_read_b64_tr_b16 a[168:169], v21 offset:24576
    v_mfma_f32_16x16x32_bf16 v[44:47], a[88:91], a[56:59], v[44:47]
    v_exp_f32 v35, v35
    v_mfma_f32_16x16x32_bf16 v[44:47], a[92:95], a[60:63], v[44:47]
    ds_read_b64_tr_b16 a[170:171], v21 offset:28672
    v_cvt_pk_bf16_f32 v49, v34, v35
    v_mfma_f32_16x16x32_bf16 v[132:135], a[128:131], v[52:55], v[132:135]
    v_exp_f32 v36, v36
    v_mfma_f32_16x16x32_bf16 v[148:151], a[132:135], v[52:55], v[148:151]
    ds_read_b64_tr_b16 a[172:173], v23 offset:24576
    v_mfma_f32_16x16x32_bf16 v[164:167], a[136:139], v[52:55], v[164:167]
    v_exp_f32 v37, v37
    v_mfma_f32_16x16x32_bf16 v[180:183], a[140:143], v[52:55], v[180:183]
    ds_read_b64_tr_b16 a[174:175], v23 offset:28672
    v_cvt_pk_bf16_f32 v50, v36, v37
    v_mfma_f32_16x16x32_bf16 v[196:199], a[144:147], v[52:55], v[196:199]
    v_exp_f32 v38, v38
    v_mfma_f32_16x16x32_bf16 v[212:215], a[148:151], v[52:55], v[212:215]
    buffer_load_dwordx4 v3, s[12:15], s35 offen offset:3072 lds
    v_mfma_f32_16x16x32_bf16 v[228:231], a[152:155], v[52:55], v[228:231]
    v_exp_f32 v39, v39
    v_mfma_f32_16x16x32_bf16 v[244:247], a[156:159], v[52:55], v[244:247]
    v_cvt_pk_bf16_f32 v51, v38, v39
    s_add_u32 s35, s35, 16384
    v_mfma_f32_16x16x32_bf16 v[76:79], v[88:91], v[52:55], v[76:79]
    s_waitcnt vmcnt(8) lgkmcnt(4)
    s_barrier
    s_min_u32 s35, s35, 507904
    v_mfma_f32_16x16x32_bf16 v[32:35], a[96:99], a[0:3], v[56:59]
    v_exp_f32 v40, v40
    v_mfma_f32_16x16x32_bf16 v[32:35], a[100:103], a[4:7], v[32:35]
    ds_read_b128 a[64:67], v9 offset:32768
    v_mfma_f32_16x16x32_bf16 v[32:35], a[104:107], a[8:11], v[32:35]
    v_exp_f32 v41, v41
    v_mfma_f32_16x16x32_bf16 v[32:35], a[108:111], a[12:15], v[32:35]
    ds_read_b128 a[68:71], v11 offset:32768
    v_cvt_pk_bf16_f32 v52, v40, v41
    v_mfma_f32_16x16x32_bf16 v[36:39], a[112:115], a[0:3], v[56:59]
    v_exp_f32 v42, v42
    v_mfma_f32_16x16x32_bf16 v[36:39], a[116:119], a[4:7], v[36:39]
    ds_read_b64_tr_b16 a[176:177], v25 offset:24576
    v_mfma_f32_16x16x32_bf16 v[36:39], a[120:123], a[8:11], v[36:39]
    v_exp_f32 v43, v43
    v_mfma_f32_16x16x32_bf16 v[36:39], a[124:127], a[12:15], v[36:39]
    ds_read_b64_tr_b16 a[178:179], v25 offset:28672
    v_cvt_pk_bf16_f32 v53, v42, v43
    v_mfma_f32_16x16x32_bf16 v[136:139], a[128:131], v[48:51], v[136:139]
    v_exp_f32 v44, v44
    v_mfma_f32_16x16x32_bf16 v[152:155], a[132:135], v[48:51], v[152:155]
    ds_read_b64_tr_b16 a[180:181], v27 offset:24576
    s_add_u32 m0, s36, 32768
    v_mfma_f32_16x16x32_bf16 v[168:171], a[136:139], v[48:51], v[168:171]
    v_exp_f32 v45, v45
    v_mfma_f32_16x16x32_bf16 v[184:187], a[140:143], v[48:51], v[184:187]
    ds_read_b64_tr_b16 a[182:183], v27 offset:28672
    v_cvt_pk_bf16_f32 v54, v44, v45
    v_mfma_f32_16x16x32_bf16 v[200:203], a[144:147], v[48:51], v[200:203]
    v_exp_f32 v46, v46
    v_mfma_f32_16x16x32_bf16 v[216:219], a[148:151], v[48:51], v[216:219]
    buffer_load_dwordx4 v124, s[8:11], s35 offen offset:0 lds
    v_mfma_f32_16x16x32_bf16 v[232:235], a[152:155], v[48:51], v[232:235]
    v_exp_f32 v47, v47
    v_mfma_f32_16x16x32_bf16 v[248:251], a[156:159], v[48:51], v[248:251]
    v_cvt_pk_bf16_f32 v55, v46, v47
    v_mfma_f32_16x16x32_bf16 v[80:83], v[88:91], v[48:51], v[80:83]
    v_mfma_f32_16x16x32_bf16 v[40:43], a[96:99], a[16:19], v[60:63]
    v_exp_f32 v32, v32
    v_mfma_f32_16x16x32_bf16 v[40:43], a[100:103], a[20:23], v[40:43]
    ds_read_b128 a[72:75], v13 offset:32768
    v_mfma_f32_16x16x32_bf16 v[40:43], a[104:107], a[24:27], v[40:43]
    v_exp_f32 v33, v33
    v_mfma_f32_16x16x32_bf16 v[40:43], a[108:111], a[28:31], v[40:43]
    ds_read_b128 a[76:79], v15 offset:32768
    v_cvt_pk_bf16_f32 v48, v32, v33
    v_mfma_f32_16x16x32_bf16 v[44:47], a[112:115], a[16:19], v[60:63]
    v_exp_f32 v34, v34
    v_mfma_f32_16x16x32_bf16 v[44:47], a[116:119], a[20:23], v[44:47]
    ds_read_b64_tr_b16 a[184:185], v29 offset:24576
    v_mfma_f32_16x16x32_bf16 v[44:47], a[120:123], a[24:27], v[44:47]
    v_exp_f32 v35, v35
    v_mfma_f32_16x16x32_bf16 v[44:47], a[124:127], a[28:31], v[44:47]
    ds_read_b64_tr_b16 a[186:187], v29 offset:28672
    v_cvt_pk_bf16_f32 v49, v34, v35
    v_mfma_f32_16x16x32_bf16 v[140:143], a[128:131], v[52:55], v[140:143]
    v_exp_f32 v36, v36
    v_mfma_f32_16x16x32_bf16 v[156:159], a[132:135], v[52:55], v[156:159]
    ds_read_b64_tr_b16 a[188:189], v31 offset:24576
    v_mfma_f32_16x16x32_bf16 v[172:175], a[136:139], v[52:55], v[172:175]
    v_exp_f32 v37, v37
    v_mfma_f32_16x16x32_bf16 v[188:191], a[140:143], v[52:55], v[188:191]
    ds_read_b64_tr_b16 a[190:191], v31 offset:28672
    v_cvt_pk_bf16_f32 v50, v36, v37
    v_mfma_f32_16x16x32_bf16 v[204:207], a[144:147], v[52:55], v[204:207]
    v_exp_f32 v38, v38
    v_mfma_f32_16x16x32_bf16 v[220:223], a[148:151], v[52:55], v[220:223]
    buffer_load_dwordx4 v125, s[8:11], s35 offen offset:1024 lds
    v_mfma_f32_16x16x32_bf16 v[236:239], a[152:155], v[52:55], v[236:239]
    v_exp_f32 v39, v39
    v_mfma_f32_16x16x32_bf16 v[252:255], a[156:159], v[52:55], v[252:255]
    v_cvt_pk_bf16_f32 v51, v38, v39
    v_mfma_f32_16x16x32_bf16 v[84:87], v[88:91], v[52:55], v[84:87]
    v_mfma_f32_16x16x32_bf16 v[32:35], a[96:99], a[32:35], v[64:67]
    v_exp_f32 v40, v40
    v_mfma_f32_16x16x32_bf16 v[32:35], a[100:103], a[36:39], v[32:35]
    ds_read_b128 a[80:83], v9 offset:36864
    v_mfma_f32_16x16x32_bf16 v[32:35], a[104:107], a[40:43], v[32:35]
    v_exp_f32 v41, v41
    v_mfma_f32_16x16x32_bf16 v[32:35], a[108:111], a[44:47], v[32:35]
    ds_read_b128 a[84:87], v11 offset:36864
    v_cvt_pk_bf16_f32 v52, v40, v41
    v_mfma_f32_16x16x32_bf16 v[36:39], a[112:115], a[32:35], v[64:67]
    v_exp_f32 v42, v42
    v_mfma_f32_16x16x32_bf16 v[36:39], a[116:119], a[36:39], v[36:39]
    ds_read_b64_tr_b16 a[128:129], v17 offset:49152
    s_waitcnt lgkmcnt(3)
    v_mfma_f32_16x16x32_bf16 v[36:39], a[120:123], a[40:43], v[36:39]
    v_exp_f32 v43, v43
    v_mfma_f32_16x16x32_bf16 v[36:39], a[124:127], a[44:47], v[36:39]
    ds_read_b64_tr_b16 a[130:131], v17 offset:53248
    v_cvt_pk_bf16_f32 v53, v42, v43
    v_mfma_f32_16x16x32_bf16 v[128:131], a[160:163], v[48:51], v[128:131]
    v_exp_f32 v44, v44
    v_mfma_f32_16x16x32_bf16 v[144:147], a[164:167], v[48:51], v[144:147]
    ds_read_b64_tr_b16 a[132:133], v19 offset:49152
    v_mfma_f32_16x16x32_bf16 v[160:163], a[168:171], v[48:51], v[160:163]
    v_exp_f32 v45, v45
    v_mfma_f32_16x16x32_bf16 v[176:179], a[172:175], v[48:51], v[176:179]
    ds_read_b64_tr_b16 a[134:135], v19 offset:53248
    v_cvt_pk_bf16_f32 v54, v44, v45
    v_mfma_f32_16x16x32_bf16 v[192:195], a[176:179], v[48:51], v[192:195]
    v_exp_f32 v46, v46
    v_mfma_f32_16x16x32_bf16 v[208:211], a[180:183], v[48:51], v[208:211]
    buffer_load_dwordx4 v126, s[8:11], s35 offen offset:2048 lds
    v_mfma_f32_16x16x32_bf16 v[224:227], a[184:187], v[48:51], v[224:227]
    v_exp_f32 v47, v47
    v_mfma_f32_16x16x32_bf16 v[240:243], a[188:191], v[48:51], v[240:243]
    v_cvt_pk_bf16_f32 v55, v46, v47
    v_mfma_f32_16x16x32_bf16 v[72:75], v[88:91], v[48:51], v[72:75]
    v_mfma_f32_16x16x32_bf16 v[40:43], a[96:99], a[48:51], v[68:71]
    v_exp_f32 v32, v32
    v_mfma_f32_16x16x32_bf16 v[40:43], a[100:103], a[52:55], v[40:43]
    ds_read_b128 a[88:91], v13 offset:36864
    v_mfma_f32_16x16x32_bf16 v[40:43], a[104:107], a[56:59], v[40:43]
    v_exp_f32 v33, v33
    v_mfma_f32_16x16x32_bf16 v[40:43], a[108:111], a[60:63], v[40:43]
    ds_read_b128 a[92:95], v15 offset:36864
    v_cvt_pk_bf16_f32 v48, v32, v33
    v_mfma_f32_16x16x32_bf16 v[44:47], a[112:115], a[48:51], v[68:71]
    v_exp_f32 v34, v34
    v_mfma_f32_16x16x32_bf16 v[44:47], a[116:119], a[52:55], v[44:47]
    ds_read_b64_tr_b16 a[136:137], v21 offset:49152
    v_mfma_f32_16x16x32_bf16 v[44:47], a[120:123], a[56:59], v[44:47]
    v_exp_f32 v35, v35
    v_mfma_f32_16x16x32_bf16 v[44:47], a[124:127], a[60:63], v[44:47]
    ds_read_b64_tr_b16 a[138:139], v21 offset:53248
    v_cvt_pk_bf16_f32 v49, v34, v35
    v_mfma_f32_16x16x32_bf16 v[132:135], a[160:163], v[52:55], v[132:135]
    v_exp_f32 v36, v36
    v_mfma_f32_16x16x32_bf16 v[148:151], a[164:167], v[52:55], v[148:151]
    ds_read_b64_tr_b16 a[140:141], v23 offset:49152
    v_mfma_f32_16x16x32_bf16 v[164:167], a[168:171], v[52:55], v[164:167]
    v_exp_f32 v37, v37
    v_mfma_f32_16x16x32_bf16 v[180:183], a[172:175], v[52:55], v[180:183]
    ds_read_b64_tr_b16 a[142:143], v23 offset:53248
    v_cvt_pk_bf16_f32 v50, v36, v37
    v_mfma_f32_16x16x32_bf16 v[196:199], a[176:179], v[52:55], v[196:199]
    v_exp_f32 v38, v38
    v_mfma_f32_16x16x32_bf16 v[212:215], a[180:183], v[52:55], v[212:215]
    buffer_load_dwordx4 v127, s[8:11], s35 offen offset:3072 lds
    v_mfma_f32_16x16x32_bf16 v[228:231], a[184:187], v[52:55], v[228:231]
    v_exp_f32 v39, v39
    v_mfma_f32_16x16x32_bf16 v[244:247], a[188:191], v[52:55], v[244:247]
    v_cvt_pk_bf16_f32 v51, v38, v39
    v_mfma_f32_16x16x32_bf16 v[76:79], v[88:91], v[52:55], v[76:79]
    s_waitcnt lgkmcnt(4)
    v_mfma_f32_16x16x32_bf16 v[32:35], a[64:67], a[0:3], v[56:59]
    v_exp_f32 v40, v40
    v_mfma_f32_16x16x32_bf16 v[32:35], a[68:71], a[4:7], v[32:35]
    ds_read_b128 a[96:99], v9 offset:40960
    v_mfma_f32_16x16x32_bf16 v[32:35], a[72:75], a[8:11], v[32:35]
    v_exp_f32 v41, v41
    v_mfma_f32_16x16x32_bf16 v[32:35], a[76:79], a[12:15], v[32:35]
    ds_read_b128 a[100:103], v11 offset:40960
    v_cvt_pk_bf16_f32 v52, v40, v41
    v_mfma_f32_16x16x32_bf16 v[36:39], a[80:83], a[0:3], v[56:59]
    v_exp_f32 v42, v42
    v_mfma_f32_16x16x32_bf16 v[36:39], a[84:87], a[4:7], v[36:39]
    ds_read_b64_tr_b16 a[144:145], v25 offset:49152
    v_mfma_f32_16x16x32_bf16 v[36:39], a[88:91], a[8:11], v[36:39]
    v_exp_f32 v43, v43
    v_mfma_f32_16x16x32_bf16 v[36:39], a[92:95], a[12:15], v[36:39]
    ds_read_b64_tr_b16 a[146:147], v25 offset:53248
    v_cvt_pk_bf16_f32 v53, v42, v43
    v_mfma_f32_16x16x32_bf16 v[136:139], a[160:163], v[48:51], v[136:139]
    v_exp_f32 v44, v44
    v_mfma_f32_16x16x32_bf16 v[152:155], a[164:167], v[48:51], v[152:155]
    ds_read_b64_tr_b16 a[148:149], v27 offset:49152
    s_add_u32 m0, s36, 49152
    v_mfma_f32_16x16x32_bf16 v[168:171], a[168:171], v[48:51], v[168:171]
    v_exp_f32 v45, v45
    v_mfma_f32_16x16x32_bf16 v[184:187], a[172:175], v[48:51], v[184:187]
    ds_read_b64_tr_b16 a[150:151], v27 offset:53248
    v_cvt_pk_bf16_f32 v54, v44, v45
    v_mfma_f32_16x16x32_bf16 v[200:203], a[176:179], v[48:51], v[200:203]
    v_exp_f32 v46, v46
    v_mfma_f32_16x16x32_bf16 v[216:219], a[180:183], v[48:51], v[216:219]
    buffer_load_dwordx4 v2, s[12:15], s35 offen offset:0 lds
    v_mfma_f32_16x16x32_bf16 v[232:235], a[184:187], v[48:51], v[232:235]
    v_exp_f32 v47, v47
    v_mfma_f32_16x16x32_bf16 v[248:251], a[188:191], v[48:51], v[248:251]
    v_cvt_pk_bf16_f32 v55, v46, v47
    v_mfma_f32_16x16x32_bf16 v[80:83], v[88:91], v[48:51], v[80:83]
    v_mfma_f32_16x16x32_bf16 v[40:43], a[64:67], a[16:19], v[60:63]
    v_exp_f32 v32, v32
    v_mfma_f32_16x16x32_bf16 v[40:43], a[68:71], a[20:23], v[40:43]
    ds_read_b128 a[104:107], v13 offset:40960
    v_mfma_f32_16x16x32_bf16 v[40:43], a[72:75], a[24:27], v[40:43]
    v_exp_f32 v33, v33
    v_mfma_f32_16x16x32_bf16 v[40:43], a[76:79], a[28:31], v[40:43]
    ds_read_b128 a[108:111], v15 offset:40960
    v_cvt_pk_bf16_f32 v48, v32, v33
    v_mfma_f32_16x16x32_bf16 v[44:47], a[80:83], a[16:19], v[60:63]
    v_exp_f32 v34, v34
    v_mfma_f32_16x16x32_bf16 v[44:47], a[84:87], a[20:23], v[44:47]
    ds_read_b64_tr_b16 a[152:153], v29 offset:49152
    v_mfma_f32_16x16x32_bf16 v[44:47], a[88:91], a[24:27], v[44:47]
    v_exp_f32 v35, v35
    v_mfma_f32_16x16x32_bf16 v[44:47], a[92:95], a[28:31], v[44:47]
    ds_read_b64_tr_b16 a[154:155], v29 offset:53248
    v_cvt_pk_bf16_f32 v49, v34, v35
    v_mfma_f32_16x16x32_bf16 v[140:143], a[160:163], v[52:55], v[140:143]
    v_exp_f32 v36, v36
    v_mfma_f32_16x16x32_bf16 v[156:159], a[164:167], v[52:55], v[156:159]
    ds_read_b64_tr_b16 a[156:157], v31 offset:49152
    v_mfma_f32_16x16x32_bf16 v[172:175], a[168:171], v[52:55], v[172:175]
    v_exp_f32 v37, v37
    v_mfma_f32_16x16x32_bf16 v[188:191], a[172:175], v[52:55], v[188:191]
    ds_read_b64_tr_b16 a[158:159], v31 offset:53248
    v_cvt_pk_bf16_f32 v50, v36, v37
    v_mfma_f32_16x16x32_bf16 v[204:207], a[176:179], v[52:55], v[204:207]
    v_exp_f32 v38, v38
    v_mfma_f32_16x16x32_bf16 v[220:223], a[180:183], v[52:55], v[220:223]
    buffer_load_dwordx4 v3, s[12:15], s35 offen offset:1024 lds
    v_mfma_f32_16x16x32_bf16 v[236:239], a[184:187], v[52:55], v[236:239]
    v_exp_f32 v39, v39
    v_mfma_f32_16x16x32_bf16 v[252:255], a[188:191], v[52:55], v[252:255]
    v_cvt_pk_bf16_f32 v51, v38, v39
    v_mfma_f32_16x16x32_bf16 v[84:87], v[88:91], v[52:55], v[84:87]
    v_mfma_f32_16x16x32_bf16 v[32:35], a[64:67], a[32:35], v[64:67]
    v_exp_f32 v40, v40
    v_mfma_f32_16x16x32_bf16 v[32:35], a[68:71], a[36:39], v[32:35]
    ds_read_b128 a[112:115], v9 offset:45056
    v_mfma_f32_16x16x32_bf16 v[32:35], a[72:75], a[40:43], v[32:35]
    v_exp_f32 v41, v41
    v_mfma_f32_16x16x32_bf16 v[32:35], a[76:79], a[44:47], v[32:35]
    ds_read_b128 a[116:119], v11 offset:45056
    v_cvt_pk_bf16_f32 v52, v40, v41
    v_mfma_f32_16x16x32_bf16 v[36:39], a[80:83], a[32:35], v[64:67]
    v_exp_f32 v42, v42
    v_mfma_f32_16x16x32_bf16 v[36:39], a[84:87], a[36:39], v[36:39]
    ds_read_b64_tr_b16 a[160:161], v17 offset:57344
    s_waitcnt lgkmcnt(3)
    v_mfma_f32_16x16x32_bf16 v[36:39], a[88:91], a[40:43], v[36:39]
    v_exp_f32 v43, v43
    v_mfma_f32_16x16x32_bf16 v[36:39], a[92:95], a[44:47], v[36:39]
    ds_read_b64_tr_b16 a[162:163], v17 offset:61440
    v_cvt_pk_bf16_f32 v53, v42, v43
    v_mfma_f32_16x16x32_bf16 v[128:131], a[128:131], v[48:51], v[128:131]
    v_exp_f32 v44, v44
    v_mfma_f32_16x16x32_bf16 v[144:147], a[132:135], v[48:51], v[144:147]
    ds_read_b64_tr_b16 a[164:165], v19 offset:57344
    v_mfma_f32_16x16x32_bf16 v[160:163], a[136:139], v[48:51], v[160:163]
    v_exp_f32 v45, v45
    v_mfma_f32_16x16x32_bf16 v[176:179], a[140:143], v[48:51], v[176:179]
    ds_read_b64_tr_b16 a[166:167], v19 offset:61440
    v_cvt_pk_bf16_f32 v54, v44, v45
    v_mfma_f32_16x16x32_bf16 v[192:195], a[144:147], v[48:51], v[192:195]
    v_exp_f32 v46, v46
    v_mfma_f32_16x16x32_bf16 v[208:211], a[148:151], v[48:51], v[208:211]
    buffer_load_dwordx4 v2, s[12:15], s35 offen offset:2048 lds
    v_mfma_f32_16x16x32_bf16 v[224:227], a[152:155], v[48:51], v[224:227]
    v_exp_f32 v47, v47
    v_mfma_f32_16x16x32_bf16 v[240:243], a[156:159], v[48:51], v[240:243]
    v_cvt_pk_bf16_f32 v55, v46, v47
    v_mfma_f32_16x16x32_bf16 v[72:75], v[88:91], v[48:51], v[72:75]
    v_mfma_f32_16x16x32_bf16 v[40:43], a[64:67], a[48:51], v[68:71]
    v_exp_f32 v32, v32
    v_mfma_f32_16x16x32_bf16 v[40:43], a[68:71], a[52:55], v[40:43]
    ds_read_b128 a[120:123], v13 offset:45056
    v_mfma_f32_16x16x32_bf16 v[40:43], a[72:75], a[56:59], v[40:43]
    v_exp_f32 v33, v33
    v_mfma_f32_16x16x32_bf16 v[40:43], a[76:79], a[60:63], v[40:43]
    ds_read_b128 a[124:127], v15 offset:45056
    v_cvt_pk_bf16_f32 v48, v32, v33
    v_mfma_f32_16x16x32_bf16 v[44:47], a[80:83], a[48:51], v[68:71]
    v_exp_f32 v34, v34
    v_mfma_f32_16x16x32_bf16 v[44:47], a[84:87], a[52:55], v[44:47]
    ds_read_b64_tr_b16 a[168:169], v21 offset:57344
    v_mfma_f32_16x16x32_bf16 v[44:47], a[88:91], a[56:59], v[44:47]
    v_exp_f32 v35, v35
    v_mfma_f32_16x16x32_bf16 v[44:47], a[92:95], a[60:63], v[44:47]
    ds_read_b64_tr_b16 a[170:171], v21 offset:61440
    v_cvt_pk_bf16_f32 v49, v34, v35
    v_mfma_f32_16x16x32_bf16 v[132:135], a[128:131], v[52:55], v[132:135]
    v_exp_f32 v36, v36
    v_mfma_f32_16x16x32_bf16 v[148:151], a[132:135], v[52:55], v[148:151]
    ds_read_b64_tr_b16 a[172:173], v23 offset:57344
    v_mfma_f32_16x16x32_bf16 v[164:167], a[136:139], v[52:55], v[164:167]
    v_exp_f32 v37, v37
    v_mfma_f32_16x16x32_bf16 v[180:183], a[140:143], v[52:55], v[180:183]
    ds_read_b64_tr_b16 a[174:175], v23 offset:61440
    v_cvt_pk_bf16_f32 v50, v36, v37
    v_mfma_f32_16x16x32_bf16 v[196:199], a[144:147], v[52:55], v[196:199]
    v_exp_f32 v38, v38
    v_mfma_f32_16x16x32_bf16 v[212:215], a[148:151], v[52:55], v[212:215]
    buffer_load_dwordx4 v3, s[12:15], s35 offen offset:3072 lds
    v_mfma_f32_16x16x32_bf16 v[228:231], a[152:155], v[52:55], v[228:231]
    v_exp_f32 v39, v39
    v_mfma_f32_16x16x32_bf16 v[244:247], a[156:159], v[52:55], v[244:247]
    v_cvt_pk_bf16_f32 v51, v38, v39
    s_add_u32 s35, s35, 16384
    v_mfma_f32_16x16x32_bf16 v[76:79], v[88:91], v[52:55], v[76:79]
    s_waitcnt vmcnt(8) lgkmcnt(4)
    s_barrier
    s_min_u32 s35, s35, 507904
    v_mfma_f32_16x16x32_bf16 v[32:35], a[96:99], a[0:3], v[56:59]
    v_exp_f32 v40, v40
    v_mfma_f32_16x16x32_bf16 v[32:35], a[100:103], a[4:7], v[32:35]
    ds_read_b128 a[64:67], v8 offset:0
    v_mfma_f32_16x16x32_bf16 v[32:35], a[104:107], a[8:11], v[32:35]
    v_exp_f32 v41, v41
    v_mfma_f32_16x16x32_bf16 v[32:35], a[108:111], a[12:15], v[32:35]
    ds_read_b128 a[68:71], v10 offset:0
    v_cvt_pk_bf16_f32 v52, v40, v41
    v_mfma_f32_16x16x32_bf16 v[36:39], a[112:115], a[0:3], v[56:59]
    v_exp_f32 v42, v42
    v_mfma_f32_16x16x32_bf16 v[36:39], a[116:119], a[4:7], v[36:39]
    ds_read_b64_tr_b16 a[176:177], v25 offset:57344
    v_mfma_f32_16x16x32_bf16 v[36:39], a[120:123], a[8:11], v[36:39]
    v_exp_f32 v43, v43
    v_mfma_f32_16x16x32_bf16 v[36:39], a[124:127], a[12:15], v[36:39]
    ds_read_b64_tr_b16 a[178:179], v25 offset:61440
    v_cvt_pk_bf16_f32 v53, v42, v43
    v_mfma_f32_16x16x32_bf16 v[136:139], a[128:131], v[48:51], v[136:139]
    v_exp_f32 v44, v44
    v_mfma_f32_16x16x32_bf16 v[152:155], a[132:135], v[48:51], v[152:155]
    ds_read_b64_tr_b16 a[180:181], v27 offset:57344
    s_add_u32 m0, s36, 65536
    v_mfma_f32_16x16x32_bf16 v[168:171], a[136:139], v[48:51], v[168:171]
    v_exp_f32 v45, v45
    v_mfma_f32_16x16x32_bf16 v[184:187], a[140:143], v[48:51], v[184:187]
    ds_read_b64_tr_b16 a[182:183], v27 offset:61440
    v_cvt_pk_bf16_f32 v54, v44, v45
    v_mfma_f32_16x16x32_bf16 v[200:203], a[144:147], v[48:51], v[200:203]
    v_exp_f32 v46, v46
    v_mfma_f32_16x16x32_bf16 v[216:219], a[148:151], v[48:51], v[216:219]
    buffer_load_dwordx4 v124, s[8:11], s35 offen offset:0 lds
    v_mfma_f32_16x16x32_bf16 v[232:235], a[152:155], v[48:51], v[232:235]
    v_exp_f32 v47, v47
    v_mfma_f32_16x16x32_bf16 v[248:251], a[156:159], v[48:51], v[248:251]
    v_cvt_pk_bf16_f32 v55, v46, v47
    v_mfma_f32_16x16x32_bf16 v[80:83], v[88:91], v[48:51], v[80:83]
    v_mfma_f32_16x16x32_bf16 v[40:43], a[96:99], a[16:19], v[60:63]
    v_exp_f32 v32, v32
    v_mfma_f32_16x16x32_bf16 v[40:43], a[100:103], a[20:23], v[40:43]
    ds_read_b128 a[72:75], v12 offset:0
    v_mfma_f32_16x16x32_bf16 v[40:43], a[104:107], a[24:27], v[40:43]
    v_exp_f32 v33, v33
    v_mfma_f32_16x16x32_bf16 v[40:43], a[108:111], a[28:31], v[40:43]
    ds_read_b128 a[76:79], v14 offset:0
    v_cvt_pk_bf16_f32 v48, v32, v33
    v_mfma_f32_16x16x32_bf16 v[44:47], a[112:115], a[16:19], v[60:63]
    v_exp_f32 v34, v34
    v_mfma_f32_16x16x32_bf16 v[44:47], a[116:119], a[20:23], v[44:47]
    ds_read_b64_tr_b16 a[184:185], v29 offset:57344
    v_mfma_f32_16x16x32_bf16 v[44:47], a[120:123], a[24:27], v[44:47]
    v_exp_f32 v35, v35
    v_mfma_f32_16x16x32_bf16 v[44:47], a[124:127], a[28:31], v[44:47]
    ds_read_b64_tr_b16 a[186:187], v29 offset:61440
    v_cvt_pk_bf16_f32 v49, v34, v35
    v_mfma_f32_16x16x32_bf16 v[140:143], a[128:131], v[52:55], v[140:143]
    v_exp_f32 v36, v36
    v_mfma_f32_16x16x32_bf16 v[156:159], a[132:135], v[52:55], v[156:159]
    ds_read_b64_tr_b16 a[188:189], v31 offset:57344
    v_mfma_f32_16x16x32_bf16 v[172:175], a[136:139], v[52:55], v[172:175]
    v_exp_f32 v37, v37
    v_mfma_f32_16x16x32_bf16 v[188:191], a[140:143], v[52:55], v[188:191]
    ds_read_b64_tr_b16 a[190:191], v31 offset:61440
    v_cvt_pk_bf16_f32 v50, v36, v37
    v_mfma_f32_16x16x32_bf16 v[204:207], a[144:147], v[52:55], v[204:207]
    v_exp_f32 v38, v38
    v_mfma_f32_16x16x32_bf16 v[220:223], a[148:151], v[52:55], v[220:223]
    buffer_load_dwordx4 v125, s[8:11], s35 offen offset:1024 lds
    v_mfma_f32_16x16x32_bf16 v[236:239], a[152:155], v[52:55], v[236:239]
    v_exp_f32 v39, v39
    v_mfma_f32_16x16x32_bf16 v[252:255], a[156:159], v[52:55], v[252:255]
    v_cvt_pk_bf16_f32 v51, v38, v39
    v_mfma_f32_16x16x32_bf16 v[84:87], v[88:91], v[52:55], v[84:87]
    v_mfma_f32_16x16x32_bf16 v[32:35], a[96:99], a[32:35], v[64:67]
    v_exp_f32 v40, v40
    v_mfma_f32_16x16x32_bf16 v[32:35], a[100:103], a[36:39], v[32:35]
    ds_read_b128 a[80:83], v8 offset:4096
    v_mfma_f32_16x16x32_bf16 v[32:35], a[104:107], a[40:43], v[32:35]
    v_exp_f32 v41, v41
    v_mfma_f32_16x16x32_bf16 v[32:35], a[108:111], a[44:47], v[32:35]
    ds_read_b128 a[84:87], v10 offset:4096
    v_cvt_pk_bf16_f32 v52, v40, v41
    v_mfma_f32_16x16x32_bf16 v[36:39], a[112:115], a[32:35], v[64:67]
    v_exp_f32 v42, v42
    v_mfma_f32_16x16x32_bf16 v[36:39], a[116:119], a[36:39], v[36:39]
    ds_read_b64_tr_b16 a[128:129], v16 offset:16384
    s_waitcnt lgkmcnt(3)
    v_mfma_f32_16x16x32_bf16 v[36:39], a[120:123], a[40:43], v[36:39]
    v_exp_f32 v43, v43
    v_mfma_f32_16x16x32_bf16 v[36:39], a[124:127], a[44:47], v[36:39]
    ds_read_b64_tr_b16 a[130:131], v16 offset:20480
    v_cvt_pk_bf16_f32 v53, v42, v43
    v_mfma_f32_16x16x32_bf16 v[128:131], a[160:163], v[48:51], v[128:131]
    v_exp_f32 v44, v44
    v_mfma_f32_16x16x32_bf16 v[144:147], a[164:167], v[48:51], v[144:147]
    ds_read_b64_tr_b16 a[132:133], v18 offset:16384
    v_mfma_f32_16x16x32_bf16 v[160:163], a[168:171], v[48:51], v[160:163]
    v_exp_f32 v45, v45
    v_mfma_f32_16x16x32_bf16 v[176:179], a[172:175], v[48:51], v[176:179]
    ds_read_b64_tr_b16 a[134:135], v18 offset:20480
    v_cvt_pk_bf16_f32 v54, v44, v45
    v_mfma_f32_16x16x32_bf16 v[192:195], a[176:179], v[48:51], v[192:195]
    v_exp_f32 v46, v46
    v_mfma_f32_16x16x32_bf16 v[208:211], a[180:183], v[48:51], v[208:211]
    buffer_load_dwordx4 v126, s[8:11], s35 offen offset:2048 lds
    v_mfma_f32_16x16x32_bf16 v[224:227], a[184:187], v[48:51], v[224:227]
    v_exp_f32 v47, v47
    v_mfma_f32_16x16x32_bf16 v[240:243], a[188:191], v[48:51], v[240:243]
    v_cvt_pk_bf16_f32 v55, v46, v47
    v_mfma_f32_16x16x32_bf16 v[72:75], v[88:91], v[48:51], v[72:75]
    v_mfma_f32_16x16x32_bf16 v[40:43], a[96:99], a[48:51], v[68:71]
    v_exp_f32 v32, v32
    v_mfma_f32_16x16x32_bf16 v[40:43], a[100:103], a[52:55], v[40:43]
    ds_read_b128 a[88:91], v12 offset:4096
    v_mfma_f32_16x16x32_bf16 v[40:43], a[104:107], a[56:59], v[40:43]
    v_exp_f32 v33, v33
    v_mfma_f32_16x16x32_bf16 v[40:43], a[108:111], a[60:63], v[40:43]
    ds_read_b128 a[92:95], v14 offset:4096
    v_cvt_pk_bf16_f32 v48, v32, v33
    v_mfma_f32_16x16x32_bf16 v[44:47], a[112:115], a[48:51], v[68:71]
    v_exp_f32 v34, v34
    v_mfma_f32_16x16x32_bf16 v[44:47], a[116:119], a[52:55], v[44:47]
    ds_read_b64_tr_b16 a[136:137], v20 offset:16384
    v_mfma_f32_16x16x32_bf16 v[44:47], a[120:123], a[56:59], v[44:47]
    v_exp_f32 v35, v35
    v_mfma_f32_16x16x32_bf16 v[44:47], a[124:127], a[60:63], v[44:47]
    ds_read_b64_tr_b16 a[138:139], v20 offset:20480
    v_cvt_pk_bf16_f32 v49, v34, v35
    v_mfma_f32_16x16x32_bf16 v[132:135], a[160:163], v[52:55], v[132:135]
    v_exp_f32 v36, v36
    v_mfma_f32_16x16x32_bf16 v[148:151], a[164:167], v[52:55], v[148:151]
    ds_read_b64_tr_b16 a[140:141], v22 offset:16384
    v_mfma_f32_16x16x32_bf16 v[164:167], a[168:171], v[52:55], v[164:167]
    v_exp_f32 v37, v37
    v_mfma_f32_16x16x32_bf16 v[180:183], a[172:175], v[52:55], v[180:183]
    ds_read_b64_tr_b16 a[142:143], v22 offset:20480
    v_cvt_pk_bf16_f32 v50, v36, v37
    v_mfma_f32_16x16x32_bf16 v[196:199], a[176:179], v[52:55], v[196:199]
    v_exp_f32 v38, v38
    v_mfma_f32_16x16x32_bf16 v[212:215], a[180:183], v[52:55], v[212:215]
    buffer_load_dwordx4 v127, s[8:11], s35 offen offset:3072 lds
    v_mfma_f32_16x16x32_bf16 v[228:231], a[184:187], v[52:55], v[228:231]
    v_exp_f32 v39, v39
    v_mfma_f32_16x16x32_bf16 v[244:247], a[188:191], v[52:55], v[244:247]
    v_cvt_pk_bf16_f32 v51, v38, v39
    v_mfma_f32_16x16x32_bf16 v[76:79], v[88:91], v[52:55], v[76:79]
    s_waitcnt lgkmcnt(4)
    v_mfma_f32_16x16x32_bf16 v[32:35], a[64:67], a[0:3], v[56:59]
    v_exp_f32 v40, v40
    v_mfma_f32_16x16x32_bf16 v[32:35], a[68:71], a[4:7], v[32:35]
    ds_read_b128 a[96:99], v8 offset:8192
    s_sub_u32 s39, s39, 1
    v_mfma_f32_16x16x32_bf16 v[32:35], a[72:75], a[8:11], v[32:35]
    v_exp_f32 v41, v41
    v_mfma_f32_16x16x32_bf16 v[32:35], a[76:79], a[12:15], v[32:35]
    ds_read_b128 a[100:103], v10 offset:8192
    v_cvt_pk_bf16_f32 v52, v40, v41
    v_mfma_f32_16x16x32_bf16 v[36:39], a[80:83], a[0:3], v[56:59]
    v_exp_f32 v42, v42
    v_mfma_f32_16x16x32_bf16 v[36:39], a[84:87], a[4:7], v[36:39]
    ds_read_b64_tr_b16 a[144:145], v24 offset:16384
    v_mfma_f32_16x16x32_bf16 v[36:39], a[88:91], a[8:11], v[36:39]
    v_exp_f32 v43, v43
    v_mfma_f32_16x16x32_bf16 v[36:39], a[92:95], a[12:15], v[36:39]
    ds_read_b64_tr_b16 a[146:147], v24 offset:20480
    v_cvt_pk_bf16_f32 v53, v42, v43
    v_mfma_f32_16x16x32_bf16 v[136:139], a[160:163], v[48:51], v[136:139]
    v_exp_f32 v44, v44
    v_mfma_f32_16x16x32_bf16 v[152:155], a[164:167], v[48:51], v[152:155]
    ds_read_b64_tr_b16 a[148:149], v26 offset:16384
    s_add_u32 m0, s36, 81920
    v_mfma_f32_16x16x32_bf16 v[168:171], a[168:171], v[48:51], v[168:171]
    v_exp_f32 v45, v45
    v_mfma_f32_16x16x32_bf16 v[184:187], a[172:175], v[48:51], v[184:187]
    ds_read_b64_tr_b16 a[150:151], v26 offset:20480
    v_cvt_pk_bf16_f32 v54, v44, v45
    v_mfma_f32_16x16x32_bf16 v[200:203], a[176:179], v[48:51], v[200:203]
    v_exp_f32 v46, v46
    v_mfma_f32_16x16x32_bf16 v[216:219], a[180:183], v[48:51], v[216:219]
    buffer_load_dwordx4 v2, s[12:15], s35 offen offset:0 lds
    v_mfma_f32_16x16x32_bf16 v[232:235], a[184:187], v[48:51], v[232:235]
    v_exp_f32 v47, v47
    v_mfma_f32_16x16x32_bf16 v[248:251], a[188:191], v[48:51], v[248:251]
    v_cvt_pk_bf16_f32 v55, v46, v47
    v_mfma_f32_16x16x32_bf16 v[80:83], v[88:91], v[48:51], v[80:83]
    s_cmp_lg_u32 s39, 0
    s_cbranch_scc1 mega_kernel_loop
    s_nop 0
    v_mfma_f32_16x16x32_bf16 v[140:143], a[160:163], v[52:55], v[140:143]
    v_mfma_f32_16x16x32_bf16 v[156:159], a[164:167], v[52:55], v[156:159]
    v_mfma_f32_16x16x32_bf16 v[172:175], a[168:171], v[52:55], v[172:175]
    v_mfma_f32_16x16x32_bf16 v[188:191], a[172:175], v[52:55], v[188:191]
    v_mfma_f32_16x16x32_bf16 v[204:207], a[176:179], v[52:55], v[204:207]
    v_mfma_f32_16x16x32_bf16 v[220:223], a[180:183], v[52:55], v[220:223]
    v_mfma_f32_16x16x32_bf16 v[236:239], a[184:187], v[52:55], v[236:239]
    v_mfma_f32_16x16x32_bf16 v[252:255], a[188:191], v[52:55], v[252:255]
    v_mfma_f32_16x16x32_bf16 v[84:87], v[88:91], v[52:55], v[84:87]
    s_nop 7
    v_mov_b32 v100, v72
    v_mov_b32 v101, v76
    v_mov_b32 v102, v80
    v_mov_b32 v103, v84
    s_nop 1
    v_permlane16_swap_b32 v72, v100
    v_permlane16_swap_b32 v76, v101
    v_permlane16_swap_b32 v80, v102
    v_permlane16_swap_b32 v84, v103
    s_nop 1
    v_add_f32 v72, v72, v100
    v_add_f32 v76, v76, v101
    v_add_f32 v80, v80, v102
    v_add_f32 v84, v84, v103
    s_nop 0
    v_mov_b32 v100, v72
    v_mov_b32 v101, v76
    v_mov_b32 v102, v80
    v_mov_b32 v103, v84
    s_nop 1
    v_permlane32_swap_b32 v72, v100
    v_permlane32_swap_b32 v76, v101
    v_permlane32_swap_b32 v80, v102
    v_permlane32_swap_b32 v84, v103
    s_nop 1
    v_add_f32 v72, v72, v100
    v_add_f32 v76, v76, v101
    v_add_f32 v80, v80, v102
    v_add_f32 v84, v84, v103
    s_nop 0
    s_waitcnt vmcnt(0) lgkmcnt(0)
    s_mov_b32 s37, 0x49800000
    s_nop 3
    v_cmp_nle_f32 vcc, v72, s37
    v_cmp_nle_f32 s[78:79], v76, s37
    s_nop 0
    s_or_b64 vcc, vcc, s[78:79]
    v_cmp_nle_f32 s[78:79], v80, s37
    s_nop 0
    s_or_b64 vcc, vcc, s[78:79]
    v_cmp_nle_f32 s[78:79], v84, s37
    s_nop 0
    s_or_b64 vcc, vcc, s[78:79]
    s_cmp_lg_u64 vcc, 0
    s_cselect_b32 s38, 1, 0
    v_mov_b32 v92, s38
    s_lshl_b32 s37, s32, 2
    s_add_u32 s37, s37, 135936
    v_mov_b32 v93, s37
    ds_write_b32 v93, v92
    v_mov_b32 v94, 135936
    v_mov_b32 v95, 0
    ds_write_b32 v94, v95 offset:32
    s_waitcnt lgkmcnt(0)
    s_barrier
    ds_read_b128 v[96:99], v94
    s_waitcnt lgkmcnt(0)
    v_or3_b32 v92, v96, v97, v98
    v_or_b32 v92, v92, v99
    s_nop 0
    v_readfirstlane_b32 s37, v92
    s_andn2_b32 s37, s37, s45
    s_cmp_lg_u32 s37, 0
    s_cbranch_scc1 mega_kernel_redo
    s_lshl_b32 s47, s34, 3
    s_lshr_b32 s46, s33, 2
    s_add_u32 s47, s47, s46
    s_lshl_b32 s47, s47, 7
    s_add_u32 s47, s47, 0
    s_lshl_b32 s46, s44, 17
    s_lshl_b32 s38, s33, 12
    s_add_u32 s46, s46, s38
    v_lshlrev_b32 v46, 4, v1
    v_rcp_f32 v48, v72
    v_rcp_f32 v50, v76
    v_rcp_f32 v52, v80
    v_rcp_f32 v54, v84
    s_nop 0
    v_pk_mul_f32 v[128:129], v[128:129], v[48:49] op_sel_hi:[1,0]
    v_pk_mul_f32 v[130:131], v[130:131], v[48:49] op_sel_hi:[1,0]
    v_pk_mul_f32 v[144:145], v[144:145], v[48:49] op_sel_hi:[1,0]
    v_pk_mul_f32 v[146:147], v[146:147], v[48:49] op_sel_hi:[1,0]
    v_cvt_pk_bf16_f32 v56, v128, v129
    v_cvt_pk_bf16_f32 v57, v130, v131
    v_cvt_pk_bf16_f32 v58, v144, v145
    v_cvt_pk_bf16_f32 v59, v146, v147
    buffer_store_dwordx4 v[56:59], v46, s[28:31], s46 offen offset:0 sc1
    v_pk_mul_f32 v[160:161], v[160:161], v[48:49] op_sel_hi:[1,0]
    v_pk_mul_f32 v[162:163], v[162:163], v[48:49] op_sel_hi:[1,0]
    v_pk_mul_f32 v[176:177], v[176:177], v[48:49] op_sel_hi:[1,0]
    v_pk_mul_f32 v[178:179], v[178:179], v[48:49] op_sel_hi:[1,0]
    v_cvt_pk_bf16_f32 v60, v160, v161
    v_cvt_pk_bf16_f32 v61, v162, v163
    v_cvt_pk_bf16_f32 v62, v176, v177
    v_cvt_pk_bf16_f32 v63, v178, v179
    buffer_store_dwordx4 v[60:63], v46, s[28:31], s46 offen offset:1024 sc1
    v_pk_mul_f32 v[192:193], v[192:193], v[48:49] op_sel_hi:[1,0]
    v_pk_mul_f32 v[194:195], v[194:195], v[48:49] op_sel_hi:[1,0]
    v_pk_mul_f32 v[208:209], v[208:209], v[48:49] op_sel_hi:[1,0]
    v_pk_mul_f32 v[210:211], v[210:211], v[48:49] op_sel_hi:[1,0]
    v_cvt_pk_bf16_f32 v64, v192, v193
    v_cvt_pk_bf16_f32 v65, v194, v195
    v_cvt_pk_bf16_f32 v66, v208, v209
    v_cvt_pk_bf16_f32 v67, v210, v211
    buffer_store_dwordx4 v[64:67], v46, s[28:31], s46 offen offset:2048 sc1
    v_pk_mul_f32 v[224:225], v[224:225], v[48:49] op_sel_hi:[1,0]
    v_pk_mul_f32 v[226:227], v[226:227], v[48:49] op_sel_hi:[1,0]
    v_pk_mul_f32 v[240:241], v[240:241], v[48:49] op_sel_hi:[1,0]
    v_pk_mul_f32 v[242:243], v[242:243], v[48:49] op_sel_hi:[1,0]
    v_cvt_pk_bf16_f32 v68, v224, v225
    v_cvt_pk_bf16_f32 v69, v226, v227
    v_cvt_pk_bf16_f32 v70, v240, v241
    v_cvt_pk_bf16_f32 v71, v242, v243
    buffer_store_dwordx4 v[68:71], v46, s[28:31], s46 offen offset:3072 sc1
    s_add_u32 s46, s46, 131072
    v_pk_mul_f32 v[132:133], v[132:133], v[50:51] op_sel_hi:[1,0]
    v_pk_mul_f32 v[134:135], v[134:135], v[50:51] op_sel_hi:[1,0]
    v_pk_mul_f32 v[148:149], v[148:149], v[50:51] op_sel_hi:[1,0]
    v_pk_mul_f32 v[150:151], v[150:151], v[50:51] op_sel_hi:[1,0]
    v_cvt_pk_bf16_f32 v56, v132, v133
    v_cvt_pk_bf16_f32 v57, v134, v135
    v_cvt_pk_bf16_f32 v58, v148, v149
    v_cvt_pk_bf16_f32 v59, v150, v151
    buffer_store_dwordx4 v[56:59], v46, s[28:31], s46 offen offset:0 sc1
    v_pk_mul_f32 v[164:165], v[164:165], v[50:51] op_sel_hi:[1,0]
    v_pk_mul_f32 v[166:167], v[166:167], v[50:51] op_sel_hi:[1,0]
    v_pk_mul_f32 v[180:181], v[180:181], v[50:51] op_sel_hi:[1,0]
    v_pk_mul_f32 v[182:183], v[182:183], v[50:51] op_sel_hi:[1,0]
    v_cvt_pk_bf16_f32 v60, v164, v165
    v_cvt_pk_bf16_f32 v61, v166, v167
    v_cvt_pk_bf16_f32 v62, v180, v181
    v_cvt_pk_bf16_f32 v63, v182, v183
    buffer_store_dwordx4 v[60:63], v46, s[28:31], s46 offen offset:1024 sc1
    v_pk_mul_f32 v[196:197], v[196:197], v[50:51] op_sel_hi:[1,0]
    v_pk_mul_f32 v[198:199], v[198:199], v[50:51] op_sel_hi:[1,0]
    v_pk_mul_f32 v[212:213], v[212:213], v[50:51] op_sel_hi:[1,0]
    v_pk_mul_f32 v[214:215], v[214:215], v[50:51] op_sel_hi:[1,0]
    v_cvt_pk_bf16_f32 v64, v196, v197
    v_cvt_pk_bf16_f32 v65, v198, v199
    v_cvt_pk_bf16_f32 v66, v212, v213
    v_cvt_pk_bf16_f32 v67, v214, v215
    buffer_store_dwordx4 v[64:67], v46, s[28:31], s46 offen offset:2048 sc1
    v_pk_mul_f32 v[228:229], v[228:229], v[50:51] op_sel_hi:[1,0]
    v_pk_mul_f32 v[230:231], v[230:231], v[50:51] op_sel_hi:[1,0]
    v_pk_mul_f32 v[244:245], v[244:245], v[50:51] op_sel_hi:[1,0]
    v_pk_mul_f32 v[246:247], v[246:247], v[50:51] op_sel_hi:[1,0]
    v_cvt_pk_bf16_f32 v68, v228, v229
    v_cvt_pk_bf16_f32 v69, v230, v231
    v_cvt_pk_bf16_f32 v70, v244, v245
    v_cvt_pk_bf16_f32 v71, v246, v247
    buffer_store_dwordx4 v[68:71], v46, s[28:31], s46 offen offset:3072 sc1
    s_add_u32 s46, s46, 131072
    v_pk_mul_f32 v[136:137], v[136:137], v[52:53] op_sel_hi:[1,0]
    v_pk_mul_f32 v[138:139], v[138:139], v[52:53] op_sel_hi:[1,0]
    v_pk_mul_f32 v[152:153], v[152:153], v[52:53] op_sel_hi:[1,0]
    v_pk_mul_f32 v[154:155], v[154:155], v[52:53] op_sel_hi:[1,0]
    v_cvt_pk_bf16_f32 v56, v136, v137
    v_cvt_pk_bf16_f32 v57, v138, v139
    v_cvt_pk_bf16_f32 v58, v152, v153
    v_cvt_pk_bf16_f32 v59, v154, v155
    buffer_store_dwordx4 v[56:59], v46, s[28:31], s46 offen offset:0 sc1
    v_pk_mul_f32 v[168:169], v[168:169], v[52:53] op_sel_hi:[1,0]
    v_pk_mul_f32 v[170:171], v[170:171], v[52:53] op_sel_hi:[1,0]
    v_pk_mul_f32 v[184:185], v[184:185], v[52:53] op_sel_hi:[1,0]
    v_pk_mul_f32 v[186:187], v[186:187], v[52:53] op_sel_hi:[1,0]
    v_cvt_pk_bf16_f32 v60, v168, v169
    v_cvt_pk_bf16_f32 v61, v170, v171
    v_cvt_pk_bf16_f32 v62, v184, v185
    v_cvt_pk_bf16_f32 v63, v186, v187
    buffer_store_dwordx4 v[60:63], v46, s[28:31], s46 offen offset:1024 sc1
    v_pk_mul_f32 v[200:201], v[200:201], v[52:53] op_sel_hi:[1,0]
    v_pk_mul_f32 v[202:203], v[202:203], v[52:53] op_sel_hi:[1,0]
    v_pk_mul_f32 v[216:217], v[216:217], v[52:53] op_sel_hi:[1,0]
    v_pk_mul_f32 v[218:219], v[218:219], v[52:53] op_sel_hi:[1,0]
    v_cvt_pk_bf16_f32 v64, v200, v201
    v_cvt_pk_bf16_f32 v65, v202, v203
    v_cvt_pk_bf16_f32 v66, v216, v217
    v_cvt_pk_bf16_f32 v67, v218, v219
    buffer_store_dwordx4 v[64:67], v46, s[28:31], s46 offen offset:2048 sc1
    v_pk_mul_f32 v[232:233], v[232:233], v[52:53] op_sel_hi:[1,0]
    v_pk_mul_f32 v[234:235], v[234:235], v[52:53] op_sel_hi:[1,0]
    v_pk_mul_f32 v[248:249], v[248:249], v[52:53] op_sel_hi:[1,0]
    v_pk_mul_f32 v[250:251], v[250:251], v[52:53] op_sel_hi:[1,0]
    v_cvt_pk_bf16_f32 v68, v232, v233
    v_cvt_pk_bf16_f32 v69, v234, v235
    v_cvt_pk_bf16_f32 v70, v248, v249
    v_cvt_pk_bf16_f32 v71, v250, v251
    buffer_store_dwordx4 v[68:71], v46, s[28:31], s46 offen offset:3072 sc1
    s_add_u32 s46, s46, 131072
    v_pk_mul_f32 v[140:141], v[140:141], v[54:55] op_sel_hi:[1,0]
    v_pk_mul_f32 v[142:143], v[142:143], v[54:55] op_sel_hi:[1,0]
    v_pk_mul_f32 v[156:157], v[156:157], v[54:55] op_sel_hi:[1,0]
    v_pk_mul_f32 v[158:159], v[158:159], v[54:55] op_sel_hi:[1,0]
    v_cvt_pk_bf16_f32 v56, v140, v141
    v_cvt_pk_bf16_f32 v57, v142, v143
    v_cvt_pk_bf16_f32 v58, v156, v157
    v_cvt_pk_bf16_f32 v59, v158, v159
    buffer_store_dwordx4 v[56:59], v46, s[28:31], s46 offen offset:0 sc1
    v_pk_mul_f32 v[172:173], v[172:173], v[54:55] op_sel_hi:[1,0]
    v_pk_mul_f32 v[174:175], v[174:175], v[54:55] op_sel_hi:[1,0]
    v_pk_mul_f32 v[188:189], v[188:189], v[54:55] op_sel_hi:[1,0]
    v_pk_mul_f32 v[190:191], v[190:191], v[54:55] op_sel_hi:[1,0]
    v_cvt_pk_bf16_f32 v60, v172, v173
    v_cvt_pk_bf16_f32 v61, v174, v175
    v_cvt_pk_bf16_f32 v62, v188, v189
    v_cvt_pk_bf16_f32 v63, v190, v191
    buffer_store_dwordx4 v[60:63], v46, s[28:31], s46 offen offset:1024 sc1
    v_pk_mul_f32 v[204:205], v[204:205], v[54:55] op_sel_hi:[1,0]
    v_pk_mul_f32 v[206:207], v[206:207], v[54:55] op_sel_hi:[1,0]
    v_pk_mul_f32 v[220:221], v[220:221], v[54:55] op_sel_hi:[1,0]
    v_pk_mul_f32 v[222:223], v[222:223], v[54:55] op_sel_hi:[1,0]
    v_cvt_pk_bf16_f32 v64, v204, v205
    v_cvt_pk_bf16_f32 v65, v206, v207
    v_cvt_pk_bf16_f32 v66, v220, v221
    v_cvt_pk_bf16_f32 v67, v222, v223
    buffer_store_dwordx4 v[64:67], v46, s[28:31], s46 offen offset:2048 sc1
    v_pk_mul_f32 v[236:237], v[236:237], v[54:55] op_sel_hi:[1,0]
    v_pk_mul_f32 v[238:239], v[238:239], v[54:55] op_sel_hi:[1,0]
    v_pk_mul_f32 v[252:253], v[252:253], v[54:55] op_sel_hi:[1,0]
    v_pk_mul_f32 v[254:255], v[254:255], v[54:55] op_sel_hi:[1,0]
    v_cvt_pk_bf16_f32 v68, v236, v237
    v_cvt_pk_bf16_f32 v69, v238, v239
    v_cvt_pk_bf16_f32 v70, v252, v253
    v_cvt_pk_bf16_f32 v71, v254, v255
    buffer_store_dwordx4 v[68:71], v46, s[28:31], s46 offen offset:3072 sc1
    s_waitcnt vmcnt(0)
    v_mov_b32 v24, 0
    v_mov_b32 v25, 1
    s_mov_b64 exec, 1
    buffer_atomic_add v25, v24, s[72:75], s47 offen sc1
    s_mov_b64 exec, -1
    s_mov_b64 s[8:9], s[56:57]
    s_and_b32 s33, s2, 7
    s_lshl_b32 s33, s33, 2
    s_lshr_b32 s34, s2, 3
    s_and_b32 s34, s34, 3
    s_add_u32 s35, s33, s34
    s_lshr_b32 s36, s2, 5
    s_lshl_b32 s37, s35, 2
    s_add_u32 s37, s37, s32
    s_lshl_b32 s38, s36, 7
    s_lshr_b32 s51, s35, 2
    s_lshl_b32 s51, s51, 10
    s_add_u32 s51, s51, 0
    v_lshlrev_b32 v28, 7, v1
    v_add_u32 v32, 22528, v28
    v_add_u32 v28, s51, v28
    v_cmp_gt_u32 vcc, 8, v1
    v_mov_b32 v29, 128
    v_mov_b32 v33, 16
    v_cndmask_b32 v28, v32, v28, vcc
    v_cndmask_b32 v29, v29, v33, vcc
    s_mov_b32 s59, 22528
    v_writelane_b32 v28, s59, 16
    v_writelane_b32 v29, 17, 16
    v_mov_b32 v31, 135968
    s_mov_b32 s57, 0
    s_lshl_b32 s46, s32, 1
    s_lshl_b32 s44, 3, s46
    s_mov_b32 s45, 0
    s_add_u32 s12, s4, 50331648
    s_addc_u32 s13, s5, 0
    s_and_b32 s13, s13, 0xffff
    s_mov_b32 s14, 4194304
    s_mov_b32 s15, 0x20000
    s_lshl_b32 s48, s36, 19
    v_lshlrev_b32 v4, 4, v1
    v_add_u32 v4, s48, v4
    s_add_u32 s16, s4, 4194304
    s_addc_u32 s17, s5, 0
    s_and_b32 s17, s17, 0xffff
    s_mov_b32 s18, 16777216
    s_mov_b32 s19, 0x20000
    s_mov_b32 s24, s4
    s_and_b32 s25, s5, 0xffff
    s_mov_b32 s26, 12288
    s_mov_b32 s27, 0x20000
    s_add_u32 s80, s4, 23068672
    s_addc_u32 s81, s5, 0
    s_and_b32 s81, s81, 0xffff
    s_mov_b32 s82, 2097152
    s_mov_b32 s83, 0x20000
    s_add_u32 s40, s4, 25165824
    s_addc_u32 s41, s5, 0
    s_and_b32 s41, s41, 0xffff
    s_mov_b32 s42, 524288
    s_mov_b32 s43, 0x20000
    s_mov_b32 s20, s6
    s_and_b32 s21, s7, 0xffff
    s_mov_b32 s22, 2097152
    s_mov_b32 s23, 0x20000
    v_lshrrev_b32 v230, 4, v1
    v_and_b32 v231, 15, v1
    v_lshlrev_b32 v232, 4, v1
    s_xor_b32 s51, s32, 0
    s_lshl_b32 s55, s35, 2
    s_add_u32 s51, s51, s55
    s_lshl_b32 s51, s51, 17
    v_add_u32 v12, s51, v232
    s_xor_b32 s51, s32, 1
    s_lshl_b32 s55, s35, 2
    s_add_u32 s51, s51, s55
    s_lshl_b32 s51, s51, 17
    v_add_u32 v13, s51, v232
    s_xor_b32 s51, s32, 2
    s_lshl_b32 s55, s35, 2
    s_add_u32 s51, s51, s55
    s_lshl_b32 s51, s51, 17
    v_add_u32 v14, s51, v232
    s_xor_b32 s51, s32, 3
    s_lshl_b32 s55, s35, 2
    s_add_u32 s51, s51, s55
    s_lshl_b32 s51, s51, 17
    v_add_u32 v15, s51, v232
    s_lshl_b32 s51, s36, 8
    v_lshlrev_b32 v233, 4, v230
    v_add_u32 v233, s51, v233
    s_lshl_b32 s51, s37, 14
    v_lshlrev_b32 v19, 10, v231
    v_add_u32 v19, s51, v19
    v_lshrrev_b32 v20, 1, v233
    v_add_u32 v19, v19, v20
    v_add_u32 v20, 4096, v233
    v_add_u32 v21, 6144, v233
    v_add_u32 v22, 8192, v233
    s_add_u32 s76, s4, 32768
    s_addc_u32 s77, s5, 0
    s_and_b32 s77, s77, 0xffff
    s_mov_b32 s78, 16384
    s_mov_b32 s79, 0x20000
    s_add_u32 s92, s4, 49152
    s_addc_u32 s93, s5, 0
    s_and_b32 s93, s93, 0xffff
    s_mov_b32 s94, 64
    s_mov_b32 s95, 0x20000
    s_mov_b32 s84, s8
    s_and_b32 s85, s9, 0xffff
    s_mov_b32 s86, 524288
    s_mov_b32 s87, 0x20000
    v_lshrrev_b32 v225, 3, v1
    v_and_b32 v224, 7, v1
    v_and_b32 v228, 6, v225
    v_xor_b32 v224, v224, v228
    s_lshl_b32 s50, s32, 3
    v_add_u32 v225, s50, v225
    s_mov_b32 s50, 1024
    v_mul_lo_u32 v225, v225, s50
    v_lshl_add_u32 v3, v224, 4, v225
    v_add_u32 v3, s38, v3
    s_lshl_b32 s90, s32, 10
    v_and_b32 v224, 15, v1
    v_lshrrev_b32 v225, 4, v1
    v_lshrrev_b32 v226, 2, v224
    v_and_b32 v227, 3, v224
    v_lshl_add_u32 v229, v225, 2, v226
    v_lshrrev_b32 v228, 1, v229
    v_and_b32 v228, 3, v228
    v_lshlrev_b32 v229, 7, v229
    v_lshl_add_u32 v229, v227, 3, v229
    v_xor_b32 v226, 0, v228
    v_lshl_add_u32 v8, v226, 5, v229
    v_xor_b32 v226, 1, v228
    v_lshl_add_u32 v9, v226, 5, v229
    v_xor_b32 v226, 2, v228
    v_lshl_add_u32 v10, v226, 5, v229
    v_xor_b32 v226, 3, v228
    v_lshl_add_u32 v11, v226, 5, v229
    v_xor_b32 v226, s32, v228
    v_lshl_add_u32 v16, v226, 5, v229
    v_mov_b32 v17, 0
    s_mov_b64 exec, 0x1ff00
    buffer_load_dword v30, v28, s[72:75], 0 offen sc1
    s_waitcnt vmcnt(0)
    s_mov_b32 s3, 100000
    s_mov_b64 exec, 0x1ff00
mega_kernel_pre5:
    v_cmp_ge_u32 vcc, v30, v29
    s_sub_u32 s3, s3, 1
    s_cmp_eq_u32 s3, 0
    s_cbranch_scc1 mega_kernel_pre4
    s_cmp_eq_u64 vcc, exec
    s_cbranch_scc1 mega_kernel_pre4
    s_sleep 16
    buffer_load_dword v30, v28, s[72:75], 0 offen sc1
    s_waitcnt vmcnt(0)
    s_branch mega_kernel_pre5
mega_kernel_pre4:
    s_mov_b64 exec, -1
    s_mov_b64 exec, -1
    s_mul_i32 s54, s32, 32768
    s_lshl_b32 s55, s32, 17
    s_add_u32 m0, s54, 0
    s_add_u32 s49, s55, 0
    buffer_load_dwordx4 v4, s[12:15], s49 offen sc1 lds
    s_add_u32 m0, s54, 1024
    s_add_u32 s49, s55, 1024
    buffer_load_dwordx4 v4, s[12:15], s49 offen sc1 lds
    s_add_u32 m0, s54, 2048
    s_add_u32 s49, s55, 2048
    buffer_load_dwordx4 v4, s[12:15], s49 offen sc1 lds
    s_add_u32 m0, s54, 3072
    s_add_u32 s49, s55, 3072
    buffer_load_dwordx4 v4, s[12:15], s49 offen sc1 lds
    s_add_u32 m0, s54, 4096
    s_add_u32 s49, s55, 4096
    buffer_load_dwordx4 v4, s[12:15], s49 offen sc1 lds
    s_add_u32 m0, s54, 5120
    s_add_u32 s49, s55, 5120
    buffer_load_dwordx4 v4, s[12:15], s49 offen sc1 lds
    s_add_u32 m0, s54, 6144
    s_add_u32 s49, s55, 6144
    buffer_load_dwordx4 v4, s[12:15], s49 offen sc1 lds
    s_add_u32 m0, s54, 7168
    s_add_u32 s49, s55, 7168
    buffer_load_dwordx4 v4, s[12:15], s49 offen sc1 lds
    s_add_u32 m0, s54, 8192
    s_add_u32 s49, s55, 8192
    buffer_load_dwordx4 v4, s[12:15], s49 offen sc1 lds
    s_add_u32 m0, s54, 9216
    s_add_u32 s49, s55, 9216
    buffer_load_dwordx4 v4, s[12:15], s49 offen sc1 lds
    s_add_u32 m0, s54, 10240
    s_add_u32 s49, s55, 10240
    buffer_load_dwordx4 v4, s[12:15], s49 offen sc1 lds
    s_add_u32 m0, s54, 11264
    s_add_u32 s49, s55, 11264
    buffer_load_dwordx4 v4, s[12:15], s49 offen sc1 lds
    s_add_u32 m0, s54, 12288
    s_add_u32 s49, s55, 12288
    buffer_load_dwordx4 v4, s[12:15], s49 offen sc1 lds
    s_add_u32 m0, s54, 13312
    s_add_u32 s49, s55, 13312
    buffer_load_dwordx4 v4, s[12:15], s49 offen sc1 lds
    s_add_u32 m0, s54, 14336
    s_add_u32 s49, s55, 14336
    buffer_load_dwordx4 v4, s[12:15], s49 offen sc1 lds
    s_add_u32 m0, s54, 15360
    s_add_u32 s49, s55, 15360
    buffer_load_dwordx4 v4, s[12:15], s49 offen sc1 lds
    s_add_u32 m0, s54, 16384
    s_add_u32 s49, s55, 65536
    buffer_load_dwordx4 v4, s[12:15], s49 offen sc1 lds
    s_add_u32 m0, s54, 17408
    s_add_u32 s49, s55, 66560
    buffer_load_dwordx4 v4, s[12:15], s49 offen sc1 lds
    s_add_u32 m0, s54, 18432
    s_add_u32 s49, s55, 67584
    buffer_load_dwordx4 v4, s[12:15], s49 offen sc1 lds
    s_add_u32 m0, s54, 19456
    s_add_u32 s49, s55, 68608
    buffer_load_dwordx4 v4, s[12:15], s49 offen sc1 lds
    s_add_u32 m0, s54, 20480
    s_add_u32 s49, s55, 69632
    buffer_load_dwordx4 v4, s[12:15], s49 offen sc1 lds
    s_add_u32 m0, s54, 21504
    s_add_u32 s49, s55, 70656
    buffer_load_dwordx4 v4, s[12:15], s49 offen sc1 lds
    s_add_u32 m0, s54, 22528
    s_add_u32 s49, s55, 71680
    buffer_load_dwordx4 v4, s[12:15], s49 offen sc1 lds
    s_add_u32 m0, s54, 23552
    s_add_u32 s49, s55, 72704
    buffer_load_dwordx4 v4, s[12:15], s49 offen sc1 lds
    s_add_u32 m0, s54, 24576
    s_add_u32 s49, s55, 73728
    buffer_load_dwordx4 v4, s[12:15], s49 offen sc1 lds
    s_add_u32 m0, s54, 25600
    s_add_u32 s49, s55, 74752
    buffer_load_dwordx4 v4, s[12:15], s49 offen sc1 lds
    s_add_u32 m0, s54, 26624
    s_add_u32 s49, s55, 75776
    buffer_load_dwordx4 v4, s[12:15], s49 offen sc1 lds
    s_add_u32 m0, s54, 27648
    s_add_u32 s49, s55, 76800
    buffer_load_dwordx4 v4, s[12:15], s49 offen sc1 lds
    s_add_u32 m0, s54, 28672
    s_add_u32 s49, s55, 77824
    buffer_load_dwordx4 v4, s[12:15], s49 offen sc1 lds
    s_add_u32 m0, s54, 29696
    s_add_u32 s49, s55, 78848
    buffer_load_dwordx4 v4, s[12:15], s49 offen sc1 lds
    s_add_u32 m0, s54, 30720
    s_add_u32 s49, s55, 79872
    buffer_load_dwordx4 v4, s[12:15], s49 offen sc1 lds
    s_add_u32 m0, s54, 31744
    s_add_u32 s49, s55, 80896
    buffer_load_dwordx4 v4, s[12:15], s49 offen sc1 lds
    s_mov_b32 s3, 100000
    s_mov_b64 exec, s[44:45]
    buffer_load_dword v30, v28, s[72:75], 0 offen sc1
    s_waitcnt vmcnt(0)
mega_kernel_cx9:
    v_cmp_ge_u32 vcc, v30, v29
    s_mov_b64 exec, 1
mega_kernel_ct6:
    s_andn2_b32 s60, vcc_lo, s57
    s_and_b32 s60, s60, 0xff
    s_cbranch_scc0 mega_kernel_cr7
    s_ff1_i32_b32 s62, s60
    s_lshl_b32 s63, 1, s62
    v_mov_b32 v32, s63
    ds_or_rtn_b32 v32, v31, v32
    s_waitcnt lgkmcnt(0)
    v_readfirstlane_b32 s60, v32
    s_or_b32 s57, s60, s63
    s_and_b32 s60, s60, s63
    s_cbranch_scc1 mega_kernel_ct6
    s_branch mega_kernel_cd8
mega_kernel_cr7:
    s_sub_u32 s3, s3, 1
    s_cmp_eq_u32 s3, 0
    s_cbranch_scc1 mega_kernel_cd8
    s_mov_b64 exec, s[44:45]
    s_sleep 8
    buffer_load_dword v30, v28, s[72:75], 0 offen sc1
    s_waitcnt vmcnt(0)
    s_branch mega_kernel_cx9
mega_kernel_cd8:
    s_mov_b64 exec, -1
    s_and_b32 s62, s62, 7
    s_lshl_b32 s63, s62, 14
    s_lshl_b32 s62, s62, 16
    s_lshr_b32 s55, s62, 16
    s_and_b32 s55, s55, 1
    s_mul_i32 s55, s55, 16384
    s_add_u32 s51, s54, s55
    v_add_u32 v5, s51, v232
    s_sub_u32 s55, 16384, s55
    s_add_u32 s51, s54, s55
    v_add_u32 v6, s51, v232
    s_add_u32 s52, s63, 0
    buffer_load_dwordx4 a[16:19], v12, s[16:19], s52 offen offset:0 sc1
    buffer_load_dwordx4 a[20:23], v13, s[16:19], s52 offen offset:0 sc1
    buffer_load_dwordx4 a[24:27], v14, s[16:19], s52 offen offset:0 sc1
    buffer_load_dwordx4 a[28:31], v15, s[16:19], s52 offen offset:0 sc1
    buffer_load_dwordx4 a[48:51], v12, s[16:19], s52 offen offset:1024 sc1
    buffer_load_dwordx4 a[52:55], v13, s[16:19], s52 offen offset:1024 sc1
    buffer_load_dwordx4 a[56:59], v14, s[16:19], s52 offen offset:1024 sc1
    buffer_load_dwordx4 a[60:63], v15, s[16:19], s52 offen offset:1024 sc1
    buffer_load_dwordx4 a[80:83], v12, s[16:19], s52 offen offset:2048 sc1
    buffer_load_dwordx4 a[84:87], v13, s[16:19], s52 offen offset:2048 sc1
    buffer_load_dwordx4 a[88:91], v14, s[16:19], s52 offen offset:2048 sc1
    buffer_load_dwordx4 a[92:95], v15, s[16:19], s52 offen offset:2048 sc1
    buffer_load_dwordx4 a[112:115], v12, s[16:19], s52 offen offset:3072 sc1
    buffer_load_dwordx4 a[116:119], v13, s[16:19], s52 offen offset:3072 sc1
    buffer_load_dwordx4 a[120:123], v14, s[16:19], s52 offen offset:3072 sc1
    buffer_load_dwordx4 a[124:127], v15, s[16:19], s52 offen offset:3072 sc1
    s_add_u32 s49, s62, 16384
    buffer_load_dwordx4 a[128:131], v4, s[12:15], s49 offen offset:0 sc1
    buffer_load_dwordx4 a[132:135], v4, s[12:15], s49 offen offset:1024 sc1
    buffer_load_dwordx4 a[136:139], v4, s[12:15], s49 offen offset:2048 sc1
    buffer_load_dwordx4 a[140:143], v4, s[12:15], s49 offen offset:3072 sc1
    s_add_u32 s52, s63, 4096
    buffer_load_dwordx4 a[144:147], v12, s[16:19], s52 offen offset:0 sc1
    buffer_load_dwordx4 a[148:151], v13, s[16:19], s52 offen offset:0 sc1
    buffer_load_dwordx4 a[152:155], v14, s[16:19], s52 offen offset:0 sc1
    buffer_load_dwordx4 a[156:159], v15, s[16:19], s52 offen offset:0 sc1
    s_add_u32 s49, s62, 20480
    buffer_load_dwordx4 a[160:163], v4, s[12:15], s49 offen offset:0 sc1
    buffer_load_dwordx4 a[164:167], v4, s[12:15], s49 offen offset:1024 sc1
    buffer_load_dwordx4 a[168:171], v4, s[12:15], s49 offen offset:2048 sc1
    buffer_load_dwordx4 a[172:175], v4, s[12:15], s49 offen offset:3072 sc1
    buffer_load_dwordx4 a[176:179], v12, s[16:19], s52 offen offset:1024 sc1
    buffer_load_dwordx4 a[180:183], v13, s[16:19], s52 offen offset:1024 sc1
    buffer_load_dwordx4 a[184:187], v14, s[16:19], s52 offen offset:1024 sc1
    buffer_load_dwordx4 a[188:191], v15, s[16:19], s52 offen offset:1024 sc1
    s_add_u32 s49, s62, 24576
    buffer_load_dwordx4 a[192:195], v4, s[12:15], s49 offen offset:0 sc1
    buffer_load_dwordx4 a[196:199], v4, s[12:15], s49 offen offset:1024 sc1
    buffer_load_dwordx4 a[200:203], v4, s[12:15], s49 offen offset:2048 sc1
    buffer_load_dwordx4 a[204:207], v4, s[12:15], s49 offen offset:3072 sc1
    buffer_load_dwordx4 a[208:211], v12, s[16:19], s52 offen offset:2048 sc1
    buffer_load_dwordx4 a[212:215], v13, s[16:19], s52 offen offset:2048 sc1
    buffer_load_dwordx4 a[216:219], v14, s[16:19], s52 offen offset:2048 sc1
    buffer_load_dwordx4 a[220:223], v15, s[16:19], s52 offen offset:2048 sc1
    s_waitcnt vmcnt(36)
    ds_read_b128 a[0:3], v5 offset:0
    ds_read_b128 a[4:7], v5 offset:1024
    ds_read_b128 a[8:11], v5 offset:2048
    ds_read_b128 a[12:15], v5 offset:3072
    s_waitcnt lgkmcnt(0)
    v_mfma_f32_16x16x32_bf16 v[160:163], a[0:3], a[16:19], 0
    v_mfma_f32_16x16x32_bf16 v[176:179], a[0:3], a[20:23], 0
    s_add_u32 s49, s62, 28672
    buffer_load_dwordx4 a[224:227], v4, s[12:15], s49 offen offset:0 sc1
    buffer_load_dwordx4 a[228:231], v4, s[12:15], s49 offen offset:1024 sc1
    buffer_load_dwordx4 a[232:235], v4, s[12:15], s49 offen offset:2048 sc1
    buffer_load_dwordx4 a[236:239], v4, s[12:15], s49 offen offset:3072 sc1
    buffer_load_dwordx4 a[240:243], v12, s[16:19], s52 offen offset:3072 sc1
    buffer_load_dwordx4 a[244:247], v13, s[16:19], s52 offen offset:3072 sc1
    buffer_load_dwordx4 a[248:251], v14, s[16:19], s52 offen offset:3072 sc1
    buffer_load_dwordx4 a[252:255], v15, s[16:19], s52 offen offset:3072 sc1
    v_mfma_f32_16x16x32_bf16 v[192:195], a[0:3], a[24:27], 0
    v_mfma_f32_16x16x32_bf16 v[208:211], a[0:3], a[28:31], 0
    v_mfma_f32_16x16x32_bf16 v[164:167], a[4:7], a[16:19], 0
    ds_read_b128 a[32:35], v5 offset:4096
    v_mfma_f32_16x16x32_bf16 v[180:183], a[4:7], a[20:23], 0
    ds_read_b128 a[36:39], v5 offset:5120
    v_mfma_f32_16x16x32_bf16 v[196:199], a[4:7], a[24:27], 0
    ds_read_b128 a[40:43], v5 offset:6144
    v_mfma_f32_16x16x32_bf16 v[212:215], a[4:7], a[28:31], 0
    ds_read_b128 a[44:47], v5 offset:7168
    v_mfma_f32_16x16x32_bf16 v[168:171], a[8:11], a[16:19], 0
    v_mfma_f32_16x16x32_bf16 v[184:187], a[8:11], a[20:23], 0
    v_mfma_f32_16x16x32_bf16 v[200:203], a[8:11], a[24:27], 0
    v_mfma_f32_16x16x32_bf16 v[216:219], a[8:11], a[28:31], 0
    v_mfma_f32_16x16x32_bf16 v[172:175], a[12:15], a[16:19], 0
    v_mfma_f32_16x16x32_bf16 v[188:191], a[12:15], a[20:23], 0
    v_mfma_f32_16x16x32_bf16 v[204:207], a[12:15], a[24:27], 0
    v_mfma_f32_16x16x32_bf16 v[220:223], a[12:15], a[28:31], 0
    s_waitcnt vmcnt(40) lgkmcnt(0)
    v_mfma_f32_16x16x32_bf16 v[160:163], a[32:35], a[48:51], v[160:163]
    v_mfma_f32_16x16x32_bf16 v[176:179], a[32:35], a[52:55], v[176:179]
    s_add_u32 s49, s62, 32768
    buffer_load_dwordx4 a[0:3], v4, s[12:15], s49 offen offset:0 sc1
    buffer_load_dwordx4 a[4:7], v4, s[12:15], s49 offen offset:1024 sc1
    buffer_load_dwordx4 a[8:11], v4, s[12:15], s49 offen offset:2048 sc1
    buffer_load_dwordx4 a[12:15], v4, s[12:15], s49 offen offset:3072 sc1
    s_add_u32 s52, s63, 8192
    buffer_load_dwordx4 a[16:19], v12, s[16:19], s52 offen offset:0 sc1
    buffer_load_dwordx4 a[20:23], v13, s[16:19], s52 offen offset:0 sc1
    buffer_load_dwordx4 a[24:27], v14, s[16:19], s52 offen offset:0 sc1
    buffer_load_dwordx4 a[28:31], v15, s[16:19], s52 offen offset:0 sc1
    v_mfma_f32_16x16x32_bf16 v[192:195], a[32:35], a[56:59], v[192:195]
    v_mfma_f32_16x16x32_bf16 v[208:211], a[32:35], a[60:63], v[208:211]
    v_mfma_f32_16x16x32_bf16 v[164:167], a[36:39], a[48:51], v[164:167]
    ds_read_b128 a[64:67], v5 offset:8192
    v_mfma_f32_16x16x32_bf16 v[180:183], a[36:39], a[52:55], v[180:183]
    ds_read_b128 a[68:71], v5 offset:9216
    v_mfma_f32_16x16x32_bf16 v[196:199], a[36:39], a[56:59], v[196:199]
    ds_read_b128 a[72:75], v5 offset:10240
    v_mfma_f32_16x16x32_bf16 v[212:215], a[36:39], a[60:63], v[212:215]
    ds_read_b128 a[76:79], v5 offset:11264
    v_mfma_f32_16x16x32_bf16 v[168:171], a[40:43], a[48:51], v[168:171]
    v_mfma_f32_16x16x32_bf16 v[184:187], a[40:43], a[52:55], v[184:187]
    v_mfma_f32_16x16x32_bf16 v[200:203], a[40:43], a[56:59], v[200:203]
    v_mfma_f32_16x16x32_bf16 v[216:219], a[40:43], a[60:63], v[216:219]
    v_mfma_f32_16x16x32_bf16 v[172:175], a[44:47], a[48:51], v[172:175]
    v_mfma_f32_16x16x32_bf16 v[188:191], a[44:47], a[52:55], v[188:191]
    v_mfma_f32_16x16x32_bf16 v[204:207], a[44:47], a[56:59], v[204:207]
    v_mfma_f32_16x16x32_bf16 v[220:223], a[44:47], a[60:63], v[220:223]
    s_waitcnt vmcnt(44) lgkmcnt(0)
    v_mfma_f32_16x16x32_bf16 v[160:163], a[64:67], a[80:83], v[160:163]
    v_mfma_f32_16x16x32_bf16 v[176:179], a[64:67], a[84:87], v[176:179]
    s_add_u32 s49, s62, 36864
    buffer_load_dwordx4 a[32:35], v4, s[12:15], s49 offen offset:0 sc1
    buffer_load_dwordx4 a[36:39], v4, s[12:15], s49 offen offset:1024 sc1
    buffer_load_dwordx4 a[40:43], v4, s[12:15], s49 offen offset:2048 sc1
    buffer_load_dwordx4 a[44:47], v4, s[12:15], s49 offen offset:3072 sc1
    buffer_load_dwordx4 a[48:51], v12, s[16:19], s52 offen offset:1024 sc1
    buffer_load_dwordx4 a[52:55], v13, s[16:19], s52 offen offset:1024 sc1
    buffer_load_dwordx4 a[56:59], v14, s[16:19], s52 offen offset:1024 sc1
    buffer_load_dwordx4 a[60:63], v15, s[16:19], s52 offen offset:1024 sc1
    v_mfma_f32_16x16x32_bf16 v[192:195], a[64:67], a[88:91], v[192:195]
    v_mfma_f32_16x16x32_bf16 v[208:211], a[64:67], a[92:95], v[208:211]
    v_mfma_f32_16x16x32_bf16 v[164:167], a[68:71], a[80:83], v[164:167]
    ds_read_b128 a[96:99], v5 offset:12288
    v_mfma_f32_16x16x32_bf16 v[180:183], a[68:71], a[84:87], v[180:183]
    ds_read_b128 a[100:103], v5 offset:13312
    v_mfma_f32_16x16x32_bf16 v[196:199], a[68:71], a[88:91], v[196:199]
    ds_read_b128 a[104:107], v5 offset:14336
    v_mfma_f32_16x16x32_bf16 v[212:215], a[68:71], a[92:95], v[212:215]
    ds_read_b128 a[108:111], v5 offset:15360
    v_mfma_f32_16x16x32_bf16 v[168:171], a[72:75], a[80:83], v[168:171]
    v_mfma_f32_16x16x32_bf16 v[184:187], a[72:75], a[84:87], v[184:187]
    v_mfma_f32_16x16x32_bf16 v[200:203], a[72:75], a[88:91], v[200:203]
    v_mfma_f32_16x16x32_bf16 v[216:219], a[72:75], a[92:95], v[216:219]
    v_mfma_f32_16x16x32_bf16 v[172:175], a[76:79], a[80:83], v[172:175]
    v_mfma_f32_16x16x32_bf16 v[188:191], a[76:79], a[84:87], v[188:191]
    v_mfma_f32_16x16x32_bf16 v[204:207], a[76:79], a[88:91], v[204:207]
    v_mfma_f32_16x16x32_bf16 v[220:223], a[76:79], a[92:95], v[220:223]
    s_waitcnt vmcnt(48) lgkmcnt(0)
    v_mfma_f32_16x16x32_bf16 v[160:163], a[96:99], a[112:115], v[160:163]
    v_mfma_f32_16x16x32_bf16 v[176:179], a[96:99], a[116:119], v[176:179]
    s_add_u32 s49, s62, 40960
    buffer_load_dwordx4 a[64:67], v4, s[12:15], s49 offen offset:0 sc1
    buffer_load_dwordx4 a[68:71], v4, s[12:15], s49 offen offset:1024 sc1
    buffer_load_dwordx4 a[72:75], v4, s[12:15], s49 offen offset:2048 sc1
    buffer_load_dwordx4 a[76:79], v4, s[12:15], s49 offen offset:3072 sc1
    buffer_load_dwordx4 a[80:83], v12, s[16:19], s52 offen offset:2048 sc1
    buffer_load_dwordx4 a[84:87], v13, s[16:19], s52 offen offset:2048 sc1
    buffer_load_dwordx4 a[88:91], v14, s[16:19], s52 offen offset:2048 sc1
    buffer_load_dwordx4 a[92:95], v15, s[16:19], s52 offen offset:2048 sc1
    v_mfma_f32_16x16x32_bf16 v[192:195], a[96:99], a[120:123], v[192:195]
    v_mfma_f32_16x16x32_bf16 v[208:211], a[96:99], a[124:127], v[208:211]
    v_mfma_f32_16x16x32_bf16 v[164:167], a[100:103], a[112:115], v[164:167]
    v_mfma_f32_16x16x32_bf16 v[180:183], a[100:103], a[116:119], v[180:183]
    v_mfma_f32_16x16x32_bf16 v[196:199], a[100:103], a[120:123], v[196:199]
    v_mfma_f32_16x16x32_bf16 v[212:215], a[100:103], a[124:127], v[212:215]
    v_mfma_f32_16x16x32_bf16 v[168:171], a[104:107], a[112:115], v[168:171]
    v_mfma_f32_16x16x32_bf16 v[184:187], a[104:107], a[116:119], v[184:187]
    v_mfma_f32_16x16x32_bf16 v[200:203], a[104:107], a[120:123], v[200:203]
    v_mfma_f32_16x16x32_bf16 v[216:219], a[104:107], a[124:127], v[216:219]
    v_mfma_f32_16x16x32_bf16 v[172:175], a[108:111], a[112:115], v[172:175]
    v_mfma_f32_16x16x32_bf16 v[188:191], a[108:111], a[116:119], v[188:191]
    v_mfma_f32_16x16x32_bf16 v[204:207], a[108:111], a[120:123], v[204:207]
    v_mfma_f32_16x16x32_bf16 v[220:223], a[108:111], a[124:127], v[220:223]
    s_waitcnt vmcnt(48)
    v_mfma_f32_16x16x32_bf16 v[160:163], a[128:131], a[144:147], v[160:163]
    v_mfma_f32_16x16x32_bf16 v[176:179], a[128:131], a[148:151], v[176:179]
    s_mov_b64 exec, s[44:45]
    buffer_load_dword v30, v28, s[72:75], 0 offen sc1
    s_mov_b64 exec, -1
    s_add_u32 s49, s62, 45056
    buffer_load_dwordx4 a[96:99], v4, s[12:15], s49 offen offset:0 sc1
    buffer_load_dwordx4 a[100:103], v4, s[12:15], s49 offen offset:1024 sc1
    buffer_load_dwordx4 a[104:107], v4, s[12:15], s49 offen offset:2048 sc1
    buffer_load_dwordx4 a[108:111], v4, s[12:15], s49 offen offset:3072 sc1
    buffer_load_dwordx4 a[112:115], v12, s[16:19], s52 offen offset:3072 sc1
    buffer_load_dwordx4 a[116:119], v13, s[16:19], s52 offen offset:3072 sc1
    buffer_load_dwordx4 a[120:123], v14, s[16:19], s52 offen offset:3072 sc1
    buffer_load_dwordx4 a[124:127], v15, s[16:19], s52 offen offset:3072 sc1
    v_mfma_f32_16x16x32_bf16 v[192:195], a[128:131], a[152:155], v[192:195]
    v_mfma_f32_16x16x32_bf16 v[208:211], a[128:131], a[156:159], v[208:211]
    v_mfma_f32_16x16x32_bf16 v[164:167], a[132:135], a[144:147], v[164:167]
    v_mfma_f32_16x16x32_bf16 v[180:183], a[132:135], a[148:151], v[180:183]
    v_mfma_f32_16x16x32_bf16 v[196:199], a[132:135], a[152:155], v[196:199]
    v_mfma_f32_16x16x32_bf16 v[212:215], a[132:135], a[156:159], v[212:215]
    v_mfma_f32_16x16x32_bf16 v[168:171], a[136:139], a[144:147], v[168:171]
    v_mfma_f32_16x16x32_bf16 v[184:187], a[136:139], a[148:151], v[184:187]
    v_mfma_f32_16x16x32_bf16 v[200:203], a[136:139], a[152:155], v[200:203]
    v_mfma_f32_16x16x32_bf16 v[216:219], a[136:139], a[156:159], v[216:219]
    v_mfma_f32_16x16x32_bf16 v[172:175], a[140:143], a[144:147], v[172:175]
    v_mfma_f32_16x16x32_bf16 v[188:191], a[140:143], a[148:151], v[188:191]
    v_mfma_f32_16x16x32_bf16 v[204:207], a[140:143], a[152:155], v[204:207]
    v_mfma_f32_16x16x32_bf16 v[220:223], a[140:143], a[156:159], v[220:223]
    s_waitcnt vmcnt(49)
    v_mfma_f32_16x16x32_bf16 v[160:163], a[160:163], a[176:179], v[160:163]
    v_mfma_f32_16x16x32_bf16 v[176:179], a[160:163], a[180:183], v[176:179]
    s_add_u32 s49, s62, 49152
    buffer_load_dwordx4 a[128:131], v4, s[12:15], s49 offen offset:0 sc1
    buffer_load_dwordx4 a[132:135], v4, s[12:15], s49 offen offset:1024 sc1
    buffer_load_dwordx4 a[136:139], v4, s[12:15], s49 offen offset:2048 sc1
    buffer_load_dwordx4 a[140:143], v4, s[12:15], s49 offen offset:3072 sc1
    s_add_u32 s52, s63, 12288
    buffer_load_dwordx4 a[144:147], v12, s[16:19], s52 offen offset:0 sc1
    buffer_load_dwordx4 a[148:151], v13, s[16:19], s52 offen offset:0 sc1
    buffer_load_dwordx4 a[152:155], v14, s[16:19], s52 offen offset:0 sc1
    buffer_load_dwordx4 a[156:159], v15, s[16:19], s52 offen offset:0 sc1
    v_mfma_f32_16x16x32_bf16 v[192:195], a[160:163], a[184:187], v[192:195]
    v_mfma_f32_16x16x32_bf16 v[208:211], a[160:163], a[188:191], v[208:211]
    v_mfma_f32_16x16x32_bf16 v[164:167], a[164:167], a[176:179], v[164:167]
    v_mfma_f32_16x16x32_bf16 v[180:183], a[164:167], a[180:183], v[180:183]
    v_mfma_f32_16x16x32_bf16 v[196:199], a[164:167], a[184:187], v[196:199]
    v_mfma_f32_16x16x32_bf16 v[212:215], a[164:167], a[188:191], v[212:215]
    v_mfma_f32_16x16x32_bf16 v[168:171], a[168:171], a[176:179], v[168:171]
    v_mfma_f32_16x16x32_bf16 v[184:187], a[168:171], a[180:183], v[184:187]
    v_mfma_f32_16x16x32_bf16 v[200:203], a[168:171], a[184:187], v[200:203]
    v_mfma_f32_16x16x32_bf16 v[216:219], a[168:171], a[188:191], v[216:219]
    v_mfma_f32_16x16x32_bf16 v[172:175], a[172:175], a[176:179], v[172:175]
    v_mfma_f32_16x16x32_bf16 v[188:191], a[172:175], a[180:183], v[188:191]
    v_mfma_f32_16x16x32_bf16 v[204:207], a[172:175], a[184:187], v[204:207]
    v_mfma_f32_16x16x32_bf16 v[220:223], a[172:175], a[188:191], v[220:223]
    s_waitcnt vmcnt(49)
    v_mfma_f32_16x16x32_bf16 v[160:163], a[192:195], a[208:211], v[160:163]
    v_mfma_f32_16x16x32_bf16 v[176:179], a[192:195], a[212:215], v[176:179]
    s_add_u32 s49, s62, 53248
    buffer_load_dwordx4 a[160:163], v4, s[12:15], s49 offen offset:0 sc1
    buffer_load_dwordx4 a[164:167], v4, s[12:15], s49 offen offset:1024 sc1
    buffer_load_dwordx4 a[168:171], v4, s[12:15], s49 offen offset:2048 sc1
    buffer_load_dwordx4 a[172:175], v4, s[12:15], s49 offen offset:3072 sc1
    buffer_load_dwordx4 a[176:179], v12, s[16:19], s52 offen offset:1024 sc1
    buffer_load_dwordx4 a[180:183], v13, s[16:19], s52 offen offset:1024 sc1
    buffer_load_dwordx4 a[184:187], v14, s[16:19], s52 offen offset:1024 sc1
    buffer_load_dwordx4 a[188:191], v15, s[16:19], s52 offen offset:1024 sc1
    v_mfma_f32_16x16x32_bf16 v[192:195], a[192:195], a[216:219], v[192:195]
    v_mfma_f32_16x16x32_bf16 v[208:211], a[192:195], a[220:223], v[208:211]
    v_mfma_f32_16x16x32_bf16 v[164:167], a[196:199], a[208:211], v[164:167]
    v_mfma_f32_16x16x32_bf16 v[180:183], a[196:199], a[212:215], v[180:183]
    v_mfma_f32_16x16x32_bf16 v[196:199], a[196:199], a[216:219], v[196:199]
    v_mfma_f32_16x16x32_bf16 v[212:215], a[196:199], a[220:223], v[212:215]
    v_mfma_f32_16x16x32_bf16 v[168:171], a[200:203], a[208:211], v[168:171]
    v_mfma_f32_16x16x32_bf16 v[184:187], a[200:203], a[212:215], v[184:187]
    v_mfma_f32_16x16x32_bf16 v[200:203], a[200:203], a[216:219], v[200:203]
    v_mfma_f32_16x16x32_bf16 v[216:219], a[200:203], a[220:223], v[216:219]
    v_mfma_f32_16x16x32_bf16 v[172:175], a[204:207], a[208:211], v[172:175]
    v_mfma_f32_16x16x32_bf16 v[188:191], a[204:207], a[212:215], v[188:191]
    v_mfma_f32_16x16x32_bf16 v[204:207], a[204:207], a[216:219], v[204:207]
    v_mfma_f32_16x16x32_bf16 v[220:223], a[204:207], a[220:223], v[220:223]
    s_waitcnt vmcnt(49)
    v_mfma_f32_16x16x32_bf16 v[160:163], a[224:227], a[240:243], v[160:163]
    v_mfma_f32_16x16x32_bf16 v[176:179], a[224:227], a[244:247], v[176:179]
    s_add_u32 s49, s62, 57344
    buffer_load_dwordx4 a[192:195], v4, s[12:15], s49 offen offset:0 sc1
    buffer_load_dwordx4 a[196:199], v4, s[12:15], s49 offen offset:1024 sc1
    buffer_load_dwordx4 a[200:203], v4, s[12:15], s49 offen offset:2048 sc1
    buffer_load_dwordx4 a[204:207], v4, s[12:15], s49 offen offset:3072 sc1
    buffer_load_dwordx4 a[208:211], v12, s[16:19], s52 offen offset:2048 sc1
    buffer_load_dwordx4 a[212:215], v13, s[16:19], s52 offen offset:2048 sc1
    buffer_load_dwordx4 a[216:219], v14, s[16:19], s52 offen offset:2048 sc1
    buffer_load_dwordx4 a[220:223], v15, s[16:19], s52 offen offset:2048 sc1
    v_mfma_f32_16x16x32_bf16 v[192:195], a[224:227], a[248:251], v[192:195]
    v_mfma_f32_16x16x32_bf16 v[208:211], a[224:227], a[252:255], v[208:211]
    v_mfma_f32_16x16x32_bf16 v[164:167], a[228:231], a[240:243], v[164:167]
    v_mfma_f32_16x16x32_bf16 v[180:183], a[228:231], a[244:247], v[180:183]
    v_mfma_f32_16x16x32_bf16 v[196:199], a[228:231], a[248:251], v[196:199]
    v_mfma_f32_16x16x32_bf16 v[212:215], a[228:231], a[252:255], v[212:215]
    v_mfma_f32_16x16x32_bf16 v[168:171], a[232:235], a[240:243], v[168:171]
    v_mfma_f32_16x16x32_bf16 v[184:187], a[232:235], a[244:247], v[184:187]
    v_mfma_f32_16x16x32_bf16 v[200:203], a[232:235], a[248:251], v[200:203]
    v_mfma_f32_16x16x32_bf16 v[216:219], a[232:235], a[252:255], v[216:219]
    v_mfma_f32_16x16x32_bf16 v[172:175], a[236:239], a[240:243], v[172:175]
    v_mfma_f32_16x16x32_bf16 v[188:191], a[236:239], a[244:247], v[188:191]
    v_mfma_f32_16x16x32_bf16 v[204:207], a[236:239], a[248:251], v[204:207]
    v_mfma_f32_16x16x32_bf16 v[220:223], a[236:239], a[252:255], v[220:223]
    s_waitcnt vmcnt(49)
    v_mfma_f32_16x16x32_bf16 v[160:163], a[0:3], a[16:19], v[160:163]
    v_mfma_f32_16x16x32_bf16 v[176:179], a[0:3], a[20:23], v[176:179]
    s_add_u32 s49, s62, 61440
    buffer_load_dwordx4 a[224:227], v4, s[12:15], s49 offen offset:0 sc1
    buffer_load_dwordx4 a[228:231], v4, s[12:15], s49 offen offset:1024 sc1
    buffer_load_dwordx4 a[232:235], v4, s[12:15], s49 offen offset:2048 sc1
    buffer_load_dwordx4 a[236:239], v4, s[12:15], s49 offen offset:3072 sc1
    buffer_load_dwordx4 a[240:243], v12, s[16:19], s52 offen offset:3072 sc1
    buffer_load_dwordx4 a[244:247], v13, s[16:19], s52 offen offset:3072 sc1
    buffer_load_dwordx4 a[248:251], v14, s[16:19], s52 offen offset:3072 sc1
    buffer_load_dwordx4 a[252:255], v15, s[16:19], s52 offen offset:3072 sc1
    v_mfma_f32_16x16x32_bf16 v[192:195], a[0:3], a[24:27], v[192:195]
    v_mfma_f32_16x16x32_bf16 v[208:211], a[0:3], a[28:31], v[208:211]
    v_mfma_f32_16x16x32_bf16 v[164:167], a[4:7], a[16:19], v[164:167]
    v_mfma_f32_16x16x32_bf16 v[180:183], a[4:7], a[20:23], v[180:183]
    v_mfma_f32_16x16x32_bf16 v[196:199], a[4:7], a[24:27], v[196:199]
    v_mfma_f32_16x16x32_bf16 v[212:215], a[4:7], a[28:31], v[212:215]
    v_mfma_f32_16x16x32_bf16 v[168:171], a[8:11], a[16:19], v[168:171]
    v_mfma_f32_16x16x32_bf16 v[184:187], a[8:11], a[20:23], v[184:187]
    v_mfma_f32_16x16x32_bf16 v[200:203], a[8:11], a[24:27], v[200:203]
    v_mfma_f32_16x16x32_bf16 v[216:219], a[8:11], a[28:31], v[216:219]
    v_mfma_f32_16x16x32_bf16 v[172:175], a[12:15], a[16:19], v[172:175]
    v_mfma_f32_16x16x32_bf16 v[188:191], a[12:15], a[20:23], v[188:191]
    v_mfma_f32_16x16x32_bf16 v[204:207], a[12:15], a[24:27], v[204:207]
    v_mfma_f32_16x16x32_bf16 v[220:223], a[12:15], a[28:31], v[220:223]
    s_waitcnt vmcnt(49)
    v_mfma_f32_16x16x32_bf16 v[160:163], a[32:35], a[48:51], v[160:163]
    v_mfma_f32_16x16x32_bf16 v[176:179], a[32:35], a[52:55], v[176:179]
    s_mov_b32 s3, 100000
    s_mov_b64 exec, s[44:45]
    s_waitcnt vmcnt(40)
mega_kernel_cx13:
    v_cmp_ge_u32 vcc, v30, v29
    s_mov_b64 exec, 1
mega_kernel_ct10:
    s_andn2_b32 s60, vcc_lo, s57
    s_and_b32 s60, s60, 0xff
    s_cbranch_scc0 mega_kernel_cr11
    s_ff1_i32_b32 s62, s60
    s_lshl_b32 s63, 1, s62
    v_mov_b32 v32, s63
    ds_or_rtn_b32 v32, v31, v32
    s_waitcnt lgkmcnt(0)
    v_readfirstlane_b32 s60, v32
    s_or_b32 s57, s60, s63
    s_and_b32 s60, s60, s63
    s_cbranch_scc1 mega_kernel_ct10
    s_branch mega_kernel_cd12
mega_kernel_cr11:
    s_sub_u32 s3, s3, 1
    s_cmp_eq_u32 s3, 0
    s_cbranch_scc1 mega_kernel_cd12
    s_mov_b64 exec, s[44:45]
    s_sleep 8
    buffer_load_dword v30, v28, s[72:75], 0 offen sc1
    s_waitcnt vmcnt(0)
    s_branch mega_kernel_cx13
mega_kernel_cd12:
    s_mov_b64 exec, -1
    s_and_b32 s62, s62, 7
    s_lshl_b32 s63, s62, 14
    s_lshl_b32 s62, s62, 16
    s_add_u32 s52, s63, 0
    buffer_load_dwordx4 a[16:19], v12, s[16:19], s52 offen offset:0 sc1
    buffer_load_dwordx4 a[20:23], v13, s[16:19], s52 offen offset:0 sc1
    buffer_load_dwordx4 a[24:27], v14, s[16:19], s52 offen offset:0 sc1
    buffer_load_dwordx4 a[28:31], v15, s[16:19], s52 offen offset:0 sc1
    v_mfma_f32_16x16x32_bf16 v[192:195], a[32:35], a[56:59], v[192:195]
    v_mfma_f32_16x16x32_bf16 v[208:211], a[32:35], a[60:63], v[208:211]
    v_mfma_f32_16x16x32_bf16 v[164:167], a[36:39], a[48:51], v[164:167]
    v_mfma_f32_16x16x32_bf16 v[180:183], a[36:39], a[52:55], v[180:183]
    v_mfma_f32_16x16x32_bf16 v[196:199], a[36:39], a[56:59], v[196:199]
    v_mfma_f32_16x16x32_bf16 v[212:215], a[36:39], a[60:63], v[212:215]
    v_mfma_f32_16x16x32_bf16 v[168:171], a[40:43], a[48:51], v[168:171]
    v_mfma_f32_16x16x32_bf16 v[184:187], a[40:43], a[52:55], v[184:187]
    v_mfma_f32_16x16x32_bf16 v[200:203], a[40:43], a[56:59], v[200:203]
    v_mfma_f32_16x16x32_bf16 v[216:219], a[40:43], a[60:63], v[216:219]
    v_mfma_f32_16x16x32_bf16 v[172:175], a[44:47], a[48:51], v[172:175]
    v_mfma_f32_16x16x32_bf16 v[188:191], a[44:47], a[52:55], v[188:191]
    v_mfma_f32_16x16x32_bf16 v[204:207], a[44:47], a[56:59], v[204:207]
    v_mfma_f32_16x16x32_bf16 v[220:223], a[44:47], a[60:63], v[220:223]
    s_waitcnt vmcnt(45)
    v_mfma_f32_16x16x32_bf16 v[160:163], a[64:67], a[80:83], v[160:163]
    v_mfma_f32_16x16x32_bf16 v[176:179], a[64:67], a[84:87], v[176:179]
    buffer_load_dwordx4 a[48:51], v12, s[16:19], s52 offen offset:1024 sc1
    buffer_load_dwordx4 a[52:55], v13, s[16:19], s52 offen offset:1024 sc1
    buffer_load_dwordx4 a[56:59], v14, s[16:19], s52 offen offset:1024 sc1
    buffer_load_dwordx4 a[60:63], v15, s[16:19], s52 offen offset:1024 sc1
    v_mfma_f32_16x16x32_bf16 v[192:195], a[64:67], a[88:91], v[192:195]
    v_mfma_f32_16x16x32_bf16 v[208:211], a[64:67], a[92:95], v[208:211]
    v_mfma_f32_16x16x32_bf16 v[164:167], a[68:71], a[80:83], v[164:167]
    v_mfma_f32_16x16x32_bf16 v[180:183], a[68:71], a[84:87], v[180:183]
    v_mfma_f32_16x16x32_bf16 v[196:199], a[68:71], a[88:91], v[196:199]
    v_mfma_f32_16x16x32_bf16 v[212:215], a[68:71], a[92:95], v[212:215]
    v_mfma_f32_16x16x32_bf16 v[168:171], a[72:75], a[80:83], v[168:171]
    v_mfma_f32_16x16x32_bf16 v[184:187], a[72:75], a[84:87], v[184:187]
    v_mfma_f32_16x16x32_bf16 v[200:203], a[72:75], a[88:91], v[200:203]
    v_mfma_f32_16x16x32_bf16 v[216:219], a[72:75], a[92:95], v[216:219]
    v_mfma_f32_16x16x32_bf16 v[172:175], a[76:79], a[80:83], v[172:175]
    v_mfma_f32_16x16x32_bf16 v[188:191], a[76:79], a[84:87], v[188:191]
    v_mfma_f32_16x16x32_bf16 v[204:207], a[76:79], a[88:91], v[204:207]
    v_mfma_f32_16x16x32_bf16 v[220:223], a[76:79], a[92:95], v[220:223]
    s_waitcnt vmcnt(40)
    v_mfma_f32_16x16x32_bf16 v[160:163], a[96:99], a[112:115], v[160:163]
    v_mfma_f32_16x16x32_bf16 v[176:179], a[96:99], a[116:119], v[176:179]
    buffer_load_dwordx4 a[80:83], v12, s[16:19], s52 offen offset:2048 sc1
    buffer_load_dwordx4 a[84:87], v13, s[16:19], s52 offen offset:2048 sc1
    buffer_load_dwordx4 a[88:91], v14, s[16:19], s52 offen offset:2048 sc1
    buffer_load_dwordx4 a[92:95], v15, s[16:19], s52 offen offset:2048 sc1
    v_mfma_f32_16x16x32_bf16 v[192:195], a[96:99], a[120:123], v[192:195]
    v_mfma_f32_16x16x32_bf16 v[208:211], a[96:99], a[124:127], v[208:211]
    v_mfma_f32_16x16x32_bf16 v[164:167], a[100:103], a[112:115], v[164:167]
    v_mfma_f32_16x16x32_bf16 v[180:183], a[100:103], a[116:119], v[180:183]
    v_mfma_f32_16x16x32_bf16 v[196:199], a[100:103], a[120:123], v[196:199]
    v_mfma_f32_16x16x32_bf16 v[212:215], a[100:103], a[124:127], v[212:215]
    v_mfma_f32_16x16x32_bf16 v[168:171], a[104:107], a[112:115], v[168:171]
    v_mfma_f32_16x16x32_bf16 v[184:187], a[104:107], a[116:119], v[184:187]
    v_mfma_f32_16x16x32_bf16 v[200:203], a[104:107], a[120:123], v[200:203]
    v_mfma_f32_16x16x32_bf16 v[216:219], a[104:107], a[124:127], v[216:219]
    v_mfma_f32_16x16x32_bf16 v[172:175], a[108:111], a[112:115], v[172:175]
    v_mfma_f32_16x16x32_bf16 v[188:191], a[108:111], a[116:119], v[188:191]
    v_mfma_f32_16x16x32_bf16 v[204:207], a[108:111], a[120:123], v[204:207]
    v_mfma_f32_16x16x32_bf16 v[220:223], a[108:111], a[124:127], v[220:223]
    s_waitcnt vmcnt(36)
    v_mfma_f32_16x16x32_bf16 v[160:163], a[128:131], a[144:147], v[160:163]
    v_mfma_f32_16x16x32_bf16 v[176:179], a[128:131], a[148:151], v[176:179]
    buffer_load_dwordx4 a[112:115], v12, s[16:19], s52 offen offset:3072 sc1
    buffer_load_dwordx4 a[116:119], v13, s[16:19], s52 offen offset:3072 sc1
    buffer_load_dwordx4 a[120:123], v14, s[16:19], s52 offen offset:3072 sc1
    buffer_load_dwordx4 a[124:127], v15, s[16:19], s52 offen offset:3072 sc1
    v_mfma_f32_16x16x32_bf16 v[192:195], a[128:131], a[152:155], v[192:195]
    v_mfma_f32_16x16x32_bf16 v[208:211], a[128:131], a[156:159], v[208:211]
    v_mfma_f32_16x16x32_bf16 v[164:167], a[132:135], a[144:147], v[164:167]
    v_mfma_f32_16x16x32_bf16 v[180:183], a[132:135], a[148:151], v[180:183]
    v_mfma_f32_16x16x32_bf16 v[196:199], a[132:135], a[152:155], v[196:199]
    v_mfma_f32_16x16x32_bf16 v[212:215], a[132:135], a[156:159], v[212:215]
    v_mfma_f32_16x16x32_bf16 v[168:171], a[136:139], a[144:147], v[168:171]
    v_mfma_f32_16x16x32_bf16 v[184:187], a[136:139], a[148:151], v[184:187]
    v_mfma_f32_16x16x32_bf16 v[200:203], a[136:139], a[152:155], v[200:203]
    v_mfma_f32_16x16x32_bf16 v[216:219], a[136:139], a[156:159], v[216:219]
    v_mfma_f32_16x16x32_bf16 v[172:175], a[140:143], a[144:147], v[172:175]
    v_mfma_f32_16x16x32_bf16 v[188:191], a[140:143], a[148:151], v[188:191]
    v_mfma_f32_16x16x32_bf16 v[204:207], a[140:143], a[152:155], v[204:207]
    v_mfma_f32_16x16x32_bf16 v[220:223], a[140:143], a[156:159], v[220:223]
    s_waitcnt vmcnt(32)
    v_mfma_f32_16x16x32_bf16 v[160:163], a[160:163], a[176:179], v[160:163]
    v_mfma_f32_16x16x32_bf16 v[176:179], a[160:163], a[180:183], v[176:179]
    s_add_u32 s49, s62, 16384
    buffer_load_dwordx4 a[128:131], v4, s[12:15], s49 offen offset:0 sc1
    buffer_load_dwordx4 a[132:135], v4, s[12:15], s49 offen offset:1024 sc1
    buffer_load_dwordx4 a[136:139], v4, s[12:15], s49 offen offset:2048 sc1
    buffer_load_dwordx4 a[140:143], v4, s[12:15], s49 offen offset:3072 sc1
    s_add_u32 s52, s63, 4096
    buffer_load_dwordx4 a[144:147], v12, s[16:19], s52 offen offset:0 sc1
    buffer_load_dwordx4 a[148:151], v13, s[16:19], s52 offen offset:0 sc1
    buffer_load_dwordx4 a[152:155], v14, s[16:19], s52 offen offset:0 sc1
    buffer_load_dwordx4 a[156:159], v15, s[16:19], s52 offen offset:0 sc1
    v_mfma_f32_16x16x32_bf16 v[192:195], a[160:163], a[184:187], v[192:195]
    v_mfma_f32_16x16x32_bf16 v[208:211], a[160:163], a[188:191], v[208:211]
    v_mfma_f32_16x16x32_bf16 v[164:167], a[164:167], a[176:179], v[164:167]
    v_mfma_f32_16x16x32_bf16 v[180:183], a[164:167], a[180:183], v[180:183]
    v_mfma_f32_16x16x32_bf16 v[196:199], a[164:167], a[184:187], v[196:199]
    v_mfma_f32_16x16x32_bf16 v[212:215], a[164:167], a[188:191], v[212:215]
    v_mfma_f32_16x16x32_bf16 v[168:171], a[168:171], a[176:179], v[168:171]
    v_mfma_f32_16x16x32_bf16 v[184:187], a[168:171], a[180:183], v[184:187]
    v_mfma_f32_16x16x32_bf16 v[200:203], a[168:171], a[184:187], v[200:203]
    v_mfma_f32_16x16x32_bf16 v[216:219], a[168:171], a[188:191], v[216:219]
    v_mfma_f32_16x16x32_bf16 v[172:175], a[172:175], a[176:179], v[172:175]
    v_mfma_f32_16x16x32_bf16 v[188:191], a[172:175], a[180:183], v[188:191]
    v_mfma_f32_16x16x32_bf16 v[204:207], a[172:175], a[184:187], v[204:207]
    v_mfma_f32_16x16x32_bf16 v[220:223], a[172:175], a[188:191], v[220:223]
    s_waitcnt vmcnt(32)
    v_mfma_f32_16x16x32_bf16 v[160:163], a[192:195], a[208:211], v[160:163]
    v_mfma_f32_16x16x32_bf16 v[176:179], a[192:195], a[212:215], v[176:179]
    s_add_u32 s49, s62, 20480
    buffer_load_dwordx4 a[160:163], v4, s[12:15], s49 offen offset:0 sc1
    buffer_load_dwordx4 a[164:167], v4, s[12:15], s49 offen offset:1024 sc1
    buffer_load_dwordx4 a[168:171], v4, s[12:15], s49 offen offset:2048 sc1
    buffer_load_dwordx4 a[172:175], v4, s[12:15], s49 offen offset:3072 sc1
    buffer_load_dwordx4 a[176:179], v12, s[16:19], s52 offen offset:1024 sc1
    buffer_load_dwordx4 a[180:183], v13, s[16:19], s52 offen offset:1024 sc1
    buffer_load_dwordx4 a[184:187], v14, s[16:19], s52 offen offset:1024 sc1
    buffer_load_dwordx4 a[188:191], v15, s[16:19], s52 offen offset:1024 sc1
    v_mfma_f32_16x16x32_bf16 v[192:195], a[192:195], a[216:219], v[192:195]
    v_mfma_f32_16x16x32_bf16 v[208:211], a[192:195], a[220:223], v[208:211]
    v_mfma_f32_16x16x32_bf16 v[164:167], a[196:199], a[208:211], v[164:167]
    v_mfma_f32_16x16x32_bf16 v[180:183], a[196:199], a[212:215], v[180:183]
    v_mfma_f32_16x16x32_bf16 v[196:199], a[196:199], a[216:219], v[196:199]
    v_mfma_f32_16x16x32_bf16 v[212:215], a[196:199], a[220:223], v[212:215]
    v_mfma_f32_16x16x32_bf16 v[168:171], a[200:203], a[208:211], v[168:171]
    v_mfma_f32_16x16x32_bf16 v[184:187], a[200:203], a[212:215], v[184:187]
    v_mfma_f32_16x16x32_bf16 v[200:203], a[200:203], a[216:219], v[200:203]
    v_mfma_f32_16x16x32_bf16 v[216:219], a[200:203], a[220:223], v[216:219]
    v_mfma_f32_16x16x32_bf16 v[172:175], a[204:207], a[208:211], v[172:175]
    v_mfma_f32_16x16x32_bf16 v[188:191], a[204:207], a[212:215], v[188:191]
    v_mfma_f32_16x16x32_bf16 v[204:207], a[204:207], a[216:219], v[204:207]
    v_mfma_f32_16x16x32_bf16 v[220:223], a[204:207], a[220:223], v[220:223]
    s_waitcnt vmcnt(32)
    v_mfma_f32_16x16x32_bf16 v[160:163], a[224:227], a[240:243], v[160:163]
    v_mfma_f32_16x16x32_bf16 v[176:179], a[224:227], a[244:247], v[176:179]
    s_add_u32 s49, s62, 24576
    buffer_load_dwordx4 a[192:195], v4, s[12:15], s49 offen offset:0 sc1
    buffer_load_dwordx4 a[196:199], v4, s[12:15], s49 offen offset:1024 sc1
    buffer_load_dwordx4 a[200:203], v4, s[12:15], s49 offen offset:2048 sc1
    buffer_load_dwordx4 a[204:207], v4, s[12:15], s49 offen offset:3072 sc1
    buffer_load_dwordx4 a[208:211], v12, s[16:19], s52 offen offset:2048 sc1
    buffer_load_dwordx4 a[212:215], v13, s[16:19], s52 offen offset:2048 sc1
    buffer_load_dwordx4 a[216:219], v14, s[16:19], s52 offen offset:2048 sc1
    buffer_load_dwordx4 a[220:223], v15, s[16:19], s52 offen offset:2048 sc1
    v_mfma_f32_16x16x32_bf16 v[192:195], a[224:227], a[248:251], v[192:195]
    v_mfma_f32_16x16x32_bf16 v[208:211], a[224:227], a[252:255], v[208:211]
    v_mfma_f32_16x16x32_bf16 v[164:167], a[228:231], a[240:243], v[164:167]
    ds_read_b128 a[0:3], v6 offset:0
    v_mfma_f32_16x16x32_bf16 v[180:183], a[228:231], a[244:247], v[180:183]
    ds_read_b128 a[4:7], v6 offset:1024
    v_mfma_f32_16x16x32_bf16 v[196:199], a[228:231], a[248:251], v[196:199]
    ds_read_b128 a[8:11], v6 offset:2048
    v_mfma_f32_16x16x32_bf16 v[212:215], a[228:231], a[252:255], v[212:215]
    ds_read_b128 a[12:15], v6 offset:3072
    v_mfma_f32_16x16x32_bf16 v[168:171], a[232:235], a[240:243], v[168:171]
    v_mfma_f32_16x16x32_bf16 v[184:187], a[232:235], a[244:247], v[184:187]
    v_mfma_f32_16x16x32_bf16 v[200:203], a[232:235], a[248:251], v[200:203]
    v_mfma_f32_16x16x32_bf16 v[216:219], a[232:235], a[252:255], v[216:219]
    v_mfma_f32_16x16x32_bf16 v[172:175], a[236:239], a[240:243], v[172:175]
    v_mfma_f32_16x16x32_bf16 v[188:191], a[236:239], a[244:247], v[188:191]
    v_mfma_f32_16x16x32_bf16 v[204:207], a[236:239], a[248:251], v[204:207]
    v_mfma_f32_16x16x32_bf16 v[220:223], a[236:239], a[252:255], v[220:223]
    s_waitcnt vmcnt(36) lgkmcnt(0)
    v_mfma_f32_16x16x32_bf16 v[160:163], a[0:3], a[16:19], v[160:163]
    v_mfma_f32_16x16x32_bf16 v[176:179], a[0:3], a[20:23], v[176:179]
    s_add_u32 s49, s62, 28672
    buffer_load_dwordx4 a[224:227], v4, s[12:15], s49 offen offset:0 sc1
    buffer_load_dwordx4 a[228:231], v4, s[12:15], s49 offen offset:1024 sc1
    buffer_load_dwordx4 a[232:235], v4, s[12:15], s49 offen offset:2048 sc1
    buffer_load_dwordx4 a[236:239], v4, s[12:15], s49 offen offset:3072 sc1
    buffer_load_dwordx4 a[240:243], v12, s[16:19], s52 offen offset:3072 sc1
    buffer_load_dwordx4 a[244:247], v13, s[16:19], s52 offen offset:3072 sc1
    buffer_load_dwordx4 a[248:251], v14, s[16:19], s52 offen offset:3072 sc1
    buffer_load_dwordx4 a[252:255], v15, s[16:19], s52 offen offset:3072 sc1
    v_mfma_f32_16x16x32_bf16 v[192:195], a[0:3], a[24:27], v[192:195]
    v_mfma_f32_16x16x32_bf16 v[208:211], a[0:3], a[28:31], v[208:211]
    v_mfma_f32_16x16x32_bf16 v[164:167], a[4:7], a[16:19], v[164:167]
    ds_read_b128 a[32:35], v6 offset:4096
    v_mfma_f32_16x16x32_bf16 v[180:183], a[4:7], a[20:23], v[180:183]
    ds_read_b128 a[36:39], v6 offset:5120
    v_mfma_f32_16x16x32_bf16 v[196:199], a[4:7], a[24:27], v[196:199]
    ds_read_b128 a[40:43], v6 offset:6144
    v_mfma_f32_16x16x32_bf16 v[212:215], a[4:7], a[28:31], v[212:215]
    ds_read_b128 a[44:47], v6 offset:7168
    v_mfma_f32_16x16x32_bf16 v[168:171], a[8:11], a[16:19], v[168:171]
    v_mfma_f32_16x16x32_bf16 v[184:187], a[8:11], a[20:23], v[184:187]
    v_mfma_f32_16x16x32_bf16 v[200:203], a[8:11], a[24:27], v[200:203]
    v_mfma_f32_16x16x32_bf16 v[216:219], a[8:11], a[28:31], v[216:219]
    v_mfma_f32_16x16x32_bf16 v[172:175], a[12:15], a[16:19], v[172:175]
    v_mfma_f32_16x16x32_bf16 v[188:191], a[12:15], a[20:23], v[188:191]
    v_mfma_f32_16x16x32_bf16 v[204:207], a[12:15], a[24:27], v[204:207]
    v_mfma_f32_16x16x32_bf16 v[220:223], a[12:15], a[28:31], v[220:223]
    s_waitcnt vmcnt(40) lgkmcnt(0)
    v_mfma_f32_16x16x32_bf16 v[160:163], a[32:35], a[48:51], v[160:163]
    v_mfma_f32_16x16x32_bf16 v[176:179], a[32:35], a[52:55], v[176:179]
    s_add_u32 s49, s62, 32768
    buffer_load_dwordx4 a[0:3], v4, s[12:15], s49 offen offset:0 sc1
    buffer_load_dwordx4 a[4:7], v4, s[12:15], s49 offen offset:1024 sc1
    buffer_load_dwordx4 a[8:11], v4, s[12:15], s49 offen offset:2048 sc1
    buffer_load_dwordx4 a[12:15], v4, s[12:15], s49 offen offset:3072 sc1
    s_add_u32 s52, s63, 8192
    buffer_load_dwordx4 a[16:19], v12, s[16:19], s52 offen offset:0 sc1
    buffer_load_dwordx4 a[20:23], v13, s[16:19], s52 offen offset:0 sc1
    buffer_load_dwordx4 a[24:27], v14, s[16:19], s52 offen offset:0 sc1
    buffer_load_dwordx4 a[28:31], v15, s[16:19], s52 offen offset:0 sc1
    v_mfma_f32_16x16x32_bf16 v[192:195], a[32:35], a[56:59], v[192:195]
    v_mfma_f32_16x16x32_bf16 v[208:211], a[32:35], a[60:63], v[208:211]
    v_mfma_f32_16x16x32_bf16 v[164:167], a[36:39], a[48:51], v[164:167]
    ds_read_b128 a[64:67], v6 offset:8192
    v_mfma_f32_16x16x32_bf16 v[180:183], a[36:39], a[52:55], v[180:183]
    ds_read_b128 a[68:71], v6 offset:9216
    v_mfma_f32_16x16x32_bf16 v[196:199], a[36:39], a[56:59], v[196:199]
    ds_read_b128 a[72:75], v6 offset:10240
    v_mfma_f32_16x16x32_bf16 v[212:215], a[36:39], a[60:63], v[212:215]
    ds_read_b128 a[76:79], v6 offset:11264
    v_mfma_f32_16x16x32_bf16 v[168:171], a[40:43], a[48:51], v[168:171]
    v_mfma_f32_16x16x32_bf16 v[184:187], a[40:43], a[52:55], v[184:187]
    v_mfma_f32_16x16x32_bf16 v[200:203], a[40:43], a[56:59], v[200:203]
    v_mfma_f32_16x16x32_bf16 v[216:219], a[40:43], a[60:63], v[216:219]
    v_mfma_f32_16x16x32_bf16 v[172:175], a[44:47], a[48:51], v[172:175]
    v_mfma_f32_16x16x32_bf16 v[188:191], a[44:47], a[52:55], v[188:191]
    v_mfma_f32_16x16x32_bf16 v[204:207], a[44:47], a[56:59], v[204:207]
    v_mfma_f32_16x16x32_bf16 v[220:223], a[44:47], a[60:63], v[220:223]
    s_waitcnt vmcnt(44) lgkmcnt(0)
    v_mfma_f32_16x16x32_bf16 v[160:163], a[64:67], a[80:83], v[160:163]
    v_mfma_f32_16x16x32_bf16 v[176:179], a[64:67], a[84:87], v[176:179]
    s_add_u32 s49, s62, 36864
    buffer_load_dwordx4 a[32:35], v4, s[12:15], s49 offen offset:0 sc1
    buffer_load_dwordx4 a[36:39], v4, s[12:15], s49 offen offset:1024 sc1
    buffer_load_dwordx4 a[40:43], v4, s[12:15], s49 offen offset:2048 sc1
    buffer_load_dwordx4 a[44:47], v4, s[12:15], s49 offen offset:3072 sc1
    buffer_load_dwordx4 a[48:51], v12, s[16:19], s52 offen offset:1024 sc1
    buffer_load_dwordx4 a[52:55], v13, s[16:19], s52 offen offset:1024 sc1
    buffer_load_dwordx4 a[56:59], v14, s[16:19], s52 offen offset:1024 sc1
    buffer_load_dwordx4 a[60:63], v15, s[16:19], s52 offen offset:1024 sc1
    v_mfma_f32_16x16x32_bf16 v[192:195], a[64:67], a[88:91], v[192:195]
    v_mfma_f32_16x16x32_bf16 v[208:211], a[64:67], a[92:95], v[208:211]
    v_mfma_f32_16x16x32_bf16 v[164:167], a[68:71], a[80:83], v[164:167]
    ds_read_b128 a[96:99], v6 offset:12288
    v_mfma_f32_16x16x32_bf16 v[180:183], a[68:71], a[84:87], v[180:183]
    ds_read_b128 a[100:103], v6 offset:13312
    v_mfma_f32_16x16x32_bf16 v[196:199], a[68:71], a[88:91], v[196:199]
    ds_read_b128 a[104:107], v6 offset:14336
    v_mfma_f32_16x16x32_bf16 v[212:215], a[68:71], a[92:95], v[212:215]
    ds_read_b128 a[108:111], v6 offset:15360
    v_mfma_f32_16x16x32_bf16 v[168:171], a[72:75], a[80:83], v[168:171]
    v_mfma_f32_16x16x32_bf16 v[184:187], a[72:75], a[84:87], v[184:187]
    v_mfma_f32_16x16x32_bf16 v[200:203], a[72:75], a[88:91], v[200:203]
    v_mfma_f32_16x16x32_bf16 v[216:219], a[72:75], a[92:95], v[216:219]
    v_mfma_f32_16x16x32_bf16 v[172:175], a[76:79], a[80:83], v[172:175]
    v_mfma_f32_16x16x32_bf16 v[188:191], a[76:79], a[84:87], v[188:191]
    v_mfma_f32_16x16x32_bf16 v[204:207], a[76:79], a[88:91], v[204:207]
    v_mfma_f32_16x16x32_bf16 v[220:223], a[76:79], a[92:95], v[220:223]
    s_waitcnt vmcnt(48) lgkmcnt(0)
    v_mfma_f32_16x16x32_bf16 v[160:163], a[96:99], a[112:115], v[160:163]
    v_mfma_f32_16x16x32_bf16 v[176:179], a[96:99], a[116:119], v[176:179]
    s_add_u32 s49, s62, 40960
    buffer_load_dwordx4 a[64:67], v4, s[12:15], s49 offen offset:0 sc1
    buffer_load_dwordx4 a[68:71], v4, s[12:15], s49 offen offset:1024 sc1
    buffer_load_dwordx4 a[72:75], v4, s[12:15], s49 offen offset:2048 sc1
    buffer_load_dwordx4 a[76:79], v4, s[12:15], s49 offen offset:3072 sc1
    buffer_load_dwordx4 a[80:83], v12, s[16:19], s52 offen offset:2048 sc1
    buffer_load_dwordx4 a[84:87], v13, s[16:19], s52 offen offset:2048 sc1
    buffer_load_dwordx4 a[88:91], v14, s[16:19], s52 offen offset:2048 sc1
    buffer_load_dwordx4 a[92:95], v15, s[16:19], s52 offen offset:2048 sc1
    v_mfma_f32_16x16x32_bf16 v[192:195], a[96:99], a[120:123], v[192:195]
    v_mfma_f32_16x16x32_bf16 v[208:211], a[96:99], a[124:127], v[208:211]
    v_mfma_f32_16x16x32_bf16 v[164:167], a[100:103], a[112:115], v[164:167]
    v_mfma_f32_16x16x32_bf16 v[180:183], a[100:103], a[116:119], v[180:183]
    v_mfma_f32_16x16x32_bf16 v[196:199], a[100:103], a[120:123], v[196:199]
    v_mfma_f32_16x16x32_bf16 v[212:215], a[100:103], a[124:127], v[212:215]
    v_mfma_f32_16x16x32_bf16 v[168:171], a[104:107], a[112:115], v[168:171]
    v_mfma_f32_16x16x32_bf16 v[184:187], a[104:107], a[116:119], v[184:187]
    v_mfma_f32_16x16x32_bf16 v[200:203], a[104:107], a[120:123], v[200:203]
    v_mfma_f32_16x16x32_bf16 v[216:219], a[104:107], a[124:127], v[216:219]
    v_mfma_f32_16x16x32_bf16 v[172:175], a[108:111], a[112:115], v[172:175]
    v_mfma_f32_16x16x32_bf16 v[188:191], a[108:111], a[116:119], v[188:191]
    v_mfma_f32_16x16x32_bf16 v[204:207], a[108:111], a[120:123], v[204:207]
    v_mfma_f32_16x16x32_bf16 v[220:223], a[108:111], a[124:127], v[220:223]
    s_waitcnt vmcnt(48)
    v_mfma_f32_16x16x32_bf16 v[160:163], a[128:131], a[144:147], v[160:163]
    v_mfma_f32_16x16x32_bf16 v[176:179], a[128:131], a[148:151], v[176:179]
    s_add_u32 s49, s62, 45056
    buffer_load_dwordx4 a[96:99], v4, s[12:15], s49 offen offset:0 sc1
    buffer_load_dwordx4 a[100:103], v4, s[12:15], s49 offen offset:1024 sc1
    buffer_load_dwordx4 a[104:107], v4, s[12:15], s49 offen offset:2048 sc1
    buffer_load_dwordx4 a[108:111], v4, s[12:15], s49 offen offset:3072 sc1
    buffer_load_dwordx4 a[112:115], v12, s[16:19], s52 offen offset:3072 sc1
    buffer_load_dwordx4 a[116:119], v13, s[16:19], s52 offen offset:3072 sc1
    buffer_load_dwordx4 a[120:123], v14, s[16:19], s52 offen offset:3072 sc1
    buffer_load_dwordx4 a[124:127], v15, s[16:19], s52 offen offset:3072 sc1
    v_mfma_f32_16x16x32_bf16 v[192:195], a[128:131], a[152:155], v[192:195]
    v_mfma_f32_16x16x32_bf16 v[208:211], a[128:131], a[156:159], v[208:211]
    v_mfma_f32_16x16x32_bf16 v[164:167], a[132:135], a[144:147], v[164:167]
    v_mfma_f32_16x16x32_bf16 v[180:183], a[132:135], a[148:151], v[180:183]
    v_mfma_f32_16x16x32_bf16 v[196:199], a[132:135], a[152:155], v[196:199]
    v_mfma_f32_16x16x32_bf16 v[212:215], a[132:135], a[156:159], v[212:215]
    v_mfma_f32_16x16x32_bf16 v[168:171], a[136:139], a[144:147], v[168:171]
    v_mfma_f32_16x16x32_bf16 v[184:187], a[136:139], a[148:151], v[184:187]
    v_mfma_f32_16x16x32_bf16 v[200:203], a[136:139], a[152:155], v[200:203]
    v_mfma_f32_16x16x32_bf16 v[216:219], a[136:139], a[156:159], v[216:219]
    v_mfma_f32_16x16x32_bf16 v[172:175], a[140:143], a[144:147], v[172:175]
    v_mfma_f32_16x16x32_bf16 v[188:191], a[140:143], a[148:151], v[188:191]
    v_mfma_f32_16x16x32_bf16 v[204:207], a[140:143], a[152:155], v[204:207]
    v_mfma_f32_16x16x32_bf16 v[220:223], a[140:143], a[156:159], v[220:223]
    s_waitcnt vmcnt(48)
    v_mfma_f32_16x16x32_bf16 v[160:163], a[160:163], a[176:179], v[160:163]
    v_mfma_f32_16x16x32_bf16 v[176:179], a[160:163], a[180:183], v[176:179]
    s_add_u32 s49, s62, 49152
    buffer_load_dwordx4 a[128:131], v4, s[12:15], s49 offen offset:0 sc1
    buffer_load_dwordx4 a[132:135], v4, s[12:15], s49 offen offset:1024 sc1
    buffer_load_dwordx4 a[136:139], v4, s[12:15], s49 offen offset:2048 sc1
    buffer_load_dwordx4 a[140:143], v4, s[12:15], s49 offen offset:3072 sc1
    s_add_u32 s52, s63, 12288
    buffer_load_dwordx4 a[144:147], v12, s[16:19], s52 offen offset:0 sc1
    buffer_load_dwordx4 a[148:151], v13, s[16:19], s52 offen offset:0 sc1
    buffer_load_dwordx4 a[152:155], v14, s[16:19], s52 offen offset:0 sc1
    buffer_load_dwordx4 a[156:159], v15, s[16:19], s52 offen offset:0 sc1
    v_mfma_f32_16x16x32_bf16 v[192:195], a[160:163], a[184:187], v[192:195]
    v_mfma_f32_16x16x32_bf16 v[208:211], a[160:163], a[188:191], v[208:211]
    v_mfma_f32_16x16x32_bf16 v[164:167], a[164:167], a[176:179], v[164:167]
    v_mfma_f32_16x16x32_bf16 v[180:183], a[164:167], a[180:183], v[180:183]
    v_mfma_f32_16x16x32_bf16 v[196:199], a[164:167], a[184:187], v[196:199]
    v_mfma_f32_16x16x32_bf16 v[212:215], a[164:167], a[188:191], v[212:215]
    v_mfma_f32_16x16x32_bf16 v[168:171], a[168:171], a[176:179], v[168:171]
    v_mfma_f32_16x16x32_bf16 v[184:187], a[168:171], a[180:183], v[184:187]
    v_mfma_f32_16x16x32_bf16 v[200:203], a[168:171], a[184:187], v[200:203]
    v_mfma_f32_16x16x32_bf16 v[216:219], a[168:171], a[188:191], v[216:219]
    v_mfma_f32_16x16x32_bf16 v[172:175], a[172:175], a[176:179], v[172:175]
    v_mfma_f32_16x16x32_bf16 v[188:191], a[172:175], a[180:183], v[188:191]
    v_mfma_f32_16x16x32_bf16 v[204:207], a[172:175], a[184:187], v[204:207]
    v_mfma_f32_16x16x32_bf16 v[220:223], a[172:175], a[188:191], v[220:223]
    s_waitcnt vmcnt(48)
    v_mfma_f32_16x16x32_bf16 v[160:163], a[192:195], a[208:211], v[160:163]
    v_mfma_f32_16x16x32_bf16 v[176:179], a[192:195], a[212:215], v[176:179]
    s_add_u32 s49, s62, 53248
    buffer_load_dwordx4 a[160:163], v4, s[12:15], s49 offen offset:0 sc1
    buffer_load_dwordx4 a[164:167], v4, s[12:15], s49 offen offset:1024 sc1
    buffer_load_dwordx4 a[168:171], v4, s[12:15], s49 offen offset:2048 sc1
    buffer_load_dwordx4 a[172:175], v4, s[12:15], s49 offen offset:3072 sc1
    buffer_load_dwordx4 a[176:179], v12, s[16:19], s52 offen offset:1024 sc1
    buffer_load_dwordx4 a[180:183], v13, s[16:19], s52 offen offset:1024 sc1
    buffer_load_dwordx4 a[184:187], v14, s[16:19], s52 offen offset:1024 sc1
    buffer_load_dwordx4 a[188:191], v15, s[16:19], s52 offen offset:1024 sc1
    v_mfma_f32_16x16x32_bf16 v[192:195], a[192:195], a[216:219], v[192:195]
    v_mfma_f32_16x16x32_bf16 v[208:211], a[192:195], a[220:223], v[208:211]
    v_mfma_f32_16x16x32_bf16 v[164:167], a[196:199], a[208:211], v[164:167]
    v_mfma_f32_16x16x32_bf16 v[180:183], a[196:199], a[212:215], v[180:183]
    v_mfma_f32_16x16x32_bf16 v[196:199], a[196:199], a[216:219], v[196:199]
    v_mfma_f32_16x16x32_bf16 v[212:215], a[196:199], a[220:223], v[212:215]
    v_mfma_f32_16x16x32_bf16 v[168:171], a[200:203], a[208:211], v[168:171]
    v_mfma_f32_16x16x32_bf16 v[184:187], a[200:203], a[212:215], v[184:187]
    v_mfma_f32_16x16x32_bf16 v[200:203], a[200:203], a[216:219], v[200:203]
    v_mfma_f32_16x16x32_bf16 v[216:219], a[200:203], a[220:223], v[216:219]
    v_mfma_f32_16x16x32_bf16 v[172:175], a[204:207], a[208:211], v[172:175]
    v_mfma_f32_16x16x32_bf16 v[188:191], a[204:207], a[212:215], v[188:191]
    v_mfma_f32_16x16x32_bf16 v[204:207], a[204:207], a[216:219], v[204:207]
    v_mfma_f32_16x16x32_bf16 v[220:223], a[204:207], a[220:223], v[220:223]
    s_waitcnt vmcnt(48)
    v_mfma_f32_16x16x32_bf16 v[160:163], a[224:227], a[240:243], v[160:163]
    v_mfma_f32_16x16x32_bf16 v[176:179], a[224:227], a[244:247], v[176:179]
    s_add_u32 s49, s62, 57344
    buffer_load_dwordx4 a[192:195], v4, s[12:15], s49 offen offset:0 sc1
    buffer_load_dwordx4 a[196:199], v4, s[12:15], s49 offen offset:1024 sc1
    buffer_load_dwordx4 a[200:203], v4, s[12:15], s49 offen offset:2048 sc1
    buffer_load_dwordx4 a[204:207], v4, s[12:15], s49 offen offset:3072 sc1
    buffer_load_dwordx4 a[208:211], v12, s[16:19], s52 offen offset:2048 sc1
    buffer_load_dwordx4 a[212:215], v13, s[16:19], s52 offen offset:2048 sc1
    buffer_load_dwordx4 a[216:219], v14, s[16:19], s52 offen offset:2048 sc1
    buffer_load_dwordx4 a[220:223], v15, s[16:19], s52 offen offset:2048 sc1
    v_mfma_f32_16x16x32_bf16 v[192:195], a[224:227], a[248:251], v[192:195]
    v_mfma_f32_16x16x32_bf16 v[208:211], a[224:227], a[252:255], v[208:211]
    v_mfma_f32_16x16x32_bf16 v[164:167], a[228:231], a[240:243], v[164:167]
    v_mfma_f32_16x16x32_bf16 v[180:183], a[228:231], a[244:247], v[180:183]
    v_mfma_f32_16x16x32_bf16 v[196:199], a[228:231], a[248:251], v[196:199]
    v_mfma_f32_16x16x32_bf16 v[212:215], a[228:231], a[252:255], v[212:215]
    v_mfma_f32_16x16x32_bf16 v[168:171], a[232:235], a[240:243], v[168:171]
    v_mfma_f32_16x16x32_bf16 v[184:187], a[232:235], a[244:247], v[184:187]
    v_mfma_f32_16x16x32_bf16 v[200:203], a[232:235], a[248:251], v[200:203]
    v_mfma_f32_16x16x32_bf16 v[216:219], a[232:235], a[252:255], v[216:219]
    v_mfma_f32_16x16x32_bf16 v[172:175], a[236:239], a[240:243], v[172:175]
    v_mfma_f32_16x16x32_bf16 v[188:191], a[236:239], a[244:247], v[188:191]
    v_mfma_f32_16x16x32_bf16 v[204:207], a[236:239], a[248:251], v[204:207]
    v_mfma_f32_16x16x32_bf16 v[220:223], a[236:239], a[252:255], v[220:223]
    s_waitcnt vmcnt(48)
    v_mfma_f32_16x16x32_bf16 v[160:163], a[0:3], a[16:19], v[160:163]
    v_mfma_f32_16x16x32_bf16 v[176:179], a[0:3], a[20:23], v[176:179]
    s_add_u32 s49, s62, 61440
    buffer_load_dwordx4 a[224:227], v4, s[12:15], s49 offen offset:0 sc1
    buffer_load_dwordx4 a[228:231], v4, s[12:15], s49 offen offset:1024 sc1
    buffer_load_dwordx4 a[232:235], v4, s[12:15], s49 offen offset:2048 sc1
    buffer_load_dwordx4 a[236:239], v4, s[12:15], s49 offen offset:3072 sc1
    buffer_load_dwordx4 a[240:243], v12, s[16:19], s52 offen offset:3072 sc1
    buffer_load_dwordx4 a[244:247], v13, s[16:19], s52 offen offset:3072 sc1
    buffer_load_dwordx4 a[248:251], v14, s[16:19], s52 offen offset:3072 sc1
    buffer_load_dwordx4 a[252:255], v15, s[16:19], s52 offen offset:3072 sc1
    v_mfma_f32_16x16x32_bf16 v[192:195], a[0:3], a[24:27], v[192:195]
    v_mfma_f32_16x16x32_bf16 v[208:211], a[0:3], a[28:31], v[208:211]
    v_mfma_f32_16x16x32_bf16 v[164:167], a[4:7], a[16:19], v[164:167]
    v_mfma_f32_16x16x32_bf16 v[180:183], a[4:7], a[20:23], v[180:183]
    v_mfma_f32_16x16x32_bf16 v[196:199], a[4:7], a[24:27], v[196:199]
    v_mfma_f32_16x16x32_bf16 v[212:215], a[4:7], a[28:31], v[212:215]
    v_mfma_f32_16x16x32_bf16 v[168:171], a[8:11], a[16:19], v[168:171]
    v_mfma_f32_16x16x32_bf16 v[184:187], a[8:11], a[20:23], v[184:187]
    v_mfma_f32_16x16x32_bf16 v[200:203], a[8:11], a[24:27], v[200:203]
    v_mfma_f32_16x16x32_bf16 v[216:219], a[8:11], a[28:31], v[216:219]
    v_mfma_f32_16x16x32_bf16 v[172:175], a[12:15], a[16:19], v[172:175]
    v_mfma_f32_16x16x32_bf16 v[188:191], a[12:15], a[20:23], v[188:191]
    v_mfma_f32_16x16x32_bf16 v[204:207], a[12:15], a[24:27], v[204:207]
    v_mfma_f32_16x16x32_bf16 v[220:223], a[12:15], a[28:31], v[220:223]
    s_waitcnt vmcnt(48)
    v_mfma_f32_16x16x32_bf16 v[160:163], a[32:35], a[48:51], v[160:163]
    v_mfma_f32_16x16x32_bf16 v[176:179], a[32:35], a[52:55], v[176:179]
    v_mfma_f32_16x16x32_bf16 v[192:195], a[32:35], a[56:59], v[192:195]
    v_mfma_f32_16x16x32_bf16 v[208:211], a[32:35], a[60:63], v[208:211]
    v_mfma_f32_16x16x32_bf16 v[164:167], a[36:39], a[48:51], v[164:167]
    v_mfma_f32_16x16x32_bf16 v[180:183], a[36:39], a[52:55], v[180:183]
    v_mfma_f32_16x16x32_bf16 v[196:199], a[36:39], a[56:59], v[196:199]
    v_mfma_f32_16x16x32_bf16 v[212:215], a[36:39], a[60:63], v[212:215]
    v_mfma_f32_16x16x32_bf16 v[168:171], a[40:43], a[48:51], v[168:171]
    v_mfma_f32_16x16x32_bf16 v[184:187], a[40:43], a[52:55], v[184:187]
    v_mfma_f32_16x16x32_bf16 v[200:203], a[40:43], a[56:59], v[200:203]
    v_mfma_f32_16x16x32_bf16 v[216:219], a[40:43], a[60:63], v[216:219]
    v_mfma_f32_16x16x32_bf16 v[172:175], a[44:47], a[48:51], v[172:175]
    v_mfma_f32_16x16x32_bf16 v[188:191], a[44:47], a[52:55], v[188:191]
    v_mfma_f32_16x16x32_bf16 v[204:207], a[44:47], a[56:59], v[204:207]
    v_mfma_f32_16x16x32_bf16 v[220:223], a[44:47], a[60:63], v[220:223]
    s_waitcnt vmcnt(40)
    v_mfma_f32_16x16x32_bf16 v[160:163], a[64:67], a[80:83], v[160:163]
    v_mfma_f32_16x16x32_bf16 v[176:179], a[64:67], a[84:87], v[176:179]
    v_mfma_f32_16x16x32_bf16 v[192:195], a[64:67], a[88:91], v[192:195]
    v_mfma_f32_16x16x32_bf16 v[208:211], a[64:67], a[92:95], v[208:211]
    v_mfma_f32_16x16x32_bf16 v[164:167], a[68:71], a[80:83], v[164:167]
    v_mfma_f32_16x16x32_bf16 v[180:183], a[68:71], a[84:87], v[180:183]
    v_mfma_f32_16x16x32_bf16 v[196:199], a[68:71], a[88:91], v[196:199]
    v_mfma_f32_16x16x32_bf16 v[212:215], a[68:71], a[92:95], v[212:215]
    v_mfma_f32_16x16x32_bf16 v[168:171], a[72:75], a[80:83], v[168:171]
    v_mfma_f32_16x16x32_bf16 v[184:187], a[72:75], a[84:87], v[184:187]
    v_mfma_f32_16x16x32_bf16 v[200:203], a[72:75], a[88:91], v[200:203]
    v_mfma_f32_16x16x32_bf16 v[216:219], a[72:75], a[92:95], v[216:219]
    v_mfma_f32_16x16x32_bf16 v[172:175], a[76:79], a[80:83], v[172:175]
    v_mfma_f32_16x16x32_bf16 v[188:191], a[76:79], a[84:87], v[188:191]
    v_mfma_f32_16x16x32_bf16 v[204:207], a[76:79], a[88:91], v[204:207]
    v_mfma_f32_16x16x32_bf16 v[220:223], a[76:79], a[92:95], v[220:223]
    s_waitcnt vmcnt(32)
    v_mfma_f32_16x16x32_bf16 v[160:163], a[96:99], a[112:115], v[160:163]
    v_mfma_f32_16x16x32_bf16 v[176:179], a[96:99], a[116:119], v[176:179]
    v_mfma_f32_16x16x32_bf16 v[192:195], a[96:99], a[120:123], v[192:195]
    v_mfma_f32_16x16x32_bf16 v[208:211], a[96:99], a[124:127], v[208:211]
    v_mfma_f32_16x16x32_bf16 v[164:167], a[100:103], a[112:115], v[164:167]
    v_mfma_f32_16x16x32_bf16 v[180:183], a[100:103], a[116:119], v[180:183]
    v_mfma_f32_16x16x32_bf16 v[196:199], a[100:103], a[120:123], v[196:199]
    v_mfma_f32_16x16x32_bf16 v[212:215], a[100:103], a[124:127], v[212:215]
    v_mfma_f32_16x16x32_bf16 v[168:171], a[104:107], a[112:115], v[168:171]
    v_mfma_f32_16x16x32_bf16 v[184:187], a[104:107], a[116:119], v[184:187]
    v_mfma_f32_16x16x32_bf16 v[200:203], a[104:107], a[120:123], v[200:203]
    v_mfma_f32_16x16x32_bf16 v[216:219], a[104:107], a[124:127], v[216:219]
    v_mfma_f32_16x16x32_bf16 v[172:175], a[108:111], a[112:115], v[172:175]
    v_mfma_f32_16x16x32_bf16 v[188:191], a[108:111], a[116:119], v[188:191]
    v_mfma_f32_16x16x32_bf16 v[204:207], a[108:111], a[120:123], v[204:207]
    v_mfma_f32_16x16x32_bf16 v[220:223], a[108:111], a[124:127], v[220:223]
    s_waitcnt vmcnt(24)
    v_mfma_f32_16x16x32_bf16 v[160:163], a[128:131], a[144:147], v[160:163]
    v_mfma_f32_16x16x32_bf16 v[176:179], a[128:131], a[148:151], v[176:179]
    v_mfma_f32_16x16x32_bf16 v[192:195], a[128:131], a[152:155], v[192:195]
    v_mfma_f32_16x16x32_bf16 v[208:211], a[128:131], a[156:159], v[208:211]
    v_mfma_f32_16x16x32_bf16 v[164:167], a[132:135], a[144:147], v[164:167]
    v_mfma_f32_16x16x32_bf16 v[180:183], a[132:135], a[148:151], v[180:183]
    v_mfma_f32_16x16x32_bf16 v[196:199], a[132:135], a[152:155], v[196:199]
    v_mfma_f32_16x16x32_bf16 v[212:215], a[132:135], a[156:159], v[212:215]
    v_mfma_f32_16x16x32_bf16 v[168:171], a[136:139], a[144:147], v[168:171]
    v_mfma_f32_16x16x32_bf16 v[184:187], a[136:139], a[148:151], v[184:187]
    v_mfma_f32_16x16x32_bf16 v[200:203], a[136:139], a[152:155], v[200:203]
    v_mfma_f32_16x16x32_bf16 v[216:219], a[136:139], a[156:159], v[216:219]
    v_mfma_f32_16x16x32_bf16 v[172:175], a[140:143], a[144:147], v[172:175]
    v_mfma_f32_16x16x32_bf16 v[188:191], a[140:143], a[148:151], v[188:191]
    v_mfma_f32_16x16x32_bf16 v[204:207], a[140:143], a[152:155], v[204:207]
    v_mfma_f32_16x16x32_bf16 v[220:223], a[140:143], a[156:159], v[220:223]
    s_waitcnt vmcnt(16)
    v_mfma_f32_16x16x32_bf16 v[160:163], a[160:163], a[176:179], v[160:163]
    v_mfma_f32_16x16x32_bf16 v[176:179], a[160:163], a[180:183], v[176:179]
    buffer_load_dwordx2 v[40:41], v19, s[20:23], 0 offen offset:0
    buffer_load_dwordx2 v[42:43], v19, s[20:23], 0 offen offset:32
    buffer_load_dwordx2 v[44:45], v19, s[20:23], 0 offen offset:64
    buffer_load_dwordx2 v[46:47], v19, s[20:23], 0 offen offset:96
    buffer_load_dwordx4 v[48:51], v20, s[24:27], 0 offen offset:0
    buffer_load_dwordx4 v[52:55], v20, s[24:27], 0 offen offset:64
    buffer_load_dwordx4 v[56:59], v20, s[24:27], 0 offen offset:128
    buffer_load_dwordx4 v[60:63], v20, s[24:27], 0 offen offset:192
    buffer_load_dwordx4 v[80:83], v21, s[24:27], 0 offen offset:0
    buffer_load_dwordx4 v[84:87], v21, s[24:27], 0 offen offset:64
    buffer_load_dwordx4 v[88:91], v21, s[24:27], 0 offen offset:128
    buffer_load_dwordx4 v[92:95], v21, s[24:27], 0 offen offset:192
    buffer_load_dwordx4 v[64:67], v22, s[24:27], 0 offen offset:0
    buffer_load_dwordx4 v[68:71], v22, s[24:27], 0 offen offset:64
    buffer_load_dwordx4 v[72:75], v22, s[24:27], 0 offen offset:128
    buffer_load_dwordx4 v[76:79], v22, s[24:27], 0 offen offset:192
    v_mfma_f32_16x16x32_bf16 v[192:195], a[160:163], a[184:187], v[192:195]
    v_mfma_f32_16x16x32_bf16 v[208:211], a[160:163], a[188:191], v[208:211]
    v_mfma_f32_16x16x32_bf16 v[164:167], a[164:167], a[176:179], v[164:167]
    v_mfma_f32_16x16x32_bf16 v[180:183], a[164:167], a[180:183], v[180:183]
    v_mfma_f32_16x16x32_bf16 v[196:199], a[164:167], a[184:187], v[196:199]
    v_mfma_f32_16x16x32_bf16 v[212:215], a[164:167], a[188:191], v[212:215]
    v_mfma_f32_16x16x32_bf16 v[168:171], a[168:171], a[176:179], v[168:171]
    v_mfma_f32_16x16x32_bf16 v[184:187], a[168:171], a[180:183], v[184:187]
    v_mfma_f32_16x16x32_bf16 v[200:203], a[168:171], a[184:187], v[200:203]
    v_mfma_f32_16x16x32_bf16 v[216:219], a[168:171], a[188:191], v[216:219]
    v_mfma_f32_16x16x32_bf16 v[172:175], a[172:175], a[176:179], v[172:175]
    v_mfma_f32_16x16x32_bf16 v[188:191], a[172:175], a[180:183], v[188:191]
    v_mfma_f32_16x16x32_bf16 v[204:207], a[172:175], a[184:187], v[204:207]
    v_mfma_f32_16x16x32_bf16 v[220:223], a[172:175], a[188:191], v[220:223]
    s_waitcnt vmcnt(24)
    v_mfma_f32_16x16x32_bf16 v[160:163], a[192:195], a[208:211], v[160:163]
    v_mfma_f32_16x16x32_bf16 v[176:179], a[192:195], a[212:215], v[176:179]
    v_mfma_f32_16x16x32_bf16 v[192:195], a[192:195], a[216:219], v[192:195]
    v_mfma_f32_16x16x32_bf16 v[208:211], a[192:195], a[220:223], v[208:211]
    v_mfma_f32_16x16x32_bf16 v[164:167], a[196:199], a[208:211], v[164:167]
    v_mfma_f32_16x16x32_bf16 v[180:183], a[196:199], a[212:215], v[180:183]
    v_mfma_f32_16x16x32_bf16 v[196:199], a[196:199], a[216:219], v[196:199]
    v_mfma_f32_16x16x32_bf16 v[212:215], a[196:199], a[220:223], v[212:215]
    v_mfma_f32_16x16x32_bf16 v[168:171], a[200:203], a[208:211], v[168:171]
    v_mfma_f32_16x16x32_bf16 v[184:187], a[200:203], a[212:215], v[184:187]
    v_mfma_f32_16x16x32_bf16 v[200:203], a[200:203], a[216:219], v[200:203]
    v_mfma_f32_16x16x32_bf16 v[216:219], a[200:203], a[220:223], v[216:219]
    v_mfma_f32_16x16x32_bf16 v[172:175], a[204:207], a[208:211], v[172:175]
    v_mfma_f32_16x16x32_bf16 v[188:191], a[204:207], a[212:215], v[188:191]
    v_mfma_f32_16x16x32_bf16 v[204:207], a[204:207], a[216:219], v[204:207]
    v_mfma_f32_16x16x32_bf16 v[220:223], a[204:207], a[220:223], v[220:223]
    s_waitcnt vmcnt(16)
    v_mfma_f32_16x16x32_bf16 v[160:163], a[224:227], a[240:243], v[160:163]
    v_mfma_f32_16x16x32_bf16 v[176:179], a[224:227], a[244:247], v[176:179]
    v_mfma_f32_16x16x32_bf16 v[192:195], a[224:227], a[248:251], v[192:195]
    v_mfma_f32_16x16x32_bf16 v[208:211], a[224:227], a[252:255], v[208:211]
    v_mfma_f32_16x16x32_bf16 v[164:167], a[228:231], a[240:243], v[164:167]
    v_mfma_f32_16x16x32_bf16 v[180:183], a[228:231], a[244:247], v[180:183]
    v_mfma_f32_16x16x32_bf16 v[196:199], a[228:231], a[248:251], v[196:199]
    v_mfma_f32_16x16x32_bf16 v[212:215], a[228:231], a[252:255], v[212:215]
    v_mfma_f32_16x16x32_bf16 v[168:171], a[232:235], a[240:243], v[168:171]
    v_mfma_f32_16x16x32_bf16 v[184:187], a[232:235], a[244:247], v[184:187]
    v_mfma_f32_16x16x32_bf16 v[200:203], a[232:235], a[248:251], v[200:203]
    v_mfma_f32_16x16x32_bf16 v[216:219], a[232:235], a[252:255], v[216:219]
    v_mfma_f32_16x16x32_bf16 v[172:175], a[236:239], a[240:243], v[172:175]
    v_mfma_f32_16x16x32_bf16 v[188:191], a[236:239], a[244:247], v[188:191]
    v_mfma_f32_16x16x32_bf16 v[204:207], a[236:239], a[248:251], v[204:207]
    v_mfma_f32_16x16x32_bf16 v[220:223], a[236:239], a[252:255], v[220:223]
    s_nop 7
    s_mul_i32 s51, s32, 32768
    v_lshlrev_b32 v24, 4, v1
    v_add_u32 v24, s51, v24
    ds_write_b128 v24, v[176:179] offset:4096
    ds_write_b128 v24, v[180:183] offset:5120
    ds_write_b128 v24, v[184:187] offset:6144
    ds_write_b128 v24, v[188:191] offset:7168
    ds_write_b128 v24, v[192:195] offset:8192
    ds_write_b128 v24, v[196:199] offset:9216
    ds_write_b128 v24, v[200:203] offset:10240
    ds_write_b128 v24, v[204:207] offset:11264
    ds_write_b128 v24, v[208:211] offset:12288
    ds_write_b128 v24, v[212:215] offset:13312
    ds_write_b128 v24, v[216:219] offset:14336
    ds_write_b128 v24, v[220:223] offset:15360
    s_xor_b32 s51, s32, 1
    s_mul_i32 s51, s51, 32768
    v_lshlrev_b32 v25, 4, v1
    v_add_u32 v25, s51, v25
    s_xor_b32 s51, s32, 2
    s_mul_i32 s51, s51, 32768
    v_lshlrev_b32 v26, 4, v1
    v_add_u32 v26, s51, v26
    s_xor_b32 s51, s32, 3
    s_mul_i32 s51, s51, 32768
    v_lshlrev_b32 v27, 4, v1
    v_add_u32 v27, s51, v27
    s_waitcnt lgkmcnt(0)
    s_barrier
    ds_read_b128 v[176:179], v25 offset:4096
    ds_read_b128 v[180:183], v25 offset:5120
    ds_read_b128 v[184:187], v25 offset:6144
    ds_read_b128 v[188:191], v25 offset:7168
    ds_read_b128 v[192:195], v26 offset:8192
    ds_read_b128 v[196:199], v26 offset:9216
    ds_read_b128 v[200:203], v26 offset:10240
    ds_read_b128 v[204:207], v26 offset:11264
    ds_read_b128 v[208:211], v27 offset:12288
    ds_read_b128 v[212:215], v27 offset:13312
    ds_read_b128 v[216:219], v27 offset:14336
    ds_read_b128 v[220:223], v27 offset:15360
    s_waitcnt lgkmcnt(8)
    v_pk_add_f32 v[160:161], v[160:161], v[176:177]
    v_pk_add_f32 v[162:163], v[162:163], v[178:179]
    v_pk_add_f32 v[164:165], v[164:165], v[180:181]
    v_pk_add_f32 v[166:167], v[166:167], v[182:183]
    v_pk_add_f32 v[168:169], v[168:169], v[184:185]
    v_pk_add_f32 v[170:171], v[170:171], v[186:187]
    v_pk_add_f32 v[172:173], v[172:173], v[188:189]
    v_pk_add_f32 v[174:175], v[174:175], v[190:191]
    s_waitcnt lgkmcnt(4)
    v_pk_add_f32 v[160:161], v[160:161], v[192:193]
    v_pk_add_f32 v[162:163], v[162:163], v[194:195]
    v_pk_add_f32 v[164:165], v[164:165], v[196:197]
    v_pk_add_f32 v[166:167], v[166:167], v[198:199]
    v_pk_add_f32 v[168:169], v[168:169], v[200:201]
    v_pk_add_f32 v[170:171], v[170:171], v[202:203]
    v_pk_add_f32 v[172:173], v[172:173], v[204:205]
    v_pk_add_f32 v[174:175], v[174:175], v[206:207]
    s_waitcnt lgkmcnt(0)
    v_pk_add_f32 v[160:161], v[160:161], v[208:209]
    v_pk_add_f32 v[162:163], v[162:163], v[210:211]
    v_pk_add_f32 v[164:165], v[164:165], v[212:213]
    v_pk_add_f32 v[166:167], v[166:167], v[214:215]
    v_pk_add_f32 v[168:169], v[168:169], v[216:217]
    v_pk_add_f32 v[170:171], v[170:171], v[218:219]
    v_pk_add_f32 v[172:173], v[172:173], v[220:221]
    v_pk_add_f32 v[174:175], v[174:175], v[222:223]
    s_barrier
    s_add_u32 m0, s90, 0
    s_mov_b32 s91, 0
    buffer_load_dwordx4 v3, s[84:87], s91 offen lds
    s_add_u32 m0, s90, 4096
    s_mov_b32 s91, 32768
    buffer_load_dwordx4 v3, s[84:87], s91 offen lds
    s_add_u32 m0, s90, 8192
    s_mov_b32 s91, 65536
    buffer_load_dwordx4 v3, s[84:87], s91 offen lds
    s_add_u32 m0, s90, 12288
    s_mov_b32 s91, 98304
    buffer_load_dwordx4 v3, s[84:87], s91 offen lds
    s_add_u32 m0, s90, 16384
    s_mov_b32 s91, 131072
    buffer_load_dwordx4 v3, s[84:87], s91 offen lds
    s_add_u32 m0, s90, 20480
    s_mov_b32 s91, 163840
    buffer_load_dwordx4 v3, s[84:87], s91 offen lds
    s_add_u32 m0, s90, 24576
    s_mov_b32 s91, 196608
    buffer_load_dwordx4 v3, s[84:87], s91 offen lds
    s_add_u32 m0, s90, 28672
    s_mov_b32 s91, 229376
    buffer_load_dwordx4 v3, s[84:87], s91 offen lds
    s_add_u32 m0, s90, 32768
    s_mov_b32 s91, 262144
    buffer_load_dwordx4 v3, s[84:87], s91 offen lds
    s_add_u32 m0, s90, 36864
    s_mov_b32 s91, 294912
    buffer_load_dwordx4 v3, s[84:87], s91 offen lds
    s_add_u32 m0, s90, 40960
    s_mov_b32 s91, 327680
    buffer_load_dwordx4 v3, s[84:87], s91 offen lds
    s_add_u32 m0, s90, 45056
    s_mov_b32 s91, 360448
    buffer_load_dwordx4 v3, s[84:87], s91 offen lds
    s_add_u32 m0, s90, 49152
    s_mov_b32 s91, 393216
    buffer_load_dwordx4 v3, s[84:87], s91 offen lds
    s_add_u32 m0, s90, 53248
    s_mov_b32 s91, 425984
    buffer_load_dwordx4 v3, s[84:87], s91 offen lds
    s_add_u32 m0, s90, 57344
    s_mov_b32 s91, 458752
    buffer_load_dwordx4 v3, s[84:87], s91 offen lds
    s_add_u32 m0, s90, 61440
    s_mov_b32 s91, 491520
    buffer_load_dwordx4 v3, s[84:87], s91 offen lds
    s_lshl_b32 s53, s32, 12
    s_add_u32 m0, s53, 136192
    s_add_u32 s54, s53, 0
    buffer_load_dwordx4 v232, s[76:79], s54 offen sc1 lds
    s_add_u32 m0, s53, 137216
    s_add_u32 s54, s53, 1024
    buffer_load_dwordx4 v232, s[76:79], s54 offen sc1 lds
    s_add_u32 m0, s53, 138240
    s_add_u32 s54, s53, 2048
    buffer_load_dwordx4 v232, s[76:79], s54 offen sc1 lds
    s_add_u32 m0, s53, 139264
    s_add_u32 s54, s53, 3072
    buffer_load_dwordx4 v232, s[76:79], s54 offen sc1 lds
    buffer_load_dwordx4 v[34:37], v17, s[92:95], 0 offen sc1
    buffer_load_dword v38, v17, s[92:95], 0 offen offset:16 sc1
    s_waitcnt vmcnt(22)
    v_lshlrev_b32 v96, 16, v40
    v_and_b32 v97, 0xffff0000, v40
    v_lshlrev_b32 v98, 16, v41
    v_and_b32 v99, 0xffff0000, v41
    v_lshlrev_b32 v100, 16, v42
    v_and_b32 v101, 0xffff0000, v42
    v_lshlrev_b32 v102, 16, v43
    v_and_b32 v103, 0xffff0000, v43
    v_lshlrev_b32 v104, 16, v44
    v_and_b32 v105, 0xffff0000, v44
    v_lshlrev_b32 v106, 16, v45
    v_and_b32 v107, 0xffff0000, v45
    v_lshlrev_b32 v108, 16, v46
    v_and_b32 v109, 0xffff0000, v46
    v_lshlrev_b32 v110, 16, v47
    v_and_b32 v111, 0xffff0000, v47
    v_pk_fma_f32 v[96:97], v[48:49], v[160:161], v[96:97]
    v_pk_fma_f32 v[98:99], v[50:51], v[162:163], v[98:99]
    v_pk_fma_f32 v[100:101], v[52:53], v[164:165], v[100:101]
    v_pk_fma_f32 v[102:103], v[54:55], v[166:167], v[102:103]
    v_pk_fma_f32 v[104:105], v[56:57], v[168:169], v[104:105]
    v_pk_fma_f32 v[106:107], v[58:59], v[170:171], v[106:107]
    v_pk_fma_f32 v[108:109], v[60:61], v[172:173], v[108:109]
    v_pk_fma_f32 v[110:111], v[62:63], v[174:175], v[110:111]
    v_cvt_pk_bf16_f32 v240, v96, v97
    v_cvt_pk_bf16_f32 v241, v98, v99
    v_cvt_pk_bf16_f32 v242, v100, v101
    v_cvt_pk_bf16_f32 v243, v102, v103
    v_cvt_pk_bf16_f32 v244, v104, v105
    v_cvt_pk_bf16_f32 v245, v106, v107
    v_cvt_pk_bf16_f32 v246, v108, v109
    v_cvt_pk_bf16_f32 v247, v110, v111
    v_lshlrev_b32 v96, 16, v240
    v_and_b32 v97, 0xffff0000, v240
    v_lshlrev_b32 v98, 16, v241
    v_and_b32 v99, 0xffff0000, v241
    v_lshlrev_b32 v100, 16, v242
    v_and_b32 v101, 0xffff0000, v242
    v_lshlrev_b32 v102, 16, v243
    v_and_b32 v103, 0xffff0000, v243
    v_lshlrev_b32 v104, 16, v244
    v_and_b32 v105, 0xffff0000, v244
    v_lshlrev_b32 v106, 16, v245
    v_and_b32 v107, 0xffff0000, v245
    v_lshlrev_b32 v108, 16, v246
    v_and_b32 v109, 0xffff0000, v246
    v_lshlrev_b32 v110, 16, v247
    v_and_b32 v111, 0xffff0000, v247
    v_pk_mul_f32 v[120:121], v[96:97], v[64:65]
    v_pk_mul_f32 v[122:123], v[98:99], v[66:67]
    v_pk_mul_f32 v[124:125], v[100:101], v[68:69]
    v_pk_mul_f32 v[126:127], v[102:103], v[70:71]
    v_pk_mul_f32 v[128:129], v[104:105], v[72:73]
    v_pk_mul_f32 v[130:131], v[106:107], v[74:75]
    v_pk_mul_f32 v[132:133], v[108:109], v[76:77]
    v_pk_mul_f32 v[134:135], v[110:111], v[78:79]
    v_cvt_pk_bf16_f32 v136, v120, v121
    v_cvt_pk_bf16_f32 v137, v122, v123
    v_cvt_pk_bf16_f32 v138, v124, v125
    v_cvt_pk_bf16_f32 v139, v126, v127
    v_cvt_pk_bf16_f32 v140, v128, v129
    v_cvt_pk_bf16_f32 v141, v130, v131
    v_cvt_pk_bf16_f32 v142, v132, v133
    v_cvt_pk_bf16_f32 v143, v134, v135
    s_lshl_b32 s51, s37, 14
    s_lshl_b32 s53, s36, 11
    s_add_u32 s51, s51, s53
    buffer_store_dwordx4 v[136:139], v232, s[80:83], s51 offen offset:0 sc1
    buffer_store_dwordx4 v[140:143], v232, s[80:83], s51 offen offset:1024 sc1
    v_pk_add_f32 v[144:145], v[96:97], v[98:99]
    v_pk_mul_f32 v[146:147], v[96:97], v[96:97]
    v_pk_add_f32 v[148:149], v[120:121], v[122:123]
    v_pk_mul_f32 v[150:151], v[120:121], v[120:121]
    v_pk_mul_f32 v[152:153], v[120:121], v[64:65]
    v_pk_mul_f32 v[154:155], v[120:121], v[80:81]
    v_pk_fma_f32 v[146:147], v[98:99], v[98:99], v[146:147]
    v_pk_fma_f32 v[150:151], v[122:123], v[122:123], v[150:151]
    v_pk_fma_f32 v[152:153], v[122:123], v[66:67], v[152:153]
    v_pk_fma_f32 v[154:155], v[122:123], v[82:83], v[154:155]
    v_pk_add_f32 v[144:145], v[144:145], v[100:101]
    v_pk_add_f32 v[148:149], v[148:149], v[124:125]
    v_pk_fma_f32 v[146:147], v[100:101], v[100:101], v[146:147]
    v_pk_fma_f32 v[150:151], v[124:125], v[124:125], v[150:151]
    v_pk_fma_f32 v[152:153], v[124:125], v[68:69], v[152:153]
    v_pk_fma_f32 v[154:155], v[124:125], v[84:85], v[154:155]
    v_pk_add_f32 v[144:145], v[144:145], v[102:103]
    v_pk_add_f32 v[148:149], v[148:149], v[126:127]
    v_pk_fma_f32 v[146:147], v[102:103], v[102:103], v[146:147]
    v_pk_fma_f32 v[150:151], v[126:127], v[126:127], v[150:151]
    v_pk_fma_f32 v[152:153], v[126:127], v[70:71], v[152:153]
    v_pk_fma_f32 v[154:155], v[126:127], v[86:87], v[154:155]
    v_pk_add_f32 v[144:145], v[144:145], v[104:105]
    v_pk_add_f32 v[148:149], v[148:149], v[128:129]
    v_pk_fma_f32 v[146:147], v[104:105], v[104:105], v[146:147]
    v_pk_fma_f32 v[150:151], v[128:129], v[128:129], v[150:151]
    v_pk_fma_f32 v[152:153], v[128:129], v[72:73], v[152:153]
    v_pk_fma_f32 v[154:155], v[128:129], v[88:89], v[154:155]
    v_pk_add_f32 v[144:145], v[144:145], v[106:107]
    v_pk_add_f32 v[148:149], v[148:149], v[130:131]
    v_pk_fma_f32 v[146:147], v[106:107], v[106:107], v[146:147]
    v_pk_fma_f32 v[150:151], v[130:131], v[130:131], v[150:151]
    v_pk_fma_f32 v[152:153], v[130:131], v[74:75], v[152:153]
    v_pk_fma_f32 v[154:155], v[130:131], v[90:91], v[154:155]
    v_pk_add_f32 v[144:145], v[144:145], v[108:109]
    v_pk_add_f32 v[148:149], v[148:149], v[132:133]
    v_pk_fma_f32 v[146:147], v[108:109], v[108:109], v[146:147]
    v_pk_fma_f32 v[150:151], v[132:133], v[132:133], v[150:151]
    v_pk_fma_f32 v[152:153], v[132:133], v[76:77], v[152:153]
    v_pk_fma_f32 v[154:155], v[132:133], v[92:93], v[154:155]
    v_pk_add_f32 v[144:145], v[144:145], v[110:111]
    v_pk_add_f32 v[148:149], v[148:149], v[134:135]
    v_pk_fma_f32 v[146:147], v[110:111], v[110:111], v[146:147]
    v_pk_fma_f32 v[150:151], v[134:135], v[134:135], v[150:151]
    v_pk_fma_f32 v[152:153], v[134:135], v[78:79], v[152:153]
    v_pk_fma_f32 v[154:155], v[134:135], v[94:95], v[154:155]
    v_add_f32 v176, v144, v145
    v_add_f32 v177, v146, v147
    v_add_f32 v178, v148, v149
    v_add_f32 v179, v150, v151
    v_add_f32 v180, v152, v153
    v_add_f32 v181, v154, v155
    v_mov_b32 v184, v176
    v_mov_b32 v185, v177
    v_mov_b32 v186, v178
    v_mov_b32 v187, v179
    v_mov_b32 v188, v180
    v_mov_b32 v189, v181
    s_nop 1
    v_permlane16_swap_b32 v176, v184
    v_permlane16_swap_b32 v177, v185
    v_permlane16_swap_b32 v178, v186
    v_permlane16_swap_b32 v179, v187
    v_permlane16_swap_b32 v180, v188
    v_permlane16_swap_b32 v181, v189
    s_nop 1
    v_add_f32 v176, v176, v184
    v_add_f32 v177, v177, v185
    v_add_f32 v178, v178, v186
    v_add_f32 v179, v179, v187
    v_add_f32 v180, v180, v188
    v_add_f32 v181, v181, v189
    s_nop 0
    v_mov_b32 v184, v176
    v_mov_b32 v185, v177
    v_mov_b32 v186, v178
    v_mov_b32 v187, v179
    v_mov_b32 v188, v180
    v_mov_b32 v189, v181
    s_nop 1
    v_permlane32_swap_b32 v176, v184
    v_permlane32_swap_b32 v177, v185
    v_permlane32_swap_b32 v178, v186
    v_permlane32_swap_b32 v179, v187
    v_permlane32_swap_b32 v180, v188
    v_permlane32_swap_b32 v181, v189
    s_nop 1
    v_add_f32 v176, v176, v184
    v_add_f32 v177, v177, v185
    v_add_f32 v178, v178, v186
    v_add_f32 v179, v179, v187
    v_add_f32 v180, v180, v188
    v_add_f32 v181, v181, v189
    s_nop 0
    v_mov_b32 v182, 0
    v_mov_b32 v183, 0
    s_lshl_b32 s51, s37, 12
    s_lshl_b32 s53, s36, 5
    s_add_u32 s51, s51, s53
    v_lshlrev_b32 v14, 8, v231
    s_mov_b64 exec, 0xffff
    buffer_store_dwordx4 v[176:179], v14, s[40:43], s51 offen sc1
    buffer_store_dwordx4 v[180:183], v14, s[40:43], s51 offen offset:16 sc1
    s_mov_b64 exec, -1
    s_lshl_b32 s47, s35, 7
    s_add_u32 s47, s47, 8192
    s_waitcnt vmcnt(0)
    s_barrier
    s_cmp_eq_u32 s32, 0
    s_cbranch_scc0 mega_kernel_sig14
    v_mov_b32 v20, 0
    v_mov_b32 v21, 1
    s_mov_b64 exec, 1
    buffer_atomic_add v21, v20, s[72:75], s47 offen sc1
    s_mov_b64 exec, -1
mega_kernel_sig14:
    s_lshl_b32 s53, s35, 7
    s_add_u32 s53, s53, 8192
    s_add_u32 s16, s4, 23068672
    s_addc_u32 s17, s5, 0
    s_and_b32 s17, s17, 0xffff
    s_mov_b32 s18, 2097152
    s_mov_b32 s19, 0x20000
    s_add_u32 s24, s4, 25165824
    s_addc_u32 s25, s5, 0
    s_and_b32 s25, s25, 0xffff
    s_mov_b32 s26, 524288
    s_mov_b32 s27, 0x20000
    s_add_u32 s28, s4, 26214400
    s_addc_u32 s29, s5, 0
    s_and_b32 s29, s29, 0xffff
    s_mov_b32 s30, 2097152
    s_mov_b32 s31, 0x20000
    s_lshl_b32 s51, s37, 14
    v_add_u32 v18, s51, v232
    s_lshl_b32 s51, s37, 12
    v_lshlrev_b32 v19, 8, v231
    v_lshl_add_u32 v19, v230, 6, v19
    v_add_u32 v19, s51, v19
    v_add_u32 v15, 136192, v232
    ds_read_b128 a[0:3], v15 offset:0
    ds_read_b64_tr_b16 a[64:65], v16 offset:0
    ds_read_b64_tr_b16 a[66:67], v16 offset:2048
    ds_read_b128 a[4:7], v15 offset:1024
    ds_read_b64_tr_b16 a[68:69], v16 offset:4096
    ds_read_b64_tr_b16 a[70:71], v16 offset:6144
    ds_read_b128 a[8:11], v15 offset:2048
    ds_read_b64_tr_b16 a[72:73], v16 offset:8192
    ds_read_b64_tr_b16 a[74:75], v16 offset:10240
    ds_read_b128 a[12:15], v15 offset:3072
    ds_read_b64_tr_b16 a[76:77], v16 offset:12288
    ds_read_b64_tr_b16 a[78:79], v16 offset:14336
    ds_read_b128 a[16:19], v15 offset:4096
    ds_read_b64_tr_b16 a[80:81], v16 offset:16384
    ds_read_b64_tr_b16 a[82:83], v16 offset:18432
    ds_read_b128 a[20:23], v15 offset:5120
    ds_read_b64_tr_b16 a[84:85], v16 offset:20480
    ds_read_b64_tr_b16 a[86:87], v16 offset:22528
    ds_read_b128 a[24:27], v15 offset:6144
    ds_read_b64_tr_b16 a[88:89], v16 offset:24576
    ds_read_b64_tr_b16 a[90:91], v16 offset:26624
    ds_read_b128 a[28:31], v15 offset:7168
    ds_read_b64_tr_b16 a[92:93], v16 offset:28672
    ds_read_b64_tr_b16 a[94:95], v16 offset:30720
    ds_read_b128 a[32:35], v15 offset:8192
    ds_read_b64_tr_b16 a[96:97], v16 offset:32768
    ds_read_b64_tr_b16 a[98:99], v16 offset:34816
    ds_read_b128 a[36:39], v15 offset:9216
    ds_read_b64_tr_b16 a[100:101], v16 offset:36864
    ds_read_b64_tr_b16 a[102:103], v16 offset:38912
    ds_read_b128 a[40:43], v15 offset:10240
    ds_read_b64_tr_b16 a[104:105], v16 offset:40960
    ds_read_b64_tr_b16 a[106:107], v16 offset:43008
    ds_read_b128 a[44:47], v15 offset:11264
    ds_read_b64_tr_b16 a[108:109], v16 offset:45056
    ds_read_b64_tr_b16 a[110:111], v16 offset:47104
    ds_read_b128 a[48:51], v15 offset:12288
    ds_read_b64_tr_b16 a[112:113], v16 offset:49152
    ds_read_b64_tr_b16 a[114:115], v16 offset:51200
    ds_read_b128 a[52:55], v15 offset:13312
    ds_read_b64_tr_b16 a[116:117], v16 offset:53248
    ds_read_b64_tr_b16 a[118:119], v16 offset:55296
    ds_read_b128 a[56:59], v15 offset:14336
    ds_read_b64_tr_b16 a[120:121], v16 offset:57344
    ds_read_b64_tr_b16 a[122:123], v16 offset:59392
    ds_read_b128 a[60:63], v15 offset:15360
    ds_read_b64_tr_b16 a[124:125], v16 offset:61440
    ds_read_b64_tr_b16 a[126:127], v16 offset:63488
    s_waitcnt lgkmcnt(0)
    v_mfma_f32_16x16x32_bf16 v[24:27], a[64:67], a[0:3], 0
    v_mfma_f32_16x16x32_bf16 v[24:27], a[68:71], a[4:7], v[24:27]
    v_mfma_f32_16x16x32_bf16 v[24:27], a[72:75], a[8:11], v[24:27]
    v_mfma_f32_16x16x32_bf16 v[24:27], a[76:79], a[12:15], v[24:27]
    v_mfma_f32_16x16x32_bf16 v[24:27], a[80:83], a[16:19], v[24:27]
    v_mfma_f32_16x16x32_bf16 v[24:27], a[84:87], a[20:23], v[24:27]
    v_mfma_f32_16x16x32_bf16 v[24:27], a[88:91], a[24:27], v[24:27]
    v_mfma_f32_16x16x32_bf16 v[24:27], a[92:95], a[28:31], v[24:27]
    v_mfma_f32_16x16x32_bf16 v[24:27], a[96:99], a[32:35], v[24:27]
    v_mfma_f32_16x16x32_bf16 v[24:27], a[100:103], a[36:39], v[24:27]
    v_mfma_f32_16x16x32_bf16 v[24:27], a[104:107], a[40:43], v[24:27]
    v_mfma_f32_16x16x32_bf16 v[24:27], a[108:111], a[44:47], v[24:27]
    v_mfma_f32_16x16x32_bf16 v[24:27], a[112:115], a[48:51], v[24:27]
    v_mfma_f32_16x16x32_bf16 v[24:27], a[116:119], a[52:55], v[24:27]
    v_mfma_f32_16x16x32_bf16 v[24:27], a[120:123], a[56:59], v[24:27]
    v_mfma_f32_16x16x32_bf16 v[24:27], a[124:127], a[60:63], v[24:27]
    v_lshlrev_b32 v15, 8, v231
    v_lshl_add_u32 v15, v230, 4, v15
    s_lshl_b32 s51, s32, 6
    s_add_u32 s51, s51, 135168
    v_add_u32 v15, s51, v15
    v_cmp_gt_u32 vcc, 3, v231
    s_nop 3
    s_and_saveexec_b64 s[54:55], vcc
    ds_write_b128 v15, v[24:27]
    s_mov_b64 exec, s[54:55]
    s_waitcnt lgkmcnt(0)
    s_barrier
    v_lshlrev_b32 v15, 4, v230
    v_add_u32 v15, 135168, v15
    ds_read_b128 v[96:99], v15 offset:0
    ds_read_b128 v[100:103], v15 offset:64
    ds_read_b128 v[104:107], v15 offset:128
    ds_read_b128 v[108:111], v15 offset:192
    ds_read_b128 v[112:115], v15 offset:256
    ds_read_b128 v[116:119], v15 offset:320
    ds_read_b128 v[120:123], v15 offset:384
    ds_read_b128 v[124:127], v15 offset:448
    ds_read_b128 v[160:163], v15 offset:512
    ds_read_b128 v[164:167], v15 offset:576
    ds_read_b128 v[168:171], v15 offset:640
    ds_read_b128 v[172:175], v15 offset:704
    s_mov_b32 s56, 0xbdd2d3e8
    s_mov_b32 s57, 0xbdd2d3e8
    v_mov_b32 v142, 0xc0135761
    v_mov_b32 v143, 0xc0135761
    s_mov_b32 s12, s96
    s_and_b32 s13, s97, 0xffff
    s_mov_b32 s14, 524288
    s_mov_b32 s15, 0x20000
    v_lshrrev_b32 v225, 3, v1
    v_and_b32 v224, 7, v1
    v_and_b32 v228, 6, v225
    v_xor_b32 v224, v224, v228
    s_lshl_b32 s50, s32, 3
    v_add_u32 v225, s50, v225
    s_mov_b32 s50, 1024
    v_mul_lo_u32 v225, v225, s50
    v_lshl_add_u32 v3, v224, 4, v225
    v_add_u32 v3, s38, v3
    s_lshl_b32 s48, s32, 10
    v_and_b32 v224, 15, v1
    v_lshrrev_b32 v225, 4, v1
    v_lshrrev_b32 v226, 2, v224
    v_and_b32 v227, 3, v224
    v_lshl_add_u32 v229, v225, 2, v226
    v_lshrrev_b32 v228, 1, v229
    v_and_b32 v228, 3, v228
    v_lshlrev_b32 v229, 7, v229
    v_lshl_add_u32 v229, v227, 3, v229
    v_add_u32 v229, 65536, v229
    v_xor_b32 v226, 0, v228
    v_lshl_add_u32 v4, v226, 5, v229
    v_xor_b32 v226, 1, v228
    v_lshl_add_u32 v5, v226, 5, v229
    v_xor_b32 v226, 2, v228
    v_lshl_add_u32 v6, v226, 5, v229
    v_xor_b32 v226, 3, v228
    v_lshl_add_u32 v7, v226, 5, v229
    s_waitcnt lgkmcnt(0)
    s_cmp_eq_u32 s32, 0
    s_cbranch_scc0 mega_kernel_pe15
    v_mov_b32 v20, s53
    v_mov_b32 v21, 8
    s_mov_b64 exec, 1
    buffer_load_dword v22, v20, s[72:75], 0 offen sc1
    s_mov_b64 exec, -1
    s_mov_b64 exec, 1
    s_mov_b32 s3, 100000
    s_waitcnt vmcnt(0)
mega_kernel_pl16:
    v_cmp_ge_u32 vcc, v22, v21
    s_sub_u32 s3, s3, 1
    s_cmp_eq_u32 s3, 0
    s_cbranch_scc1 mega_kernel_pq17
    s_cmp_eq_u64 vcc, exec
    s_cbranch_scc1 mega_kernel_pq17
    s_sleep 4
    buffer_load_dword v22, v20, s[72:75], 0 offen sc1
    s_waitcnt vmcnt(0)
    s_branch mega_kernel_pl16
mega_kernel_pq17:
    s_mov_b64 exec, -1
mega_kernel_pe15:
    s_barrier
    buffer_load_dwordx4 v[144:147], v19, s[24:27], 0 offen offset:0 sc1
    buffer_load_dwordx4 v[148:151], v19, s[24:27], 0 offen offset:16 sc1
    buffer_load_dwordx4 v[152:155], v19, s[24:27], 0 offen offset:32 sc1
    buffer_load_dwordx4 v[156:159], v19, s[24:27], 0 offen offset:48 sc1
    s_mov_b32 s52, 0
    buffer_load_dwordx4 a[48:51], v18, s[16:19], s52 offen offset:0 sc1
    buffer_load_dwordx4 a[52:55], v18, s[16:19], s52 offen offset:1024 sc1
    buffer_load_dwordx4 a[56:59], v18, s[16:19], s52 offen offset:2048 sc1
    buffer_load_dwordx4 a[60:63], v18, s[16:19], s52 offen offset:3072 sc1
    s_mov_b32 s52, 4096
    buffer_load_dwordx4 a[64:67], v18, s[16:19], s52 offen offset:0 sc1
    buffer_load_dwordx4 a[68:71], v18, s[16:19], s52 offen offset:1024 sc1
    buffer_load_dwordx4 a[72:75], v18, s[16:19], s52 offen offset:2048 sc1
    buffer_load_dwordx4 a[76:79], v18, s[16:19], s52 offen offset:3072 sc1
    s_waitcnt vmcnt(8)
    v_add_f32 v192, v144, v152
    v_add_f32 v193, v145, v153
    v_add_f32 v194, v146, v154
    v_add_f32 v195, v147, v155
    v_add_f32 v196, v148, v156
    v_add_f32 v197, v149, v157
    v_mov_b32 v200, v192
    v_mov_b32 v201, v193
    v_mov_b32 v202, v194
    v_mov_b32 v203, v195
    v_mov_b32 v204, v196
    v_mov_b32 v205, v197
    s_nop 1
    v_permlane16_swap_b32 v192, v200
    v_permlane16_swap_b32 v193, v201
    v_permlane16_swap_b32 v194, v202
    v_permlane16_swap_b32 v195, v203
    v_permlane16_swap_b32 v196, v204
    v_permlane16_swap_b32 v197, v205
    s_nop 1
    v_add_f32 v192, v192, v200
    v_add_f32 v193, v193, v201
    v_add_f32 v194, v194, v202
    v_add_f32 v195, v195, v203
    v_add_f32 v196, v196, v204
    v_add_f32 v197, v197, v205
    s_nop 0
    v_mov_b32 v200, v192
    v_mov_b32 v201, v193
    v_mov_b32 v202, v194
    v_mov_b32 v203, v195
    v_mov_b32 v204, v196
    v_mov_b32 v205, v197
    s_nop 1
    v_permlane32_swap_b32 v192, v200
    v_permlane32_swap_b32 v193, v201
    v_permlane32_swap_b32 v194, v202
    v_permlane32_swap_b32 v195, v203
    v_permlane32_swap_b32 v196, v204
    v_permlane32_swap_b32 v197, v205
    s_nop 1
    v_add_f32 v192, v192, v200
    v_add_f32 v193, v193, v201
    v_add_f32 v194, v194, v202
    v_add_f32 v195, v195, v203
    v_add_f32 v196, v196, v204
    v_add_f32 v197, v197, v205
    s_nop 0
    v_mul_f32 v238, 0x3b000000, v192
    v_mul_f32 v132, 0x3b000000, v193
    v_fma_f32 v132, -v238, v238, v132
    v_max_f32 v132, 0, v132
    v_add_f32 v132, 0x3727c5ac, v132
    v_rsq_f32 v239, v132
    v_fma_f32 v132, -v238, v34, v194
    v_fma_f32 v132, v132, v239, v35
    v_mul_f32 v130, 0x3b000000, v132
    v_mul_f32 v132, v36, v238
    v_fma_f32 v132, -2.0, v196, v132
    v_fma_f32 v132, v132, v238, v195
    v_mul_f32 v132, v132, v239
    v_fma_f32 v133, -v238, v37, v197
    v_fma_f32 v132, 2.0, v133, v132
    v_fma_f32 v132, v132, v239, v38
    v_mul_f32 v131, 0x3b000000, v132
    v_fma_f32 v132, -v130, v130, v131
    v_max_f32 v132, 0, v132
    v_add_f32 v132, 0x3727c5ac, v132
    v_rsq_f32 v134, v132
    s_nop 0
    v_mul_f32 v136, v239, v134
    v_mul_f32 v138, -v130, v134
    v_mul_f32 v140, -v238, v136
    v_pk_mul_f32 v[176:177], v[96:97], v[134:135] op_sel_hi:[1,0]
    v_pk_fma_f32 v[176:177], v[112:113], v[138:139], v[176:177] op_sel_hi:[1,0,1]
    v_pk_fma_f32 v[176:177], v[160:161], v[140:141], v[176:177] op_sel_hi:[1,0,1]
    v_pk_mul_f32 v[178:179], v[98:99], v[134:135] op_sel_hi:[1,0]
    v_pk_fma_f32 v[178:179], v[114:115], v[138:139], v[178:179] op_sel_hi:[1,0,1]
    v_pk_fma_f32 v[178:179], v[162:163], v[140:141], v[178:179] op_sel_hi:[1,0,1]
    v_pk_mul_f32 v[180:181], v[100:101], v[134:135] op_sel_hi:[1,0]
    v_pk_fma_f32 v[180:181], v[116:117], v[138:139], v[180:181] op_sel_hi:[1,0,1]
    v_pk_fma_f32 v[180:181], v[164:165], v[140:141], v[180:181] op_sel_hi:[1,0,1]
    v_pk_mul_f32 v[182:183], v[102:103], v[134:135] op_sel_hi:[1,0]
    v_pk_fma_f32 v[182:183], v[118:119], v[138:139], v[182:183] op_sel_hi:[1,0,1]
    v_pk_fma_f32 v[182:183], v[166:167], v[140:141], v[182:183] op_sel_hi:[1,0,1]
    v_pk_mul_f32 v[184:185], v[104:105], v[134:135] op_sel_hi:[1,0]
    v_pk_fma_f32 v[184:185], v[120:121], v[138:139], v[184:185] op_sel_hi:[1,0,1]
    v_pk_fma_f32 v[184:185], v[168:169], v[140:141], v[184:185] op_sel_hi:[1,0,1]
    v_pk_mul_f32 v[186:187], v[106:107], v[134:135] op_sel_hi:[1,0]
    v_pk_fma_f32 v[186:187], v[122:123], v[138:139], v[186:187] op_sel_hi:[1,0,1]
    v_pk_fma_f32 v[186:187], v[170:171], v[140:141], v[186:187] op_sel_hi:[1,0,1]
    v_pk_mul_f32 v[188:189], v[108:109], v[134:135] op_sel_hi:[1,0]
    v_pk_fma_f32 v[188:189], v[124:125], v[138:139], v[188:189] op_sel_hi:[1,0,1]
    v_pk_fma_f32 v[188:189], v[172:173], v[140:141], v[188:189] op_sel_hi:[1,0,1]
    v_pk_mul_f32 v[190:191], v[110:111], v[134:135] op_sel_hi:[1,0]
    v_pk_fma_f32 v[190:191], v[126:127], v[138:139], v[190:191] op_sel_hi:[1,0,1]
    v_pk_fma_f32 v[190:191], v[174:175], v[140:141], v[190:191] op_sel_hi:[1,0,1]
    s_waitcnt vmcnt(4)
    s_barrier
    ds_read_b64_tr_b16 a[0:1], v8 offset:0
    ds_read_b64_tr_b16 a[2:3], v8 offset:2048
    ds_read_b64_tr_b16 a[4:5], v9 offset:0
    ds_read_b64_tr_b16 a[6:7], v9 offset:2048
    ds_read_b64_tr_b16 a[8:9], v10 offset:0
    ds_read_b64_tr_b16 a[10:11], v10 offset:2048
    ds_read_b64_tr_b16 a[12:13], v11 offset:0
    ds_read_b64_tr_b16 a[14:15], v11 offset:2048
    ds_read_b64_tr_b16 a[16:17], v8 offset:4096
    ds_read_b64_tr_b16 a[18:19], v8 offset:6144
    ds_read_b64_tr_b16 a[20:21], v9 offset:4096
    ds_read_b64_tr_b16 a[22:23], v9 offset:6144
    ds_read_b64_tr_b16 a[24:25], v10 offset:4096
    ds_read_b64_tr_b16 a[26:27], v10 offset:6144
    ds_read_b64_tr_b16 a[28:29], v11 offset:4096
    ds_read_b64_tr_b16 a[30:31], v11 offset:6144
    s_waitcnt lgkmcnt(8)
    v_mfma_f32_16x16x32_bf16 v[40:43], a[0:3], a[48:51], 0
    ds_read_b64_tr_b16 a[32:33], v8 offset:8192
    ds_read_b64_tr_b16 a[34:35], v8 offset:10240
    v_mfma_f32_16x16x32_bf16 v[44:47], a[4:7], a[48:51], 0
    ds_read_b64_tr_b16 a[36:37], v9 offset:8192
    ds_read_b64_tr_b16 a[38:39], v9 offset:10240
    v_mfma_f32_16x16x32_bf16 v[48:51], a[8:11], a[48:51], 0
    ds_read_b64_tr_b16 a[40:41], v10 offset:8192
    ds_read_b64_tr_b16 a[42:43], v10 offset:10240
    v_mfma_f32_16x16x32_bf16 v[52:55], a[12:15], a[48:51], 0
    ds_read_b64_tr_b16 a[44:45], v11 offset:8192
    ds_read_b64_tr_b16 a[46:47], v11 offset:10240
    s_mov_b32 s52, 8192
    buffer_load_dwordx4 a[80:83], v18, s[16:19], s52 offen offset:0 sc1
    s_waitcnt lgkmcnt(8)
    v_mfma_f32_16x16x32_bf16 v[40:43], a[16:19], a[52:55], v[40:43]
    ds_read_b64_tr_b16 a[0:1], v8 offset:12288
    ds_read_b64_tr_b16 a[2:3], v8 offset:14336
    v_mfma_f32_16x16x32_bf16 v[44:47], a[20:23], a[52:55], v[44:47]
    ds_read_b64_tr_b16 a[4:5], v9 offset:12288
    ds_read_b64_tr_b16 a[6:7], v9 offset:14336
    v_mfma_f32_16x16x32_bf16 v[48:51], a[24:27], a[52:55], v[48:51]
    ds_read_b64_tr_b16 a[8:9], v10 offset:12288
    ds_read_b64_tr_b16 a[10:11], v10 offset:14336
    v_mfma_f32_16x16x32_bf16 v[52:55], a[28:31], a[52:55], v[52:55]
    ds_read_b64_tr_b16 a[12:13], v11 offset:12288
    ds_read_b64_tr_b16 a[14:15], v11 offset:14336
    buffer_load_dwordx4 a[84:87], v18, s[16:19], s52 offen offset:1024 sc1
    s_waitcnt lgkmcnt(8)
    s_waitcnt vmcnt(2)
    s_barrier
    v_mfma_f32_16x16x32_bf16 v[40:43], a[32:35], a[56:59], v[40:43]
    ds_read_b64_tr_b16 a[16:17], v8 offset:16384
    ds_read_b64_tr_b16 a[18:19], v8 offset:18432
    v_mfma_f32_16x16x32_bf16 v[44:47], a[36:39], a[56:59], v[44:47]
    ds_read_b64_tr_b16 a[20:21], v9 offset:16384
    ds_read_b64_tr_b16 a[22:23], v9 offset:18432
    v_mfma_f32_16x16x32_bf16 v[48:51], a[40:43], a[56:59], v[48:51]
    ds_read_b64_tr_b16 a[24:25], v10 offset:16384
    ds_read_b64_tr_b16 a[26:27], v10 offset:18432
    v_mfma_f32_16x16x32_bf16 v[52:55], a[44:47], a[56:59], v[52:55]
    ds_read_b64_tr_b16 a[28:29], v11 offset:16384
    ds_read_b64_tr_b16 a[30:31], v11 offset:18432
    buffer_load_dwordx4 a[88:91], v18, s[16:19], s52 offen offset:2048 sc1
    s_waitcnt lgkmcnt(8)
    v_mfma_f32_16x16x32_bf16 v[40:43], a[0:3], a[60:63], v[40:43]
    ds_read_b64_tr_b16 a[32:33], v8 offset:20480
    ds_read_b64_tr_b16 a[34:35], v8 offset:22528
    v_mfma_f32_16x16x32_bf16 v[44:47], a[4:7], a[60:63], v[44:47]
    ds_read_b64_tr_b16 a[36:37], v9 offset:20480
    ds_read_b64_tr_b16 a[38:39], v9 offset:22528
    v_mfma_f32_16x16x32_bf16 v[48:51], a[8:11], a[60:63], v[48:51]
    ds_read_b64_tr_b16 a[40:41], v10 offset:20480
    ds_read_b64_tr_b16 a[42:43], v10 offset:22528
    v_mfma_f32_16x16x32_bf16 v[52:55], a[12:15], a[60:63], v[52:55]
    ds_read_b64_tr_b16 a[44:45], v11 offset:20480
    ds_read_b64_tr_b16 a[46:47], v11 offset:22528
    buffer_load_dwordx4 a[92:95], v18, s[16:19], s52 offen offset:3072 sc1
    s_waitcnt lgkmcnt(8)
    v_mfma_f32_16x16x32_bf16 v[40:43], a[16:19], a[64:67], v[40:43]
    ds_read_b64_tr_b16 a[0:1], v8 offset:24576
    ds_read_b64_tr_b16 a[2:3], v8 offset:26624
    v_mfma_f32_16x16x32_bf16 v[44:47], a[20:23], a[64:67], v[44:47]
    ds_read_b64_tr_b16 a[4:5], v9 offset:24576
    ds_read_b64_tr_b16 a[6:7], v9 offset:26624
    v_mfma_f32_16x16x32_bf16 v[48:51], a[24:27], a[64:67], v[48:51]
    ds_read_b64_tr_b16 a[8:9], v10 offset:24576
    ds_read_b64_tr_b16 a[10:11], v10 offset:26624
    v_mfma_f32_16x16x32_bf16 v[52:55], a[28:31], a[64:67], v[52:55]
    ds_read_b64_tr_b16 a[12:13], v11 offset:24576
    ds_read_b64_tr_b16 a[14:15], v11 offset:26624
    s_mov_b32 s52, 12288
    buffer_load_dwordx4 a[96:99], v18, s[16:19], s52 offen offset:0 sc1
    s_waitcnt lgkmcnt(8)
    v_mfma_f32_16x16x32_bf16 v[40:43], a[32:35], a[68:71], v[40:43]
    ds_read_b64_tr_b16 a[16:17], v8 offset:28672
    ds_read_b64_tr_b16 a[18:19], v8 offset:30720
    v_mfma_f32_16x16x32_bf16 v[44:47], a[36:39], a[68:71], v[44:47]
    ds_read_b64_tr_b16 a[20:21], v9 offset:28672
    ds_read_b64_tr_b16 a[22:23], v9 offset:30720
    v_mfma_f32_16x16x32_bf16 v[48:51], a[40:43], a[68:71], v[48:51]
    ds_read_b64_tr_b16 a[24:25], v10 offset:28672
    ds_read_b64_tr_b16 a[26:27], v10 offset:30720
    v_mfma_f32_16x16x32_bf16 v[52:55], a[44:47], a[68:71], v[52:55]
    ds_read_b64_tr_b16 a[28:29], v11 offset:28672
    ds_read_b64_tr_b16 a[30:31], v11 offset:30720
    buffer_load_dwordx4 a[100:103], v18, s[16:19], s52 offen offset:1024 sc1
    s_waitcnt lgkmcnt(8)
    s_waitcnt vmcnt(2)
    s_barrier
    v_mfma_f32_16x16x32_bf16 v[40:43], a[0:3], a[72:75], v[40:43]
    ds_read_b64_tr_b16 a[32:33], v8 offset:32768
    ds_read_b64_tr_b16 a[34:35], v8 offset:34816
    v_mfma_f32_16x16x32_bf16 v[44:47], a[4:7], a[72:75], v[44:47]
    ds_read_b64_tr_b16 a[36:37], v9 offset:32768
    ds_read_b64_tr_b16 a[38:39], v9 offset:34816
    v_mfma_f32_16x16x32_bf16 v[48:51], a[8:11], a[72:75], v[48:51]
    ds_read_b64_tr_b16 a[40:41], v10 offset:32768
    ds_read_b64_tr_b16 a[42:43], v10 offset:34816
    v_mfma_f32_16x16x32_bf16 v[52:55], a[12:15], a[72:75], v[52:55]
    ds_read_b64_tr_b16 a[44:45], v11 offset:32768
    ds_read_b64_tr_b16 a[46:47], v11 offset:34816
    buffer_load_dwordx4 a[104:107], v18, s[16:19], s52 offen offset:2048 sc1
    s_waitcnt lgkmcnt(8)
    v_mfma_f32_16x16x32_bf16 v[40:43], a[16:19], a[76:79], v[40:43]
    ds_read_b64_tr_b16 a[0:1], v8 offset:36864
    ds_read_b64_tr_b16 a[2:3], v8 offset:38912
    v_mfma_f32_16x16x32_bf16 v[44:47], a[20:23], a[76:79], v[44:47]
    ds_read_b64_tr_b16 a[4:5], v9 offset:36864
    ds_read_b64_tr_b16 a[6:7], v9 offset:38912
    v_mfma_f32_16x16x32_bf16 v[48:51], a[24:27], a[76:79], v[48:51]
    ds_read_b64_tr_b16 a[8:9], v10 offset:36864
    ds_read_b64_tr_b16 a[10:11], v10 offset:38912
    v_mfma_f32_16x16x32_bf16 v[52:55], a[28:31], a[76:79], v[52:55]
    ds_read_b64_tr_b16 a[12:13], v11 offset:36864
    ds_read_b64_tr_b16 a[14:15], v11 offset:38912
    buffer_load_dwordx4 a[108:111], v18, s[16:19], s52 offen offset:3072 sc1
    s_waitcnt lgkmcnt(8)
    v_mfma_f32_16x16x32_bf16 v[40:43], a[32:35], a[80:83], v[40:43]
    ds_read_b64_tr_b16 a[16:17], v8 offset:40960
    ds_read_b64_tr_b16 a[18:19], v8 offset:43008
    v_mfma_f32_16x16x32_bf16 v[44:47], a[36:39], a[80:83], v[44:47]
    ds_read_b64_tr_b16 a[20:21], v9 offset:40960
    ds_read_b64_tr_b16 a[22:23], v9 offset:43008
    v_mfma_f32_16x16x32_bf16 v[48:51], a[40:43], a[80:83], v[48:51]
    ds_read_b64_tr_b16 a[24:25], v10 offset:40960
    ds_read_b64_tr_b16 a[26:27], v10 offset:43008
    v_mfma_f32_16x16x32_bf16 v[52:55], a[44:47], a[80:83], v[52:55]
    ds_read_b64_tr_b16 a[28:29], v11 offset:40960
    ds_read_b64_tr_b16 a[30:31], v11 offset:43008
    s_add_u32 m0, s48, 65536
    s_mov_b32 s49, 0
    buffer_load_dwordx4 v3, s[12:15], s49 offen lds
    s_add_u32 m0, s48, 69632
    s_mov_b32 s49, 32768
    buffer_load_dwordx4 v3, s[12:15], s49 offen lds
    s_add_u32 m0, s48, 73728
    s_mov_b32 s49, 65536
    buffer_load_dwordx4 v3, s[12:15], s49 offen lds
    s_add_u32 m0, s48, 77824
    s_mov_b32 s49, 98304
    buffer_load_dwordx4 v3, s[12:15], s49 offen lds
    s_add_u32 m0, s48, 81920
    s_mov_b32 s49, 131072
    buffer_load_dwordx4 v3, s[12:15], s49 offen lds
    s_add_u32 m0, s48, 86016
    s_mov_b32 s49, 163840
    buffer_load_dwordx4 v3, s[12:15], s49 offen lds
    s_add_u32 m0, s48, 90112
    s_mov_b32 s49, 196608
    buffer_load_dwordx4 v3, s[12:15], s49 offen lds
    s_add_u32 m0, s48, 94208
    s_mov_b32 s49, 229376
    buffer_load_dwordx4 v3, s[12:15], s49 offen lds
    s_add_u32 m0, s48, 98304
    s_mov_b32 s49, 262144
    buffer_load_dwordx4 v3, s[12:15], s49 offen lds
    s_add_u32 m0, s48, 102400
    s_mov_b32 s49, 294912
    buffer_load_dwordx4 v3, s[12:15], s49 offen lds
    s_add_u32 m0, s48, 106496
    s_mov_b32 s49, 327680
    buffer_load_dwordx4 v3, s[12:15], s49 offen lds
    s_add_u32 m0, s48, 110592
    s_mov_b32 s49, 360448
    buffer_load_dwordx4 v3, s[12:15], s49 offen lds
    s_add_u32 m0, s48, 114688
    s_mov_b32 s49, 393216
    buffer_load_dwordx4 v3, s[12:15], s49 offen lds
    s_add_u32 m0, s48, 118784
    s_mov_b32 s49, 425984
    buffer_load_dwordx4 v3, s[12:15], s49 offen lds
    s_add_u32 m0, s48, 122880
    s_mov_b32 s49, 458752
    buffer_load_dwordx4 v3, s[12:15], s49 offen lds
    s_add_u32 m0, s48, 126976
    s_mov_b32 s49, 491520
    buffer_load_dwordx4 v3, s[12:15], s49 offen lds
    s_waitcnt lgkmcnt(8)
    v_mfma_f32_16x16x32_bf16 v[40:43], a[0:3], a[84:87], v[40:43]
    ds_read_b64_tr_b16 a[32:33], v8 offset:45056
    ds_read_b64_tr_b16 a[34:35], v8 offset:47104
    v_mfma_f32_16x16x32_bf16 v[44:47], a[4:7], a[84:87], v[44:47]
    ds_read_b64_tr_b16 a[36:37], v9 offset:45056
    ds_read_b64_tr_b16 a[38:39], v9 offset:47104
    v_mfma_f32_16x16x32_bf16 v[48:51], a[8:11], a[84:87], v[48:51]
    ds_read_b64_tr_b16 a[40:41], v10 offset:45056
    ds_read_b64_tr_b16 a[42:43], v10 offset:47104
    v_mfma_f32_16x16x32_bf16 v[52:55], a[12:15], a[84:87], v[52:55]
    ds_read_b64_tr_b16 a[44:45], v11 offset:45056
    ds_read_b64_tr_b16 a[46:47], v11 offset:47104
    s_waitcnt lgkmcnt(8)
    s_waitcnt vmcnt(16)
    s_barrier
    v_mfma_f32_16x16x32_bf16 v[40:43], a[16:19], a[88:91], v[40:43]
    ds_read_b64_tr_b16 a[0:1], v8 offset:49152
    ds_read_b64_tr_b16 a[2:3], v8 offset:51200
    v_mfma_f32_16x16x32_bf16 v[44:47], a[20:23], a[88:91], v[44:47]
    ds_read_b64_tr_b16 a[4:5], v9 offset:49152
    ds_read_b64_tr_b16 a[6:7], v9 offset:51200
    v_mfma_f32_16x16x32_bf16 v[48:51], a[24:27], a[88:91], v[48:51]
    ds_read_b64_tr_b16 a[8:9], v10 offset:49152
    ds_read_b64_tr_b16 a[10:11], v10 offset:51200
    v_mfma_f32_16x16x32_bf16 v[52:55], a[28:31], a[88:91], v[52:55]
    ds_read_b64_tr_b16 a[12:13], v11 offset:49152
    ds_read_b64_tr_b16 a[14:15], v11 offset:51200
    s_waitcnt lgkmcnt(8)
    v_mfma_f32_16x16x32_bf16 v[40:43], a[32:35], a[92:95], v[40:43]
    ds_read_b64_tr_b16 a[16:17], v8 offset:53248
    ds_read_b64_tr_b16 a[18:19], v8 offset:55296
    v_mfma_f32_16x16x32_bf16 v[44:47], a[36:39], a[92:95], v[44:47]
    ds_read_b64_tr_b16 a[20:21], v9 offset:53248
    ds_read_b64_tr_b16 a[22:23], v9 offset:55296
    v_mfma_f32_16x16x32_bf16 v[48:51], a[40:43], a[92:95], v[48:51]
    ds_read_b64_tr_b16 a[24:25], v10 offset:53248
    ds_read_b64_tr_b16 a[26:27], v10 offset:55296
    v_mfma_f32_16x16x32_bf16 v[52:55], a[44:47], a[92:95], v[52:55]
    ds_read_b64_tr_b16 a[28:29], v11 offset:53248
    ds_read_b64_tr_b16 a[30:31], v11 offset:55296
    s_waitcnt lgkmcnt(8)
    v_mfma_f32_16x16x32_bf16 v[40:43], a[0:3], a[96:99], v[40:43]
    ds_read_b64_tr_b16 a[32:33], v8 offset:57344
    ds_read_b64_tr_b16 a[34:35], v8 offset:59392
    v_mfma_f32_16x16x32_bf16 v[44:47], a[4:7], a[96:99], v[44:47]
    ds_read_b64_tr_b16 a[36:37], v9 offset:57344
    ds_read_b64_tr_b16 a[38:39], v9 offset:59392
    v_mfma_f32_16x16x32_bf16 v[48:51], a[8:11], a[96:99], v[48:51]
    ds_read_b64_tr_b16 a[40:41], v10 offset:57344
    ds_read_b64_tr_b16 a[42:43], v10 offset:59392
    v_mfma_f32_16x16x32_bf16 v[52:55], a[12:15], a[96:99], v[52:55]
    ds_read_b64_tr_b16 a[44:45], v11 offset:57344
    ds_read_b64_tr_b16 a[46:47], v11 offset:59392
    s_waitcnt lgkmcnt(8)
    v_mfma_f32_16x16x32_bf16 v[40:43], a[16:19], a[100:103], v[40:43]
    ds_read_b64_tr_b16 a[0:1], v8 offset:61440
    ds_read_b64_tr_b16 a[2:3], v8 offset:63488
    v_mfma_f32_16x16x32_bf16 v[44:47], a[20:23], a[100:103], v[44:47]
    ds_read_b64_tr_b16 a[4:5], v9 offset:61440
    ds_read_b64_tr_b16 a[6:7], v9 offset:63488
    v_mfma_f32_16x16x32_bf16 v[48:51], a[24:27], a[100:103], v[48:51]
    ds_read_b64_tr_b16 a[8:9], v10 offset:61440
    ds_read_b64_tr_b16 a[10:11], v10 offset:63488
    v_mfma_f32_16x16x32_bf16 v[52:55], a[28:31], a[100:103], v[52:55]
    ds_read_b64_tr_b16 a[12:13], v11 offset:61440
    ds_read_b64_tr_b16 a[14:15], v11 offset:63488
    s_waitcnt lgkmcnt(8)
    v_mfma_f32_16x16x32_bf16 v[40:43], a[32:35], a[104:107], v[40:43]
    v_mfma_f32_16x16x32_bf16 v[44:47], a[36:39], a[104:107], v[44:47]
    v_mfma_f32_16x16x32_bf16 v[48:51], a[40:43], a[104:107], v[48:51]
    v_mfma_f32_16x16x32_bf16 v[52:55], a[44:47], a[104:107], v[52:55]
    s_waitcnt lgkmcnt(0)
    v_mfma_f32_16x16x32_bf16 v[40:43], a[0:3], a[108:111], v[40:43]
    v_mfma_f32_16x16x32_bf16 v[44:47], a[4:7], a[108:111], v[44:47]
    v_mfma_f32_16x16x32_bf16 v[48:51], a[8:11], a[108:111], v[48:51]
    v_mfma_f32_16x16x32_bf16 v[52:55], a[12:15], a[108:111], v[52:55]
    s_nop 5
    v_pk_fma_f32 v[40:41], v[40:41], v[136:137], v[176:177] op_sel_hi:[1,0,1]
    v_pk_fma_f32 v[42:43], v[42:43], v[136:137], v[178:179] op_sel_hi:[1,0,1]
    v_pk_fma_f32 v[44:45], v[44:45], v[136:137], v[180:181] op_sel_hi:[1,0,1]
    v_pk_fma_f32 v[46:47], v[46:47], v[136:137], v[182:183] op_sel_hi:[1,0,1]
    v_pk_fma_f32 v[48:49], v[48:49], v[136:137], v[184:185] op_sel_hi:[1,0,1]
    v_pk_fma_f32 v[50:51], v[50:51], v[136:137], v[186:187] op_sel_hi:[1,0,1]
    v_pk_fma_f32 v[52:53], v[52:53], v[136:137], v[188:189] op_sel_hi:[1,0,1]
    v_pk_fma_f32 v[54:55], v[54:55], v[136:137], v[190:191] op_sel_hi:[1,0,1]
    v_pk_mul_f32 v[144:145], v[40:41], v[40:41]
    v_pk_mul_f32 v[146:147], v[42:43], v[42:43]
    v_pk_mul_f32 v[148:149], v[44:45], v[44:45]
    v_pk_mul_f32 v[150:151], v[46:47], v[46:47]
    v_pk_mul_f32 v[152:153], v[48:49], v[48:49]
    v_pk_mul_f32 v[154:155], v[50:51], v[50:51]
    v_pk_mul_f32 v[156:157], v[52:53], v[52:53]
    v_pk_mul_f32 v[158:159], v[54:55], v[54:55]
    v_pk_fma_f32 v[144:145], v[144:145], s[56:57], v[142:143]
    v_pk_fma_f32 v[146:147], v[146:147], s[56:57], v[142:143]
    v_pk_fma_f32 v[148:149], v[148:149], s[56:57], v[142:143]
    v_pk_fma_f32 v[150:151], v[150:151], s[56:57], v[142:143]
    v_pk_fma_f32 v[152:153], v[152:153], s[56:57], v[142:143]
    v_pk_fma_f32 v[154:155], v[154:155], s[56:57], v[142:143]
    v_pk_fma_f32 v[156:157], v[156:157], s[56:57], v[142:143]
    v_pk_fma_f32 v[158:159], v[158:159], s[56:57], v[142:143]
    v_pk_mul_f32 v[144:145], v[144:145], v[40:41]
    v_pk_mul_f32 v[146:147], v[146:147], v[42:43]
    v_pk_mul_f32 v[148:149], v[148:149], v[44:45]
    v_pk_mul_f32 v[150:151], v[150:151], v[46:47]
    v_pk_mul_f32 v[152:153], v[152:153], v[48:49]
    v_pk_mul_f32 v[154:155], v[154:155], v[50:51]
    v_pk_mul_f32 v[156:157], v[156:157], v[52:53]
    v_pk_mul_f32 v[158:159], v[158:159], v[54:55]
    v_exp_f32 v144, v144
    v_exp_f32 v145, v145
    v_exp_f32 v146, v146
    v_exp_f32 v147, v147
    v_exp_f32 v148, v148
    v_exp_f32 v149, v149
    v_exp_f32 v150, v150
    v_exp_f32 v151, v151
    v_exp_f32 v152, v152
    v_exp_f32 v153, v153
    v_exp_f32 v154, v154
    v_exp_f32 v155, v155
    v_exp_f32 v156, v156
    v_exp_f32 v157, v157
    v_exp_f32 v158, v158
    v_exp_f32 v159, v159
    s_nop 0
    v_pk_add_f32 v[144:145], v[144:145], 1.0 op_sel_hi:[1,0]
    v_pk_add_f32 v[146:147], v[146:147], 1.0 op_sel_hi:[1,0]
    v_pk_add_f32 v[148:149], v[148:149], 1.0 op_sel_hi:[1,0]
    v_pk_add_f32 v[150:151], v[150:151], 1.0 op_sel_hi:[1,0]
    v_pk_add_f32 v[152:153], v[152:153], 1.0 op_sel_hi:[1,0]
    v_pk_add_f32 v[154:155], v[154:155], 1.0 op_sel_hi:[1,0]
    v_pk_add_f32 v[156:157], v[156:157], 1.0 op_sel_hi:[1,0]
    v_pk_add_f32 v[158:159], v[158:159], 1.0 op_sel_hi:[1,0]
    v_rcp_f32 v144, v144
    v_rcp_f32 v145, v145
    v_rcp_f32 v146, v146
    v_rcp_f32 v147, v147
    v_rcp_f32 v148, v148
    v_rcp_f32 v149, v149
    v_rcp_f32 v150, v150
    v_rcp_f32 v151, v151
    v_rcp_f32 v152, v152
    v_rcp_f32 v153, v153
    v_rcp_f32 v154, v154
    v_rcp_f32 v155, v155
    v_rcp_f32 v156, v156
    v_rcp_f32 v157, v157
    v_rcp_f32 v158, v158
    v_rcp_f32 v159, v159
    s_nop 0
    v_pk_mul_f32 v[40:41], v[40:41], v[144:145]
    v_pk_mul_f32 v[42:43], v[42:43], v[146:147]
    v_pk_mul_f32 v[44:45], v[44:45], v[148:149]
    v_pk_mul_f32 v[46:47], v[46:47], v[150:151]
    v_pk_mul_f32 v[48:49], v[48:49], v[152:153]
    v_pk_mul_f32 v[50:51], v[50:51], v[154:155]
    v_pk_mul_f32 v[52:53], v[52:53], v[156:157]
    v_pk_mul_f32 v[54:55], v[54:55], v[158:159]
    v_cvt_pk_bf16_f32 v160, v40, v41
    v_cvt_pk_bf16_f32 v161, v42, v43
    v_cvt_pk_bf16_f32 v162, v44, v45
    v_cvt_pk_bf16_f32 v163, v46, v47
    v_cvt_pk_bf16_f32 v164, v48, v49
    v_cvt_pk_bf16_f32 v165, v50, v51
    v_cvt_pk_bf16_f32 v166, v52, v53
    v_cvt_pk_bf16_f32 v167, v54, v55
    s_lshl_b32 s51, s37, 14
    s_lshl_b32 s53, s36, 11
    s_add_u32 s51, s51, s53
    buffer_store_dwordx4 v[160:163], v232, s[28:31], s51 offen offset:0 sc1
    buffer_store_dwordx4 v[164:167], v232, s[28:31], s51 offen offset:1024 sc1
    s_lshl_b32 s47, s35, 7
    s_add_u32 s47, s47, 12288
    s_waitcnt vmcnt(0)
    s_barrier
    s_cmp_eq_u32 s32, 0
    s_cbranch_scc0 mega_kernel_sig18
    v_mov_b32 v20, 0
    v_mov_b32 v21, 1
    s_mov_b64 exec, 1
    buffer_atomic_add v21, v20, s[72:75], s47 offen sc1
    s_mov_b64 exec, -1
mega_kernel_sig18:
    s_and_b32 s33, s2, 7
    s_lshl_b32 s33, s33, 1
    s_lshr_b32 s34, s2, 3
    s_and_b32 s34, s34, 1
    s_add_u32 s88, s33, s34
    s_lshr_b32 s89, s2, 4
    s_lshl_b32 s90, s88, 3
    s_lshl_b32 s33, s32, 1
    s_add_u32 s90, s90, s33
    s_lshl_b32 s91, s89, 8
    s_mov_b32 s84, s98
    s_and_b32 s85, s99, 0xffff
    s_mov_b32 s86, 1835008
    s_mov_b32 s87, 0x20000
    v_lshrrev_b32 v225, 4, v1
    v_and_b32 v224, 15, v1
    s_lshl_b32 s50, s32, 3
    v_add_u32 v229, s50, v225
    s_mov_b32 s50, 3584
    v_mul_lo_u32 v229, v229, s50
    v_add_u32 v229, s91, v229
    v_or_b32 v228, 0, v225
    v_lshlrev_b32 v228, 1, v228
    v_xor_b32 v228, v228, v224
    v_lshl_add_u32 v216, v228, 4, v229
    v_or_b32 v228, 4, v225
    v_lshlrev_b32 v228, 1, v228
    v_xor_b32 v228, v228, v224
    v_lshl_add_u32 v217, v228, 4, v229
    v_add_u32 v217, 14336, v217
    s_lshl_b32 s92, s32, 11
    v_and_b32 v224, 15, v1
    v_lshrrev_b32 v225, 4, v1
    v_lshrrev_b32 v226, 2, v224
    v_and_b32 v227, 3, v224
    v_lshl_add_u32 v229, v225, 2, v226
    v_and_b32 v228, 7, v229
    v_lshlrev_b32 v229, 8, v229
    v_lshl_add_u32 v229, v227, 3, v229
    v_xor_b32 v226, 0, v228
    v_lshl_add_u32 v200, v226, 5, v229
    v_add_u32 v201, 65536, v200
    v_xor_b32 v226, 1, v228
    v_lshl_add_u32 v202, v226, 5, v229
    v_add_u32 v203, 65536, v202
    v_xor_b32 v226, 2, v228
    v_lshl_add_u32 v204, v226, 5, v229
    v_add_u32 v205, 65536, v204
    v_xor_b32 v226, 3, v228
    v_lshl_add_u32 v206, v226, 5, v229
    v_add_u32 v207, 65536, v206
    v_xor_b32 v226, 4, v228
    v_lshl_add_u32 v208, v226, 5, v229
    v_add_u32 v209, 65536, v208
    v_xor_b32 v226, 5, v228
    v_lshl_add_u32 v210, v226, 5, v229
    v_add_u32 v211, 65536, v210
    v_xor_b32 v226, 6, v228
    v_lshl_add_u32 v212, v226, 5, v229
    v_add_u32 v213, 65536, v212
    v_xor_b32 v226, 7, v228
    v_lshl_add_u32 v214, v226, 5, v229
    v_add_u32 v215, 65536, v214
    s_cmp_eq_u32 s32, 0
    s_cbranch_scc1 mega_kernel_iw19
    s_add_u32 m0, s92, 0
    s_mov_b32 s93, 0
    buffer_load_dwordx4 v216, s[84:87], s93 offen lds
    s_add_u32 m0, s92, 1024
    s_nop 0
    buffer_load_dwordx4 v217, s[84:87], s93 offen lds
    s_add_u32 m0, s92, 8192
    s_mov_b32 s93, 114688
    buffer_load_dwordx4 v216, s[84:87], s93 offen lds
    s_add_u32 m0, s92, 9216
    s_nop 0
    buffer_load_dwordx4 v217, s[84:87], s93 offen lds
    s_add_u32 m0, s92, 16384
    s_mov_b32 s93, 229376
    buffer_load_dwordx4 v216, s[84:87], s93 offen lds
    s_add_u32 m0, s92, 17408
    s_nop 0
    buffer_load_dwordx4 v217, s[84:87], s93 offen lds
    s_add_u32 m0, s92, 24576
    s_mov_b32 s93, 344064
    buffer_load_dwordx4 v216, s[84:87], s93 offen lds
    s_add_u32 m0, s92, 25600
    s_nop 0
    buffer_load_dwordx4 v217, s[84:87], s93 offen lds
    s_add_u32 m0, s92, 32768
    s_mov_b32 s93, 458752
    buffer_load_dwordx4 v216, s[84:87], s93 offen lds
    s_add_u32 m0, s92, 33792
    s_nop 0
    buffer_load_dwordx4 v217, s[84:87], s93 offen lds
    s_add_u32 m0, s92, 40960
    s_mov_b32 s93, 573440
    buffer_load_dwordx4 v216, s[84:87], s93 offen lds
    s_add_u32 m0, s92, 41984
    s_nop 0
    buffer_load_dwordx4 v217, s[84:87], s93 offen lds
    s_add_u32 m0, s92, 49152
    s_mov_b32 s93, 688128
    buffer_load_dwordx4 v216, s[84:87], s93 offen lds
    s_add_u32 m0, s92, 50176
    s_nop 0
    buffer_load_dwordx4 v217, s[84:87], s93 offen lds
    s_add_u32 m0, s92, 57344
    s_mov_b32 s93, 802816
    buffer_load_dwordx4 v216, s[84:87], s93 offen lds
    s_add_u32 m0, s92, 58368
    s_nop 0
    buffer_load_dwordx4 v217, s[84:87], s93 offen lds
mega_kernel_iw19:
    s_lshl_b32 s53, s35, 7
    s_add_u32 s53, s53, 12288
    s_max_u32 s51, s35, 1
    s_sub_u32 s51, s51, 1
    s_lshl_b32 s54, s51, 7
    s_add_u32 s54, s54, 12288
    s_add_u32 s51, s35, 1
    s_min_u32 s51, s51, 31
    s_lshl_b32 s55, s51, 7
    s_add_u32 s55, s55, 12288
    s_add_u32 s16, s4, 26214400
    s_addc_u32 s17, s5, 0
    s_and_b32 s17, s17, 0xffff
    s_mov_b32 s18, 2097152
    s_mov_b32 s19, 0x20000
    s_add_u32 s24, s4, 29360128
    s_addc_u32 s25, s5, 0
    s_and_b32 s25, s25, 0xffff
    s_mov_b32 s26, 2097152
    s_mov_b32 s27, 0x20000
    s_add_u32 s28, s4, 33554432
    s_addc_u32 s29, s5, 0
    s_and_b32 s29, s29, 0xffff
    s_mov_b32 s30, 131072
    s_mov_b32 s31, 0x20000
    s_lshl_b32 s51, s37, 4
    v_add_u32 v14, s51, v231
    v_add_u32 v15, -1, v14
    v_lshrrev_b32 v16, 4, v15
    v_lshlrev_b32 v16, 14, v16
    v_and_b32 v17, 15, v15
    v_lshl_add_u32 v17, v230, 4, v17
    v_lshl_add_u32 v40, v17, 4, v16
    v_cmp_gt_u32 vcc, 2048, v15
    v_mov_b32 v17, 0x7f000000
    s_nop 0
    v_cndmask_b32 v40, v17, v40, vcc
    v_add_u32 v15, 1, v14
    v_lshrrev_b32 v16, 4, v15
    v_lshlrev_b32 v16, 14, v16
    v_and_b32 v17, 15, v15
    v_lshl_add_u32 v17, v230, 4, v17
    v_lshl_add_u32 v41, v17, 4, v16
    v_cmp_gt_u32 vcc, 2048, v15
    v_mov_b32 v17, 0x7f000000
    s_nop 0
    v_cndmask_b32 v41, v17, v41, vcc
    v_add_u32 v15, -2, v14
    v_lshrrev_b32 v16, 4, v15
    v_lshlrev_b32 v16, 14, v16
    v_and_b32 v17, 15, v15
    v_lshl_add_u32 v17, v230, 4, v17
    v_lshl_add_u32 v42, v17, 4, v16
    v_cmp_gt_u32 vcc, 2048, v15
    v_mov_b32 v17, 0x7f000000
    s_nop 0
    v_cndmask_b32 v42, v17, v42, vcc
    v_add_u32 v15, 2, v14
    v_lshrrev_b32 v16, 4, v15
    v_lshlrev_b32 v16, 14, v16
    v_and_b32 v17, 15, v15
    v_lshl_add_u32 v17, v230, 4, v17
    v_lshl_add_u32 v43, v17, 4, v16
    v_cmp_gt_u32 vcc, 2048, v15
    v_mov_b32 v17, 0x7f000000
    s_nop 0
    v_cndmask_b32 v43, v17, v43, vcc
    v_lshlrev_b32 v24, 16, v240
    v_and_b32 v25, 0xffff0000, v240
    v_lshlrev_b32 v26, 16, v241
    v_and_b32 v27, 0xffff0000, v241
    v_lshlrev_b32 v28, 16, v242
    v_and_b32 v29, 0xffff0000, v242
    v_lshlrev_b32 v30, 16, v243
    v_and_b32 v31, 0xffff0000, v243
    v_lshlrev_b32 v32, 16, v244
    v_and_b32 v33, 0xffff0000, v244
    v_lshlrev_b32 v34, 16, v245
    v_and_b32 v35, 0xffff0000, v245
    v_lshlrev_b32 v36, 16, v246
    v_and_b32 v37, 0xffff0000, v246
    v_lshlrev_b32 v38, 16, v247
    v_and_b32 v39, 0xffff0000, v247
    v_mul_f32 v56, -v238, v239
    v_mov_b32 v58, v239
    v_pk_fma_f32 v[24:25], v[24:25], v[58:59], v[56:57] op_sel_hi:[1,0,0]
    v_pk_fma_f32 v[24:25], v[24:25], v[64:65], v[80:81]
    v_pk_fma_f32 v[26:27], v[26:27], v[58:59], v[56:57] op_sel_hi:[1,0,0]
    v_pk_fma_f32 v[26:27], v[26:27], v[66:67], v[82:83]
    v_pk_fma_f32 v[28:29], v[28:29], v[58:59], v[56:57] op_sel_hi:[1,0,0]
    v_pk_fma_f32 v[28:29], v[28:29], v[68:69], v[84:85]
    v_pk_fma_f32 v[30:31], v[30:31], v[58:59], v[56:57] op_sel_hi:[1,0,0]
    v_pk_fma_f32 v[30:31], v[30:31], v[70:71], v[86:87]
    v_pk_fma_f32 v[32:33], v[32:33], v[58:59], v[56:57] op_sel_hi:[1,0,0]
    v_pk_fma_f32 v[32:33], v[32:33], v[72:73], v[88:89]
    v_pk_fma_f32 v[34:35], v[34:35], v[58:59], v[56:57] op_sel_hi:[1,0,0]
    v_pk_fma_f32 v[34:35], v[34:35], v[74:75], v[90:91]
    v_pk_fma_f32 v[36:37], v[36:37], v[58:59], v[56:57] op_sel_hi:[1,0,0]
    v_pk_fma_f32 v[36:37], v[36:37], v[76:77], v[92:93]
    v_pk_fma_f32 v[38:39], v[38:39], v[58:59], v[56:57] op_sel_hi:[1,0,0]
    v_pk_fma_f32 v[38:39], v[38:39], v[78:79], v[94:95]
    s_cmp_eq_u32 s32, 0
    s_cbranch_scc0 mega_kernel_pe20
    v_mov_b32 v20, s53
    v_mov_b32 v21, 8
    v_writelane_b32 v20, s54, 1
    v_writelane_b32 v21, 8, 1
    v_writelane_b32 v20, s55, 2
    v_writelane_b32 v21, 8, 2
    s_mov_b64 exec, 7
    buffer_load_dword v22, v20, s[72:75], 0 offen sc1
    s_mov_b64 exec, -1
    s_mov_b64 exec, 7
    s_mov_b32 s3, 100000
    s_waitcnt vmcnt(0)
mega_kernel_pl21:
    v_cmp_ge_u32 vcc, v22, v21
    s_sub_u32 s3, s3, 1
    s_cmp_eq_u32 s3, 0
    s_cbranch_scc1 mega_kernel_pq22
    s_cmp_eq_u64 vcc, exec
    s_cbranch_scc1 mega_kernel_pq22
    s_sleep 4
    buffer_load_dword v22, v20, s[72:75], 0 offen sc1
    s_waitcnt vmcnt(0)
    s_branch mega_kernel_pl21
mega_kernel_pq22:
    s_mov_b64 exec, -1
    s_cmp_eq_u32 s32, 0
    s_cbranch_scc0 mega_kernel_iw23
    s_add_u32 m0, s92, 0
    s_mov_b32 s93, 0
    buffer_load_dwordx4 v216, s[84:87], s93 offen lds
    s_add_u32 m0, s92, 1024
    s_nop 0
    buffer_load_dwordx4 v217, s[84:87], s93 offen lds
    s_add_u32 m0, s92, 8192
    s_mov_b32 s93, 114688
    buffer_load_dwordx4 v216, s[84:87], s93 offen lds
    s_add_u32 m0, s92, 9216
    s_nop 0
    buffer_load_dwordx4 v217, s[84:87], s93 offen lds
    s_add_u32 m0, s92, 16384
    s_mov_b32 s93, 229376
    buffer_load_dwordx4 v216, s[84:87], s93 offen lds
    s_add_u32 m0, s92, 17408
    s_nop 0
    buffer_load_dwordx4 v217, s[84:87], s93 offen lds
    s_add_u32 m0, s92, 24576
    s_mov_b32 s93, 344064
    buffer_load_dwordx4 v216, s[84:87], s93 offen lds
    s_add_u32 m0, s92, 25600
    s_nop 0
    buffer_load_dwordx4 v217, s[84:87], s93 offen lds
    s_add_u32 m0, s92, 32768
    s_mov_b32 s93, 458752
    buffer_load_dwordx4 v216, s[84:87], s93 offen lds
    s_add_u32 m0, s92, 33792
    s_nop 0
    buffer_load_dwordx4 v217, s[84:87], s93 offen lds
    s_add_u32 m0, s92, 40960
    s_mov_b32 s93, 573440
    buffer_load_dwordx4 v216, s[84:87], s93 offen lds
    s_add_u32 m0, s92, 41984
    s_nop 0
    buffer_load_dwordx4 v217, s[84:87], s93 offen lds
    s_add_u32 m0, s92, 49152
    s_mov_b32 s93, 688128
    buffer_load_dwordx4 v216, s[84:87], s93 offen lds
    s_add_u32 m0, s92, 50176
    s_nop 0
    buffer_load_dwordx4 v217, s[84:87], s93 offen lds
    s_add_u32 m0, s92, 57344
    s_mov_b32 s93, 802816
    buffer_load_dwordx4 v216, s[84:87], s93 offen lds
    s_add_u32 m0, s92, 58368
    s_nop 0
    buffer_load_dwordx4 v217, s[84:87], s93 offen lds
mega_kernel_iw23:
mega_kernel_pe20:
    s_barrier
    s_mov_b32 s52, 0
    buffer_load_dwordx4 a[48:51], v40, s[16:19], s52 offen offset:0 sc1
    buffer_load_dwordx4 a[52:55], v40, s[16:19], s52 offen offset:1024 sc1
    buffer_load_dwordx4 a[56:59], v40, s[16:19], s52 offen offset:2048 sc1
    buffer_load_dwordx4 a[60:63], v40, s[16:19], s52 offen offset:3072 sc1
    s_mov_b32 s52, 4096
    buffer_load_dwordx4 a[64:67], v41, s[16:19], s52 offen offset:0 sc1
    buffer_load_dwordx4 a[68:71], v41, s[16:19], s52 offen offset:1024 sc1
    buffer_load_dwordx4 a[72:75], v41, s[16:19], s52 offen offset:2048 sc1
    buffer_load_dwordx4 a[76:79], v41, s[16:19], s52 offen offset:3072 sc1
    s_waitcnt vmcnt(4)
    s_barrier
    ds_read_b64_tr_b16 a[0:1], v4 offset:0
    ds_read_b64_tr_b16 a[2:3], v4 offset:2048
    ds_read_b64_tr_b16 a[4:5], v5 offset:0
    ds_read_b64_tr_b16 a[6:7], v5 offset:2048
    ds_read_b64_tr_b16 a[8:9], v6 offset:0
    ds_read_b64_tr_b16 a[10:11], v6 offset:2048
    ds_read_b64_tr_b16 a[12:13], v7 offset:0
    ds_read_b64_tr_b16 a[14:15], v7 offset:2048
    ds_read_b64_tr_b16 a[16:17], v4 offset:4096
    ds_read_b64_tr_b16 a[18:19], v4 offset:6144
    ds_read_b64_tr_b16 a[20:21], v5 offset:4096
    ds_read_b64_tr_b16 a[22:23], v5 offset:6144
    ds_read_b64_tr_b16 a[24:25], v6 offset:4096
    ds_read_b64_tr_b16 a[26:27], v6 offset:6144
    ds_read_b64_tr_b16 a[28:29], v7 offset:4096
    ds_read_b64_tr_b16 a[30:31], v7 offset:6144
    s_waitcnt lgkmcnt(8)
    v_mfma_f32_16x16x32_bf16 v[24:27], a[0:3], a[48:51], v[24:27]
    ds_read_b64_tr_b16 a[32:33], v4 offset:8192
    ds_read_b64_tr_b16 a[34:35], v4 offset:10240
    v_mfma_f32_16x16x32_bf16 v[28:31], a[4:7], a[48:51], v[28:31]
    ds_read_b64_tr_b16 a[36:37], v5 offset:8192
    ds_read_b64_tr_b16 a[38:39], v5 offset:10240
    v_mfma_f32_16x16x32_bf16 v[32:35], a[8:11], a[48:51], v[32:35]
    ds_read_b64_tr_b16 a[40:41], v6 offset:8192
    ds_read_b64_tr_b16 a[42:43], v6 offset:10240
    v_mfma_f32_16x16x32_bf16 v[36:39], a[12:15], a[48:51], v[36:39]
    ds_read_b64_tr_b16 a[44:45], v7 offset:8192
    ds_read_b64_tr_b16 a[46:47], v7 offset:10240
    s_mov_b32 s52, 8192
    buffer_load_dwordx4 a[80:83], v42, s[16:19], s52 offen offset:0 sc1
    s_waitcnt lgkmcnt(8)
    v_mfma_f32_16x16x32_bf16 v[24:27], a[16:19], a[52:55], v[24:27]
    ds_read_b64_tr_b16 a[0:1], v4 offset:12288
    ds_read_b64_tr_b16 a[2:3], v4 offset:14336
    v_mfma_f32_16x16x32_bf16 v[28:31], a[20:23], a[52:55], v[28:31]
    ds_read_b64_tr_b16 a[4:5], v5 offset:12288
    ds_read_b64_tr_b16 a[6:7], v5 offset:14336
    v_mfma_f32_16x16x32_bf16 v[32:35], a[24:27], a[52:55], v[32:35]
    ds_read_b64_tr_b16 a[8:9], v6 offset:12288
    ds_read_b64_tr_b16 a[10:11], v6 offset:14336
    v_mfma_f32_16x16x32_bf16 v[36:39], a[28:31], a[52:55], v[36:39]
    ds_read_b64_tr_b16 a[12:13], v7 offset:12288
    ds_read_b64_tr_b16 a[14:15], v7 offset:14336
    buffer_load_dwordx4 a[84:87], v42, s[16:19], s52 offen offset:1024 sc1
    s_waitcnt lgkmcnt(8)
    s_waitcnt vmcnt(2)
    s_barrier
    v_mfma_f32_16x16x32_bf16 v[24:27], a[32:35], a[56:59], v[24:27]
    ds_read_b64_tr_b16 a[16:17], v4 offset:16384
    ds_read_b64_tr_b16 a[18:19], v4 offset:18432
    v_mfma_f32_16x16x32_bf16 v[28:31], a[36:39], a[56:59], v[28:31]
    ds_read_b64_tr_b16 a[20:21], v5 offset:16384
    ds_read_b64_tr_b16 a[22:23], v5 offset:18432
    v_mfma_f32_16x16x32_bf16 v[32:35], a[40:43], a[56:59], v[32:35]
    ds_read_b64_tr_b16 a[24:25], v6 offset:16384
    ds_read_b64_tr_b16 a[26:27], v6 offset:18432
    v_mfma_f32_16x16x32_bf16 v[36:39], a[44:47], a[56:59], v[36:39]
    ds_read_b64_tr_b16 a[28:29], v7 offset:16384
    ds_read_b64_tr_b16 a[30:31], v7 offset:18432
    buffer_load_dwordx4 a[88:91], v42, s[16:19], s52 offen offset:2048 sc1
    s_waitcnt lgkmcnt(8)
    v_mfma_f32_16x16x32_bf16 v[24:27], a[0:3], a[60:63], v[24:27]
    ds_read_b64_tr_b16 a[32:33], v4 offset:20480
    ds_read_b64_tr_b16 a[34:35], v4 offset:22528
    v_mfma_f32_16x16x32_bf16 v[28:31], a[4:7], a[60:63], v[28:31]
    ds_read_b64_tr_b16 a[36:37], v5 offset:20480
    ds_read_b64_tr_b16 a[38:39], v5 offset:22528
    v_mfma_f32_16x16x32_bf16 v[32:35], a[8:11], a[60:63], v[32:35]
    ds_read_b64_tr_b16 a[40:41], v6 offset:20480
    ds_read_b64_tr_b16 a[42:43], v6 offset:22528
    v_mfma_f32_16x16x32_bf16 v[36:39], a[12:15], a[60:63], v[36:39]
    ds_read_b64_tr_b16 a[44:45], v7 offset:20480
    ds_read_b64_tr_b16 a[46:47], v7 offset:22528
    buffer_load_dwordx4 a[92:95], v42, s[16:19], s52 offen offset:3072 sc1
    s_waitcnt lgkmcnt(8)
    v_mfma_f32_16x16x32_bf16 v[24:27], a[16:19], a[64:67], v[24:27]
    ds_read_b64_tr_b16 a[0:1], v4 offset:24576
    ds_read_b64_tr_b16 a[2:3], v4 offset:26624
    v_mfma_f32_16x16x32_bf16 v[28:31], a[20:23], a[64:67], v[28:31]
    ds_read_b64_tr_b16 a[4:5], v5 offset:24576
    ds_read_b64_tr_b16 a[6:7], v5 offset:26624
    v_mfma_f32_16x16x32_bf16 v[32:35], a[24:27], a[64:67], v[32:35]
    ds_read_b64_tr_b16 a[8:9], v6 offset:24576
    ds_read_b64_tr_b16 a[10:11], v6 offset:26624
    v_mfma_f32_16x16x32_bf16 v[36:39], a[28:31], a[64:67], v[36:39]
    ds_read_b64_tr_b16 a[12:13], v7 offset:24576
    ds_read_b64_tr_b16 a[14:15], v7 offset:26624
    s_mov_b32 s52, 12288
    buffer_load_dwordx4 a[96:99], v43, s[16:19], s52 offen offset:0 sc1
    s_waitcnt lgkmcnt(8)
    v_mfma_f32_16x16x32_bf16 v[24:27], a[32:35], a[68:71], v[24:27]
    ds_read_b64_tr_b16 a[16:17], v4 offset:28672
    ds_read_b64_tr_b16 a[18:19], v4 offset:30720
    v_mfma_f32_16x16x32_bf16 v[28:31], a[36:39], a[68:71], v[28:31]
    ds_read_b64_tr_b16 a[20:21], v5 offset:28672
    ds_read_b64_tr_b16 a[22:23], v5 offset:30720
    v_mfma_f32_16x16x32_bf16 v[32:35], a[40:43], a[68:71], v[32:35]
    ds_read_b64_tr_b16 a[24:25], v6 offset:28672
    ds_read_b64_tr_b16 a[26:27], v6 offset:30720
    v_mfma_f32_16x16x32_bf16 v[36:39], a[44:47], a[68:71], v[36:39]
    ds_read_b64_tr_b16 a[28:29], v7 offset:28672
    ds_read_b64_tr_b16 a[30:31], v7 offset:30720
    buffer_load_dwordx4 a[100:103], v43, s[16:19], s52 offen offset:1024 sc1
    s_waitcnt lgkmcnt(8)
    s_waitcnt vmcnt(2)
    s_barrier
    v_mfma_f32_16x16x32_bf16 v[24:27], a[0:3], a[72:75], v[24:27]
    ds_read_b64_tr_b16 a[32:33], v4 offset:32768
    ds_read_b64_tr_b16 a[34:35], v4 offset:34816
    v_mfma_f32_16x16x32_bf16 v[28:31], a[4:7], a[72:75], v[28:31]
    ds_read_b64_tr_b16 a[36:37], v5 offset:32768
    ds_read_b64_tr_b16 a[38:39], v5 offset:34816
    v_mfma_f32_16x16x32_bf16 v[32:35], a[8:11], a[72:75], v[32:35]
    ds_read_b64_tr_b16 a[40:41], v6 offset:32768
    ds_read_b64_tr_b16 a[42:43], v6 offset:34816
    v_mfma_f32_16x16x32_bf16 v[36:39], a[12:15], a[72:75], v[36:39]
    ds_read_b64_tr_b16 a[44:45], v7 offset:32768
    ds_read_b64_tr_b16 a[46:47], v7 offset:34816
    buffer_load_dwordx4 a[104:107], v43, s[16:19], s52 offen offset:2048 sc1
    s_waitcnt lgkmcnt(8)
    v_mfma_f32_16x16x32_bf16 v[24:27], a[16:19], a[76:79], v[24:27]
    ds_read_b64_tr_b16 a[0:1], v4 offset:36864
    ds_read_b64_tr_b16 a[2:3], v4 offset:38912
    v_mfma_f32_16x16x32_bf16 v[28:31], a[20:23], a[76:79], v[28:31]
    ds_read_b64_tr_b16 a[4:5], v5 offset:36864
    ds_read_b64_tr_b16 a[6:7], v5 offset:38912
    v_mfma_f32_16x16x32_bf16 v[32:35], a[24:27], a[76:79], v[32:35]
    ds_read_b64_tr_b16 a[8:9], v6 offset:36864
    ds_read_b64_tr_b16 a[10:11], v6 offset:38912
    v_mfma_f32_16x16x32_bf16 v[36:39], a[28:31], a[76:79], v[36:39]
    ds_read_b64_tr_b16 a[12:13], v7 offset:36864
    ds_read_b64_tr_b16 a[14:15], v7 offset:38912
    buffer_load_dwordx4 a[108:111], v43, s[16:19], s52 offen offset:3072 sc1
    s_waitcnt lgkmcnt(8)
    v_mfma_f32_16x16x32_bf16 v[24:27], a[32:35], a[80:83], v[24:27]
    ds_read_b64_tr_b16 a[16:17], v4 offset:40960
    ds_read_b64_tr_b16 a[18:19], v4 offset:43008
    v_mfma_f32_16x16x32_bf16 v[28:31], a[36:39], a[80:83], v[28:31]
    ds_read_b64_tr_b16 a[20:21], v5 offset:40960
    ds_read_b64_tr_b16 a[22:23], v5 offset:43008
    v_mfma_f32_16x16x32_bf16 v[32:35], a[40:43], a[80:83], v[32:35]
    ds_read_b64_tr_b16 a[24:25], v6 offset:40960
    ds_read_b64_tr_b16 a[26:27], v6 offset:43008
    v_mfma_f32_16x16x32_bf16 v[36:39], a[44:47], a[80:83], v[36:39]
    ds_read_b64_tr_b16 a[28:29], v7 offset:40960
    ds_read_b64_tr_b16 a[30:31], v7 offset:43008
    s_waitcnt lgkmcnt(8)
    v_mfma_f32_16x16x32_bf16 v[24:27], a[0:3], a[84:87], v[24:27]
    ds_read_b64_tr_b16 a[32:33], v4 offset:45056
    ds_read_b64_tr_b16 a[34:35], v4 offset:47104
    v_mfma_f32_16x16x32_bf16 v[28:31], a[4:7], a[84:87], v[28:31]
    ds_read_b64_tr_b16 a[36:37], v5 offset:45056
    ds_read_b64_tr_b16 a[38:39], v5 offset:47104
    v_mfma_f32_16x16x32_bf16 v[32:35], a[8:11], a[84:87], v[32:35]
    ds_read_b64_tr_b16 a[40:41], v6 offset:45056
    ds_read_b64_tr_b16 a[42:43], v6 offset:47104
    v_mfma_f32_16x16x32_bf16 v[36:39], a[12:15], a[84:87], v[36:39]
    ds_read_b64_tr_b16 a[44:45], v7 offset:45056
    ds_read_b64_tr_b16 a[46:47], v7 offset:47104
    s_waitcnt lgkmcnt(8)
    s_waitcnt vmcnt(0)
    s_barrier
    v_mfma_f32_16x16x32_bf16 v[24:27], a[16:19], a[88:91], v[24:27]
    ds_read_b64_tr_b16 a[0:1], v4 offset:49152
    ds_read_b64_tr_b16 a[2:3], v4 offset:51200
    v_mfma_f32_16x16x32_bf16 v[28:31], a[20:23], a[88:91], v[28:31]
    ds_read_b64_tr_b16 a[4:5], v5 offset:49152
    ds_read_b64_tr_b16 a[6:7], v5 offset:51200
    v_mfma_f32_16x16x32_bf16 v[32:35], a[24:27], a[88:91], v[32:35]
    ds_read_b64_tr_b16 a[8:9], v6 offset:49152
    ds_read_b64_tr_b16 a[10:11], v6 offset:51200
    v_mfma_f32_16x16x32_bf16 v[36:39], a[28:31], a[88:91], v[36:39]
    ds_read_b64_tr_b16 a[12:13], v7 offset:49152
    ds_read_b64_tr_b16 a[14:15], v7 offset:51200
    s_waitcnt lgkmcnt(8)
    v_mfma_f32_16x16x32_bf16 v[24:27], a[32:35], a[92:95], v[24:27]
    ds_read_b64_tr_b16 a[16:17], v4 offset:53248
    ds_read_b64_tr_b16 a[18:19], v4 offset:55296
    v_mfma_f32_16x16x32_bf16 v[28:31], a[36:39], a[92:95], v[28:31]
    ds_read_b64_tr_b16 a[20:21], v5 offset:53248
    ds_read_b64_tr_b16 a[22:23], v5 offset:55296
    v_mfma_f32_16x16x32_bf16 v[32:35], a[40:43], a[92:95], v[32:35]
    ds_read_b64_tr_b16 a[24:25], v6 offset:53248
    ds_read_b64_tr_b16 a[26:27], v6 offset:55296
    v_mfma_f32_16x16x32_bf16 v[36:39], a[44:47], a[92:95], v[36:39]
    ds_read_b64_tr_b16 a[28:29], v7 offset:53248
    ds_read_b64_tr_b16 a[30:31], v7 offset:55296
    s_waitcnt lgkmcnt(8)
    v_mfma_f32_16x16x32_bf16 v[24:27], a[0:3], a[96:99], v[24:27]
    ds_read_b64_tr_b16 a[32:33], v4 offset:57344
    ds_read_b64_tr_b16 a[34:35], v4 offset:59392
    v_mfma_f32_16x16x32_bf16 v[28:31], a[4:7], a[96:99], v[28:31]
    ds_read_b64_tr_b16 a[36:37], v5 offset:57344
    ds_read_b64_tr_b16 a[38:39], v5 offset:59392
    v_mfma_f32_16x16x32_bf16 v[32:35], a[8:11], a[96:99], v[32:35]
    ds_read_b64_tr_b16 a[40:41], v6 offset:57344
    ds_read_b64_tr_b16 a[42:43], v6 offset:59392
    v_mfma_f32_16x16x32_bf16 v[36:39], a[12:15], a[96:99], v[36:39]
    ds_read_b64_tr_b16 a[44:45], v7 offset:57344
    ds_read_b64_tr_b16 a[46:47], v7 offset:59392
    s_waitcnt lgkmcnt(8)
    v_mfma_f32_16x16x32_bf16 v[24:27], a[16:19], a[100:103], v[24:27]
    ds_read_b64_tr_b16 a[0:1], v4 offset:61440
    ds_read_b64_tr_b16 a[2:3], v4 offset:63488
    v_mfma_f32_16x16x32_bf16 v[28:31], a[20:23], a[100:103], v[28:31]
    ds_read_b64_tr_b16 a[4:5], v5 offset:61440
    ds_read_b64_tr_b16 a[6:7], v5 offset:63488
    v_mfma_f32_16x16x32_bf16 v[32:35], a[24:27], a[100:103], v[32:35]
    ds_read_b64_tr_b16 a[8:9], v6 offset:61440
    ds_read_b64_tr_b16 a[10:11], v6 offset:63488
    v_mfma_f32_16x16x32_bf16 v[36:39], a[28:31], a[100:103], v[36:39]
    ds_read_b64_tr_b16 a[12:13], v7 offset:61440
    ds_read_b64_tr_b16 a[14:15], v7 offset:63488
    s_waitcnt lgkmcnt(8)
    v_mfma_f32_16x16x32_bf16 v[24:27], a[32:35], a[104:107], v[24:27]
    v_mfma_f32_16x16x32_bf16 v[28:31], a[36:39], a[104:107], v[28:31]
    v_mfma_f32_16x16x32_bf16 v[32:35], a[40:43], a[104:107], v[32:35]
    v_mfma_f32_16x16x32_bf16 v[36:39], a[44:47], a[104:107], v[36:39]
    s_waitcnt lgkmcnt(0)
    v_mfma_f32_16x16x32_bf16 v[24:27], a[0:3], a[108:111], v[24:27]
    v_mfma_f32_16x16x32_bf16 v[28:31], a[4:7], a[108:111], v[28:31]
    v_mfma_f32_16x16x32_bf16 v[32:35], a[8:11], a[108:111], v[32:35]
    v_mfma_f32_16x16x32_bf16 v[36:39], a[12:15], a[108:111], v[36:39]
    s_nop 5
    v_cvt_pk_bf16_f32 v248, v24, v25
    v_cvt_pk_bf16_f32 v249, v26, v27
    v_cvt_pk_bf16_f32 v250, v28, v29
    v_cvt_pk_bf16_f32 v251, v30, v31
    v_cvt_pk_bf16_f32 v252, v32, v33
    v_cvt_pk_bf16_f32 v253, v34, v35
    v_cvt_pk_bf16_f32 v254, v36, v37
    v_cvt_pk_bf16_f32 v255, v38, v39
    s_lshl_b32 s51, s37, 14
    s_lshl_b32 s53, s36, 11
    s_add_u32 s51, s51, s53
    buffer_store_dwordx4 v[248:251], v232, s[24:27], s51 offen offset:0 sc1
    buffer_store_dwordx4 v[252:255], v232, s[24:27], s51 offen offset:1024 sc1
    v_lshlrev_b32 v96, 16, v248
    v_and_b32 v97, 0xffff0000, v248
    v_lshlrev_b32 v98, 16, v249
    v_and_b32 v99, 0xffff0000, v249
    v_lshlrev_b32 v100, 16, v250
    v_and_b32 v101, 0xffff0000, v250
    v_lshlrev_b32 v102, 16, v251
    v_and_b32 v103, 0xffff0000, v251
    v_lshlrev_b32 v104, 16, v252
    v_and_b32 v105, 0xffff0000, v252
    v_lshlrev_b32 v106, 16, v253
    v_and_b32 v107, 0xffff0000, v253
    v_lshlrev_b32 v108, 16, v254
    v_and_b32 v109, 0xffff0000, v254
    v_lshlrev_b32 v110, 16, v255
    v_and_b32 v111, 0xffff0000, v255
    v_pk_add_f32 v[120:121], v[96:97], v[98:99]
    v_pk_mul_f32 v[122:123], v[96:97], v[96:97]
    v_pk_fma_f32 v[122:123], v[98:99], v[98:99], v[122:123]
    v_pk_add_f32 v[120:121], v[120:121], v[100:101]
    v_pk_fma_f32 v[122:123], v[100:101], v[100:101], v[122:123]
    v_pk_add_f32 v[120:121], v[120:121], v[102:103]
    v_pk_fma_f32 v[122:123], v[102:103], v[102:103], v[122:123]
    v_pk_add_f32 v[120:121], v[120:121], v[104:105]
    v_pk_fma_f32 v[122:123], v[104:105], v[104:105], v[122:123]
    v_pk_add_f32 v[120:121], v[120:121], v[106:107]
    v_pk_fma_f32 v[122:123], v[106:107], v[106:107], v[122:123]
    v_pk_add_f32 v[120:121], v[120:121], v[108:109]
    v_pk_fma_f32 v[122:123], v[108:109], v[108:109], v[122:123]
    v_pk_add_f32 v[120:121], v[120:121], v[110:111]
    v_pk_fma_f32 v[122:123], v[110:111], v[110:111], v[122:123]
    v_add_f32 v124, v120, v121
    v_add_f32 v125, v122, v123
    v_mov_b32 v126, v124
    v_mov_b32 v127, v125
    s_nop 1
    v_permlane16_swap_b32 v124, v126
    v_permlane16_swap_b32 v125, v127
    s_nop 1
    v_add_f32 v124, v124, v126
    v_add_f32 v125, v125, v127
    s_nop 0
    v_mov_b32 v126, v124
    v_mov_b32 v127, v125
    s_nop 1
    v_permlane32_swap_b32 v124, v126
    v_permlane32_swap_b32 v125, v127
    s_nop 1
    v_add_f32 v124, v124, v126
    v_add_f32 v125, v125, v127
    s_nop 0
    s_lshl_b32 s51, s37, 10
    s_lshl_b32 s53, s36, 3
    s_add_u32 s51, s51, s53
    v_lshlrev_b32 v14, 6, v231
    s_mov_b64 exec, 0xffff
    buffer_store_dwordx2 v[124:125], v14, s[28:31], s51 offen sc1
    s_mov_b64 exec, -1
    s_lshl_b32 s47, s35, 7
    s_add_u32 s47, s47, 16384
    s_waitcnt vmcnt(0)
    s_barrier
    s_cmp_eq_u32 s32, 0
    s_cbranch_scc0 mega_kernel_sig24
    v_mov_b32 v20, 0
    v_mov_b32 v21, 1
    s_mov_b64 exec, 1
    buffer_atomic_add v21, v20, s[72:75], s47 offen sc1
    s_mov_b64 exec, -1
mega_kernel_sig24:
    s_cmp_eq_u32 s32, 0
    s_cbranch_scc1 mega_kernel_iw25
    s_add_u32 m0, s92, 65536
    s_mov_b32 s93, 917504
    buffer_load_dwordx4 v216, s[84:87], s93 offen lds
    s_add_u32 m0, s92, 66560
    s_nop 0
    buffer_load_dwordx4 v217, s[84:87], s93 offen lds
    s_add_u32 m0, s92, 73728
    s_mov_b32 s93, 1032192
    buffer_load_dwordx4 v216, s[84:87], s93 offen lds
    s_add_u32 m0, s92, 74752
    s_nop 0
    buffer_load_dwordx4 v217, s[84:87], s93 offen lds
    s_add_u32 m0, s92, 81920
    s_mov_b32 s93, 1146880
    buffer_load_dwordx4 v216, s[84:87], s93 offen lds
    s_add_u32 m0, s92, 82944
    s_nop 0
    buffer_load_dwordx4 v217, s[84:87], s93 offen lds
    s_add_u32 m0, s92, 90112
    s_mov_b32 s93, 1261568
    buffer_load_dwordx4 v216, s[84:87], s93 offen lds
    s_add_u32 m0, s92, 91136
    s_nop 0
    buffer_load_dwordx4 v217, s[84:87], s93 offen lds
    s_add_u32 m0, s92, 98304
    s_mov_b32 s93, 1376256
    buffer_load_dwordx4 v216, s[84:87], s93 offen lds
    s_add_u32 m0, s92, 99328
    s_nop 0
    buffer_load_dwordx4 v217, s[84:87], s93 offen lds
    s_add_u32 m0, s92, 106496
    s_mov_b32 s93, 1490944
    buffer_load_dwordx4 v216, s[84:87], s93 offen lds
    s_add_u32 m0, s92, 107520
    s_nop 0
    buffer_load_dwordx4 v217, s[84:87], s93 offen lds
    s_add_u32 m0, s92, 114688
    s_mov_b32 s93, 1605632
    buffer_load_dwordx4 v216, s[84:87], s93 offen lds
    s_add_u32 m0, s92, 115712
    s_nop 0
    buffer_load_dwordx4 v217, s[84:87], s93 offen lds
    s_add_u32 m0, s92, 122880
    s_mov_b32 s93, 1720320
    buffer_load_dwordx4 v216, s[84:87], s93 offen lds
    s_add_u32 m0, s92, 123904
    s_nop 0
    buffer_load_dwordx4 v217, s[84:87], s93 offen lds
mega_kernel_iw25:
    s_cmp_ge_u32 s2, 224
    s_cbranch_scc1 mega_kernel_no4b
    s_lshl_b32 s51, s88, 1
    s_lshl_b32 s53, s51, 7
    s_add_u32 s53, s53, 16384
    s_add_u32 s54, s53, 128
    s_add_u32 s16, s4, 29360128
    s_addc_u32 s17, s5, 0
    s_and_b32 s17, s17, 0xffff
    s_mov_b32 s18, 2097152
    s_mov_b32 s19, 0x20000
    s_add_u32 s20, s4, 33554432
    s_addc_u32 s21, s5, 0
    s_and_b32 s21, s21, 0xffff
    s_mov_b32 s22, 131072
    s_mov_b32 s23, 0x20000
    s_add_u32 s24, s4, 24576
    s_addc_u32 s25, s5, 0
    s_and_b32 s25, s25, 0xffff
    s_mov_b32 s26, 7168
    s_mov_b32 s27, 0x20000
    s_add_u32 s28, s4, 34603008
    s_addc_u32 s29, s5, 0
    s_and_b32 s29, s29, 0xffff
    s_mov_b32 s30, 7340032
    s_mov_b32 s31, 0x20000
    s_lshl_b32 s51, s90, 14
    v_add_u32 v14, s51, v232
    v_add_u32 v15, 16384, v14
    s_lshl_b32 s51, s90, 10
    v_lshlrev_b32 v16, 6, v231
    v_lshl_add_u32 v16, v230, 4, v16
    v_add_u32 v16, s51, v16
    v_add_u32 v17, 1024, v16
    s_lshl_b32 s51, s89, 9
    v_lshlrev_b32 v18, 4, v230
    v_add_u32 v18, s51, v18
    buffer_load_dwordx4 v[128:131], v18, s[24:27], 0 offen offset:0
    buffer_load_dwordx4 v[132:135], v18, s[24:27], 0 offen offset:64
    buffer_load_dwordx4 v[136:139], v18, s[24:27], 0 offen offset:128
    buffer_load_dwordx4 v[140:143], v18, s[24:27], 0 offen offset:192
    buffer_load_dwordx4 v[144:147], v18, s[24:27], 0 offen offset:256
    buffer_load_dwordx4 v[148:151], v18, s[24:27], 0 offen offset:320
    buffer_load_dwordx4 v[152:155], v18, s[24:27], 0 offen offset:384
    buffer_load_dwordx4 v[156:159], v18, s[24:27], 0 offen offset:448
    s_mov_b32 s56, 0xbdd2d3e8
    s_mov_b32 s57, 0xbdd2d3e8
    v_mov_b32 v22, 0xc0135761
    v_mov_b32 v23, 0xc0135761
    s_cmp_eq_u32 s32, 0
    s_cbranch_scc0 mega_kernel_pe26
    v_mov_b32 v28, s53
    v_mov_b32 v29, 8
    v_writelane_b32 v28, s54, 1
    v_writelane_b32 v29, 8, 1
    s_mov_b64 exec, 3
    buffer_load_dword v30, v28, s[72:75], 0 offen sc1
    s_mov_b64 exec, -1
    s_mov_b64 exec, 3
    s_mov_b32 s3, 100000
    s_waitcnt vmcnt(0)
mega_kernel_pl27:
    v_cmp_ge_u32 vcc, v30, v29
    s_sub_u32 s3, s3, 1
    s_cmp_eq_u32 s3, 0
    s_cbranch_scc1 mega_kernel_pq28
    s_cmp_eq_u64 vcc, exec
    s_cbranch_scc1 mega_kernel_pq28
    s_sleep 4
    buffer_load_dword v30, v28, s[72:75], 0 offen sc1
    s_waitcnt vmcnt(0)
    s_branch mega_kernel_pl27
mega_kernel_pq28:
    s_mov_b64 exec, -1
    s_cmp_eq_u32 s32, 0
    s_cbranch_scc0 mega_kernel_iw29
    s_add_u32 m0, s92, 65536
    s_mov_b32 s93, 917504
    buffer_load_dwordx4 v216, s[84:87], s93 offen lds
    s_add_u32 m0, s92, 66560
    s_nop 0
    buffer_load_dwordx4 v217, s[84:87], s93 offen lds
    s_add_u32 m0, s92, 73728
    s_mov_b32 s93, 1032192
    buffer_load_dwordx4 v216, s[84:87], s93 offen lds
    s_add_u32 m0, s92, 74752
    s_nop 0
    buffer_load_dwordx4 v217, s[84:87], s93 offen lds
    s_add_u32 m0, s92, 81920
    s_mov_b32 s93, 1146880
    buffer_load_dwordx4 v216, s[84:87], s93 offen lds
    s_add_u32 m0, s92, 82944
    s_nop 0
    buffer_load_dwordx4 v217, s[84:87], s93 offen lds
    s_add_u32 m0, s92, 90112
    s_mov_b32 s93, 1261568
    buffer_load_dwordx4 v216, s[84:87], s93 offen lds
    s_add_u32 m0, s92, 91136
    s_nop 0
    buffer_load_dwordx4 v217, s[84:87], s93 offen lds
    s_add_u32 m0, s92, 98304
    s_mov_b32 s93, 1376256
    buffer_load_dwordx4 v216, s[84:87], s93 offen lds
    s_add_u32 m0, s92, 99328
    s_nop 0
    buffer_load_dwordx4 v217, s[84:87], s93 offen lds
    s_add_u32 m0, s92, 106496
    s_mov_b32 s93, 1490944
    buffer_load_dwordx4 v216, s[84:87], s93 offen lds
    s_add_u32 m0, s92, 107520
    s_nop 0
    buffer_load_dwordx4 v217, s[84:87], s93 offen lds
    s_add_u32 m0, s92, 114688
    s_mov_b32 s93, 1605632
    buffer_load_dwordx4 v216, s[84:87], s93 offen lds
    s_add_u32 m0, s92, 115712
    s_nop 0
    buffer_load_dwordx4 v217, s[84:87], s93 offen lds
    s_add_u32 m0, s92, 122880
    s_mov_b32 s93, 1720320
    buffer_load_dwordx4 v216, s[84:87], s93 offen lds
    s_add_u32 m0, s92, 123904
    s_nop 0
    buffer_load_dwordx4 v217, s[84:87], s93 offen lds
mega_kernel_iw29:
mega_kernel_pe26:
    s_barrier
    buffer_load_dwordx4 v[40:43], v16, s[20:23], 0 offen sc1
    buffer_load_dwordx4 v[44:47], v17, s[20:23], 0 offen sc1
    s_mov_b32 s52, 0
    buffer_load_dwordx4 a[64:67], v14, s[16:19], s52 offen offset:0 sc1
    buffer_load_dwordx4 a[68:71], v15, s[16:19], s52 offen offset:0 sc1
    buffer_load_dwordx4 a[72:75], v14, s[16:19], s52 offen offset:1024 sc1
    buffer_load_dwordx4 a[76:79], v15, s[16:19], s52 offen offset:1024 sc1
    buffer_load_dwordx4 a[80:83], v14, s[16:19], s52 offen offset:2048 sc1
    buffer_load_dwordx4 a[84:87], v15, s[16:19], s52 offen offset:2048 sc1
    buffer_load_dwordx4 a[88:91], v14, s[16:19], s52 offen offset:3072 sc1
    buffer_load_dwordx4 a[92:95], v15, s[16:19], s52 offen offset:3072 sc1
    s_mov_b32 s52, 4096
    buffer_load_dwordx4 a[96:99], v14, s[16:19], s52 offen offset:0 sc1
    buffer_load_dwordx4 a[100:103], v15, s[16:19], s52 offen offset:0 sc1
    buffer_load_dwordx4 a[104:107], v14, s[16:19], s52 offen offset:1024 sc1
    buffer_load_dwordx4 a[108:111], v15, s[16:19], s52 offen offset:1024 sc1
    buffer_load_dwordx4 a[112:115], v14, s[16:19], s52 offen offset:2048 sc1
    buffer_load_dwordx4 a[116:119], v15, s[16:19], s52 offen offset:2048 sc1
    buffer_load_dwordx4 a[120:123], v14, s[16:19], s52 offen offset:3072 sc1
    buffer_load_dwordx4 a[124:127], v15, s[16:19], s52 offen offset:3072 sc1
    s_waitcnt vmcnt(16)
    v_add_f32 v48, v40, v42
    v_add_f32 v49, v41, v43
    v_add_f32 v50, v44, v46
    v_add_f32 v51, v45, v47
    v_mov_b32 v52, v48
    v_mov_b32 v53, v49
    v_mov_b32 v54, v50
    v_mov_b32 v55, v51
    s_nop 1
    v_permlane16_swap_b32 v48, v52
    v_permlane16_swap_b32 v49, v53
    v_permlane16_swap_b32 v50, v54
    v_permlane16_swap_b32 v51, v55
    s_nop 1
    v_add_f32 v48, v48, v52
    v_add_f32 v49, v49, v53
    v_add_f32 v50, v50, v54
    v_add_f32 v51, v51, v55
    s_nop 0
    v_mov_b32 v52, v48
    v_mov_b32 v53, v49
    v_mov_b32 v54, v50
    v_mov_b32 v55, v51
    s_nop 1
    v_permlane32_swap_b32 v48, v52
    v_permlane32_swap_b32 v49, v53
    v_permlane32_swap_b32 v50, v54
    v_permlane32_swap_b32 v51, v55
    s_nop 1
    v_add_f32 v48, v48, v52
    v_add_f32 v49, v49, v53
    v_add_f32 v50, v50, v54
    v_add_f32 v51, v51, v55
    s_nop 0
    v_mul_f32 v56, 0x3b000000, v48
    v_mul_f32 v24, 0x3b000000, v49
    v_fma_f32 v24, -v56, v56, v24
    v_max_f32 v24, 0, v24
    v_add_f32 v24, 0x3727c5ac, v24
    v_rsq_f32 v58, v24
    s_nop 0
    v_sub_f32 v56, 0, v56
    v_mul_f32 v60, 0x3b000000, v50
    v_mul_f32 v24, 0x3b000000, v51
    v_fma_f32 v24, -v60, v60, v24
    v_max_f32 v24, 0, v24
    v_add_f32 v24, 0x3727c5ac, v24
    v_rsq_f32 v62, v24
    s_nop 0
    v_sub_f32 v60, 0, v60
    v_pk_mul_f32 v[64:65], v[128:129], v[56:57] op_sel_hi:[1,0]
    v_pk_mul_f32 v[66:67], v[130:131], v[56:57] op_sel_hi:[1,0]
    v_pk_mul_f32 v[68:69], v[132:133], v[56:57] op_sel_hi:[1,0]
    v_pk_mul_f32 v[70:71], v[134:135], v[56:57] op_sel_hi:[1,0]
    v_pk_mul_f32 v[72:73], v[136:137], v[56:57] op_sel_hi:[1,0]
    v_pk_mul_f32 v[74:75], v[138:139], v[56:57] op_sel_hi:[1,0]
    v_pk_mul_f32 v[76:77], v[140:141], v[56:57] op_sel_hi:[1,0]
    v_pk_mul_f32 v[78:79], v[142:143], v[56:57] op_sel_hi:[1,0]
    v_pk_mul_f32 v[80:81], v[144:145], v[56:57] op_sel_hi:[1,0]
    v_pk_mul_f32 v[82:83], v[146:147], v[56:57] op_sel_hi:[1,0]
    v_pk_mul_f32 v[84:85], v[148:149], v[56:57] op_sel_hi:[1,0]
    v_pk_mul_f32 v[86:87], v[150:151], v[56:57] op_sel_hi:[1,0]
    v_pk_mul_f32 v[88:89], v[152:153], v[56:57] op_sel_hi:[1,0]
    v_pk_mul_f32 v[90:91], v[154:155], v[56:57] op_sel_hi:[1,0]
    v_pk_mul_f32 v[92:93], v[156:157], v[56:57] op_sel_hi:[1,0]
    v_pk_mul_f32 v[94:95], v[158:159], v[56:57] op_sel_hi:[1,0]
    v_pk_mul_f32 v[96:97], v[128:129], v[60:61] op_sel_hi:[1,0]
    v_pk_mul_f32 v[98:99], v[130:131], v[60:61] op_sel_hi:[1,0]
    v_pk_mul_f32 v[100:101], v[132:133], v[60:61] op_sel_hi:[1,0]
    v_pk_mul_f32 v[102:103], v[134:135], v[60:61] op_sel_hi:[1,0]
    v_pk_mul_f32 v[104:105], v[136:137], v[60:61] op_sel_hi:[1,0]
    v_pk_mul_f32 v[106:107], v[138:139], v[60:61] op_sel_hi:[1,0]
    v_pk_mul_f32 v[108:109], v[140:141], v[60:61] op_sel_hi:[1,0]
    v_pk_mul_f32 v[110:111], v[142:143], v[60:61] op_sel_hi:[1,0]
    v_pk_mul_f32 v[112:113], v[144:145], v[60:61] op_sel_hi:[1,0]
    v_pk_mul_f32 v[114:115], v[146:147], v[60:61] op_sel_hi:[1,0]
    v_pk_mul_f32 v[116:117], v[148:149], v[60:61] op_sel_hi:[1,0]
    v_pk_mul_f32 v[118:119], v[150:151], v[60:61] op_sel_hi:[1,0]
    v_pk_mul_f32 v[120:121], v[152:153], v[60:61] op_sel_hi:[1,0]
    v_pk_mul_f32 v[122:123], v[154:155], v[60:61] op_sel_hi:[1,0]
    v_pk_mul_f32 v[124:125], v[156:157], v[60:61] op_sel_hi:[1,0]
    v_pk_mul_f32 v[126:127], v[158:159], v[60:61] op_sel_hi:[1,0]
    s_waitcnt vmcnt(8)
    s_barrier
    ds_read_b64_tr_b16 a[0:1], v200 offset:0
    ds_read_b64_tr_b16 a[2:3], v200 offset:4096
    ds_read_b64_tr_b16 a[4:5], v202 offset:0
    ds_read_b64_tr_b16 a[6:7], v202 offset:4096
    ds_read_b64_tr_b16 a[8:9], v204 offset:0
    ds_read_b64_tr_b16 a[10:11], v204 offset:4096
    ds_read_b64_tr_b16 a[12:13], v206 offset:0
    ds_read_b64_tr_b16 a[14:15], v206 offset:4096
    ds_read_b64_tr_b16 a[16:17], v208 offset:0
    ds_read_b64_tr_b16 a[18:19], v208 offset:4096
    ds_read_b64_tr_b16 a[20:21], v210 offset:0
    ds_read_b64_tr_b16 a[22:23], v210 offset:4096
    ds_read_b64_tr_b16 a[24:25], v212 offset:0
    ds_read_b64_tr_b16 a[26:27], v212 offset:4096
    ds_read_b64_tr_b16 a[28:29], v214 offset:0
    ds_read_b64_tr_b16 a[30:31], v214 offset:4096
    s_waitcnt lgkmcnt(0)
    v_mfma_f32_16x16x32_bf16 v[64:67], a[0:3], a[64:67], v[64:67]
    ds_read_b64_tr_b16 a[32:33], v200 offset:8192
    ds_read_b64_tr_b16 a[34:35], v200 offset:12288
    v_mfma_f32_16x16x32_bf16 v[96:99], a[0:3], a[68:71], v[96:99]
    ds_read_b64_tr_b16 a[36:37], v202 offset:8192
    ds_read_b64_tr_b16 a[38:39], v202 offset:12288
    v_mfma_f32_16x16x32_bf16 v[68:71], a[4:7], a[64:67], v[68:71]
    ds_read_b64_tr_b16 a[40:41], v204 offset:8192
    ds_read_b64_tr_b16 a[42:43], v204 offset:12288
    v_mfma_f32_16x16x32_bf16 v[100:103], a[4:7], a[68:71], v[100:103]
    ds_read_b64_tr_b16 a[44:45], v206 offset:8192
    ds_read_b64_tr_b16 a[46:47], v206 offset:12288
    v_mfma_f32_16x16x32_bf16 v[72:75], a[8:11], a[64:67], v[72:75]
    ds_read_b64_tr_b16 a[48:49], v208 offset:8192
    ds_read_b64_tr_b16 a[50:51], v208 offset:12288
    v_mfma_f32_16x16x32_bf16 v[104:107], a[8:11], a[68:71], v[104:107]
    ds_read_b64_tr_b16 a[52:53], v210 offset:8192
    ds_read_b64_tr_b16 a[54:55], v210 offset:12288
    v_mfma_f32_16x16x32_bf16 v[76:79], a[12:15], a[64:67], v[76:79]
    ds_read_b64_tr_b16 a[56:57], v212 offset:8192
    ds_read_b64_tr_b16 a[58:59], v212 offset:12288
    v_mfma_f32_16x16x32_bf16 v[108:111], a[12:15], a[68:71], v[108:111]
    ds_read_b64_tr_b16 a[60:61], v214 offset:8192
    ds_read_b64_tr_b16 a[62:63], v214 offset:12288
    v_mfma_f32_16x16x32_bf16 v[80:83], a[16:19], a[64:67], v[80:83]
    v_mfma_f32_16x16x32_bf16 v[112:115], a[16:19], a[68:71], v[112:115]
    v_mfma_f32_16x16x32_bf16 v[84:87], a[20:23], a[64:67], v[84:87]
    v_mfma_f32_16x16x32_bf16 v[116:119], a[20:23], a[68:71], v[116:119]
    v_mfma_f32_16x16x32_bf16 v[88:91], a[24:27], a[64:67], v[88:91]
    v_mfma_f32_16x16x32_bf16 v[120:123], a[24:27], a[68:71], v[120:123]
    v_mfma_f32_16x16x32_bf16 v[92:95], a[28:31], a[64:67], v[92:95]
    v_mfma_f32_16x16x32_bf16 v[124:127], a[28:31], a[68:71], v[124:127]
    s_mov_b32 s52, 8192
    buffer_load_dwordx4 a[128:131], v14, s[16:19], s52 offen offset:0 sc1
    buffer_load_dwordx4 a[132:135], v15, s[16:19], s52 offen offset:0 sc1
    s_waitcnt lgkmcnt(0)
    v_mfma_f32_16x16x32_bf16 v[64:67], a[32:35], a[72:75], v[64:67]
    ds_read_b64_tr_b16 a[0:1], v200 offset:16384
    ds_read_b64_tr_b16 a[2:3], v200 offset:20480
    v_mfma_f32_16x16x32_bf16 v[96:99], a[32:35], a[76:79], v[96:99]
    ds_read_b64_tr_b16 a[4:5], v202 offset:16384
    ds_read_b64_tr_b16 a[6:7], v202 offset:20480
    v_mfma_f32_16x16x32_bf16 v[68:71], a[36:39], a[72:75], v[68:71]
    ds_read_b64_tr_b16 a[8:9], v204 offset:16384
    ds_read_b64_tr_b16 a[10:11], v204 offset:20480
    v_mfma_f32_16x16x32_bf16 v[100:103], a[36:39], a[76:79], v[100:103]
    ds_read_b64_tr_b16 a[12:13], v206 offset:16384
    ds_read_b64_tr_b16 a[14:15], v206 offset:20480
    v_mfma_f32_16x16x32_bf16 v[72:75], a[40:43], a[72:75], v[72:75]
    ds_read_b64_tr_b16 a[16:17], v208 offset:16384
    ds_read_b64_tr_b16 a[18:19], v208 offset:20480
    v_mfma_f32_16x16x32_bf16 v[104:107], a[40:43], a[76:79], v[104:107]
    ds_read_b64_tr_b16 a[20:21], v210 offset:16384
    ds_read_b64_tr_b16 a[22:23], v210 offset:20480
    v_mfma_f32_16x16x32_bf16 v[76:79], a[44:47], a[72:75], v[76:79]
    ds_read_b64_tr_b16 a[24:25], v212 offset:16384
    ds_read_b64_tr_b16 a[26:27], v212 offset:20480
    v_mfma_f32_16x16x32_bf16 v[108:111], a[44:47], a[76:79], v[108:111]
    ds_read_b64_tr_b16 a[28:29], v214 offset:16384
    ds_read_b64_tr_b16 a[30:31], v214 offset:20480
    v_mfma_f32_16x16x32_bf16 v[80:83], a[48:51], a[72:75], v[80:83]
    v_mfma_f32_16x16x32_bf16 v[112:115], a[48:51], a[76:79], v[112:115]
    v_mfma_f32_16x16x32_bf16 v[84:87], a[52:55], a[72:75], v[84:87]
    v_mfma_f32_16x16x32_bf16 v[116:119], a[52:55], a[76:79], v[116:119]
    v_mfma_f32_16x16x32_bf16 v[88:91], a[56:59], a[72:75], v[88:91]
    v_mfma_f32_16x16x32_bf16 v[120:123], a[56:59], a[76:79], v[120:123]
    v_mfma_f32_16x16x32_bf16 v[92:95], a[60:63], a[72:75], v[92:95]
    v_mfma_f32_16x16x32_bf16 v[124:127], a[60:63], a[76:79], v[124:127]
    buffer_load_dwordx4 a[136:139], v14, s[16:19], s52 offen offset:1024 sc1
    buffer_load_dwordx4 a[140:143], v15, s[16:19], s52 offen offset:1024 sc1
    s_waitcnt lgkmcnt(0)
    v_mfma_f32_16x16x32_bf16 v[64:67], a[0:3], a[80:83], v[64:67]
    ds_read_b64_tr_b16 a[32:33], v200 offset:24576
    ds_read_b64_tr_b16 a[34:35], v200 offset:28672
    v_mfma_f32_16x16x32_bf16 v[96:99], a[0:3], a[84:87], v[96:99]
    ds_read_b64_tr_b16 a[36:37], v202 offset:24576
    ds_read_b64_tr_b16 a[38:39], v202 offset:28672
    v_mfma_f32_16x16x32_bf16 v[68:71], a[4:7], a[80:83], v[68:71]
    ds_read_b64_tr_b16 a[40:41], v204 offset:24576
    ds_read_b64_tr_b16 a[42:43], v204 offset:28672
    v_mfma_f32_16x16x32_bf16 v[100:103], a[4:7], a[84:87], v[100:103]
    ds_read_b64_tr_b16 a[44:45], v206 offset:24576
    ds_read_b64_tr_b16 a[46:47], v206 offset:28672
    v_mfma_f32_16x16x32_bf16 v[72:75], a[8:11], a[80:83], v[72:75]
    ds_read_b64_tr_b16 a[48:49], v208 offset:24576
    ds_read_b64_tr_b16 a[50:51], v208 offset:28672
    v_mfma_f32_16x16x32_bf16 v[104:107], a[8:11], a[84:87], v[104:107]
    ds_read_b64_tr_b16 a[52:53], v210 offset:24576
    ds_read_b64_tr_b16 a[54:55], v210 offset:28672
    v_mfma_f32_16x16x32_bf16 v[76:79], a[12:15], a[80:83], v[76:79]
    ds_read_b64_tr_b16 a[56:57], v212 offset:24576
    ds_read_b64_tr_b16 a[58:59], v212 offset:28672
    v_mfma_f32_16x16x32_bf16 v[108:111], a[12:15], a[84:87], v[108:111]
    ds_read_b64_tr_b16 a[60:61], v214 offset:24576
    ds_read_b64_tr_b16 a[62:63], v214 offset:28672
    v_mfma_f32_16x16x32_bf16 v[80:83], a[16:19], a[80:83], v[80:83]
    v_mfma_f32_16x16x32_bf16 v[112:115], a[16:19], a[84:87], v[112:115]
    v_mfma_f32_16x16x32_bf16 v[84:87], a[20:23], a[80:83], v[84:87]
    v_mfma_f32_16x16x32_bf16 v[116:119], a[20:23], a[84:87], v[116:119]
    v_mfma_f32_16x16x32_bf16 v[88:91], a[24:27], a[80:83], v[88:91]
    v_mfma_f32_16x16x32_bf16 v[120:123], a[24:27], a[84:87], v[120:123]
    v_mfma_f32_16x16x32_bf16 v[92:95], a[28:31], a[80:83], v[92:95]
    v_mfma_f32_16x16x32_bf16 v[124:127], a[28:31], a[84:87], v[124:127]
    buffer_load_dwordx4 a[144:147], v14, s[16:19], s52 offen offset:2048 sc1
    buffer_load_dwordx4 a[148:151], v15, s[16:19], s52 offen offset:2048 sc1
    s_waitcnt lgkmcnt(0)
    s_waitcnt vmcnt(6)
    s_barrier
    v_mfma_f32_16x16x32_bf16 v[64:67], a[32:35], a[88:91], v[64:67]
    ds_read_b64_tr_b16 a[0:1], v200 offset:32768
    ds_read_b64_tr_b16 a[2:3], v200 offset:36864
    v_mfma_f32_16x16x32_bf16 v[96:99], a[32:35], a[92:95], v[96:99]
    ds_read_b64_tr_b16 a[4:5], v202 offset:32768
    ds_read_b64_tr_b16 a[6:7], v202 offset:36864
    v_mfma_f32_16x16x32_bf16 v[68:71], a[36:39], a[88:91], v[68:71]
    ds_read_b64_tr_b16 a[8:9], v204 offset:32768
    ds_read_b64_tr_b16 a[10:11], v204 offset:36864
    v_mfma_f32_16x16x32_bf16 v[100:103], a[36:39], a[92:95], v[100:103]
    ds_read_b64_tr_b16 a[12:13], v206 offset:32768
    ds_read_b64_tr_b16 a[14:15], v206 offset:36864
    v_mfma_f32_16x16x32_bf16 v[72:75], a[40:43], a[88:91], v[72:75]
    ds_read_b64_tr_b16 a[16:17], v208 offset:32768
    ds_read_b64_tr_b16 a[18:19], v208 offset:36864
    v_mfma_f32_16x16x32_bf16 v[104:107], a[40:43], a[92:95], v[104:107]
    ds_read_b64_tr_b16 a[20:21], v210 offset:32768
    ds_read_b64_tr_b16 a[22:23], v210 offset:36864
    v_mfma_f32_16x16x32_bf16 v[76:79], a[44:47], a[88:91], v[76:79]
    ds_read_b64_tr_b16 a[24:25], v212 offset:32768
    ds_read_b64_tr_b16 a[26:27], v212 offset:36864
    v_mfma_f32_16x16x32_bf16 v[108:111], a[44:47], a[92:95], v[108:111]
    ds_read_b64_tr_b16 a[28:29], v214 offset:32768
    ds_read_b64_tr_b16 a[30:31], v214 offset:36864
    v_mfma_f32_16x16x32_bf16 v[80:83], a[48:51], a[88:91], v[80:83]
    v_mfma_f32_16x16x32_bf16 v[112:115], a[48:51], a[92:95], v[112:115]
    v_mfma_f32_16x16x32_bf16 v[84:87], a[52:55], a[88:91], v[84:87]
    v_mfma_f32_16x16x32_bf16 v[116:119], a[52:55], a[92:95], v[116:119]
    v_mfma_f32_16x16x32_bf16 v[88:91], a[56:59], a[88:91], v[88:91]
    v_mfma_f32_16x16x32_bf16 v[120:123], a[56:59], a[92:95], v[120:123]
    v_mfma_f32_16x16x32_bf16 v[92:95], a[60:63], a[88:91], v[92:95]
    v_mfma_f32_16x16x32_bf16 v[124:127], a[60:63], a[92:95], v[124:127]
    buffer_load_dwordx4 a[152:155], v14, s[16:19], s52 offen offset:3072 sc1
    buffer_load_dwordx4 a[156:159], v15, s[16:19], s52 offen offset:3072 sc1
    s_waitcnt lgkmcnt(0)
    v_mfma_f32_16x16x32_bf16 v[64:67], a[0:3], a[96:99], v[64:67]
    ds_read_b64_tr_b16 a[32:33], v200 offset:40960
    ds_read_b64_tr_b16 a[34:35], v200 offset:45056
    v_mfma_f32_16x16x32_bf16 v[96:99], a[0:3], a[100:103], v[96:99]
    ds_read_b64_tr_b16 a[36:37], v202 offset:40960
    ds_read_b64_tr_b16 a[38:39], v202 offset:45056
    v_mfma_f32_16x16x32_bf16 v[68:71], a[4:7], a[96:99], v[68:71]
    ds_read_b64_tr_b16 a[40:41], v204 offset:40960
    ds_read_b64_tr_b16 a[42:43], v204 offset:45056
    v_mfma_f32_16x16x32_bf16 v[100:103], a[4:7], a[100:103], v[100:103]
    ds_read_b64_tr_b16 a[44:45], v206 offset:40960
    ds_read_b64_tr_b16 a[46:47], v206 offset:45056
    v_mfma_f32_16x16x32_bf16 v[72:75], a[8:11], a[96:99], v[72:75]
    ds_read_b64_tr_b16 a[48:49], v208 offset:40960
    ds_read_b64_tr_b16 a[50:51], v208 offset:45056
    v_mfma_f32_16x16x32_bf16 v[104:107], a[8:11], a[100:103], v[104:107]
    ds_read_b64_tr_b16 a[52:53], v210 offset:40960
    ds_read_b64_tr_b16 a[54:55], v210 offset:45056
    v_mfma_f32_16x16x32_bf16 v[76:79], a[12:15], a[96:99], v[76:79]
    ds_read_b64_tr_b16 a[56:57], v212 offset:40960
    ds_read_b64_tr_b16 a[58:59], v212 offset:45056
    v_mfma_f32_16x16x32_bf16 v[108:111], a[12:15], a[100:103], v[108:111]
    ds_read_b64_tr_b16 a[60:61], v214 offset:40960
    ds_read_b64_tr_b16 a[62:63], v214 offset:45056
    v_mfma_f32_16x16x32_bf16 v[80:83], a[16:19], a[96:99], v[80:83]
    v_mfma_f32_16x16x32_bf16 v[112:115], a[16:19], a[100:103], v[112:115]
    v_mfma_f32_16x16x32_bf16 v[84:87], a[20:23], a[96:99], v[84:87]
    v_mfma_f32_16x16x32_bf16 v[116:119], a[20:23], a[100:103], v[116:119]
    v_mfma_f32_16x16x32_bf16 v[88:91], a[24:27], a[96:99], v[88:91]
    v_mfma_f32_16x16x32_bf16 v[120:123], a[24:27], a[100:103], v[120:123]
    v_mfma_f32_16x16x32_bf16 v[92:95], a[28:31], a[96:99], v[92:95]
    v_mfma_f32_16x16x32_bf16 v[124:127], a[28:31], a[100:103], v[124:127]
    s_mov_b32 s52, 12288
    buffer_load_dwordx4 a[160:163], v14, s[16:19], s52 offen offset:0 sc1
    buffer_load_dwordx4 a[164:167], v15, s[16:19], s52 offen offset:0 sc1
    s_waitcnt lgkmcnt(0)
    v_mfma_f32_16x16x32_bf16 v[64:67], a[32:35], a[104:107], v[64:67]
    ds_read_b64_tr_b16 a[0:1], v200 offset:49152
    ds_read_b64_tr_b16 a[2:3], v200 offset:53248
    v_mfma_f32_16x16x32_bf16 v[96:99], a[32:35], a[108:111], v[96:99]
    ds_read_b64_tr_b16 a[4:5], v202 offset:49152
    ds_read_b64_tr_b16 a[6:7], v202 offset:53248
    v_mfma_f32_16x16x32_bf16 v[68:71], a[36:39], a[104:107], v[68:71]
    ds_read_b64_tr_b16 a[8:9], v204 offset:49152
    ds_read_b64_tr_b16 a[10:11], v204 offset:53248
    v_mfma_f32_16x16x32_bf16 v[100:103], a[36:39], a[108:111], v[100:103]
    ds_read_b64_tr_b16 a[12:13], v206 offset:49152
    ds_read_b64_tr_b16 a[14:15], v206 offset:53248
    v_mfma_f32_16x16x32_bf16 v[72:75], a[40:43], a[104:107], v[72:75]
    ds_read_b64_tr_b16 a[16:17], v208 offset:49152
    ds_read_b64_tr_b16 a[18:19], v208 offset:53248
    v_mfma_f32_16x16x32_bf16 v[104:107], a[40:43], a[108:111], v[104:107]
    ds_read_b64_tr_b16 a[20:21], v210 offset:49152
    ds_read_b64_tr_b16 a[22:23], v210 offset:53248
    v_mfma_f32_16x16x32_bf16 v[76:79], a[44:47], a[104:107], v[76:79]
    ds_read_b64_tr_b16 a[24:25], v212 offset:49152
    ds_read_b64_tr_b16 a[26:27], v212 offset:53248
    v_mfma_f32_16x16x32_bf16 v[108:111], a[44:47], a[108:111], v[108:111]
    ds_read_b64_tr_b16 a[28:29], v214 offset:49152
    ds_read_b64_tr_b16 a[30:31], v214 offset:53248
    v_mfma_f32_16x16x32_bf16 v[80:83], a[48:51], a[104:107], v[80:83]
    v_mfma_f32_16x16x32_bf16 v[112:115], a[48:51], a[108:111], v[112:115]
    v_mfma_f32_16x16x32_bf16 v[84:87], a[52:55], a[104:107], v[84:87]
    v_mfma_f32_16x16x32_bf16 v[116:119], a[52:55], a[108:111], v[116:119]
    v_mfma_f32_16x16x32_bf16 v[88:91], a[56:59], a[104:107], v[88:91]
    v_mfma_f32_16x16x32_bf16 v[120:123], a[56:59], a[108:111], v[120:123]
    v_mfma_f32_16x16x32_bf16 v[92:95], a[60:63], a[104:107], v[92:95]
    v_mfma_f32_16x16x32_bf16 v[124:127], a[60:63], a[108:111], v[124:127]
    buffer_load_dwordx4 a[168:171], v14, s[16:19], s52 offen offset:1024 sc1
    buffer_load_dwordx4 a[172:175], v15, s[16:19], s52 offen offset:1024 sc1
    s_waitcnt lgkmcnt(0)
    v_mfma_f32_16x16x32_bf16 v[64:67], a[0:3], a[112:115], v[64:67]
    ds_read_b64_tr_b16 a[32:33], v200 offset:57344
    ds_read_b64_tr_b16 a[34:35], v200 offset:61440
    v_mfma_f32_16x16x32_bf16 v[96:99], a[0:3], a[116:119], v[96:99]
    ds_read_b64_tr_b16 a[36:37], v202 offset:57344
    ds_read_b64_tr_b16 a[38:39], v202 offset:61440
    v_mfma_f32_16x16x32_bf16 v[68:71], a[4:7], a[112:115], v[68:71]
    ds_read_b64_tr_b16 a[40:41], v204 offset:57344
    ds_read_b64_tr_b16 a[42:43], v204 offset:61440
    v_mfma_f32_16x16x32_bf16 v[100:103], a[4:7], a[116:119], v[100:103]
    ds_read_b64_tr_b16 a[44:45], v206 offset:57344
    ds_read_b64_tr_b16 a[46:47], v206 offset:61440
    v_mfma_f32_16x16x32_bf16 v[72:75], a[8:11], a[112:115], v[72:75]
    ds_read_b64_tr_b16 a[48:49], v208 offset:57344
    ds_read_b64_tr_b16 a[50:51], v208 offset:61440
    v_mfma_f32_16x16x32_bf16 v[104:107], a[8:11], a[116:119], v[104:107]
    ds_read_b64_tr_b16 a[52:53], v210 offset:57344
    ds_read_b64_tr_b16 a[54:55], v210 offset:61440
    v_mfma_f32_16x16x32_bf16 v[76:79], a[12:15], a[112:115], v[76:79]
    ds_read_b64_tr_b16 a[56:57], v212 offset:57344
    ds_read_b64_tr_b16 a[58:59], v212 offset:61440
    v_mfma_f32_16x16x32_bf16 v[108:111], a[12:15], a[116:119], v[108:111]
    ds_read_b64_tr_b16 a[60:61], v214 offset:57344
    ds_read_b64_tr_b16 a[62:63], v214 offset:61440
    v_mfma_f32_16x16x32_bf16 v[80:83], a[16:19], a[112:115], v[80:83]
    v_mfma_f32_16x16x32_bf16 v[112:115], a[16:19], a[116:119], v[112:115]
    v_mfma_f32_16x16x32_bf16 v[84:87], a[20:23], a[112:115], v[84:87]
    v_mfma_f32_16x16x32_bf16 v[116:119], a[20:23], a[116:119], v[116:119]
    v_mfma_f32_16x16x32_bf16 v[88:91], a[24:27], a[112:115], v[88:91]
    v_mfma_f32_16x16x32_bf16 v[120:123], a[24:27], a[116:119], v[120:123]
    v_mfma_f32_16x16x32_bf16 v[92:95], a[28:31], a[112:115], v[92:95]
    v_mfma_f32_16x16x32_bf16 v[124:127], a[28:31], a[116:119], v[124:127]
    buffer_load_dwordx4 a[176:179], v14, s[16:19], s52 offen offset:2048 sc1
    buffer_load_dwordx4 a[180:183], v15, s[16:19], s52 offen offset:2048 sc1
    s_waitcnt lgkmcnt(0)
    s_waitcnt vmcnt(6)
    s_barrier
    v_mfma_f32_16x16x32_bf16 v[64:67], a[32:35], a[120:123], v[64:67]
    ds_read_b64_tr_b16 a[0:1], v201 offset:0
    ds_read_b64_tr_b16 a[2:3], v201 offset:4096
    v_mfma_f32_16x16x32_bf16 v[96:99], a[32:35], a[124:127], v[96:99]
    ds_read_b64_tr_b16 a[4:5], v203 offset:0
    ds_read_b64_tr_b16 a[6:7], v203 offset:4096
    v_mfma_f32_16x16x32_bf16 v[68:71], a[36:39], a[120:123], v[68:71]
    ds_read_b64_tr_b16 a[8:9], v205 offset:0
    ds_read_b64_tr_b16 a[10:11], v205 offset:4096
    v_mfma_f32_16x16x32_bf16 v[100:103], a[36:39], a[124:127], v[100:103]
    ds_read_b64_tr_b16 a[12:13], v207 offset:0
    ds_read_b64_tr_b16 a[14:15], v207 offset:4096
    v_mfma_f32_16x16x32_bf16 v[72:75], a[40:43], a[120:123], v[72:75]
    ds_read_b64_tr_b16 a[16:17], v209 offset:0
    ds_read_b64_tr_b16 a[18:19], v209 offset:4096
    v_mfma_f32_16x16x32_bf16 v[104:107], a[40:43], a[124:127], v[104:107]
    ds_read_b64_tr_b16 a[20:21], v211 offset:0
    ds_read_b64_tr_b16 a[22:23], v211 offset:4096
    v_mfma_f32_16x16x32_bf16 v[76:79], a[44:47], a[120:123], v[76:79]
    ds_read_b64_tr_b16 a[24:25], v213 offset:0
    ds_read_b64_tr_b16 a[26:27], v213 offset:4096
    v_mfma_f32_16x16x32_bf16 v[108:111], a[44:47], a[124:127], v[108:111]
    ds_read_b64_tr_b16 a[28:29], v215 offset:0
    ds_read_b64_tr_b16 a[30:31], v215 offset:4096
    v_mfma_f32_16x16x32_bf16 v[80:83], a[48:51], a[120:123], v[80:83]
    v_mfma_f32_16x16x32_bf16 v[112:115], a[48:51], a[124:127], v[112:115]
    v_mfma_f32_16x16x32_bf16 v[84:87], a[52:55], a[120:123], v[84:87]
    v_mfma_f32_16x16x32_bf16 v[116:119], a[52:55], a[124:127], v[116:119]
    v_mfma_f32_16x16x32_bf16 v[88:91], a[56:59], a[120:123], v[88:91]
    v_mfma_f32_16x16x32_bf16 v[120:123], a[56:59], a[124:127], v[120:123]
    v_mfma_f32_16x16x32_bf16 v[92:95], a[60:63], a[120:123], v[92:95]
    v_mfma_f32_16x16x32_bf16 v[124:127], a[60:63], a[124:127], v[124:127]
    buffer_load_dwordx4 a[184:187], v14, s[16:19], s52 offen offset:3072 sc1
    buffer_load_dwordx4 a[188:191], v15, s[16:19], s52 offen offset:3072 sc1
    s_waitcnt lgkmcnt(0)
    v_mfma_f32_16x16x32_bf16 v[64:67], a[0:3], a[128:131], v[64:67]
    ds_read_b64_tr_b16 a[32:33], v201 offset:8192
    ds_read_b64_tr_b16 a[34:35], v201 offset:12288
    v_mfma_f32_16x16x32_bf16 v[96:99], a[0:3], a[132:135], v[96:99]
    ds_read_b64_tr_b16 a[36:37], v203 offset:8192
    ds_read_b64_tr_b16 a[38:39], v203 offset:12288
    v_mfma_f32_16x16x32_bf16 v[68:71], a[4:7], a[128:131], v[68:71]
    ds_read_b64_tr_b16 a[40:41], v205 offset:8192
    ds_read_b64_tr_b16 a[42:43], v205 offset:12288
    v_mfma_f32_16x16x32_bf16 v[100:103], a[4:7], a[132:135], v[100:103]
    ds_read_b64_tr_b16 a[44:45], v207 offset:8192
    ds_read_b64_tr_b16 a[46:47], v207 offset:12288
    v_mfma_f32_16x16x32_bf16 v[72:75], a[8:11], a[128:131], v[72:75]
    ds_read_b64_tr_b16 a[48:49], v209 offset:8192
    ds_read_b64_tr_b16 a[50:51], v209 offset:12288
    v_mfma_f32_16x16x32_bf16 v[104:107], a[8:11], a[132:135], v[104:107]
    ds_read_b64_tr_b16 a[52:53], v211 offset:8192
    ds_read_b64_tr_b16 a[54:55], v211 offset:12288
    v_mfma_f32_16x16x32_bf16 v[76:79], a[12:15], a[128:131], v[76:79]
    ds_read_b64_tr_b16 a[56:57], v213 offset:8192
    ds_read_b64_tr_b16 a[58:59], v213 offset:12288
    v_mfma_f32_16x16x32_bf16 v[108:111], a[12:15], a[132:135], v[108:111]
    ds_read_b64_tr_b16 a[60:61], v215 offset:8192
    ds_read_b64_tr_b16 a[62:63], v215 offset:12288
    v_mfma_f32_16x16x32_bf16 v[80:83], a[16:19], a[128:131], v[80:83]
    v_mfma_f32_16x16x32_bf16 v[112:115], a[16:19], a[132:135], v[112:115]
    v_mfma_f32_16x16x32_bf16 v[84:87], a[20:23], a[128:131], v[84:87]
    v_mfma_f32_16x16x32_bf16 v[116:119], a[20:23], a[132:135], v[116:119]
    v_mfma_f32_16x16x32_bf16 v[88:91], a[24:27], a[128:131], v[88:91]
    v_mfma_f32_16x16x32_bf16 v[120:123], a[24:27], a[132:135], v[120:123]
    v_mfma_f32_16x16x32_bf16 v[92:95], a[28:31], a[128:131], v[92:95]
    v_mfma_f32_16x16x32_bf16 v[124:127], a[28:31], a[132:135], v[124:127]
    s_waitcnt lgkmcnt(0)
    v_mfma_f32_16x16x32_bf16 v[64:67], a[32:35], a[136:139], v[64:67]
    ds_read_b64_tr_b16 a[0:1], v201 offset:16384
    ds_read_b64_tr_b16 a[2:3], v201 offset:20480
    v_mfma_f32_16x16x32_bf16 v[96:99], a[32:35], a[140:143], v[96:99]
    ds_read_b64_tr_b16 a[4:5], v203 offset:16384
    ds_read_b64_tr_b16 a[6:7], v203 offset:20480
    v_mfma_f32_16x16x32_bf16 v[68:71], a[36:39], a[136:139], v[68:71]
    ds_read_b64_tr_b16 a[8:9], v205 offset:16384
    ds_read_b64_tr_b16 a[10:11], v205 offset:20480
    v_mfma_f32_16x16x32_bf16 v[100:103], a[36:39], a[140:143], v[100:103]
    ds_read_b64_tr_b16 a[12:13], v207 offset:16384
    ds_read_b64_tr_b16 a[14:15], v207 offset:20480
    v_mfma_f32_16x16x32_bf16 v[72:75], a[40:43], a[136:139], v[72:75]
    ds_read_b64_tr_b16 a[16:17], v209 offset:16384
    ds_read_b64_tr_b16 a[18:19], v209 offset:20480
    v_mfma_f32_16x16x32_bf16 v[104:107], a[40:43], a[140:143], v[104:107]
    ds_read_b64_tr_b16 a[20:21], v211 offset:16384
    ds_read_b64_tr_b16 a[22:23], v211 offset:20480
    v_mfma_f32_16x16x32_bf16 v[76:79], a[44:47], a[136:139], v[76:79]
    ds_read_b64_tr_b16 a[24:25], v213 offset:16384
    ds_read_b64_tr_b16 a[26:27], v213 offset:20480
    v_mfma_f32_16x16x32_bf16 v[108:111], a[44:47], a[140:143], v[108:111]
    ds_read_b64_tr_b16 a[28:29], v215 offset:16384
    ds_read_b64_tr_b16 a[30:31], v215 offset:20480
    v_mfma_f32_16x16x32_bf16 v[80:83], a[48:51], a[136:139], v[80:83]
    v_mfma_f32_16x16x32_bf16 v[112:115], a[48:51], a[140:143], v[112:115]
    v_mfma_f32_16x16x32_bf16 v[84:87], a[52:55], a[136:139], v[84:87]
    v_mfma_f32_16x16x32_bf16 v[116:119], a[52:55], a[140:143], v[116:119]
    v_mfma_f32_16x16x32_bf16 v[88:91], a[56:59], a[136:139], v[88:91]
    v_mfma_f32_16x16x32_bf16 v[120:123], a[56:59], a[140:143], v[120:123]
    v_mfma_f32_16x16x32_bf16 v[92:95], a[60:63], a[136:139], v[92:95]
    v_mfma_f32_16x16x32_bf16 v[124:127], a[60:63], a[140:143], v[124:127]
    s_waitcnt lgkmcnt(0)
    v_mfma_f32_16x16x32_bf16 v[64:67], a[0:3], a[144:147], v[64:67]
    ds_read_b64_tr_b16 a[32:33], v201 offset:24576
    ds_read_b64_tr_b16 a[34:35], v201 offset:28672
    v_mfma_f32_16x16x32_bf16 v[96:99], a[0:3], a[148:151], v[96:99]
    ds_read_b64_tr_b16 a[36:37], v203 offset:24576
    ds_read_b64_tr_b16 a[38:39], v203 offset:28672
    v_mfma_f32_16x16x32_bf16 v[68:71], a[4:7], a[144:147], v[68:71]
    ds_read_b64_tr_b16 a[40:41], v205 offset:24576
    ds_read_b64_tr_b16 a[42:43], v205 offset:28672
    v_mfma_f32_16x16x32_bf16 v[100:103], a[4:7], a[148:151], v[100:103]
    ds_read_b64_tr_b16 a[44:45], v207 offset:24576
    ds_read_b64_tr_b16 a[46:47], v207 offset:28672
    v_mfma_f32_16x16x32_bf16 v[72:75], a[8:11], a[144:147], v[72:75]
    ds_read_b64_tr_b16 a[48:49], v209 offset:24576
    ds_read_b64_tr_b16 a[50:51], v209 offset:28672
    v_mfma_f32_16x16x32_bf16 v[104:107], a[8:11], a[148:151], v[104:107]
    ds_read_b64_tr_b16 a[52:53], v211 offset:24576
    ds_read_b64_tr_b16 a[54:55], v211 offset:28672
    v_mfma_f32_16x16x32_bf16 v[76:79], a[12:15], a[144:147], v[76:79]
    ds_read_b64_tr_b16 a[56:57], v213 offset:24576
    ds_read_b64_tr_b16 a[58:59], v213 offset:28672
    v_mfma_f32_16x16x32_bf16 v[108:111], a[12:15], a[148:151], v[108:111]
    ds_read_b64_tr_b16 a[60:61], v215 offset:24576
    ds_read_b64_tr_b16 a[62:63], v215 offset:28672
    v_mfma_f32_16x16x32_bf16 v[80:83], a[16:19], a[144:147], v[80:83]
    v_mfma_f32_16x16x32_bf16 v[112:115], a[16:19], a[148:151], v[112:115]
    v_mfma_f32_16x16x32_bf16 v[84:87], a[20:23], a[144:147], v[84:87]
    v_mfma_f32_16x16x32_bf16 v[116:119], a[20:23], a[148:151], v[116:119]
    v_mfma_f32_16x16x32_bf16 v[88:91], a[24:27], a[144:147], v[88:91]
    v_mfma_f32_16x16x32_bf16 v[120:123], a[24:27], a[148:151], v[120:123]
    v_mfma_f32_16x16x32_bf16 v[92:95], a[28:31], a[144:147], v[92:95]
    v_mfma_f32_16x16x32_bf16 v[124:127], a[28:31], a[148:151], v[124:127]
    s_waitcnt lgkmcnt(0)
    s_waitcnt vmcnt(0)
    s_barrier
    v_mfma_f32_16x16x32_bf16 v[64:67], a[32:35], a[152:155], v[64:67]
    ds_read_b64_tr_b16 a[0:1], v201 offset:32768
    ds_read_b64_tr_b16 a[2:3], v201 offset:36864
    v_mfma_f32_16x16x32_bf16 v[96:99], a[32:35], a[156:159], v[96:99]
    ds_read_b64_tr_b16 a[4:5], v203 offset:32768
    ds_read_b64_tr_b16 a[6:7], v203 offset:36864
    v_mfma_f32_16x16x32_bf16 v[68:71], a[36:39], a[152:155], v[68:71]
    ds_read_b64_tr_b16 a[8:9], v205 offset:32768
    ds_read_b64_tr_b16 a[10:11], v205 offset:36864
    v_mfma_f32_16x16x32_bf16 v[100:103], a[36:39], a[156:159], v[100:103]
    ds_read_b64_tr_b16 a[12:13], v207 offset:32768
    ds_read_b64_tr_b16 a[14:15], v207 offset:36864
    v_mfma_f32_16x16x32_bf16 v[72:75], a[40:43], a[152:155], v[72:75]
    ds_read_b64_tr_b16 a[16:17], v209 offset:32768
    ds_read_b64_tr_b16 a[18:19], v209 offset:36864
    v_mfma_f32_16x16x32_bf16 v[104:107], a[40:43], a[156:159], v[104:107]
    ds_read_b64_tr_b16 a[20:21], v211 offset:32768
    ds_read_b64_tr_b16 a[22:23], v211 offset:36864
    v_mfma_f32_16x16x32_bf16 v[76:79], a[44:47], a[152:155], v[76:79]
    ds_read_b64_tr_b16 a[24:25], v213 offset:32768
    ds_read_b64_tr_b16 a[26:27], v213 offset:36864
    v_mfma_f32_16x16x32_bf16 v[108:111], a[44:47], a[156:159], v[108:111]
    ds_read_b64_tr_b16 a[28:29], v215 offset:32768
    ds_read_b64_tr_b16 a[30:31], v215 offset:36864
    v_mfma_f32_16x16x32_bf16 v[80:83], a[48:51], a[152:155], v[80:83]
    v_mfma_f32_16x16x32_bf16 v[112:115], a[48:51], a[156:159], v[112:115]
    v_mfma_f32_16x16x32_bf16 v[84:87], a[52:55], a[152:155], v[84:87]
    v_mfma_f32_16x16x32_bf16 v[116:119], a[52:55], a[156:159], v[116:119]
    v_mfma_f32_16x16x32_bf16 v[88:91], a[56:59], a[152:155], v[88:91]
    v_mfma_f32_16x16x32_bf16 v[120:123], a[56:59], a[156:159], v[120:123]
    v_mfma_f32_16x16x32_bf16 v[92:95], a[60:63], a[152:155], v[92:95]
    v_mfma_f32_16x16x32_bf16 v[124:127], a[60:63], a[156:159], v[124:127]
    s_waitcnt lgkmcnt(0)
    v_mfma_f32_16x16x32_bf16 v[64:67], a[0:3], a[160:163], v[64:67]
    ds_read_b64_tr_b16 a[32:33], v201 offset:40960
    ds_read_b64_tr_b16 a[34:35], v201 offset:45056
    v_mfma_f32_16x16x32_bf16 v[96:99], a[0:3], a[164:167], v[96:99]
    ds_read_b64_tr_b16 a[36:37], v203 offset:40960
    ds_read_b64_tr_b16 a[38:39], v203 offset:45056
    v_mfma_f32_16x16x32_bf16 v[68:71], a[4:7], a[160:163], v[68:71]
    ds_read_b64_tr_b16 a[40:41], v205 offset:40960
    ds_read_b64_tr_b16 a[42:43], v205 offset:45056
    v_mfma_f32_16x16x32_bf16 v[100:103], a[4:7], a[164:167], v[100:103]
    ds_read_b64_tr_b16 a[44:45], v207 offset:40960
    ds_read_b64_tr_b16 a[46:47], v207 offset:45056
    v_mfma_f32_16x16x32_bf16 v[72:75], a[8:11], a[160:163], v[72:75]
    ds_read_b64_tr_b16 a[48:49], v209 offset:40960
    ds_read_b64_tr_b16 a[50:51], v209 offset:45056
    v_mfma_f32_16x16x32_bf16 v[104:107], a[8:11], a[164:167], v[104:107]
    ds_read_b64_tr_b16 a[52:53], v211 offset:40960
    ds_read_b64_tr_b16 a[54:55], v211 offset:45056
    v_mfma_f32_16x16x32_bf16 v[76:79], a[12:15], a[160:163], v[76:79]
    ds_read_b64_tr_b16 a[56:57], v213 offset:40960
    ds_read_b64_tr_b16 a[58:59], v213 offset:45056
    v_mfma_f32_16x16x32_bf16 v[108:111], a[12:15], a[164:167], v[108:111]
    ds_read_b64_tr_b16 a[60:61], v215 offset:40960
    ds_read_b64_tr_b16 a[62:63], v215 offset:45056
    v_mfma_f32_16x16x32_bf16 v[80:83], a[16:19], a[160:163], v[80:83]
    v_mfma_f32_16x16x32_bf16 v[112:115], a[16:19], a[164:167], v[112:115]
    v_mfma_f32_16x16x32_bf16 v[84:87], a[20:23], a[160:163], v[84:87]
    v_mfma_f32_16x16x32_bf16 v[116:119], a[20:23], a[164:167], v[116:119]
    v_mfma_f32_16x16x32_bf16 v[88:91], a[24:27], a[160:163], v[88:91]
    v_mfma_f32_16x16x32_bf16 v[120:123], a[24:27], a[164:167], v[120:123]
    v_mfma_f32_16x16x32_bf16 v[92:95], a[28:31], a[160:163], v[92:95]
    v_mfma_f32_16x16x32_bf16 v[124:127], a[28:31], a[164:167], v[124:127]
    s_waitcnt lgkmcnt(0)
    v_mfma_f32_16x16x32_bf16 v[64:67], a[32:35], a[168:171], v[64:67]
    ds_read_b64_tr_b16 a[0:1], v201 offset:49152
    ds_read_b64_tr_b16 a[2:3], v201 offset:53248
    v_mfma_f32_16x16x32_bf16 v[96:99], a[32:35], a[172:175], v[96:99]
    ds_read_b64_tr_b16 a[4:5], v203 offset:49152
    ds_read_b64_tr_b16 a[6:7], v203 offset:53248
    v_mfma_f32_16x16x32_bf16 v[68:71], a[36:39], a[168:171], v[68:71]
    ds_read_b64_tr_b16 a[8:9], v205 offset:49152
    ds_read_b64_tr_b16 a[10:11], v205 offset:53248
    v_mfma_f32_16x16x32_bf16 v[100:103], a[36:39], a[172:175], v[100:103]
    ds_read_b64_tr_b16 a[12:13], v207 offset:49152
    ds_read_b64_tr_b16 a[14:15], v207 offset:53248
    v_mfma_f32_16x16x32_bf16 v[72:75], a[40:43], a[168:171], v[72:75]
    ds_read_b64_tr_b16 a[16:17], v209 offset:49152
    ds_read_b64_tr_b16 a[18:19], v209 offset:53248
    v_mfma_f32_16x16x32_bf16 v[104:107], a[40:43], a[172:175], v[104:107]
    ds_read_b64_tr_b16 a[20:21], v211 offset:49152
    ds_read_b64_tr_b16 a[22:23], v211 offset:53248
    v_mfma_f32_16x16x32_bf16 v[76:79], a[44:47], a[168:171], v[76:79]
    ds_read_b64_tr_b16 a[24:25], v213 offset:49152
    ds_read_b64_tr_b16 a[26:27], v213 offset:53248
    v_mfma_f32_16x16x32_bf16 v[108:111], a[44:47], a[172:175], v[108:111]
    ds_read_b64_tr_b16 a[28:29], v215 offset:49152
    ds_read_b64_tr_b16 a[30:31], v215 offset:53248
    v_mfma_f32_16x16x32_bf16 v[80:83], a[48:51], a[168:171], v[80:83]
    v_mfma_f32_16x16x32_bf16 v[112:115], a[48:51], a[172:175], v[112:115]
    v_mfma_f32_16x16x32_bf16 v[84:87], a[52:55], a[168:171], v[84:87]
    v_mfma_f32_16x16x32_bf16 v[116:119], a[52:55], a[172:175], v[116:119]
    v_mfma_f32_16x16x32_bf16 v[88:91], a[56:59], a[168:171], v[88:91]
    v_mfma_f32_16x16x32_bf16 v[120:123], a[56:59], a[172:175], v[120:123]
    v_mfma_f32_16x16x32_bf16 v[92:95], a[60:63], a[168:171], v[92:95]
    v_mfma_f32_16x16x32_bf16 v[124:127], a[60:63], a[172:175], v[124:127]
    s_waitcnt lgkmcnt(0)
    v_mfma_f32_16x16x32_bf16 v[64:67], a[0:3], a[176:179], v[64:67]
    ds_read_b64_tr_b16 a[32:33], v201 offset:57344
    ds_read_b64_tr_b16 a[34:35], v201 offset:61440
    v_mfma_f32_16x16x32_bf16 v[96:99], a[0:3], a[180:183], v[96:99]
    ds_read_b64_tr_b16 a[36:37], v203 offset:57344
    ds_read_b64_tr_b16 a[38:39], v203 offset:61440
    v_mfma_f32_16x16x32_bf16 v[68:71], a[4:7], a[176:179], v[68:71]
    ds_read_b64_tr_b16 a[40:41], v205 offset:57344
    ds_read_b64_tr_b16 a[42:43], v205 offset:61440
    v_mfma_f32_16x16x32_bf16 v[100:103], a[4:7], a[180:183], v[100:103]
    ds_read_b64_tr_b16 a[44:45], v207 offset:57344
    ds_read_b64_tr_b16 a[46:47], v207 offset:61440
    v_mfma_f32_16x16x32_bf16 v[72:75], a[8:11], a[176:179], v[72:75]
    ds_read_b64_tr_b16 a[48:49], v209 offset:57344
    ds_read_b64_tr_b16 a[50:51], v209 offset:61440
    v_mfma_f32_16x16x32_bf16 v[104:107], a[8:11], a[180:183], v[104:107]
    ds_read_b64_tr_b16 a[52:53], v211 offset:57344
    ds_read_b64_tr_b16 a[54:55], v211 offset:61440
    v_mfma_f32_16x16x32_bf16 v[76:79], a[12:15], a[176:179], v[76:79]
    ds_read_b64_tr_b16 a[56:57], v213 offset:57344
    ds_read_b64_tr_b16 a[58:59], v213 offset:61440
    v_mfma_f32_16x16x32_bf16 v[108:111], a[12:15], a[180:183], v[108:111]
    ds_read_b64_tr_b16 a[60:61], v215 offset:57344
    ds_read_b64_tr_b16 a[62:63], v215 offset:61440
    v_mfma_f32_16x16x32_bf16 v[80:83], a[16:19], a[176:179], v[80:83]
    v_mfma_f32_16x16x32_bf16 v[112:115], a[16:19], a[180:183], v[112:115]
    v_mfma_f32_16x16x32_bf16 v[84:87], a[20:23], a[176:179], v[84:87]
    v_mfma_f32_16x16x32_bf16 v[116:119], a[20:23], a[180:183], v[116:119]
    v_mfma_f32_16x16x32_bf16 v[88:91], a[24:27], a[176:179], v[88:91]
    v_mfma_f32_16x16x32_bf16 v[120:123], a[24:27], a[180:183], v[120:123]
    v_mfma_f32_16x16x32_bf16 v[92:95], a[28:31], a[176:179], v[92:95]
    v_mfma_f32_16x16x32_bf16 v[124:127], a[28:31], a[180:183], v[124:127]
    s_waitcnt lgkmcnt(0)
    v_mfma_f32_16x16x32_bf16 v[64:67], a[32:35], a[184:187], v[64:67]
    v_mfma_f32_16x16x32_bf16 v[96:99], a[32:35], a[188:191], v[96:99]
    v_mfma_f32_16x16x32_bf16 v[68:71], a[36:39], a[184:187], v[68:71]
    v_mfma_f32_16x16x32_bf16 v[100:103], a[36:39], a[188:191], v[100:103]
    v_mfma_f32_16x16x32_bf16 v[72:75], a[40:43], a[184:187], v[72:75]
    v_mfma_f32_16x16x32_bf16 v[104:107], a[40:43], a[188:191], v[104:107]
    v_mfma_f32_16x16x32_bf16 v[76:79], a[44:47], a[184:187], v[76:79]
    v_mfma_f32_16x16x32_bf16 v[108:111], a[44:47], a[188:191], v[108:111]
    v_mfma_f32_16x16x32_bf16 v[80:83], a[48:51], a[184:187], v[80:83]
    v_mfma_f32_16x16x32_bf16 v[112:115], a[48:51], a[188:191], v[112:115]
    v_mfma_f32_16x16x32_bf16 v[84:87], a[52:55], a[184:187], v[84:87]
    v_mfma_f32_16x16x32_bf16 v[116:119], a[52:55], a[188:191], v[116:119]
    v_mfma_f32_16x16x32_bf16 v[88:91], a[56:59], a[184:187], v[88:91]
    v_mfma_f32_16x16x32_bf16 v[120:123], a[56:59], a[188:191], v[120:123]
    v_mfma_f32_16x16x32_bf16 v[92:95], a[60:63], a[184:187], v[92:95]
    v_mfma_f32_16x16x32_bf16 v[124:127], a[60:63], a[188:191], v[124:127]
    s_barrier
    s_add_u32 s12, s4, 54525952
    s_addc_u32 s13, s5, 0
    s_and_b32 s13, s13, 0xffff
    s_mov_b32 s14, 1835008
    s_mov_b32 s15, 0x20000
    s_mul_i32 s48, s36, 229376
    s_mul_i32 s62, s32, 57344
    s_add_u32 s62, s62, s48
    s_mul_i32 s61, s32, 28672
    v_lshlrev_b32 v4, 4, v1
    s_nop 5
    s_mul_i32 s51, s90, 57344
    s_lshl_b32 s53, s89, 12
    s_add_u32 s51, s51, s53
    v_pk_mul_f32 v[64:65], v[64:65], v[58:59] op_sel_hi:[1,0]
    v_pk_mul_f32 v[66:67], v[66:67], v[58:59] op_sel_hi:[1,0]
    v_pk_mul_f32 v[68:69], v[68:69], v[58:59] op_sel_hi:[1,0]
    v_pk_mul_f32 v[70:71], v[70:71], v[58:59] op_sel_hi:[1,0]
    v_pk_mul_f32 v[72:73], v[72:73], v[58:59] op_sel_hi:[1,0]
    v_pk_mul_f32 v[74:75], v[74:75], v[58:59] op_sel_hi:[1,0]
    v_pk_mul_f32 v[76:77], v[76:77], v[58:59] op_sel_hi:[1,0]
    v_pk_mul_f32 v[78:79], v[78:79], v[58:59] op_sel_hi:[1,0]
    v_pk_mul_f32 v[160:161], v[64:65], v[64:65]
    s_add_u32 m0, s61, 0
    s_add_u32 s50, s62, 28672
    buffer_load_dwordx4 v4, s[12:15], s50 offen sc1 lds
    v_pk_mul_f32 v[162:163], v[66:67], v[66:67]
    v_pk_mul_f32 v[164:165], v[68:69], v[68:69]
    v_pk_mul_f32 v[166:167], v[70:71], v[70:71]
    v_pk_mul_f32 v[168:169], v[72:73], v[72:73]
    v_pk_mul_f32 v[170:171], v[74:75], v[74:75]
    v_pk_mul_f32 v[172:173], v[76:77], v[76:77]
    v_pk_mul_f32 v[174:175], v[78:79], v[78:79]
    v_pk_fma_f32 v[160:161], v[160:161], s[56:57], v[22:23]
    v_pk_fma_f32 v[162:163], v[162:163], s[56:57], v[22:23]
    s_add_u32 m0, s61, 1024
    s_add_u32 s50, s62, 29696
    buffer_load_dwordx4 v4, s[12:15], s50 offen sc1 lds
    v_pk_fma_f32 v[164:165], v[164:165], s[56:57], v[22:23]
    v_pk_fma_f32 v[166:167], v[166:167], s[56:57], v[22:23]
    v_pk_fma_f32 v[168:169], v[168:169], s[56:57], v[22:23]
    v_pk_fma_f32 v[170:171], v[170:171], s[56:57], v[22:23]
    v_pk_fma_f32 v[172:173], v[172:173], s[56:57], v[22:23]
    v_pk_fma_f32 v[174:175], v[174:175], s[56:57], v[22:23]
    v_pk_mul_f32 v[160:161], v[160:161], v[64:65]
    v_pk_mul_f32 v[162:163], v[162:163], v[66:67]
    v_pk_mul_f32 v[164:165], v[164:165], v[68:69]
    s_add_u32 m0, s61, 2048
    s_add_u32 s50, s62, 30720
    buffer_load_dwordx4 v4, s[12:15], s50 offen sc1 lds
    v_pk_mul_f32 v[166:167], v[166:167], v[70:71]
    v_pk_mul_f32 v[168:169], v[168:169], v[72:73]
    v_pk_mul_f32 v[170:171], v[170:171], v[74:75]
    v_pk_mul_f32 v[172:173], v[172:173], v[76:77]
    v_pk_mul_f32 v[174:175], v[174:175], v[78:79]
    v_exp_f32 v160, v160
    v_exp_f32 v161, v161
    v_exp_f32 v162, v162
    v_exp_f32 v163, v163
    s_add_u32 m0, s61, 3072
    s_add_u32 s50, s62, 31744
    buffer_load_dwordx4 v4, s[12:15], s50 offen sc1 lds
    v_exp_f32 v164, v164
    v_exp_f32 v165, v165
    v_exp_f32 v166, v166
    v_exp_f32 v167, v167
    v_exp_f32 v168, v168
    v_exp_f32 v169, v169
    v_exp_f32 v170, v170
    v_exp_f32 v171, v171
    v_exp_f32 v172, v172
    s_add_u32 m0, s61, 4096
    s_add_u32 s50, s62, 32768
    buffer_load_dwordx4 v4, s[12:15], s50 offen sc1 lds
    v_exp_f32 v173, v173
    v_exp_f32 v174, v174
    v_exp_f32 v175, v175
    s_nop 0
    v_pk_add_f32 v[160:161], v[160:161], 1.0 op_sel_hi:[1,0]
    v_pk_add_f32 v[162:163], v[162:163], 1.0 op_sel_hi:[1,0]
    v_pk_add_f32 v[164:165], v[164:165], 1.0 op_sel_hi:[1,0]
    v_pk_add_f32 v[166:167], v[166:167], 1.0 op_sel_hi:[1,0]
    v_pk_add_f32 v[168:169], v[168:169], 1.0 op_sel_hi:[1,0]
    s_add_u32 m0, s61, 5120
    s_add_u32 s50, s62, 33792
    buffer_load_dwordx4 v4, s[12:15], s50 offen sc1 lds
    v_pk_add_f32 v[170:171], v[170:171], 1.0 op_sel_hi:[1,0]
    v_pk_add_f32 v[172:173], v[172:173], 1.0 op_sel_hi:[1,0]
    v_pk_add_f32 v[174:175], v[174:175], 1.0 op_sel_hi:[1,0]
    v_rcp_f32 v160, v160
    v_rcp_f32 v161, v161
    v_rcp_f32 v162, v162
    v_rcp_f32 v163, v163
    v_rcp_f32 v164, v164
    v_rcp_f32 v165, v165
    s_add_u32 m0, s61, 6144
    s_add_u32 s50, s62, 34816
    buffer_load_dwordx4 v4, s[12:15], s50 offen sc1 lds
    v_rcp_f32 v166, v166
    v_rcp_f32 v167, v167
    v_rcp_f32 v168, v168
    v_rcp_f32 v169, v169
    v_rcp_f32 v170, v170
    v_rcp_f32 v171, v171
    v_rcp_f32 v172, v172
    v_rcp_f32 v173, v173
    v_rcp_f32 v174, v174
    s_add_u32 m0, s61, 7168
    s_add_u32 s50, s62, 35840
    buffer_load_dwordx4 v4, s[12:15], s50 offen sc1 lds
    v_rcp_f32 v175, v175
    s_nop 0
    v_pk_mul_f32 v[64:65], v[64:65], v[160:161]
    v_pk_mul_f32 v[66:67], v[66:67], v[162:163]
    v_pk_mul_f32 v[68:69], v[68:69], v[164:165]
    v_pk_mul_f32 v[70:71], v[70:71], v[166:167]
    v_pk_mul_f32 v[72:73], v[72:73], v[168:169]
    v_pk_mul_f32 v[74:75], v[74:75], v[170:171]
    v_pk_mul_f32 v[76:77], v[76:77], v[172:173]
    s_add_u32 m0, s61, 8192
    s_add_u32 s50, s62, 36864
    buffer_load_dwordx4 v4, s[12:15], s50 offen sc1 lds
    v_pk_mul_f32 v[78:79], v[78:79], v[174:175]
    v_cvt_pk_bf16_f32 v180, v64, v65
    v_cvt_pk_bf16_f32 v181, v66, v67
    v_cvt_pk_bf16_f32 v182, v68, v69
    v_cvt_pk_bf16_f32 v183, v70, v71
    v_cvt_pk_bf16_f32 v184, v72, v73
    v_cvt_pk_bf16_f32 v185, v74, v75
    v_cvt_pk_bf16_f32 v186, v76, v77
    v_cvt_pk_bf16_f32 v187, v78, v79
    s_add_u32 m0, s61, 9216
    s_add_u32 s50, s62, 37888
    buffer_load_dwordx4 v4, s[12:15], s50 offen sc1 lds
    buffer_store_dwordx4 v[180:183], v232, s[28:31], s51 offen offset:0 sc1
    buffer_store_dwordx4 v[184:187], v232, s[28:31], s51 offen offset:1024 sc1
    v_pk_mul_f32 v[80:81], v[80:81], v[58:59] op_sel_hi:[1,0]
    v_pk_mul_f32 v[82:83], v[82:83], v[58:59] op_sel_hi:[1,0]
    v_pk_mul_f32 v[84:85], v[84:85], v[58:59] op_sel_hi:[1,0]
    v_pk_mul_f32 v[86:87], v[86:87], v[58:59] op_sel_hi:[1,0]
    v_pk_mul_f32 v[88:89], v[88:89], v[58:59] op_sel_hi:[1,0]
    v_pk_mul_f32 v[90:91], v[90:91], v[58:59] op_sel_hi:[1,0]
    v_pk_mul_f32 v[92:93], v[92:93], v[58:59] op_sel_hi:[1,0]
    s_add_u32 m0, s61, 10240
    s_add_u32 s50, s62, 38912
    buffer_load_dwordx4 v4, s[12:15], s50 offen sc1 lds
    v_pk_mul_f32 v[94:95], v[94:95], v[58:59] op_sel_hi:[1,0]
    v_pk_mul_f32 v[160:161], v[80:81], v[80:81]
    v_pk_mul_f32 v[162:163], v[82:83], v[82:83]
    v_pk_mul_f32 v[164:165], v[84:85], v[84:85]
    v_pk_mul_f32 v[166:167], v[86:87], v[86:87]
    v_pk_mul_f32 v[168:169], v[88:89], v[88:89]
    v_pk_mul_f32 v[170:171], v[90:91], v[90:91]
    v_pk_mul_f32 v[172:173], v[92:93], v[92:93]
    v_pk_mul_f32 v[174:175], v[94:95], v[94:95]
    s_add_u32 m0, s61, 11264
    s_add_u32 s50, s62, 39936
    buffer_load_dwordx4 v4, s[12:15], s50 offen sc1 lds
    v_pk_fma_f32 v[160:161], v[160:161], s[56:57], v[22:23]
    v_pk_fma_f32 v[162:163], v[162:163], s[56:57], v[22:23]
    v_pk_fma_f32 v[164:165], v[164:165], s[56:57], v[22:23]
    v_pk_fma_f32 v[166:167], v[166:167], s[56:57], v[22:23]
    v_pk_fma_f32 v[168:169], v[168:169], s[56:57], v[22:23]
    v_pk_fma_f32 v[170:171], v[170:171], s[56:57], v[22:23]
    v_pk_fma_f32 v[172:173], v[172:173], s[56:57], v[22:23]
    v_pk_fma_f32 v[174:175], v[174:175], s[56:57], v[22:23]
    v_pk_mul_f32 v[160:161], v[160:161], v[80:81]
    s_add_u32 m0, s61, 12288
    s_add_u32 s50, s62, 40960
    buffer_load_dwordx4 v4, s[12:15], s50 offen sc1 lds
    v_pk_mul_f32 v[162:163], v[162:163], v[82:83]
    v_pk_mul_f32 v[164:165], v[164:165], v[84:85]
    v_pk_mul_f32 v[166:167], v[166:167], v[86:87]
    v_pk_mul_f32 v[168:169], v[168:169], v[88:89]
    v_pk_mul_f32 v[170:171], v[170:171], v[90:91]
    v_pk_mul_f32 v[172:173], v[172:173], v[92:93]
    v_pk_mul_f32 v[174:175], v[174:175], v[94:95]
    v_exp_f32 v160, v160
    v_exp_f32 v161, v161
    s_add_u32 m0, s61, 13312
    s_add_u32 s50, s62, 41984
    buffer_load_dwordx4 v4, s[12:15], s50 offen sc1 lds
    v_exp_f32 v162, v162
    v_exp_f32 v163, v163
    v_exp_f32 v164, v164
    v_exp_f32 v165, v165
    v_exp_f32 v166, v166
    v_exp_f32 v167, v167
    v_exp_f32 v168, v168
    v_exp_f32 v169, v169
    v_exp_f32 v170, v170
    s_add_u32 m0, s61, 14336
    s_add_u32 s50, s62, 43008
    buffer_load_dwordx4 v4, s[12:15], s50 offen sc1 lds
    v_exp_f32 v171, v171
    v_exp_f32 v172, v172
    v_exp_f32 v173, v173
    v_exp_f32 v174, v174
    v_exp_f32 v175, v175
    s_nop 0
    v_pk_add_f32 v[160:161], v[160:161], 1.0 op_sel_hi:[1,0]
    v_pk_add_f32 v[162:163], v[162:163], 1.0 op_sel_hi:[1,0]
    v_pk_add_f32 v[164:165], v[164:165], 1.0 op_sel_hi:[1,0]
    s_add_u32 m0, s61, 15360
    s_add_u32 s50, s62, 44032
    buffer_load_dwordx4 v4, s[12:15], s50 offen sc1 lds
    v_pk_add_f32 v[166:167], v[166:167], 1.0 op_sel_hi:[1,0]
    v_pk_add_f32 v[168:169], v[168:169], 1.0 op_sel_hi:[1,0]
    v_pk_add_f32 v[170:171], v[170:171], 1.0 op_sel_hi:[1,0]
    v_pk_add_f32 v[172:173], v[172:173], 1.0 op_sel_hi:[1,0]
    v_pk_add_f32 v[174:175], v[174:175], 1.0 op_sel_hi:[1,0]
    v_rcp_f32 v160, v160
    v_rcp_f32 v161, v161
    v_rcp_f32 v162, v162
    v_rcp_f32 v163, v163
    s_add_u32 m0, s61, 16384
    s_add_u32 s50, s62, 45056
    buffer_load_dwordx4 v4, s[12:15], s50 offen sc1 lds
    v_rcp_f32 v164, v164
    v_rcp_f32 v165, v165
    v_rcp_f32 v166, v166
    v_rcp_f32 v167, v167
    v_rcp_f32 v168, v168
    v_rcp_f32 v169, v169
    v_rcp_f32 v170, v170
    v_rcp_f32 v171, v171
    v_rcp_f32 v172, v172
    s_add_u32 m0, s61, 17408
    s_add_u32 s50, s62, 46080
    buffer_load_dwordx4 v4, s[12:15], s50 offen sc1 lds
    v_rcp_f32 v173, v173
    v_rcp_f32 v174, v174
    v_rcp_f32 v175, v175
    s_nop 0
    v_pk_mul_f32 v[80:81], v[80:81], v[160:161]
    v_pk_mul_f32 v[82:83], v[82:83], v[162:163]
    v_pk_mul_f32 v[84:85], v[84:85], v[164:165]
    v_pk_mul_f32 v[86:87], v[86:87], v[166:167]
    v_pk_mul_f32 v[88:89], v[88:89], v[168:169]
    s_add_u32 m0, s61, 18432
    s_add_u32 s50, s62, 47104
    buffer_load_dwordx4 v4, s[12:15], s50 offen sc1 lds
    v_pk_mul_f32 v[90:91], v[90:91], v[170:171]
    v_pk_mul_f32 v[92:93], v[92:93], v[172:173]
    v_pk_mul_f32 v[94:95], v[94:95], v[174:175]
    v_cvt_pk_bf16_f32 v188, v80, v81
    v_cvt_pk_bf16_f32 v189, v82, v83
    v_cvt_pk_bf16_f32 v190, v84, v85
    v_cvt_pk_bf16_f32 v191, v86, v87
    v_cvt_pk_bf16_f32 v192, v88, v89
    v_cvt_pk_bf16_f32 v193, v90, v91
    s_add_u32 m0, s61, 19456
    s_add_u32 s50, s62, 48128
    buffer_load_dwordx4 v4, s[12:15], s50 offen sc1 lds
    v_cvt_pk_bf16_f32 v194, v92, v93
    v_cvt_pk_bf16_f32 v195, v94, v95
    buffer_store_dwordx4 v[188:191], v232, s[28:31], s51 offen offset:2048 sc1
    buffer_store_dwordx4 v[192:195], v232, s[28:31], s51 offen offset:3072 sc1
    s_add_u32 s51, s51, 57344
    v_pk_mul_f32 v[96:97], v[96:97], v[62:63] op_sel_hi:[1,0]
    v_pk_mul_f32 v[98:99], v[98:99], v[62:63] op_sel_hi:[1,0]
    v_pk_mul_f32 v[100:101], v[100:101], v[62:63] op_sel_hi:[1,0]
    v_pk_mul_f32 v[102:103], v[102:103], v[62:63] op_sel_hi:[1,0]
    s_add_u32 m0, s61, 20480
    s_add_u32 s50, s62, 49152
    buffer_load_dwordx4 v4, s[12:15], s50 offen sc1 lds
    v_pk_mul_f32 v[104:105], v[104:105], v[62:63] op_sel_hi:[1,0]
    v_pk_mul_f32 v[106:107], v[106:107], v[62:63] op_sel_hi:[1,0]
    v_pk_mul_f32 v[108:109], v[108:109], v[62:63] op_sel_hi:[1,0]
    v_pk_mul_f32 v[110:111], v[110:111], v[62:63] op_sel_hi:[1,0]
    v_pk_mul_f32 v[160:161], v[96:97], v[96:97]
    v_pk_mul_f32 v[162:163], v[98:99], v[98:99]
    v_pk_mul_f32 v[164:165], v[100:101], v[100:101]
    v_pk_mul_f32 v[166:167], v[102:103], v[102:103]
    v_pk_mul_f32 v[168:169], v[104:105], v[104:105]
    s_add_u32 m0, s61, 21504
    s_add_u32 s50, s62, 50176
    buffer_load_dwordx4 v4, s[12:15], s50 offen sc1 lds
    v_pk_mul_f32 v[170:171], v[106:107], v[106:107]
    v_pk_mul_f32 v[172:173], v[108:109], v[108:109]
    v_pk_mul_f32 v[174:175], v[110:111], v[110:111]
    v_pk_fma_f32 v[160:161], v[160:161], s[56:57], v[22:23]
    v_pk_fma_f32 v[162:163], v[162:163], s[56:57], v[22:23]
    v_pk_fma_f32 v[164:165], v[164:165], s[56:57], v[22:23]
    v_pk_fma_f32 v[166:167], v[166:167], s[56:57], v[22:23]
    v_pk_fma_f32 v[168:169], v[168:169], s[56:57], v[22:23]
    v_pk_fma_f32 v[170:171], v[170:171], s[56:57], v[22:23]
    s_add_u32 m0, s61, 22528
    s_add_u32 s50, s62, 51200
    buffer_load_dwordx4 v4, s[12:15], s50 offen sc1 lds
    v_pk_fma_f32 v[172:173], v[172:173], s[56:57], v[22:23]
    v_pk_fma_f32 v[174:175], v[174:175], s[56:57], v[22:23]
    v_pk_mul_f32 v[160:161], v[160:161], v[96:97]
    v_pk_mul_f32 v[162:163], v[162:163], v[98:99]
    v_pk_mul_f32 v[164:165], v[164:165], v[100:101]
    v_pk_mul_f32 v[166:167], v[166:167], v[102:103]
    v_pk_mul_f32 v[168:169], v[168:169], v[104:105]
    v_pk_mul_f32 v[170:171], v[170:171], v[106:107]
    v_pk_mul_f32 v[172:173], v[172:173], v[108:109]
    s_add_u32 m0, s61, 23552
    s_add_u32 s50, s62, 52224
    buffer_load_dwordx4 v4, s[12:15], s50 offen sc1 lds
    v_pk_mul_f32 v[174:175], v[174:175], v[110:111]
    v_exp_f32 v160, v160
    v_exp_f32 v161, v161
    v_exp_f32 v162, v162
    v_exp_f32 v163, v163
    v_exp_f32 v164, v164
    v_exp_f32 v165, v165
    v_exp_f32 v166, v166
    v_exp_f32 v167, v167
    s_add_u32 m0, s61, 24576
    s_add_u32 s50, s62, 53248
    buffer_load_dwordx4 v4, s[12:15], s50 offen sc1 lds
    v_exp_f32 v168, v168
    v_exp_f32 v169, v169
    v_exp_f32 v170, v170
    v_exp_f32 v171, v171
    v_exp_f32 v172, v172
    v_exp_f32 v173, v173
    v_exp_f32 v174, v174
    v_exp_f32 v175, v175
    s_nop 0
    s_add_u32 m0, s61, 25600
    s_add_u32 s50, s62, 54272
    buffer_load_dwordx4 v4, s[12:15], s50 offen sc1 lds
    v_pk_add_f32 v[160:161], v[160:161], 1.0 op_sel_hi:[1,0]
    v_pk_add_f32 v[162:163], v[162:163], 1.0 op_sel_hi:[1,0]
    v_pk_add_f32 v[164:165], v[164:165], 1.0 op_sel_hi:[1,0]
    v_pk_add_f32 v[166:167], v[166:167], 1.0 op_sel_hi:[1,0]
    v_pk_add_f32 v[168:169], v[168:169], 1.0 op_sel_hi:[1,0]
    v_pk_add_f32 v[170:171], v[170:171], 1.0 op_sel_hi:[1,0]
    v_pk_add_f32 v[172:173], v[172:173], 1.0 op_sel_hi:[1,0]
    v_pk_add_f32 v[174:175], v[174:175], 1.0 op_sel_hi:[1,0]
    v_rcp_f32 v160, v160
    s_add_u32 m0, s61, 26624
    s_add_u32 s50, s62, 55296
    buffer_load_dwordx4 v4, s[12:15], s50 offen sc1 lds
    v_rcp_f32 v161, v161
    v_rcp_f32 v162, v162
    v_rcp_f32 v163, v163
    v_rcp_f32 v164, v164
    v_rcp_f32 v165, v165
    v_rcp_f32 v166, v166
    v_rcp_f32 v167, v167
    v_rcp_f32 v168, v168
    v_rcp_f32 v169, v169
    s_add_u32 m0, s61, 27648
    s_add_u32 s50, s62, 56320
    buffer_load_dwordx4 v4, s[12:15], s50 offen sc1 lds
    v_rcp_f32 v170, v170
    v_rcp_f32 v171, v171
    v_rcp_f32 v172, v172
    v_rcp_f32 v173, v173
    v_rcp_f32 v174, v174
    v_rcp_f32 v175, v175
    s_nop 0
    v_pk_mul_f32 v[96:97], v[96:97], v[160:161]
    v_pk_mul_f32 v[98:99], v[98:99], v[162:163]
    v_pk_mul_f32 v[100:101], v[100:101], v[164:165]
    v_pk_mul_f32 v[102:103], v[102:103], v[166:167]
    v_pk_mul_f32 v[104:105], v[104:105], v[168:169]
    v_pk_mul_f32 v[106:107], v[106:107], v[170:171]
    v_pk_mul_f32 v[108:109], v[108:109], v[172:173]
    v_pk_mul_f32 v[110:111], v[110:111], v[174:175]
    v_cvt_pk_bf16_f32 v180, v96, v97
    v_cvt_pk_bf16_f32 v181, v98, v99
    v_cvt_pk_bf16_f32 v182, v100, v101
    v_cvt_pk_bf16_f32 v183, v102, v103
    v_cvt_pk_bf16_f32 v184, v104, v105
    v_cvt_pk_bf16_f32 v185, v106, v107
    v_cvt_pk_bf16_f32 v186, v108, v109
    v_cvt_pk_bf16_f32 v187, v110, v111
    buffer_store_dwordx4 v[180:183], v232, s[28:31], s51 offen offset:0 sc1
    buffer_store_dwordx4 v[184:187], v232, s[28:31], s51 offen offset:1024 sc1
    v_pk_mul_f32 v[112:113], v[112:113], v[62:63] op_sel_hi:[1,0]
    v_pk_mul_f32 v[114:115], v[114:115], v[62:63] op_sel_hi:[1,0]
    v_pk_mul_f32 v[116:117], v[116:117], v[62:63] op_sel_hi:[1,0]
    v_pk_mul_f32 v[118:119], v[118:119], v[62:63] op_sel_hi:[1,0]
    v_pk_mul_f32 v[120:121], v[120:121], v[62:63] op_sel_hi:[1,0]
    v_pk_mul_f32 v[122:123], v[122:123], v[62:63] op_sel_hi:[1,0]
    v_pk_mul_f32 v[124:125], v[124:125], v[62:63] op_sel_hi:[1,0]
    v_pk_mul_f32 v[126:127], v[126:127], v[62:63] op_sel_hi:[1,0]
    v_pk_mul_f32 v[160:161], v[112:113], v[112:113]
    v_pk_mul_f32 v[162:163], v[114:115], v[114:115]
    v_pk_mul_f32 v[164:165], v[116:117], v[116:117]
    v_pk_mul_f32 v[166:167], v[118:119], v[118:119]
    v_pk_mul_f32 v[168:169], v[120:121], v[120:121]
    v_pk_mul_f32 v[170:171], v[122:123], v[122:123]
    v_pk_mul_f32 v[172:173], v[124:125], v[124:125]
    v_pk_mul_f32 v[174:175], v[126:127], v[126:127]
    v_pk_fma_f32 v[160:161], v[160:161], s[56:57], v[22:23]
    v_pk_fma_f32 v[162:163], v[162:163], s[56:57], v[22:23]
    v_pk_fma_f32 v[164:165], v[164:165], s[56:57], v[22:23]
    v_pk_fma_f32 v[166:167], v[166:167], s[56:57], v[22:23]
    v_pk_fma_f32 v[168:169], v[168:169], s[56:57], v[22:23]
    v_pk_fma_f32 v[170:171], v[170:171], s[56:57], v[22:23]
    v_pk_fma_f32 v[172:173], v[172:173], s[56:57], v[22:23]
    v_pk_fma_f32 v[174:175], v[174:175], s[56:57], v[22:23]
    v_pk_mul_f32 v[160:161], v[160:161], v[112:113]
    v_pk_mul_f32 v[162:163], v[162:163], v[114:115]
    v_pk_mul_f32 v[164:165], v[164:165], v[116:117]
    v_pk_mul_f32 v[166:167], v[166:167], v[118:119]
    v_pk_mul_f32 v[168:169], v[168:169], v[120:121]
    v_pk_mul_f32 v[170:171], v[170:171], v[122:123]
    v_pk_mul_f32 v[172:173], v[172:173], v[124:125]
    v_pk_mul_f32 v[174:175], v[174:175], v[126:127]
    v_exp_f32 v160, v160
    v_exp_f32 v161, v161
    v_exp_f32 v162, v162
    v_exp_f32 v163, v163
    v_exp_f32 v164, v164
    v_exp_f32 v165, v165
    v_exp_f32 v166, v166
    v_exp_f32 v167, v167
    v_exp_f32 v168, v168
    v_exp_f32 v169, v169
    v_exp_f32 v170, v170
    v_exp_f32 v171, v171
    v_exp_f32 v172, v172
    v_exp_f32 v173, v173
    v_exp_f32 v174, v174
    v_exp_f32 v175, v175
    s_nop 0
    v_pk_add_f32 v[160:161], v[160:161], 1.0 op_sel_hi:[1,0]
    v_pk_add_f32 v[162:163], v[162:163], 1.0 op_sel_hi:[1,0]
    v_pk_add_f32 v[164:165], v[164:165], 1.0 op_sel_hi:[1,0]
    v_pk_add_f32 v[166:167], v[166:167], 1.0 op_sel_hi:[1,0]
    v_pk_add_f32 v[168:169], v[168:169], 1.0 op_sel_hi:[1,0]
    v_pk_add_f32 v[170:171], v[170:171], 1.0 op_sel_hi:[1,0]
    v_pk_add_f32 v[172:173], v[172:173], 1.0 op_sel_hi:[1,0]
    v_pk_add_f32 v[174:175], v[174:175], 1.0 op_sel_hi:[1,0]
    v_rcp_f32 v160, v160
    v_rcp_f32 v161, v161
    v_rcp_f32 v162, v162
    v_rcp_f32 v163, v163
    v_rcp_f32 v164, v164
    v_rcp_f32 v165, v165
    v_rcp_f32 v166, v166
    v_rcp_f32 v167, v167
    v_rcp_f32 v168, v168
    v_rcp_f32 v169, v169
    v_rcp_f32 v170, v170
    v_rcp_f32 v171, v171
    v_rcp_f32 v172, v172
    v_rcp_f32 v173, v173
    v_rcp_f32 v174, v174
    v_rcp_f32 v175, v175
    s_nop 0
    v_pk_mul_f32 v[112:113], v[112:113], v[160:161]
    v_pk_mul_f32 v[114:115], v[114:115], v[162:163]
    v_pk_mul_f32 v[116:117], v[116:117], v[164:165]
    v_pk_mul_f32 v[118:119], v[118:119], v[166:167]
    v_pk_mul_f32 v[120:121], v[120:121], v[168:169]
    v_pk_mul_f32 v[122:123], v[122:123], v[170:171]
    v_pk_mul_f32 v[124:125], v[124:125], v[172:173]
    v_pk_mul_f32 v[126:127], v[126:127], v[174:175]
    v_cvt_pk_bf16_f32 v188, v112, v113
    v_cvt_pk_bf16_f32 v189, v114, v115
    v_cvt_pk_bf16_f32 v190, v116, v117
    v_cvt_pk_bf16_f32 v191, v118, v119
    v_cvt_pk_bf16_f32 v192, v120, v121
    v_cvt_pk_bf16_f32 v193, v122, v123
    v_cvt_pk_bf16_f32 v194, v124, v125
    v_cvt_pk_bf16_f32 v195, v126, v127
    buffer_store_dwordx4 v[188:191], v232, s[28:31], s51 offen offset:2048 sc1
    buffer_store_dwordx4 v[192:195], v232, s[28:31], s51 offen offset:3072 sc1
    s_lshl_b32 s47, s88, 7
    s_add_u32 s47, s47, 20480
    s_waitcnt vmcnt(0)
    s_barrier
    s_cmp_eq_u32 s32, 0
    s_cbranch_scc0 mega_kernel_sig30
    v_mov_b32 v20, 0
    v_mov_b32 v21, 1
    s_mov_b64 exec, 1
    buffer_atomic_add v21, v20, s[72:75], s47 offen sc1
    s_mov_b64 exec, -1
mega_kernel_sig30:
    s_cmp_eq_u32 s32, 0
    s_cbranch_scc1 mega_kernel_e531
    s_add_u32 s49, s62, 0
    buffer_load_dwordx4 a[0:3], v4, s[12:15], s49 offen offset:0 sc1
    buffer_load_dwordx4 a[4:7], v4, s[12:15], s49 offen offset:1024 sc1
    buffer_load_dwordx4 a[8:11], v4, s[12:15], s49 offen offset:2048 sc1
    buffer_load_dwordx4 a[12:15], v4, s[12:15], s49 offen offset:3072 sc1
    s_add_u32 s49, s62, 4096
    buffer_load_dwordx4 a[32:35], v4, s[12:15], s49 offen offset:0 sc1
    buffer_load_dwordx4 a[36:39], v4, s[12:15], s49 offen offset:1024 sc1
    buffer_load_dwordx4 a[40:43], v4, s[12:15], s49 offen offset:2048 sc1
    buffer_load_dwordx4 a[44:47], v4, s[12:15], s49 offen offset:3072 sc1
    s_add_u32 s49, s62, 8192
    buffer_load_dwordx4 a[64:67], v4, s[12:15], s49 offen offset:0 sc1
    buffer_load_dwordx4 a[68:71], v4, s[12:15], s49 offen offset:1024 sc1
    buffer_load_dwordx4 a[72:75], v4, s[12:15], s49 offen offset:2048 sc1
    buffer_load_dwordx4 a[76:79], v4, s[12:15], s49 offen offset:3072 sc1
    s_add_u32 s49, s62, 12288
    buffer_load_dwordx4 a[96:99], v4, s[12:15], s49 offen offset:0 sc1
    buffer_load_dwordx4 a[100:103], v4, s[12:15], s49 offen offset:1024 sc1
    buffer_load_dwordx4 a[104:107], v4, s[12:15], s49 offen offset:2048 sc1
    buffer_load_dwordx4 a[108:111], v4, s[12:15], s49 offen offset:3072 sc1
    s_add_u32 s49, s62, 16384
    buffer_load_dwordx4 a[128:131], v4, s[12:15], s49 offen offset:0 sc1
    buffer_load_dwordx4 a[132:135], v4, s[12:15], s49 offen offset:1024 sc1
    buffer_load_dwordx4 a[136:139], v4, s[12:15], s49 offen offset:2048 sc1
    buffer_load_dwordx4 a[140:143], v4, s[12:15], s49 offen offset:3072 sc1
    s_add_u32 s49, s62, 20480
    buffer_load_dwordx4 a[160:163], v4, s[12:15], s49 offen offset:0 sc1
    buffer_load_dwordx4 a[164:167], v4, s[12:15], s49 offen offset:1024 sc1
    buffer_load_dwordx4 a[168:171], v4, s[12:15], s49 offen offset:2048 sc1
    buffer_load_dwordx4 a[172:175], v4, s[12:15], s49 offen offset:3072 sc1
    s_add_u32 s49, s62, 24576
    buffer_load_dwordx4 a[192:195], v4, s[12:15], s49 offen offset:0 sc1
    buffer_load_dwordx4 a[196:199], v4, s[12:15], s49 offen offset:1024 sc1
    buffer_load_dwordx4 a[200:203], v4, s[12:15], s49 offen offset:2048 sc1
    buffer_load_dwordx4 a[204:207], v4, s[12:15], s49 offen offset:3072 sc1
mega_kernel_e531:
    s_branch mega_kernel_t5
mega_kernel_no4b:
    s_waitcnt vmcnt(0)
    s_barrier
    s_add_u32 s12, s4, 54525952
    s_addc_u32 s13, s5, 0
    s_and_b32 s13, s13, 0xffff
    s_mov_b32 s14, 1835008
    s_mov_b32 s15, 0x20000
    s_mul_i32 s48, s36, 229376
    s_mul_i32 s62, s32, 57344
    s_add_u32 s62, s62, s48
    s_mul_i32 s61, s32, 28672
    v_lshlrev_b32 v4, 4, v1
    s_add_u32 m0, s61, 0
    s_add_u32 s50, s62, 28672
    buffer_load_dwordx4 v4, s[12:15], s50 offen sc1 lds
    s_add_u32 m0, s61, 1024
    s_add_u32 s50, s62, 29696
    buffer_load_dwordx4 v4, s[12:15], s50 offen sc1 lds
    s_add_u32 m0, s61, 2048
    s_add_u32 s50, s62, 30720
    buffer_load_dwordx4 v4, s[12:15], s50 offen sc1 lds
    s_add_u32 m0, s61, 3072
    s_add_u32 s50, s62, 31744
    buffer_load_dwordx4 v4, s[12:15], s50 offen sc1 lds
    s_add_u32 m0, s61, 4096
    s_add_u32 s50, s62, 32768
    buffer_load_dwordx4 v4, s[12:15], s50 offen sc1 lds
    s_add_u32 m0, s61, 5120
    s_add_u32 s50, s62, 33792
    buffer_load_dwordx4 v4, s[12:15], s50 offen sc1 lds
    s_add_u32 m0, s61, 6144
    s_add_u32 s50, s62, 34816
    buffer_load_dwordx4 v4, s[12:15], s50 offen sc1 lds
    s_add_u32 m0, s61, 7168
    s_add_u32 s50, s62, 35840
    buffer_load_dwordx4 v4, s[12:15], s50 offen sc1 lds
    s_add_u32 m0, s61, 8192
    s_add_u32 s50, s62, 36864
    buffer_load_dwordx4 v4, s[12:15], s50 offen sc1 lds
    s_add_u32 m0, s61, 9216
    s_add_u32 s50, s62, 37888
    buffer_load_dwordx4 v4, s[12:15], s50 offen sc1 lds
    s_add_u32 m0, s61, 10240
    s_add_u32 s50, s62, 38912
    buffer_load_dwordx4 v4, s[12:15], s50 offen sc1 lds
    s_add_u32 m0, s61, 11264
    s_add_u32 s50, s62, 39936
    buffer_load_dwordx4 v4, s[12:15], s50 offen sc1 lds
    s_add_u32 m0, s61, 12288
    s_add_u32 s50, s62, 40960
    buffer_load_dwordx4 v4, s[12:15], s50 offen sc1 lds
    s_add_u32 m0, s61, 13312
    s_add_u32 s50, s62, 41984
    buffer_load_dwordx4 v4, s[12:15], s50 offen sc1 lds
    s_add_u32 m0, s61, 14336
    s_add_u32 s50, s62, 43008
    buffer_load_dwordx4 v4, s[12:15], s50 offen sc1 lds
    s_add_u32 m0, s61, 15360
    s_add_u32 s50, s62, 44032
    buffer_load_dwordx4 v4, s[12:15], s50 offen sc1 lds
    s_add_u32 m0, s61, 16384
    s_add_u32 s50, s62, 45056
    buffer_load_dwordx4 v4, s[12:15], s50 offen sc1 lds
    s_add_u32 m0, s61, 17408
    s_add_u32 s50, s62, 46080
    buffer_load_dwordx4 v4, s[12:15], s50 offen sc1 lds
    s_add_u32 m0, s61, 18432
    s_add_u32 s50, s62, 47104
    buffer_load_dwordx4 v4, s[12:15], s50 offen sc1 lds
    s_add_u32 m0, s61, 19456
    s_add_u32 s50, s62, 48128
    buffer_load_dwordx4 v4, s[12:15], s50 offen sc1 lds
    s_add_u32 m0, s61, 20480
    s_add_u32 s50, s62, 49152
    buffer_load_dwordx4 v4, s[12:15], s50 offen sc1 lds
    s_add_u32 m0, s61, 21504
    s_add_u32 s50, s62, 50176
    buffer_load_dwordx4 v4, s[12:15], s50 offen sc1 lds
    s_add_u32 m0, s61, 22528
    s_add_u32 s50, s62, 51200
    buffer_load_dwordx4 v4, s[12:15], s50 offen sc1 lds
    s_add_u32 m0, s61, 23552
    s_add_u32 s50, s62, 52224
    buffer_load_dwordx4 v4, s[12:15], s50 offen sc1 lds
    s_add_u32 m0, s61, 24576
    s_add_u32 s50, s62, 53248
    buffer_load_dwordx4 v4, s[12:15], s50 offen sc1 lds
    s_add_u32 m0, s61, 25600
    s_add_u32 s50, s62, 54272
    buffer_load_dwordx4 v4, s[12:15], s50 offen sc1 lds
    s_add_u32 m0, s61, 26624
    s_add_u32 s50, s62, 55296
    buffer_load_dwordx4 v4, s[12:15], s50 offen sc1 lds
    s_add_u32 m0, s61, 27648
    s_add_u32 s50, s62, 56320
    buffer_load_dwordx4 v4, s[12:15], s50 offen sc1 lds
    s_cmp_eq_u32 s32, 0
    s_cbranch_scc1 mega_kernel_e532
    s_add_u32 s49, s62, 0
    buffer_load_dwordx4 a[0:3], v4, s[12:15], s49 offen offset:0 sc1
    buffer_load_dwordx4 a[4:7], v4, s[12:15], s49 offen offset:1024 sc1
    buffer_load_dwordx4 a[8:11], v4, s[12:15], s49 offen offset:2048 sc1
    buffer_load_dwordx4 a[12:15], v4, s[12:15], s49 offen offset:3072 sc1
    s_add_u32 s49, s62, 4096
    buffer_load_dwordx4 a[32:35], v4, s[12:15], s49 offen offset:0 sc1
    buffer_load_dwordx4 a[36:39], v4, s[12:15], s49 offen offset:1024 sc1
    buffer_load_dwordx4 a[40:43], v4, s[12:15], s49 offen offset:2048 sc1
    buffer_load_dwordx4 a[44:47], v4, s[12:15], s49 offen offset:3072 sc1
    s_add_u32 s49, s62, 8192
    buffer_load_dwordx4 a[64:67], v4, s[12:15], s49 offen offset:0 sc1
    buffer_load_dwordx4 a[68:71], v4, s[12:15], s49 offen offset:1024 sc1
    buffer_load_dwordx4 a[72:75], v4, s[12:15], s49 offen offset:2048 sc1
    buffer_load_dwordx4 a[76:79], v4, s[12:15], s49 offen offset:3072 sc1
    s_add_u32 s49, s62, 12288
    buffer_load_dwordx4 a[96:99], v4, s[12:15], s49 offen offset:0 sc1
    buffer_load_dwordx4 a[100:103], v4, s[12:15], s49 offen offset:1024 sc1
    buffer_load_dwordx4 a[104:107], v4, s[12:15], s49 offen offset:2048 sc1
    buffer_load_dwordx4 a[108:111], v4, s[12:15], s49 offen offset:3072 sc1
    s_add_u32 s49, s62, 16384
    buffer_load_dwordx4 a[128:131], v4, s[12:15], s49 offen offset:0 sc1
    buffer_load_dwordx4 a[132:135], v4, s[12:15], s49 offen offset:1024 sc1
    buffer_load_dwordx4 a[136:139], v4, s[12:15], s49 offen offset:2048 sc1
    buffer_load_dwordx4 a[140:143], v4, s[12:15], s49 offen offset:3072 sc1
    s_add_u32 s49, s62, 20480
    buffer_load_dwordx4 a[160:163], v4, s[12:15], s49 offen offset:0 sc1
    buffer_load_dwordx4 a[164:167], v4, s[12:15], s49 offen offset:1024 sc1
    buffer_load_dwordx4 a[168:171], v4, s[12:15], s49 offen offset:2048 sc1
    buffer_load_dwordx4 a[172:175], v4, s[12:15], s49 offen offset:3072 sc1
    s_add_u32 s49, s62, 24576
    buffer_load_dwordx4 a[192:195], v4, s[12:15], s49 offen offset:0 sc1
    buffer_load_dwordx4 a[196:199], v4, s[12:15], s49 offen offset:1024 sc1
    buffer_load_dwordx4 a[200:203], v4, s[12:15], s49 offen offset:2048 sc1
    buffer_load_dwordx4 a[204:207], v4, s[12:15], s49 offen offset:3072 sc1
mega_kernel_e532:
mega_kernel_t5:
    s_lshr_b32 s51, s35, 1
    s_lshl_b32 s53, s51, 7
    s_add_u32 s53, s53, 20480
    s_add_u32 s16, s4, 34603008
    s_addc_u32 s17, s5, 0
    s_and_b32 s17, s17, 0xffff
    s_mov_b32 s18, 7340032
    s_mov_b32 s19, 0x20000
    s_mov_b32 s20, s4
    s_and_b32 s21, s5, 0xffff
    s_mov_b32 s22, 12288
    s_mov_b32 s23, 0x20000
    s_mov_b32 s24, s100
    s_and_b32 s25, s101, 0xffff
    s_mov_b32 s26, 2097152
    s_mov_b32 s27, 0x20000
    s_xor_b32 s51, s32, 0
    s_lshl_b32 s55, s35, 2
    s_add_u32 s51, s51, s55
    s_mul_i32 s51, s51, 57344
    v_add_u32 v12, s51, v232
    s_xor_b32 s51, s32, 1
    s_lshl_b32 s55, s35, 2
    s_add_u32 s51, s51, s55
    s_mul_i32 s51, s51, 57344
    v_add_u32 v13, s51, v232
    s_xor_b32 s51, s32, 2
    s_lshl_b32 s55, s35, 2
    s_add_u32 s51, s51, s55
    s_mul_i32 s51, s51, 57344
    v_add_u32 v14, s51, v232
    s_xor_b32 s51, s32, 3
    s_lshl_b32 s55, s35, 2
    s_add_u32 s51, s51, s55
    s_mul_i32 s51, s51, 57344
    v_add_u32 v15, s51, v232
    v_and_b32 v20, 1, v230
    v_lshlrev_b32 v20, 1, v20
    v_lshrrev_b32 v21, 1, v230
    v_or_b32 v20, v20, v21
    v_lshlrev_b32 v20, 4, v20
    v_lshl_add_u32 v20, v231, 10, v20
    s_lshl_b32 s51, s37, 14
    s_add_u32 s51, s51, s38
    v_add_u32 v19, s51, v20
    v_add_u32 v18, 10240, v233
    v_lshlrev_b32 v160, 16, v248
    v_and_b32 v161, 0xffff0000, v248
    v_lshlrev_b32 v162, 16, v249
    v_and_b32 v163, 0xffff0000, v249
    v_lshlrev_b32 v164, 16, v250
    v_and_b32 v165, 0xffff0000, v250
    v_lshlrev_b32 v166, 16, v251
    v_and_b32 v167, 0xffff0000, v251
    v_lshlrev_b32 v168, 16, v252
    v_and_b32 v169, 0xffff0000, v252
    v_lshlrev_b32 v170, 16, v253
    v_and_b32 v171, 0xffff0000, v253
    v_lshlrev_b32 v172, 16, v254
    v_and_b32 v173, 0xffff0000, v254
    v_lshlrev_b32 v174, 16, v255
    v_and_b32 v175, 0xffff0000, v255
    v_lshlrev_b32 v72, 16, v240
    v_and_b32 v73, 0xffff0000, v240
    v_lshlrev_b32 v74, 16, v241
    v_and_b32 v75, 0xffff0000, v241
    v_lshlrev_b32 v76, 16, v242
    v_and_b32 v77, 0xffff0000, v242
    v_lshlrev_b32 v78, 16, v243
    v_and_b32 v79, 0xffff0000, v243
    v_lshlrev_b32 v80, 16, v244
    v_and_b32 v81, 0xffff0000, v244
    v_lshlrev_b32 v82, 16, v245
    v_and_b32 v83, 0xffff0000, v245
    v_lshlrev_b32 v84, 16, v246
    v_and_b32 v85, 0xffff0000, v246
    v_lshlrev_b32 v86, 16, v247
    v_and_b32 v87, 0xffff0000, v247
    s_cmp_eq_u32 s32, 0
    s_cbranch_scc0 mega_kernel_pe33
    v_mov_b32 v20, s53
    v_mov_b32 v21, 14
    s_mov_b64 exec, 1
    buffer_load_dword v22, v20, s[72:75], 0 offen sc1
    s_mov_b64 exec, -1
    s_mov_b64 exec, 1
    s_mov_b32 s3, 100000
    s_waitcnt vmcnt(0)
mega_kernel_pl34:
    v_cmp_ge_u32 vcc, v22, v21
    s_sub_u32 s3, s3, 1
    s_cmp_eq_u32 s3, 0
    s_cbranch_scc1 mega_kernel_pq35
    s_cmp_eq_u64 vcc, exec
    s_cbranch_scc1 mega_kernel_pq35
    s_sleep 4
    buffer_load_dword v22, v20, s[72:75], 0 offen sc1
    s_waitcnt vmcnt(0)
    s_branch mega_kernel_pl34
mega_kernel_pq35:
    s_mov_b64 exec, -1
    s_add_u32 s49, s62, 0
    buffer_load_dwordx4 a[0:3], v4, s[12:15], s49 offen offset:0 sc1
    buffer_load_dwordx4 a[4:7], v4, s[12:15], s49 offen offset:1024 sc1
    buffer_load_dwordx4 a[8:11], v4, s[12:15], s49 offen offset:2048 sc1
    buffer_load_dwordx4 a[12:15], v4, s[12:15], s49 offen offset:3072 sc1
    s_add_u32 s49, s62, 4096
    buffer_load_dwordx4 a[32:35], v4, s[12:15], s49 offen offset:0 sc1
    buffer_load_dwordx4 a[36:39], v4, s[12:15], s49 offen offset:1024 sc1
    buffer_load_dwordx4 a[40:43], v4, s[12:15], s49 offen offset:2048 sc1
    buffer_load_dwordx4 a[44:47], v4, s[12:15], s49 offen offset:3072 sc1
    s_add_u32 s49, s62, 8192
    buffer_load_dwordx4 a[64:67], v4, s[12:15], s49 offen offset:0 sc1
    buffer_load_dwordx4 a[68:71], v4, s[12:15], s49 offen offset:1024 sc1
    buffer_load_dwordx4 a[72:75], v4, s[12:15], s49 offen offset:2048 sc1
    buffer_load_dwordx4 a[76:79], v4, s[12:15], s49 offen offset:3072 sc1
    s_add_u32 s49, s62, 12288
    buffer_load_dwordx4 a[96:99], v4, s[12:15], s49 offen offset:0 sc1
    buffer_load_dwordx4 a[100:103], v4, s[12:15], s49 offen offset:1024 sc1
    buffer_load_dwordx4 a[104:107], v4, s[12:15], s49 offen offset:2048 sc1
    buffer_load_dwordx4 a[108:111], v4, s[12:15], s49 offen offset:3072 sc1
    s_add_u32 s49, s62, 16384
    buffer_load_dwordx4 a[128:131], v4, s[12:15], s49 offen offset:0 sc1
    buffer_load_dwordx4 a[132:135], v4, s[12:15], s49 offen offset:1024 sc1
    buffer_load_dwordx4 a[136:139], v4, s[12:15], s49 offen offset:2048 sc1
    buffer_load_dwordx4 a[140:143], v4, s[12:15], s49 offen offset:3072 sc1
    s_add_u32 s49, s62, 20480
    buffer_load_dwordx4 a[160:163], v4, s[12:15], s49 offen offset:0 sc1
    buffer_load_dwordx4 a[164:167], v4, s[12:15], s49 offen offset:1024 sc1
    buffer_load_dwordx4 a[168:171], v4, s[12:15], s49 offen offset:2048 sc1
    buffer_load_dwordx4 a[172:175], v4, s[12:15], s49 offen offset:3072 sc1
    s_add_u32 s49, s62, 24576
    buffer_load_dwordx4 a[192:195], v4, s[12:15], s49 offen offset:0 sc1
    buffer_load_dwordx4 a[196:199], v4, s[12:15], s49 offen offset:1024 sc1
    buffer_load_dwordx4 a[200:203], v4, s[12:15], s49 offen offset:2048 sc1
    buffer_load_dwordx4 a[204:207], v4, s[12:15], s49 offen offset:3072 sc1
mega_kernel_pe33:
    s_barrier
    s_mul_i32 s63, s32, 14336
    s_mul_i32 s51, s32, 28672
    v_add_u32 v5, s51, v232
    s_add_u32 s52, s63, 0
    buffer_load_dwordx4 a[16:19], v12, s[16:19], s52 offen sc1
    buffer_load_dwordx4 a[20:23], v13, s[16:19], s52 offen sc1
    buffer_load_dwordx4 a[24:27], v14, s[16:19], s52 offen sc1
    buffer_load_dwordx4 a[28:31], v15, s[16:19], s52 offen sc1
    s_add_u32 s52, s63, 1024
    buffer_load_dwordx4 a[48:51], v12, s[16:19], s52 offen sc1
    buffer_load_dwordx4 a[52:55], v13, s[16:19], s52 offen sc1
    buffer_load_dwordx4 a[56:59], v14, s[16:19], s52 offen sc1
    buffer_load_dwordx4 a[60:63], v15, s[16:19], s52 offen sc1
    s_add_u32 s52, s63, 2048
    buffer_load_dwordx4 a[80:83], v12, s[16:19], s52 offen sc1
    buffer_load_dwordx4 a[84:87], v13, s[16:19], s52 offen sc1
    buffer_load_dwordx4 a[88:91], v14, s[16:19], s52 offen sc1
    buffer_load_dwordx4 a[92:95], v15, s[16:19], s52 offen sc1
    s_add_u32 s52, s63, 3072
    buffer_load_dwordx4 a[112:115], v12, s[16:19], s52 offen sc1
    buffer_load_dwordx4 a[116:119], v13, s[16:19], s52 offen sc1
    buffer_load_dwordx4 a[120:123], v14, s[16:19], s52 offen sc1
    buffer_load_dwordx4 a[124:127], v15, s[16:19], s52 offen sc1
    s_add_u32 s52, s63, 4096
    buffer_load_dwordx4 a[144:147], v12, s[16:19], s52 offen sc1
    buffer_load_dwordx4 a[148:151], v13, s[16:19], s52 offen sc1
    buffer_load_dwordx4 a[152:155], v14, s[16:19], s52 offen sc1
    buffer_load_dwordx4 a[156:159], v15, s[16:19], s52 offen sc1
    s_add_u32 s52, s63, 5120
    buffer_load_dwordx4 a[176:179], v12, s[16:19], s52 offen sc1
    buffer_load_dwordx4 a[180:183], v13, s[16:19], s52 offen sc1
    buffer_load_dwordx4 a[184:187], v14, s[16:19], s52 offen sc1
    buffer_load_dwordx4 a[188:191], v15, s[16:19], s52 offen sc1
    s_add_u32 s52, s63, 6144
    buffer_load_dwordx4 a[208:211], v12, s[16:19], s52 offen sc1
    buffer_load_dwordx4 a[212:215], v13, s[16:19], s52 offen sc1
    buffer_load_dwordx4 a[216:219], v14, s[16:19], s52 offen sc1
    buffer_load_dwordx4 a[220:223], v15, s[16:19], s52 offen sc1
    s_waitcnt vmcnt(24)
    v_mfma_f32_16x16x32_bf16 v[160:163], a[0:3], a[16:19], v[160:163]
    v_mfma_f32_16x16x32_bf16 v[176:179], a[0:3], a[20:23], 0
    s_add_u32 s52, s63, 7168
    buffer_load_dwordx4 a[240:243], v12, s[16:19], s52 offen sc1
    buffer_load_dwordx4 a[244:247], v13, s[16:19], s52 offen sc1
    buffer_load_dwordx4 a[248:251], v14, s[16:19], s52 offen sc1
    buffer_load_dwordx4 a[252:255], v15, s[16:19], s52 offen sc1
    v_mfma_f32_16x16x32_bf16 v[192:195], a[0:3], a[24:27], 0
    v_mfma_f32_16x16x32_bf16 v[208:211], a[0:3], a[28:31], 0
    v_mfma_f32_16x16x32_bf16 v[164:167], a[4:7], a[16:19], v[164:167]
    v_mfma_f32_16x16x32_bf16 v[180:183], a[4:7], a[20:23], 0
    v_mfma_f32_16x16x32_bf16 v[196:199], a[4:7], a[24:27], 0
    v_mfma_f32_16x16x32_bf16 v[212:215], a[4:7], a[28:31], 0
    v_mfma_f32_16x16x32_bf16 v[168:171], a[8:11], a[16:19], v[168:171]
    v_mfma_f32_16x16x32_bf16 v[184:187], a[8:11], a[20:23], 0
    v_mfma_f32_16x16x32_bf16 v[200:203], a[8:11], a[24:27], 0
    v_mfma_f32_16x16x32_bf16 v[216:219], a[8:11], a[28:31], 0
    v_mfma_f32_16x16x32_bf16 v[172:175], a[12:15], a[16:19], v[172:175]
    v_mfma_f32_16x16x32_bf16 v[188:191], a[12:15], a[20:23], 0
    v_mfma_f32_16x16x32_bf16 v[204:207], a[12:15], a[24:27], 0
    v_mfma_f32_16x16x32_bf16 v[220:223], a[12:15], a[28:31], 0
    s_waitcnt vmcnt(24)
    v_mfma_f32_16x16x32_bf16 v[160:163], a[32:35], a[48:51], v[160:163]
    v_mfma_f32_16x16x32_bf16 v[176:179], a[32:35], a[52:55], v[176:179]
    s_add_u32 s52, s63, 8192
    buffer_load_dwordx4 a[16:19], v12, s[16:19], s52 offen sc1
    buffer_load_dwordx4 a[20:23], v13, s[16:19], s52 offen sc1
    buffer_load_dwordx4 a[24:27], v14, s[16:19], s52 offen sc1
    buffer_load_dwordx4 a[28:31], v15, s[16:19], s52 offen sc1
    v_mfma_f32_16x16x32_bf16 v[192:195], a[32:35], a[56:59], v[192:195]
    v_mfma_f32_16x16x32_bf16 v[208:211], a[32:35], a[60:63], v[208:211]
    v_mfma_f32_16x16x32_bf16 v[164:167], a[36:39], a[48:51], v[164:167]
    v_mfma_f32_16x16x32_bf16 v[180:183], a[36:39], a[52:55], v[180:183]
    v_mfma_f32_16x16x32_bf16 v[196:199], a[36:39], a[56:59], v[196:199]
    v_mfma_f32_16x16x32_bf16 v[212:215], a[36:39], a[60:63], v[212:215]
    v_mfma_f32_16x16x32_bf16 v[168:171], a[40:43], a[48:51], v[168:171]
    v_mfma_f32_16x16x32_bf16 v[184:187], a[40:43], a[52:55], v[184:187]
    v_mfma_f32_16x16x32_bf16 v[200:203], a[40:43], a[56:59], v[200:203]
    v_mfma_f32_16x16x32_bf16 v[216:219], a[40:43], a[60:63], v[216:219]
    v_mfma_f32_16x16x32_bf16 v[172:175], a[44:47], a[48:51], v[172:175]
    v_mfma_f32_16x16x32_bf16 v[188:191], a[44:47], a[52:55], v[188:191]
    v_mfma_f32_16x16x32_bf16 v[204:207], a[44:47], a[56:59], v[204:207]
    v_mfma_f32_16x16x32_bf16 v[220:223], a[44:47], a[60:63], v[220:223]
    s_waitcnt vmcnt(24)
    v_mfma_f32_16x16x32_bf16 v[160:163], a[64:67], a[80:83], v[160:163]
    v_mfma_f32_16x16x32_bf16 v[176:179], a[64:67], a[84:87], v[176:179]
    s_add_u32 s52, s63, 9216
    buffer_load_dwordx4 a[48:51], v12, s[16:19], s52 offen sc1
    buffer_load_dwordx4 a[52:55], v13, s[16:19], s52 offen sc1
    buffer_load_dwordx4 a[56:59], v14, s[16:19], s52 offen sc1
    buffer_load_dwordx4 a[60:63], v15, s[16:19], s52 offen sc1
    v_mfma_f32_16x16x32_bf16 v[192:195], a[64:67], a[88:91], v[192:195]
    v_mfma_f32_16x16x32_bf16 v[208:211], a[64:67], a[92:95], v[208:211]
    v_mfma_f32_16x16x32_bf16 v[164:167], a[68:71], a[80:83], v[164:167]
    v_mfma_f32_16x16x32_bf16 v[180:183], a[68:71], a[84:87], v[180:183]
    v_mfma_f32_16x16x32_bf16 v[196:199], a[68:71], a[88:91], v[196:199]
    v_mfma_f32_16x16x32_bf16 v[212:215], a[68:71], a[92:95], v[212:215]
    v_mfma_f32_16x16x32_bf16 v[168:171], a[72:75], a[80:83], v[168:171]
    v_mfma_f32_16x16x32_bf16 v[184:187], a[72:75], a[84:87], v[184:187]
    v_mfma_f32_16x16x32_bf16 v[200:203], a[72:75], a[88:91], v[200:203]
    v_mfma_f32_16x16x32_bf16 v[216:219], a[72:75], a[92:95], v[216:219]
    v_mfma_f32_16x16x32_bf16 v[172:175], a[76:79], a[80:83], v[172:175]
    v_mfma_f32_16x16x32_bf16 v[188:191], a[76:79], a[84:87], v[188:191]
    v_mfma_f32_16x16x32_bf16 v[204:207], a[76:79], a[88:91], v[204:207]
    v_mfma_f32_16x16x32_bf16 v[220:223], a[76:79], a[92:95], v[220:223]
    s_waitcnt vmcnt(24)
    v_mfma_f32_16x16x32_bf16 v[160:163], a[96:99], a[112:115], v[160:163]
    v_mfma_f32_16x16x32_bf16 v[176:179], a[96:99], a[116:119], v[176:179]
    s_add_u32 s52, s63, 10240
    buffer_load_dwordx4 a[80:83], v12, s[16:19], s52 offen sc1
    buffer_load_dwordx4 a[84:87], v13, s[16:19], s52 offen sc1
    buffer_load_dwordx4 a[88:91], v14, s[16:19], s52 offen sc1
    buffer_load_dwordx4 a[92:95], v15, s[16:19], s52 offen sc1
    v_mfma_f32_16x16x32_bf16 v[192:195], a[96:99], a[120:123], v[192:195]
    v_mfma_f32_16x16x32_bf16 v[208:211], a[96:99], a[124:127], v[208:211]
    v_mfma_f32_16x16x32_bf16 v[164:167], a[100:103], a[112:115], v[164:167]
    v_mfma_f32_16x16x32_bf16 v[180:183], a[100:103], a[116:119], v[180:183]
    v_mfma_f32_16x16x32_bf16 v[196:199], a[100:103], a[120:123], v[196:199]
    v_mfma_f32_16x16x32_bf16 v[212:215], a[100:103], a[124:127], v[212:215]
    v_mfma_f32_16x16x32_bf16 v[168:171], a[104:107], a[112:115], v[168:171]
    v_mfma_f32_16x16x32_bf16 v[184:187], a[104:107], a[116:119], v[184:187]
    v_mfma_f32_16x16x32_bf16 v[200:203], a[104:107], a[120:123], v[200:203]
    v_mfma_f32_16x16x32_bf16 v[216:219], a[104:107], a[124:127], v[216:219]
    v_mfma_f32_16x16x32_bf16 v[172:175], a[108:111], a[112:115], v[172:175]
    v_mfma_f32_16x16x32_bf16 v[188:191], a[108:111], a[116:119], v[188:191]
    v_mfma_f32_16x16x32_bf16 v[204:207], a[108:111], a[120:123], v[204:207]
    v_mfma_f32_16x16x32_bf16 v[220:223], a[108:111], a[124:127], v[220:223]
    s_waitcnt vmcnt(24)
    v_mfma_f32_16x16x32_bf16 v[160:163], a[128:131], a[144:147], v[160:163]
    v_mfma_f32_16x16x32_bf16 v[176:179], a[128:131], a[148:151], v[176:179]
    s_add_u32 s52, s63, 11264
    buffer_load_dwordx4 a[112:115], v12, s[16:19], s52 offen sc1
    buffer_load_dwordx4 a[116:119], v13, s[16:19], s52 offen sc1
    buffer_load_dwordx4 a[120:123], v14, s[16:19], s52 offen sc1
    buffer_load_dwordx4 a[124:127], v15, s[16:19], s52 offen sc1
    v_mfma_f32_16x16x32_bf16 v[192:195], a[128:131], a[152:155], v[192:195]
    v_mfma_f32_16x16x32_bf16 v[208:211], a[128:131], a[156:159], v[208:211]
    v_mfma_f32_16x16x32_bf16 v[164:167], a[132:135], a[144:147], v[164:167]
    v_mfma_f32_16x16x32_bf16 v[180:183], a[132:135], a[148:151], v[180:183]
    v_mfma_f32_16x16x32_bf16 v[196:199], a[132:135], a[152:155], v[196:199]
    v_mfma_f32_16x16x32_bf16 v[212:215], a[132:135], a[156:159], v[212:215]
    v_mfma_f32_16x16x32_bf16 v[168:171], a[136:139], a[144:147], v[168:171]
    v_mfma_f32_16x16x32_bf16 v[184:187], a[136:139], a[148:151], v[184:187]
    v_mfma_f32_16x16x32_bf16 v[200:203], a[136:139], a[152:155], v[200:203]
    v_mfma_f32_16x16x32_bf16 v[216:219], a[136:139], a[156:159], v[216:219]
    v_mfma_f32_16x16x32_bf16 v[172:175], a[140:143], a[144:147], v[172:175]
    v_mfma_f32_16x16x32_bf16 v[188:191], a[140:143], a[148:151], v[188:191]
    v_mfma_f32_16x16x32_bf16 v[204:207], a[140:143], a[152:155], v[204:207]
    v_mfma_f32_16x16x32_bf16 v[220:223], a[140:143], a[156:159], v[220:223]
    s_waitcnt vmcnt(24)
    v_mfma_f32_16x16x32_bf16 v[160:163], a[160:163], a[176:179], v[160:163]
    v_mfma_f32_16x16x32_bf16 v[176:179], a[160:163], a[180:183], v[176:179]
    s_add_u32 s52, s63, 12288
    buffer_load_dwordx4 a[144:147], v12, s[16:19], s52 offen sc1
    buffer_load_dwordx4 a[148:151], v13, s[16:19], s52 offen sc1
    buffer_load_dwordx4 a[152:155], v14, s[16:19], s52 offen sc1
    buffer_load_dwordx4 a[156:159], v15, s[16:19], s52 offen sc1
    v_mfma_f32_16x16x32_bf16 v[192:195], a[160:163], a[184:187], v[192:195]
    v_mfma_f32_16x16x32_bf16 v[208:211], a[160:163], a[188:191], v[208:211]
    v_mfma_f32_16x16x32_bf16 v[164:167], a[164:167], a[176:179], v[164:167]
    v_mfma_f32_16x16x32_bf16 v[180:183], a[164:167], a[180:183], v[180:183]
    v_mfma_f32_16x16x32_bf16 v[196:199], a[164:167], a[184:187], v[196:199]
    v_mfma_f32_16x16x32_bf16 v[212:215], a[164:167], a[188:191], v[212:215]
    v_mfma_f32_16x16x32_bf16 v[168:171], a[168:171], a[176:179], v[168:171]
    v_mfma_f32_16x16x32_bf16 v[184:187], a[168:171], a[180:183], v[184:187]
    v_mfma_f32_16x16x32_bf16 v[200:203], a[168:171], a[184:187], v[200:203]
    v_mfma_f32_16x16x32_bf16 v[216:219], a[168:171], a[188:191], v[216:219]
    v_mfma_f32_16x16x32_bf16 v[172:175], a[172:175], a[176:179], v[172:175]
    v_mfma_f32_16x16x32_bf16 v[188:191], a[172:175], a[180:183], v[188:191]
    v_mfma_f32_16x16x32_bf16 v[204:207], a[172:175], a[184:187], v[204:207]
    v_mfma_f32_16x16x32_bf16 v[220:223], a[172:175], a[188:191], v[220:223]
    s_waitcnt vmcnt(24)
    v_mfma_f32_16x16x32_bf16 v[160:163], a[192:195], a[208:211], v[160:163]
    v_mfma_f32_16x16x32_bf16 v[176:179], a[192:195], a[212:215], v[176:179]
    s_add_u32 s52, s63, 13312
    buffer_load_dwordx4 a[176:179], v12, s[16:19], s52 offen sc1
    buffer_load_dwordx4 a[180:183], v13, s[16:19], s52 offen sc1
    buffer_load_dwordx4 a[184:187], v14, s[16:19], s52 offen sc1
    buffer_load_dwordx4 a[188:191], v15, s[16:19], s52 offen sc1
    v_mfma_f32_16x16x32_bf16 v[192:195], a[192:195], a[216:219], v[192:195]
    v_mfma_f32_16x16x32_bf16 v[208:211], a[192:195], a[220:223], v[208:211]
    v_mfma_f32_16x16x32_bf16 v[164:167], a[196:199], a[208:211], v[164:167]
    ds_read_b128 a[224:227], v5 offset:0
    v_mfma_f32_16x16x32_bf16 v[180:183], a[196:199], a[212:215], v[180:183]
    ds_read_b128 a[228:231], v5 offset:1024
    v_mfma_f32_16x16x32_bf16 v[196:199], a[196:199], a[216:219], v[196:199]
    ds_read_b128 a[232:235], v5 offset:2048
    v_mfma_f32_16x16x32_bf16 v[212:215], a[196:199], a[220:223], v[212:215]
    ds_read_b128 a[236:239], v5 offset:3072
    v_mfma_f32_16x16x32_bf16 v[168:171], a[200:203], a[208:211], v[168:171]
    v_mfma_f32_16x16x32_bf16 v[184:187], a[200:203], a[212:215], v[184:187]
    v_mfma_f32_16x16x32_bf16 v[200:203], a[200:203], a[216:219], v[200:203]
    v_mfma_f32_16x16x32_bf16 v[216:219], a[200:203], a[220:223], v[216:219]
    v_mfma_f32_16x16x32_bf16 v[172:175], a[204:207], a[208:211], v[172:175]
    v_mfma_f32_16x16x32_bf16 v[188:191], a[204:207], a[212:215], v[188:191]
    v_mfma_f32_16x16x32_bf16 v[204:207], a[204:207], a[216:219], v[204:207]
    v_mfma_f32_16x16x32_bf16 v[220:223], a[204:207], a[220:223], v[220:223]
    s_waitcnt vmcnt(24) lgkmcnt(0)
    v_mfma_f32_16x16x32_bf16 v[160:163], a[224:227], a[240:243], v[160:163]
    v_mfma_f32_16x16x32_bf16 v[176:179], a[224:227], a[244:247], v[176:179]
    v_mfma_f32_16x16x32_bf16 v[192:195], a[224:227], a[248:251], v[192:195]
    v_mfma_f32_16x16x32_bf16 v[208:211], a[224:227], a[252:255], v[208:211]
    v_mfma_f32_16x16x32_bf16 v[164:167], a[228:231], a[240:243], v[164:167]
    ds_read_b128 a[0:3], v5 offset:4096
    v_mfma_f32_16x16x32_bf16 v[180:183], a[228:231], a[244:247], v[180:183]
    ds_read_b128 a[4:7], v5 offset:5120
    v_mfma_f32_16x16x32_bf16 v[196:199], a[228:231], a[248:251], v[196:199]
    ds_read_b128 a[8:11], v5 offset:6144
    v_mfma_f32_16x16x32_bf16 v[212:215], a[228:231], a[252:255], v[212:215]
    ds_read_b128 a[12:15], v5 offset:7168
    v_mfma_f32_16x16x32_bf16 v[168:171], a[232:235], a[240:243], v[168:171]
    v_mfma_f32_16x16x32_bf16 v[184:187], a[232:235], a[244:247], v[184:187]
    v_mfma_f32_16x16x32_bf16 v[200:203], a[232:235], a[248:251], v[200:203]
    v_mfma_f32_16x16x32_bf16 v[216:219], a[232:235], a[252:255], v[216:219]
    v_mfma_f32_16x16x32_bf16 v[172:175], a[236:239], a[240:243], v[172:175]
    v_mfma_f32_16x16x32_bf16 v[188:191], a[236:239], a[244:247], v[188:191]
    v_mfma_f32_16x16x32_bf16 v[204:207], a[236:239], a[248:251], v[204:207]
    v_mfma_f32_16x16x32_bf16 v[220:223], a[236:239], a[252:255], v[220:223]
    s_waitcnt vmcnt(20) lgkmcnt(0)
    v_mfma_f32_16x16x32_bf16 v[160:163], a[0:3], a[16:19], v[160:163]
    v_mfma_f32_16x16x32_bf16 v[176:179], a[0:3], a[20:23], v[176:179]
    buffer_load_dwordx4 v[56:59], v18, s[20:23], 0 offen offset:0
    buffer_load_dwordx4 v[60:63], v18, s[20:23], 0 offen offset:64
    buffer_load_dwordx4 v[64:67], v18, s[20:23], 0 offen offset:128
    buffer_load_dwordx4 v[68:71], v18, s[20:23], 0 offen offset:192
    v_mfma_f32_16x16x32_bf16 v[192:195], a[0:3], a[24:27], v[192:195]
    v_mfma_f32_16x16x32_bf16 v[208:211], a[0:3], a[28:31], v[208:211]
    v_mfma_f32_16x16x32_bf16 v[164:167], a[4:7], a[16:19], v[164:167]
    ds_read_b128 a[32:35], v5 offset:8192
    v_mfma_f32_16x16x32_bf16 v[180:183], a[4:7], a[20:23], v[180:183]
    ds_read_b128 a[36:39], v5 offset:9216
    v_mfma_f32_16x16x32_bf16 v[196:199], a[4:7], a[24:27], v[196:199]
    ds_read_b128 a[40:43], v5 offset:10240
    v_mfma_f32_16x16x32_bf16 v[212:215], a[4:7], a[28:31], v[212:215]
    ds_read_b128 a[44:47], v5 offset:11264
    v_mfma_f32_16x16x32_bf16 v[168:171], a[8:11], a[16:19], v[168:171]
    v_mfma_f32_16x16x32_bf16 v[184:187], a[8:11], a[20:23], v[184:187]
    v_mfma_f32_16x16x32_bf16 v[200:203], a[8:11], a[24:27], v[200:203]
    v_mfma_f32_16x16x32_bf16 v[216:219], a[8:11], a[28:31], v[216:219]
    v_mfma_f32_16x16x32_bf16 v[172:175], a[12:15], a[16:19], v[172:175]
    v_mfma_f32_16x16x32_bf16 v[188:191], a[12:15], a[20:23], v[188:191]
    v_mfma_f32_16x16x32_bf16 v[204:207], a[12:15], a[24:27], v[204:207]
    v_mfma_f32_16x16x32_bf16 v[220:223], a[12:15], a[28:31], v[220:223]
    s_waitcnt vmcnt(20) lgkmcnt(0)
    v_mfma_f32_16x16x32_bf16 v[160:163], a[32:35], a[48:51], v[160:163]
    v_mfma_f32_16x16x32_bf16 v[176:179], a[32:35], a[52:55], v[176:179]
    v_mfma_f32_16x16x32_bf16 v[192:195], a[32:35], a[56:59], v[192:195]
    v_mfma_f32_16x16x32_bf16 v[208:211], a[32:35], a[60:63], v[208:211]
    v_mfma_f32_16x16x32_bf16 v[164:167], a[36:39], a[48:51], v[164:167]
    ds_read_b128 a[64:67], v5 offset:12288
    v_mfma_f32_16x16x32_bf16 v[180:183], a[36:39], a[52:55], v[180:183]
    ds_read_b128 a[68:71], v5 offset:13312
    v_mfma_f32_16x16x32_bf16 v[196:199], a[36:39], a[56:59], v[196:199]
    ds_read_b128 a[72:75], v5 offset:14336
    v_mfma_f32_16x16x32_bf16 v[212:215], a[36:39], a[60:63], v[212:215]
    ds_read_b128 a[76:79], v5 offset:15360
    v_mfma_f32_16x16x32_bf16 v[168:171], a[40:43], a[48:51], v[168:171]
    v_mfma_f32_16x16x32_bf16 v[184:187], a[40:43], a[52:55], v[184:187]
    v_mfma_f32_16x16x32_bf16 v[200:203], a[40:43], a[56:59], v[200:203]
    v_mfma_f32_16x16x32_bf16 v[216:219], a[40:43], a[60:63], v[216:219]
    v_mfma_f32_16x16x32_bf16 v[172:175], a[44:47], a[48:51], v[172:175]
    v_mfma_f32_16x16x32_bf16 v[188:191], a[44:47], a[52:55], v[188:191]
    v_mfma_f32_16x16x32_bf16 v[204:207], a[44:47], a[56:59], v[204:207]
    v_mfma_f32_16x16x32_bf16 v[220:223], a[44:47], a[60:63], v[220:223]
    s_waitcnt vmcnt(16) lgkmcnt(0)
    v_mfma_f32_16x16x32_bf16 v[160:163], a[64:67], a[80:83], v[160:163]
    v_mfma_f32_16x16x32_bf16 v[176:179], a[64:67], a[84:87], v[176:179]
    v_mfma_f32_16x16x32_bf16 v[192:195], a[64:67], a[88:91], v[192:195]
    v_mfma_f32_16x16x32_bf16 v[208:211], a[64:67], a[92:95], v[208:211]
    v_mfma_f32_16x16x32_bf16 v[164:167], a[68:71], a[80:83], v[164:167]
    ds_read_b128 a[96:99], v5 offset:16384
    v_mfma_f32_16x16x32_bf16 v[180:183], a[68:71], a[84:87], v[180:183]
    ds_read_b128 a[100:103], v5 offset:17408
    v_mfma_f32_16x16x32_bf16 v[196:199], a[68:71], a[88:91], v[196:199]
    ds_read_b128 a[104:107], v5 offset:18432
    v_mfma_f32_16x16x32_bf16 v[212:215], a[68:71], a[92:95], v[212:215]
    ds_read_b128 a[108:111], v5 offset:19456
    v_mfma_f32_16x16x32_bf16 v[168:171], a[72:75], a[80:83], v[168:171]
    v_mfma_f32_16x16x32_bf16 v[184:187], a[72:75], a[84:87], v[184:187]
    v_mfma_f32_16x16x32_bf16 v[200:203], a[72:75], a[88:91], v[200:203]
    v_mfma_f32_16x16x32_bf16 v[216:219], a[72:75], a[92:95], v[216:219]
    v_mfma_f32_16x16x32_bf16 v[172:175], a[76:79], a[80:83], v[172:175]
    v_mfma_f32_16x16x32_bf16 v[188:191], a[76:79], a[84:87], v[188:191]
    v_mfma_f32_16x16x32_bf16 v[204:207], a[76:79], a[88:91], v[204:207]
    v_mfma_f32_16x16x32_bf16 v[220:223], a[76:79], a[92:95], v[220:223]
    s_waitcnt vmcnt(12) lgkmcnt(0)
    v_mfma_f32_16x16x32_bf16 v[160:163], a[96:99], a[112:115], v[160:163]
    v_mfma_f32_16x16x32_bf16 v[176:179], a[96:99], a[116:119], v[176:179]
    v_mfma_f32_16x16x32_bf16 v[192:195], a[96:99], a[120:123], v[192:195]
    v_mfma_f32_16x16x32_bf16 v[208:211], a[96:99], a[124:127], v[208:211]
    v_mfma_f32_16x16x32_bf16 v[164:167], a[100:103], a[112:115], v[164:167]
    ds_read_b128 a[128:131], v5 offset:20480
    v_mfma_f32_16x16x32_bf16 v[180:183], a[100:103], a[116:119], v[180:183]
    ds_read_b128 a[132:135], v5 offset:21504
    v_mfma_f32_16x16x32_bf16 v[196:199], a[100:103], a[120:123], v[196:199]
    ds_read_b128 a[136:139], v5 offset:22528
    v_mfma_f32_16x16x32_bf16 v[212:215], a[100:103], a[124:127], v[212:215]
    ds_read_b128 a[140:143], v5 offset:23552
    v_mfma_f32_16x16x32_bf16 v[168:171], a[104:107], a[112:115], v[168:171]
    v_mfma_f32_16x16x32_bf16 v[184:187], a[104:107], a[116:119], v[184:187]
    v_mfma_f32_16x16x32_bf16 v[200:203], a[104:107], a[120:123], v[200:203]
    v_mfma_f32_16x16x32_bf16 v[216:219], a[104:107], a[124:127], v[216:219]
    v_mfma_f32_16x16x32_bf16 v[172:175], a[108:111], a[112:115], v[172:175]
    v_mfma_f32_16x16x32_bf16 v[188:191], a[108:111], a[116:119], v[188:191]
    v_mfma_f32_16x16x32_bf16 v[204:207], a[108:111], a[120:123], v[204:207]
    v_mfma_f32_16x16x32_bf16 v[220:223], a[108:111], a[124:127], v[220:223]
    s_waitcnt vmcnt(8) lgkmcnt(0)
    v_mfma_f32_16x16x32_bf16 v[160:163], a[128:131], a[144:147], v[160:163]
    v_mfma_f32_16x16x32_bf16 v[176:179], a[128:131], a[148:151], v[176:179]
    v_mfma_f32_16x16x32_bf16 v[192:195], a[128:131], a[152:155], v[192:195]
    v_mfma_f32_16x16x32_bf16 v[208:211], a[128:131], a[156:159], v[208:211]
    v_mfma_f32_16x16x32_bf16 v[164:167], a[132:135], a[144:147], v[164:167]
    ds_read_b128 a[160:163], v5 offset:24576
    v_mfma_f32_16x16x32_bf16 v[180:183], a[132:135], a[148:151], v[180:183]
    ds_read_b128 a[164:167], v5 offset:25600
    v_mfma_f32_16x16x32_bf16 v[196:199], a[132:135], a[152:155], v[196:199]
    ds_read_b128 a[168:171], v5 offset:26624
    v_mfma_f32_16x16x32_bf16 v[212:215], a[132:135], a[156:159], v[212:215]
    ds_read_b128 a[172:175], v5 offset:27648
    v_mfma_f32_16x16x32_bf16 v[168:171], a[136:139], a[144:147], v[168:171]
    v_mfma_f32_16x16x32_bf16 v[184:187], a[136:139], a[148:151], v[184:187]
    v_mfma_f32_16x16x32_bf16 v[200:203], a[136:139], a[152:155], v[200:203]
    v_mfma_f32_16x16x32_bf16 v[216:219], a[136:139], a[156:159], v[216:219]
    v_mfma_f32_16x16x32_bf16 v[172:175], a[140:143], a[144:147], v[172:175]
    v_mfma_f32_16x16x32_bf16 v[188:191], a[140:143], a[148:151], v[188:191]
    v_mfma_f32_16x16x32_bf16 v[204:207], a[140:143], a[152:155], v[204:207]
    v_mfma_f32_16x16x32_bf16 v[220:223], a[140:143], a[156:159], v[220:223]
    s_waitcnt vmcnt(4) lgkmcnt(0)
    v_mfma_f32_16x16x32_bf16 v[160:163], a[160:163], a[176:179], v[160:163]
    v_mfma_f32_16x16x32_bf16 v[176:179], a[160:163], a[180:183], v[176:179]
    v_mfma_f32_16x16x32_bf16 v[192:195], a[160:163], a[184:187], v[192:195]
    v_mfma_f32_16x16x32_bf16 v[208:211], a[160:163], a[188:191], v[208:211]
    v_mfma_f32_16x16x32_bf16 v[164:167], a[164:167], a[176:179], v[164:167]
    v_mfma_f32_16x16x32_bf16 v[180:183], a[164:167], a[180:183], v[180:183]
    v_mfma_f32_16x16x32_bf16 v[196:199], a[164:167], a[184:187], v[196:199]
    v_mfma_f32_16x16x32_bf16 v[212:215], a[164:167], a[188:191], v[212:215]
    v_mfma_f32_16x16x32_bf16 v[168:171], a[168:171], a[176:179], v[168:171]
    v_mfma_f32_16x16x32_bf16 v[184:187], a[168:171], a[180:183], v[184:187]
    v_mfma_f32_16x16x32_bf16 v[200:203], a[168:171], a[184:187], v[200:203]
    v_mfma_f32_16x16x32_bf16 v[216:219], a[168:171], a[188:191], v[216:219]
    v_mfma_f32_16x16x32_bf16 v[172:175], a[172:175], a[176:179], v[172:175]
    v_mfma_f32_16x16x32_bf16 v[188:191], a[172:175], a[180:183], v[188:191]
    v_mfma_f32_16x16x32_bf16 v[204:207], a[172:175], a[184:187], v[204:207]
    v_mfma_f32_16x16x32_bf16 v[220:223], a[172:175], a[188:191], v[220:223]
    s_nop 7
    s_mul_i32 s51, s32, 28672
    v_lshlrev_b32 v24, 4, v1
    v_add_u32 v24, s51, v24
    ds_write_b128 v24, v[176:179] offset:4096
    ds_write_b128 v24, v[180:183] offset:5120
    ds_write_b128 v24, v[184:187] offset:6144
    ds_write_b128 v24, v[188:191] offset:7168
    ds_write_b128 v24, v[192:195] offset:8192
    ds_write_b128 v24, v[196:199] offset:9216
    ds_write_b128 v24, v[200:203] offset:10240
    ds_write_b128 v24, v[204:207] offset:11264
    ds_write_b128 v24, v[208:211] offset:12288
    ds_write_b128 v24, v[212:215] offset:13312
    ds_write_b128 v24, v[216:219] offset:14336
    ds_write_b128 v24, v[220:223] offset:15360
    s_xor_b32 s51, s32, 1
    s_mul_i32 s51, s51, 28672
    v_lshlrev_b32 v25, 4, v1
    v_add_u32 v25, s51, v25
    s_xor_b32 s51, s32, 2
    s_mul_i32 s51, s51, 28672
    v_lshlrev_b32 v26, 4, v1
    v_add_u32 v26, s51, v26
    s_xor_b32 s51, s32, 3
    s_mul_i32 s51, s51, 28672
    v_lshlrev_b32 v27, 4, v1
    v_add_u32 v27, s51, v27
    s_waitcnt lgkmcnt(0)
    s_barrier
    ds_read_b128 v[176:179], v25 offset:4096
    ds_read_b128 v[180:183], v25 offset:5120
    ds_read_b128 v[184:187], v25 offset:6144
    ds_read_b128 v[188:191], v25 offset:7168
    ds_read_b128 v[192:195], v26 offset:8192
    ds_read_b128 v[196:199], v26 offset:9216
    ds_read_b128 v[200:203], v26 offset:10240
    ds_read_b128 v[204:207], v26 offset:11264
    ds_read_b128 v[208:211], v27 offset:12288
    ds_read_b128 v[212:215], v27 offset:13312
    ds_read_b128 v[216:219], v27 offset:14336
    ds_read_b128 v[220:223], v27 offset:15360
    s_waitcnt lgkmcnt(8)
    v_pk_add_f32 v[160:161], v[160:161], v[176:177]
    v_pk_add_f32 v[162:163], v[162:163], v[178:179]
    v_pk_add_f32 v[164:165], v[164:165], v[180:181]
    v_pk_add_f32 v[166:167], v[166:167], v[182:183]
    v_pk_add_f32 v[168:169], v[168:169], v[184:185]
    v_pk_add_f32 v[170:171], v[170:171], v[186:187]
    v_pk_add_f32 v[172:173], v[172:173], v[188:189]
    v_pk_add_f32 v[174:175], v[174:175], v[190:191]
    s_waitcnt lgkmcnt(4)
    v_pk_add_f32 v[160:161], v[160:161], v[192:193]
    v_pk_add_f32 v[162:163], v[162:163], v[194:195]
    v_pk_add_f32 v[164:165], v[164:165], v[196:197]
    v_pk_add_f32 v[166:167], v[166:167], v[198:199]
    v_pk_add_f32 v[168:169], v[168:169], v[200:201]
    v_pk_add_f32 v[170:171], v[170:171], v[202:203]
    v_pk_add_f32 v[172:173], v[172:173], v[204:205]
    v_pk_add_f32 v[174:175], v[174:175], v[206:207]
    s_waitcnt lgkmcnt(0)
    v_pk_add_f32 v[160:161], v[160:161], v[208:209]
    v_pk_add_f32 v[162:163], v[162:163], v[210:211]
    v_pk_add_f32 v[164:165], v[164:165], v[212:213]
    v_pk_add_f32 v[166:167], v[166:167], v[214:215]
    v_pk_add_f32 v[168:169], v[168:169], v[216:217]
    v_pk_add_f32 v[170:171], v[170:171], v[218:219]
    v_pk_add_f32 v[172:173], v[172:173], v[220:221]
    v_pk_add_f32 v[174:175], v[174:175], v[222:223]
    s_waitcnt vmcnt(0)
    s_nop 5
    v_pk_fma_f32 v[72:73], v[56:57], v[160:161], v[72:73]
    v_pk_fma_f32 v[74:75], v[58:59], v[162:163], v[74:75]
    v_pk_fma_f32 v[76:77], v[60:61], v[164:165], v[76:77]
    v_pk_fma_f32 v[78:79], v[62:63], v[166:167], v[78:79]
    v_pk_fma_f32 v[80:81], v[64:65], v[168:169], v[80:81]
    v_pk_fma_f32 v[82:83], v[66:67], v[170:171], v[82:83]
    v_pk_fma_f32 v[84:85], v[68:69], v[172:173], v[84:85]
    v_pk_fma_f32 v[86:87], v[70:71], v[174:175], v[86:87]
    v_cvt_pk_bf16_f32 v104, v72, v73
    v_cvt_pk_bf16_f32 v105, v74, v75
    v_cvt_pk_bf16_f32 v106, v76, v77
    v_cvt_pk_bf16_f32 v107, v78, v79
    v_cvt_pk_bf16_f32 v108, v80, v81
    v_cvt_pk_bf16_f32 v109, v82, v83
    v_cvt_pk_bf16_f32 v110, v84, v85
    v_cvt_pk_bf16_f32 v111, v86, v87
    s_nop 1
    v_permlane16_swap_b32 v104, v106
    v_permlane16_swap_b32 v105, v107
    v_permlane16_swap_b32 v108, v110
    v_permlane16_swap_b32 v109, v111
    buffer_store_dwordx4 v[104:107], v19, s[24:27], 0 offen offset:0 sc1
    buffer_store_dwordx4 v[108:111], v19, s[24:27], 0 offen offset:64 sc1
mega_kernel_end:
    s_endpgm
mega_kernel_redo:
    s_mov_b32 s45, 1
    v_mov_b32 v116, 0xff800000
    v_mov_b32 v117, 0xff800000
    v_mov_b32 v118, 0xff800000
    v_mov_b32 v119, 0xff800000
    s_mov_b32 s35, 0
mega_kernel_redo_t:
    s_barrier
    s_add_u32 m0, s36, 0
    s_nop 0
    buffer_load_dwordx4 v124, s[8:11], s35 offen offset:0 lds
    s_nop 0
    buffer_load_dwordx4 v125, s[8:11], s35 offen offset:1024 lds
    s_nop 0
    buffer_load_dwordx4 v126, s[8:11], s35 offen offset:2048 lds
    s_nop 0
    buffer_load_dwordx4 v127, s[8:11], s35 offen offset:3072 lds
    s_waitcnt vmcnt(0)
    s_barrier
    ds_read_b128 a[64:67], v8 offset:0
    ds_read_b128 a[68:71], v10 offset:0
    ds_read_b128 a[72:75], v12 offset:0
    ds_read_b128 a[76:79], v14 offset:0
    ds_read_b128 a[80:83], v8 offset:4096
    ds_read_b128 a[84:87], v10 offset:4096
    ds_read_b128 a[88:91], v12 offset:4096
    ds_read_b128 a[92:95], v14 offset:4096
    s_waitcnt lgkmcnt(0)
    v_mfma_f32_16x16x32_bf16 v[32:35], a[64:67], a[0:3], 0
    v_mfma_f32_16x16x32_bf16 v[32:35], a[68:71], a[4:7], v[32:35]
    v_mfma_f32_16x16x32_bf16 v[32:35], a[72:75], a[8:11], v[32:35]
    v_mfma_f32_16x16x32_bf16 v[32:35], a[76:79], a[12:15], v[32:35]
    v_mfma_f32_16x16x32_bf16 v[36:39], a[80:83], a[0:3], 0
    v_mfma_f32_16x16x32_bf16 v[36:39], a[84:87], a[4:7], v[36:39]
    v_mfma_f32_16x16x32_bf16 v[36:39], a[88:91], a[8:11], v[36:39]
    v_mfma_f32_16x16x32_bf16 v[36:39], a[92:95], a[12:15], v[36:39]
    s_nop 7
    v_max3_f32 v116, v116, v32, v33
    v_max3_f32 v116, v116, v34, v35
    v_max3_f32 v116, v116, v36, v37
    v_max3_f32 v116, v116, v38, v39
    v_mfma_f32_16x16x32_bf16 v[40:43], a[64:67], a[16:19], 0
    v_mfma_f32_16x16x32_bf16 v[40:43], a[68:71], a[20:23], v[40:43]
    v_mfma_f32_16x16x32_bf16 v[40:43], a[72:75], a[24:27], v[40:43]
    v_mfma_f32_16x16x32_bf16 v[40:43], a[76:79], a[28:31], v[40:43]
    v_mfma_f32_16x16x32_bf16 v[44:47], a[80:83], a[16:19], 0
    v_mfma_f32_16x16x32_bf16 v[44:47], a[84:87], a[20:23], v[44:47]
    v_mfma_f32_16x16x32_bf16 v[44:47], a[88:91], a[24:27], v[44:47]
    v_mfma_f32_16x16x32_bf16 v[44:47], a[92:95], a[28:31], v[44:47]
    s_nop 7
    v_max3_f32 v117, v117, v40, v41
    v_max3_f32 v117, v117, v42, v43
    v_max3_f32 v117, v117, v44, v45
    v_max3_f32 v117, v117, v46, v47
    v_mfma_f32_16x16x32_bf16 v[32:35], a[64:67], a[32:35], 0
    v_mfma_f32_16x16x32_bf16 v[32:35], a[68:71], a[36:39], v[32:35]
    v_mfma_f32_16x16x32_bf16 v[32:35], a[72:75], a[40:43], v[32:35]
    v_mfma_f32_16x16x32_bf16 v[32:35], a[76:79], a[44:47], v[32:35]
    v_mfma_f32_16x16x32_bf16 v[36:39], a[80:83], a[32:35], 0
    v_mfma_f32_16x16x32_bf16 v[36:39], a[84:87], a[36:39], v[36:39]
    v_mfma_f32_16x16x32_bf16 v[36:39], a[88:91], a[40:43], v[36:39]
    v_mfma_f32_16x16x32_bf16 v[36:39], a[92:95], a[44:47], v[36:39]
    s_nop 7
    v_max3_f32 v118, v118, v32, v33
    v_max3_f32 v118, v118, v34, v35
    v_max3_f32 v118, v118, v36, v37
    v_max3_f32 v118, v118, v38, v39
    v_mfma_f32_16x16x32_bf16 v[40:43], a[64:67], a[48:51], 0
    v_mfma_f32_16x16x32_bf16 v[40:43], a[68:71], a[52:55], v[40:43]
    v_mfma_f32_16x16x32_bf16 v[40:43], a[72:75], a[56:59], v[40:43]
    v_mfma_f32_16x16x32_bf16 v[40:43], a[76:79], a[60:63], v[40:43]
    v_mfma_f32_16x16x32_bf16 v[44:47], a[80:83], a[48:51], 0
    v_mfma_f32_16x16x32_bf16 v[44:47], a[84:87], a[52:55], v[44:47]
    v_mfma_f32_16x16x32_bf16 v[44:47], a[88:91], a[56:59], v[44:47]
    v_mfma_f32_16x16x32_bf16 v[44:47], a[92:95], a[60:63], v[44:47]
    s_nop 7
    v_max3_f32 v119, v119, v40, v41
    v_max3_f32 v119, v119, v42, v43
    v_max3_f32 v119, v119, v44, v45
    v_max3_f32 v119, v119, v46, v47
    ds_read_b128 a[96:99], v8 offset:8192
    ds_read_b128 a[100:103], v10 offset:8192
    ds_read_b128 a[104:107], v12 offset:8192
    ds_read_b128 a[108:111], v14 offset:8192
    ds_read_b128 a[112:115], v8 offset:12288
    ds_read_b128 a[116:119], v10 offset:12288
    ds_read_b128 a[120:123], v12 offset:12288
    ds_read_b128 a[124:127], v14 offset:12288
    s_waitcnt lgkmcnt(0)
    v_mfma_f32_16x16x32_bf16 v[32:35], a[96:99], a[0:3], 0
    v_mfma_f32_16x16x32_bf16 v[32:35], a[100:103], a[4:7], v[32:35]
    v_mfma_f32_16x16x32_bf16 v[32:35], a[104:107], a[8:11], v[32:35]
    v_mfma_f32_16x16x32_bf16 v[32:35], a[108:111], a[12:15], v[32:35]
    v_mfma_f32_16x16x32_bf16 v[36:39], a[112:115], a[0:3], 0
    v_mfma_f32_16x16x32_bf16 v[36:39], a[116:119], a[4:7], v[36:39]
    v_mfma_f32_16x16x32_bf16 v[36:39], a[120:123], a[8:11], v[36:39]
    v_mfma_f32_16x16x32_bf16 v[36:39], a[124:127], a[12:15], v[36:39]
    s_nop 7
    v_max3_f32 v116, v116, v32, v33
    v_max3_f32 v116, v116, v34, v35
    v_max3_f32 v116, v116, v36, v37
    v_max3_f32 v116, v116, v38, v39
    v_mfma_f32_16x16x32_bf16 v[40:43], a[96:99], a[16:19], 0
    v_mfma_f32_16x16x32_bf16 v[40:43], a[100:103], a[20:23], v[40:43]
    v_mfma_f32_16x16x32_bf16 v[40:43], a[104:107], a[24:27], v[40:43]
    v_mfma_f32_16x16x32_bf16 v[40:43], a[108:111], a[28:31], v[40:43]
    v_mfma_f32_16x16x32_bf16 v[44:47], a[112:115], a[16:19], 0
    v_mfma_f32_16x16x32_bf16 v[44:47], a[116:119], a[20:23], v[44:47]
    v_mfma_f32_16x16x32_bf16 v[44:47], a[120:123], a[24:27], v[44:47]
    v_mfma_f32_16x16x32_bf16 v[44:47], a[124:127], a[28:31], v[44:47]
    s_nop 7
    v_max3_f32 v117, v117, v40, v41
    v_max3_f32 v117, v117, v42, v43
    v_max3_f32 v117, v117, v44, v45
    v_max3_f32 v117, v117, v46, v47
    v_mfma_f32_16x16x32_bf16 v[32:35], a[96:99], a[32:35], 0
    v_mfma_f32_16x16x32_bf16 v[32:35], a[100:103], a[36:39], v[32:35]
    v_mfma_f32_16x16x32_bf16 v[32:35], a[104:107], a[40:43], v[32:35]
    v_mfma_f32_16x16x32_bf16 v[32:35], a[108:111], a[44:47], v[32:35]
    v_mfma_f32_16x16x32_bf16 v[36:39], a[112:115], a[32:35], 0
    v_mfma_f32_16x16x32_bf16 v[36:39], a[116:119], a[36:39], v[36:39]
    v_mfma_f32_16x16x32_bf16 v[36:39], a[120:123], a[40:43], v[36:39]
    v_mfma_f32_16x16x32_bf16 v[36:39], a[124:127], a[44:47], v[36:39]
    s_nop 7
    v_max3_f32 v118, v118, v32, v33
    v_max3_f32 v118, v118, v34, v35
    v_max3_f32 v118, v118, v36, v37
    v_max3_f32 v118, v118, v38, v39
    v_mfma_f32_16x16x32_bf16 v[40:43], a[96:99], a[48:51], 0
    v_mfma_f32_16x16x32_bf16 v[40:43], a[100:103], a[52:55], v[40:43]
    v_mfma_f32_16x16x32_bf16 v[40:43], a[104:107], a[56:59], v[40:43]
    v_mfma_f32_16x16x32_bf16 v[40:43], a[108:111], a[60:63], v[40:43]
    v_mfma_f32_16x16x32_bf16 v[44:47], a[112:115], a[48:51], 0
    v_mfma_f32_16x16x32_bf16 v[44:47], a[116:119], a[52:55], v[44:47]
    v_mfma_f32_16x16x32_bf16 v[44:47], a[120:123], a[56:59], v[44:47]
    v_mfma_f32_16x16x32_bf16 v[44:47], a[124:127], a[60:63], v[44:47]
    s_nop 7
    v_max3_f32 v119, v119, v40, v41
    v_max3_f32 v119, v119, v42, v43
    v_max3_f32 v119, v119, v44, v45
    v_max3_f32 v119, v119, v46, v47
    s_add_u32 s35, s35, 16384
    s_cmp_lt_u32 s35, 524288
    s_cbranch_scc1 mega_kernel_redo_t
    v_mov_b32 v120, v116
    v_mov_b32 v121, v117
    v_mov_b32 v122, v118
    v_mov_b32 v123, v119
    s_nop 1
    v_permlane16_swap_b32 v116, v120
    v_permlane16_swap_b32 v117, v121
    v_permlane16_swap_b32 v118, v122
    v_permlane16_swap_b32 v119, v123
    s_nop 1
    v_max_f32 v116, v116, v120
    v_max_f32 v117, v117, v121
    v_max_f32 v118, v118, v122
    v_max_f32 v119, v119, v123
    s_nop 0
    v_mov_b32 v120, v116
    v_mov_b32 v121, v117
    v_mov_b32 v122, v118
    v_mov_b32 v123, v119
    s_nop 1
    v_permlane32_swap_b32 v116, v120
    v_permlane32_swap_b32 v117, v121
    v_permlane32_swap_b32 v118, v122
    v_permlane32_swap_b32 v119, v123
    s_nop 1
    v_max_f32 v116, v116, v120
    v_max_f32 v117, v117, v121
    v_max_f32 v118, v118, v122
    v_max_f32 v119, v119, v123
    s_nop 0
    v_sub_f32 v56, 0, v116
    v_sub_f32 v57, 0, v116
    v_sub_f32 v58, 0, v116
    v_sub_f32 v59, 0, v116
    v_sub_f32 v60, 0, v117
    v_sub_f32 v61, 0, v117
    v_sub_f32 v62, 0, v117
    v_sub_f32 v63, 0, v117
    v_sub_f32 v64, 0, v118
    v_sub_f32 v65, 0, v118
    v_sub_f32 v66, 0, v118
    v_sub_f32 v67, 0, v118
    v_sub_f32 v68, 0, v119
    v_sub_f32 v69, 0, v119
    v_sub_f32 v70, 0, v119
    v_sub_f32 v71, 0, v119
    v_pk_mov_b32 v[128:129], 0, 0
    v_pk_mov_b32 v[130:131], 0, 0
    v_pk_mov_b32 v[132:133], 0, 0
    v_pk_mov_b32 v[134:135], 0, 0
    v_pk_mov_b32 v[136:137], 0, 0
    v_pk_mov_b32 v[138:139], 0, 0
    v_pk_mov_b32 v[140:141], 0, 0
    v_pk_mov_b32 v[142:143], 0, 0
    v_pk_mov_b32 v[144:145], 0, 0
    v_pk_mov_b32 v[146:147], 0, 0
    v_pk_mov_b32 v[148:149], 0, 0
    v_pk_mov_b32 v[150:151], 0, 0
    v_pk_mov_b32 v[152:153], 0, 0
    v_pk_mov_b32 v[154:155], 0, 0
    v_pk_mov_b32 v[156:157], 0, 0
    v_pk_mov_b32 v[158:159], 0, 0
    v_pk_mov_b32 v[160:161], 0, 0
    v_pk_mov_b32 v[162:163], 0, 0
    v_pk_mov_b32 v[164:165], 0, 0
    v_pk_mov_b32 v[166:167], 0, 0
    v_pk_mov_b32 v[168:169], 0, 0
    v_pk_mov_b32 v[170:171], 0, 0
    v_pk_mov_b32 v[172:173], 0, 0
    v_pk_mov_b32 v[174:175], 0, 0
    v_pk_mov_b32 v[176:177], 0, 0
    v_pk_mov_b32 v[178:179], 0, 0
    v_pk_mov_b32 v[180:181], 0, 0
    v_pk_mov_b32 v[182:183], 0, 0
    v_pk_mov_b32 v[184:185], 0, 0
    v_pk_mov_b32 v[186:187], 0, 0
    v_pk_mov_b32 v[188:189], 0, 0
    v_pk_mov_b32 v[190:191], 0, 0
    v_pk_mov_b32 v[192:193], 0, 0
    v_pk_mov_b32 v[194:195], 0, 0
    v_pk_mov_b32 v[196:197], 0, 0
    v_pk_mov_b32 v[198:199], 0, 0
    v_pk_mov_b32 v[200:201], 0, 0
    v_pk_mov_b32 v[202:203], 0, 0
    v_pk_mov_b32 v[204:205], 0, 0
    v_pk_mov_b32 v[206:207], 0, 0
    v_pk_mov_b32 v[208:209], 0, 0
    v_pk_mov_b32 v[210:211], 0, 0
    v_pk_mov_b32 v[212:213], 0, 0
    v_pk_mov_b32 v[214:215], 0, 0
    v_pk_mov_b32 v[216:217], 0, 0
    v_pk_mov_b32 v[218:219], 0, 0
    v_pk_mov_b32 v[220:221], 0, 0
    v_pk_mov_b32 v[222:223], 0, 0
    v_pk_mov_b32 v[224:225], 0, 0
    v_pk_mov_b32 v[226:227], 0, 0
    v_pk_mov_b32 v[228:229], 0, 0
    v_pk_mov_b32 v[230:231], 0, 0
    v_pk_mov_b32 v[232:233], 0, 0
    v_pk_mov_b32 v[234:235], 0, 0
    v_pk_mov_b32 v[236:237], 0, 0
    v_pk_mov_b32 v[238:239], 0, 0
    v_pk_mov_b32 v[240:241], 0, 0
    v_pk_mov_b32 v[242:243], 0, 0
    v_pk_mov_b32 v[244:245], 0, 0
    v_pk_mov_b32 v[246:247], 0, 0
    v_pk_mov_b32 v[248:249], 0, 0
    v_pk_mov_b32 v[250:251], 0, 0
    v_pk_mov_b32 v[252:253], 0, 0
    v_pk_mov_b32 v[254:255], 0, 0
    v_pk_mov_b32 v[72:73], 0, 0
    v_pk_mov_b32 v[74:75], 0, 0
    v_pk_mov_b32 v[76:77], 0, 0
    v_pk_mov_b32 v[78:79], 0, 0
    v_pk_mov_b32 v[80:81], 0, 0
    v_pk_mov_b32 v[82:83], 0, 0
    v_pk_mov_b32 v[84:85], 0, 0
    v_pk_mov_b32 v[86:87], 0, 0
    v_pk_mov_b32 v[52:53], 0, 0
    v_pk_mov_b32 v[54:55], 0, 0
    s_barrier
    s_mov_b32 s35, 0
    s_add_u32 m0, s36, 0
    s_nop 0
    buffer_load_dwordx4 v124, s[8:11], s35 offen offset:0 lds
    s_nop 0
    buffer_load_dwordx4 v125, s[8:11], s35 offen offset:1024 lds
    s_nop 0
    buffer_load_dwordx4 v126, s[8:11], s35 offen offset:2048 lds
    s_nop 0
    buffer_load_dwordx4 v127, s[8:11], s35 offen offset:3072 lds
    s_add_u32 m0, s36, 16384
    s_nop 0
    buffer_load_dwordx4 v2, s[12:15], s35 offen offset:0 lds
    s_nop 0
    buffer_load_dwordx4 v3, s[12:15], s35 offen offset:1024 lds
    s_nop 0
    buffer_load_dwordx4 v2, s[12:15], s35 offen offset:2048 lds
    s_nop 0
    buffer_load_dwordx4 v3, s[12:15], s35 offen offset:3072 lds
    s_mov_b32 s35, 16384
    s_add_u32 m0, s36, 32768
    s_nop 0
    buffer_load_dwordx4 v124, s[8:11], s35 offen offset:0 lds
    s_nop 0
    buffer_load_dwordx4 v125, s[8:11], s35 offen offset:1024 lds
    s_nop 0
    buffer_load_dwordx4 v126, s[8:11], s35 offen offset:2048 lds
    s_nop 0
    buffer_load_dwordx4 v127, s[8:11], s35 offen offset:3072 lds
    s_add_u32 m0, s36, 49152
    s_nop 0
    buffer_load_dwordx4 v2, s[12:15], s35 offen offset:0 lds
    s_nop 0
    buffer_load_dwordx4 v3, s[12:15], s35 offen offset:1024 lds
    s_nop 0
    buffer_load_dwordx4 v2, s[12:15], s35 offen offset:2048 lds
    s_nop 0
    buffer_load_dwordx4 v3, s[12:15], s35 offen offset:3072 lds
    s_waitcnt vmcnt(0)
    s_barrier
    s_mov_b32 s35, 32768
    s_add_u32 m0, s36, 65536
    s_nop 0
    buffer_load_dwordx4 v124, s[8:11], s35 offen offset:0 lds
    s_nop 0
    buffer_load_dwordx4 v125, s[8:11], s35 offen offset:1024 lds
    s_nop 0
    buffer_load_dwordx4 v126, s[8:11], s35 offen offset:2048 lds
    s_nop 0
    buffer_load_dwordx4 v127, s[8:11], s35 offen offset:3072 lds
    s_add_u32 m0, s36, 81920
    s_nop 0
    buffer_load_dwordx4 v2, s[12:15], s35 offen offset:0 lds
    ds_read_b128 a[64:67], v8 offset:0
    ds_read_b128 a[68:71], v10 offset:0
    ds_read_b128 a[72:75], v12 offset:0
    ds_read_b128 a[76:79], v14 offset:0
    ds_read_b128 a[80:83], v8 offset:4096
    ds_read_b128 a[84:87], v10 offset:4096
    ds_read_b128 a[88:91], v12 offset:4096
    ds_read_b128 a[92:95], v14 offset:4096
    ds_read_b64_tr_b16 a[160:161], v16 offset:24576
    ds_read_b64_tr_b16 a[162:163], v16 offset:28672
    ds_read_b64_tr_b16 a[164:165], v18 offset:24576
    ds_read_b64_tr_b16 a[166:167], v18 offset:28672
    ds_read_b64_tr_b16 a[168:169], v20 offset:24576
    ds_read_b64_tr_b16 a[170:171], v20 offset:28672
    ds_read_b64_tr_b16 a[172:173], v22 offset:24576
    ds_read_b64_tr_b16 a[174:175], v22 offset:28672
    ds_read_b64_tr_b16 a[176:177], v24 offset:24576
    ds_read_b64_tr_b16 a[178:179], v24 offset:28672
    ds_read_b64_tr_b16 a[180:181], v26 offset:24576
    ds_read_b64_tr_b16 a[182:183], v26 offset:28672
    ds_read_b64_tr_b16 a[184:185], v28 offset:24576
    ds_read_b64_tr_b16 a[186:187], v28 offset:28672
    ds_read_b64_tr_b16 a[188:189], v30 offset:24576
    ds_read_b64_tr_b16 a[190:191], v30 offset:28672
    s_waitcnt lgkmcnt(0)
    ds_read_b128 a[96:99], v8 offset:8192
    ds_read_b128 a[100:103], v10 offset:8192
    ds_read_b64_tr_b16 a[128:129], v16 offset:16384
    ds_read_b64_tr_b16 a[130:131], v16 offset:20480
    ds_read_b64_tr_b16 a[132:133], v18 offset:16384
    ds_read_b64_tr_b16 a[134:135], v18 offset:20480
    ds_read_b64_tr_b16 a[136:137], v20 offset:16384
    ds_read_b64_tr_b16 a[138:139], v20 offset:20480
    ds_read_b64_tr_b16 a[140:141], v22 offset:16384
    ds_read_b64_tr_b16 a[142:143], v22 offset:20480
    ds_read_b64_tr_b16 a[144:145], v24 offset:16384
    ds_read_b64_tr_b16 a[146:147], v24 offset:20480
    ds_read_b64_tr_b16 a[148:149], v26 offset:16384
    ds_read_b64_tr_b16 a[150:151], v26 offset:20480
    v_mfma_f32_16x16x32_bf16 v[32:35], a[64:67], a[0:3], v[56:59]
    v_mfma_f32_16x16x32_bf16 v[32:35], a[68:71], a[4:7], v[32:35]
    v_mfma_f32_16x16x32_bf16 v[32:35], a[72:75], a[8:11], v[32:35]
    v_mfma_f32_16x16x32_bf16 v[32:35], a[76:79], a[12:15], v[32:35]
    v_mfma_f32_16x16x32_bf16 v[36:39], a[80:83], a[0:3], v[56:59]
    v_mfma_f32_16x16x32_bf16 v[36:39], a[84:87], a[4:7], v[36:39]
    v_mfma_f32_16x16x32_bf16 v[36:39], a[88:91], a[8:11], v[36:39]
    v_mfma_f32_16x16x32_bf16 v[36:39], a[92:95], a[12:15], v[36:39]
    s_waitcnt lgkmcnt(0)
    v_lshlrev_b32 v120, 4, v1
    s_mov_b32 s39, 8
    s_nop 7
    s_branch mega_kernel_loop
mega_kernel_finish:
    s_endpgm
.section .rodata,"a"
.p2align 6
.amdhsa_kernel k0_kernel
  .amdhsa_next_free_vgpr 104
  .amdhsa_next_free_sgpr 80
  .amdhsa_accum_offset 104
  .amdhsa_group_segment_fixed_size 0
  .amdhsa_kernarg_size 120
  .amdhsa_user_sgpr_count 2
  .amdhsa_user_sgpr_kernarg_segment_ptr 1
  .amdhsa_system_sgpr_workgroup_id_x 1
  .amdhsa_float_denorm_mode_32 3
.end_amdhsa_kernel
.p2align 6
.amdhsa_kernel mega_kernel
  .amdhsa_next_free_vgpr 512
  .amdhsa_next_free_sgpr 102
  .amdhsa_accum_offset 256
  .amdhsa_group_segment_fixed_size 0
  .amdhsa_kernarg_size 120
  .amdhsa_user_sgpr_count 2
  .amdhsa_user_sgpr_kernarg_segment_ptr 1
  .amdhsa_system_sgpr_workgroup_id_x 1
  .amdhsa_float_denorm_mode_32 3
.end_amdhsa_kernel
```
